```python
import torch

def _softmax(x, axis=-1):
    return torch.softmax(x, dim=axis)

def _gelu(x):
    return torch.nn.functional.gelu(x, approximate='tanh')

def _silu(x):
    return torch.nn.functional.silu(x)

def _sigmoid(x):
    return torch.sigmoid(x)

def _layernorm(x, axis=-1, eps=1e-05):
    m = x.mean(dim=axis, keepdim=True)
    v = x.var(dim=axis, keepdim=True, unbiased=False)
    return (x - m) / torch.sqrt(v + eps)

def _scatter_add(tgt, idx, src, axis=0):
    return tgt.clone().index_add_(axis, idx, src)

def _segment_sum(src, seg, n):
    out = torch.zeros((n,) + src.shape[1:], dtype=src.dtype)
    return out.index_add_(0, seg, src)

def _pad(x, pw):
    flat = tuple((v for pair in reversed(pw) for v in pair))
    return torch.nn.functional.pad(x, flat)
kernel_name = 'parallel_sum__ssm_conv_s4__mixer_gmlp__prompt'

def setup_inputs():

    _w = lambda a: (lambda t: t.to(torch.bfloat16) if t.is_floating_point() else t)(torch.as_tensor(a))

    def _A_setup():
        B, L, D, N = (1, 2048, 576, 128)
        A_re = -(lambda _x: torch.exp(torch.as_tensor(_x)))((lambda *s: torch.randn(*s, dtype=torch.bfloat16) * 3.2)(D, N))
        A_im = torch.pi * (lambda *s: torch.randn(*s, dtype=torch.bfloat16) * 0.2)(D, N)
        B_re = (lambda *s: torch.randn(*s, dtype=torch.bfloat16) * 0.8)(D, N)
        B_im = (lambda *s: torch.randn(*s, dtype=torch.bfloat16) * 0.8)(D, N)
        C_re = (lambda *s: torch.randn(*s, dtype=torch.bfloat16) * 0.8)(D, N)
        C_im = (lambda *s: torch.randn(*s, dtype=torch.bfloat16) * 0.8)(D, N)
        log_dt = (lambda *s: torch.randn(*s, dtype=torch.bfloat16) * 0.2)(D) * 0.5 - 4.0
        Dskip = (lambda *s: torch.randn(*s, dtype=torch.bfloat16) * 1.6)(D)
        return {'u': _w((lambda *s: torch.randn(*s, dtype=torch.bfloat16) * 0.05)(B, L, D)), 'A_re': _w(A_re), 'A_im': _w(A_im), 'B_re': _w(B_re), 'B_im': _w(B_im), 'C_re': _w(C_re), 'C_im': _w(C_im), 'log_dt': _w(log_dt), 'Dskip': _w(Dskip)}
    _A_in = _A_setup()

    def _B_setup():
        B, S, D, F = (1, 2048, 576, 4608)
        Fh = F // 2
        return {'x': _w((lambda *s: torch.randn(*s, dtype=torch.bfloat16) * 0.05)(B, S, D)), 'w_in': _w((lambda *s: torch.randn(*s, dtype=torch.bfloat16) * 0.4)(D, 2 * Fh)), 'w_sp': _w(0.01 * (lambda *s: torch.randn(*s, dtype=torch.bfloat16) * 0.4)(S, S)), 'b_sp': _w(1.0 + 0.01 * (lambda *s: torch.randn(*s, dtype=torch.bfloat16) * 0.05)(S)), 'w_out': _w((lambda *s: torch.randn(*s, dtype=torch.bfloat16) * 0.05)(Fh, D))}
    _B_in = _B_setup()
    return {'A_u': _A_in['u'], 'A_A_re': _A_in['A_re'], 'A_A_im': _A_in['A_im'], 'A_B_re': _A_in['B_re'], 'A_B_im': _A_in['B_im'], 'A_C_re': _A_in['C_re'], 'A_C_im': _A_in['C_im'], 'A_log_dt': _A_in['log_dt'], 'A_Dskip': _A_in['Dskip'], 'B_x': _B_in['x'], 'B_w_in': _B_in['w_in'], 'B_w_sp': _B_in['w_sp'], 'B_b_sp': _B_in['b_sp'], 'B_w_out': _B_in['w_out']}

def reference(A_u, A_A_re, A_A_im, A_B_re, A_B_im, A_C_re, A_C_im, A_log_dt, A_Dskip, B_x, B_w_in, B_w_sp, B_b_sp, B_w_out):

    def _A_ref(u, A_re, A_im, B_re, B_im, C_re, C_im, log_dt, Dskip):
        Bsz, L, D = u.shape
        dt = torch.exp(log_dt)[:, None]
        A = A_re + 1j * A_im
        Bc = B_re + 1j * B_im
        Cc = C_re + 1j * C_im
        logdA = dt * A
        dB = dt * Bc
        l = (lambda x, dt: x.to(dt))(torch.arange(L), A_re.dtype)
        P = torch.exp(logdA[:, :, None] * l[None, None, :])
        K = torch.einsum('dn,dnl,dn->dl', Cc, P, dB).real
        L2 = 2 * L
        Kp = _pad(K, ((0, 0), (0, L)))
        up = (lambda x, *d: x.permute(*d))(u, 0, 2, 1)
        up = _pad(up, ((0, 0), (0, 0), (0, L)))
        Kf = (lambda x, axes=(-2, -1): torch.fft.rfft2(x.float(), dim=axes))(Kp[:, None, :], axes=(-2, -1))
        Uf = (lambda x, axes=(-2, -1): torch.fft.rfft2(x.float(), dim=axes))(up[:, :, None, :], axes=(-2, -1))
        Yf = Uf * Kf[None, :, :, :]
        y = (lambda x, s, axes=(-2, -1): torch.fft.irfft2(x, s=s, dim=axes).to(torch.bfloat16))(Yf, (1, L2), axes=(-2, -1))[:, :, 0, :L]
        y = (lambda x, *d: x.permute(*d))(y, 0, 2, 1) + u * Dskip[None, None, :]
        return y

    def _B_ref(x, w_in, w_sp, b_sp, w_out):
        B, S, D = x.shape
        F = w_in.shape[-1]
        Fh = F // 2
        z = _gelu(torch.einsum('bsd,df->bsf', x, w_in))
        z1 = z[..., :Fh].clone()
        z2 = _layernorm(z[..., Fh:], axis=-1)
        g = torch.einsum('ts,bsf->btf', w_sp, z2) + b_sp[None, :, None]
        return torch.einsum('bsf,fd->bsd', z1 * g, w_out)
    x = A_u
    xn = _layernorm(x, axis=-1)
    return x + _A_ref(xn, A_A_re, A_A_im, A_B_re, A_B_im, A_C_re, A_C_im, A_log_dt, A_Dskip) + _B_ref(xn, B_w_in, B_w_sp, B_b_sp, B_w_out)
```

```asm
; @launch kernel=parallel_sum__ssm_conv_s4__mixer_gmlp__prompt_kernel grid=(256,1,1) block=(512,1,1) lds=163840
.amdgcn_target "amdgcn-amd-amdhsa--gfx950"
.text
.globl parallel_sum__ssm_conv_s4__mixer_gmlp__prompt_kernel
.p2align 8
.type parallel_sum__ssm_conv_s4__mixer_gmlp__prompt_kernel,@function
parallel_sum__ssm_conv_s4__mixer_gmlp__prompt_kernel:
    s_load_dwordx2 s[6:7], s[0:1], 0
    s_load_dwordx2 s[8:9], s[0:1], 80
    s_load_dwordx2 s[4:5], s[0:1], 128
    s_getpc_b64 s[28:29]
fz_pc:
    s_cmp_ge_u32 s2, 256
    s_cbranch_scc1 fz_end
    v_lshrrev_b32 v1, 6, v0
    v_and_b32 v255, 63, v0
    v_readfirstlane_b32 s22, v1
    s_and_b32 s30, s2, 7
    s_lshr_b32 s31, s2, 3
    v_lshrrev_b32 v1, 4, v0
    v_lshl_add_u32 v1, s31, 5, v1
    v_lshlrev_b32 v1, 7, v1
    v_min_u32 v1, fz_end-fz_pc, v1
    s_mov_b32 exec_lo, 0x10001
    s_mov_b32 exec_hi, 0x10001
    global_load_dword v254, v1, s[28:29]
    s_mov_b64 exec, -1
    s_and_b32 s20, s30, 1
    s_lshl_b32 s20, s20, 3
    s_lshr_b32 s32, s31, 2
    s_add_u32 s20, s20, s32
    s_lshr_b32 s21, s30, 1
    s_lshl_b32 s21, s21, 2
    s_and_b32 s32, s31, 3
    s_add_u32 s21, s21, s32
    s_lshl_b32 s63, s2, 3
    s_add_u32 s63, s63, s22
    s_mul_i32 s31, s63, 1152
    v_lshlrev_b32 v2, 4, v255
    v_mov_b32 v3, 2146435072
    v_cmp_gt_u32 vcc, 36, v255
    s_nop 1
    v_cndmask_b32 v2, v3, v2, vcc
    s_waitcnt lgkmcnt(0)
    s_mov_b32 s12, s6
    s_mov_b32 s13, s7
    s_mov_b32 s14, 2359296
    s_mov_b32 s15, 0x20000
    buffer_load_dwordx4 v[8:11], v2, s[12:15], s31 offen
    buffer_load_dwordx4 v[12:15], v2, s[12:15], s31 offen offset:576
    s_add_u32 s10, s4, 38797312
    s_addc_u32 s11, s5, 0
    s_load_dword s23, s[10:11], 0
    s_cmp_lt_u32 s22, 4
    s_cbranch_scc1 fz_c0
    s_cmp_lt_u32 s22, 6
    s_cbranch_scc1 fz_w0
    s_sub_u32 s57, s22, 4
    s_setprio 3
    v_lshrrev_b32 v3, 3, v255
    v_and_b32 v4, 7, v255
    v_lshrrev_b32 v5, 4, v255
    v_xor_b32 v4, v4, v5
    v_mul_u32_u24 v3, 1152, v3
    v_lshl_add_u32 v3, v4, 4, v3
    v_xor_b32 v4, 64, v3
    s_sub_u32 s31, s22, 6
    s_lshl_b32 s30, s20, 7
    s_lshl_b32 s32, s31, 6
    s_add_u32 s30, s30, s32
    s_mul_i32 s30, s30, 1152
    s_lshl_b32 s44, s31, 13
    s_mov_b32 s40, 0
    v_add_u32 v200, s30, v3
    s_add_u32 s30, s30, 9216
    s_add_u32 m0, s44, 0
    s_nop 0
    buffer_load_dwordx4 v200, s[12:15], s40 offen lds
    v_add_u32 v201, s30, v4
    s_add_u32 s30, s30, 9216
    s_add_u32 m0, s44, 1024
    s_nop 0
    buffer_load_dwordx4 v201, s[12:15], s40 offen lds
    v_add_u32 v202, s30, v3
    s_add_u32 s30, s30, 9216
    s_add_u32 m0, s44, 2048
    s_nop 0
    buffer_load_dwordx4 v202, s[12:15], s40 offen lds
    v_add_u32 v203, s30, v4
    s_add_u32 s30, s30, 9216
    s_add_u32 m0, s44, 3072
    s_nop 0
    buffer_load_dwordx4 v203, s[12:15], s40 offen lds
    v_add_u32 v204, s30, v3
    s_add_u32 s30, s30, 9216
    s_add_u32 m0, s44, 4096
    s_nop 0
    buffer_load_dwordx4 v204, s[12:15], s40 offen lds
    v_add_u32 v205, s30, v4
    s_add_u32 s30, s30, 9216
    s_add_u32 m0, s44, 5120
    s_nop 0
    buffer_load_dwordx4 v205, s[12:15], s40 offen lds
    v_add_u32 v206, s30, v3
    s_add_u32 s30, s30, 9216
    s_add_u32 m0, s44, 6144
    s_nop 0
    buffer_load_dwordx4 v206, s[12:15], s40 offen lds
    v_add_u32 v207, s30, v4
    s_add_u32 s30, s30, 9216
    s_add_u32 m0, s44, 7168
    s_nop 0
    buffer_load_dwordx4 v207, s[12:15], s40 offen lds
    s_mov_b32 s41, s44
    s_mov_b32 s43, 0
    s_add_u32 s40, s40, 128
    s_add_u32 s41, s41, 34816
    s_cmp_ge_u32 s41, 139264
    s_cselect_b32 s41, s44, s41
    s_add_u32 s43, s43, 1
    s_cmp_eq_u32 s43, 9
    s_cselect_b32 s40, 0, s40
    s_mov_b32 m0, s41
    s_nop 0
    buffer_load_dwordx4 v200, s[12:15], s40 offen sc1 lds
    s_add_u32 m0, s41, 1024
    s_nop 0
    buffer_load_dwordx4 v201, s[12:15], s40 offen sc1 lds
    s_add_u32 m0, s41, 2048
    s_nop 0
    buffer_load_dwordx4 v202, s[12:15], s40 offen sc1 lds
    s_add_u32 m0, s41, 3072
    s_nop 0
    buffer_load_dwordx4 v203, s[12:15], s40 offen sc1 lds
    s_add_u32 m0, s41, 4096
    s_nop 0
    buffer_load_dwordx4 v204, s[12:15], s40 offen sc1 lds
    s_add_u32 m0, s41, 5120
    s_nop 0
    buffer_load_dwordx4 v205, s[12:15], s40 offen sc1 lds
    s_add_u32 m0, s41, 6144
    s_nop 0
    buffer_load_dwordx4 v206, s[12:15], s40 offen sc1 lds
    s_add_u32 m0, s41, 7168
    s_nop 0
    buffer_load_dwordx4 v207, s[12:15], s40 offen sc1 lds
    s_add_u32 s40, s40, 128
    s_add_u32 s41, s41, 34816
    s_cmp_ge_u32 s41, 139264
    s_cselect_b32 s41, s44, s41
    s_add_u32 s43, s43, 1
    s_cmp_eq_u32 s43, 9
    s_cselect_b32 s40, 0, s40
    s_waitcnt vmcnt(16)
    s_mov_b32 s3, 2
    s_branch fz_ln
fz_w0:
    s_sub_u32 s57, s22, 4
    s_setprio 3
    s_mul_i32 s32, s21, 288
    s_mov_b32 s33, 3641
    s_mul_i32 s31, s57, 576
    s_mul_i32 s44, s57, 9216
    s_add_u32 s44, s44, 16384
    v_add_u32 v1, s31, v255
    s_mov_b32 s40, 4608
    s_mov_b32 s12, s8
    s_mov_b32 s13, s9
    s_mov_b32 s14, 5308416
    s_mov_b32 s15, 0x20000
    v_add_u32 v3, 0, v1
    v_mul_lo_u32 v4, v3, s33
    v_lshrrev_b32 v4, 16, v4
    v_mul_u32_u24 v5, 18, v4
    v_sub_u32 v5, v3, v5
    v_and_b32 v6, 0x33, v4
    v_bfe_u32 v7, v4, 2, 1
    v_lshl_or_b32 v6, v7, 3, v6
    v_bfe_u32 v7, v4, 3, 1
    v_lshl_or_b32 v6, v7, 2, v6
    v_mul_u32_u24 v6, 9216, v6
    v_lshl_add_u32 v6, v5, 4, v6
    v_add_u32 v200, s32, v6
    s_add_u32 m0, s44, 0
    s_nop 0
    buffer_load_dwordx4 v200, s[12:15], s40 offen lds
    v_add_u32 v3, 64, v1
    v_mul_lo_u32 v4, v3, s33
    v_lshrrev_b32 v4, 16, v4
    v_mul_u32_u24 v5, 18, v4
    v_sub_u32 v5, v3, v5
    v_and_b32 v6, 0x33, v4
    v_bfe_u32 v7, v4, 2, 1
    v_lshl_or_b32 v6, v7, 3, v6
    v_bfe_u32 v7, v4, 3, 1
    v_lshl_or_b32 v6, v7, 2, v6
    v_mul_u32_u24 v6, 9216, v6
    v_lshl_add_u32 v6, v5, 4, v6
    v_add_u32 v201, s32, v6
    s_add_u32 m0, s44, 1024
    s_nop 0
    buffer_load_dwordx4 v201, s[12:15], s40 offen lds
    v_add_u32 v3, 128, v1
    v_mul_lo_u32 v4, v3, s33
    v_lshrrev_b32 v4, 16, v4
    v_mul_u32_u24 v5, 18, v4
    v_sub_u32 v5, v3, v5
    v_and_b32 v6, 0x33, v4
    v_bfe_u32 v7, v4, 2, 1
    v_lshl_or_b32 v6, v7, 3, v6
    v_bfe_u32 v7, v4, 3, 1
    v_lshl_or_b32 v6, v7, 2, v6
    v_mul_u32_u24 v6, 9216, v6
    v_lshl_add_u32 v6, v5, 4, v6
    v_add_u32 v202, s32, v6
    s_add_u32 m0, s44, 2048
    s_nop 0
    buffer_load_dwordx4 v202, s[12:15], s40 offen lds
    v_add_u32 v3, 192, v1
    v_mul_lo_u32 v4, v3, s33
    v_lshrrev_b32 v4, 16, v4
    v_mul_u32_u24 v5, 18, v4
    v_sub_u32 v5, v3, v5
    v_and_b32 v6, 0x33, v4
    v_bfe_u32 v7, v4, 2, 1
    v_lshl_or_b32 v6, v7, 3, v6
    v_bfe_u32 v7, v4, 3, 1
    v_lshl_or_b32 v6, v7, 2, v6
    v_mul_u32_u24 v6, 9216, v6
    v_lshl_add_u32 v6, v5, 4, v6
    v_add_u32 v203, s32, v6
    s_add_u32 m0, s44, 3072
    s_nop 0
    buffer_load_dwordx4 v203, s[12:15], s40 offen lds
    v_add_u32 v3, 256, v1
    v_mul_lo_u32 v4, v3, s33
    v_lshrrev_b32 v4, 16, v4
    v_mul_u32_u24 v5, 18, v4
    v_sub_u32 v5, v3, v5
    v_and_b32 v6, 0x33, v4
    v_bfe_u32 v7, v4, 2, 1
    v_lshl_or_b32 v6, v7, 3, v6
    v_bfe_u32 v7, v4, 3, 1
    v_lshl_or_b32 v6, v7, 2, v6
    v_mul_u32_u24 v6, 9216, v6
    v_lshl_add_u32 v6, v5, 4, v6
    v_add_u32 v204, s32, v6
    s_add_u32 m0, s44, 4096
    s_nop 0
    buffer_load_dwordx4 v204, s[12:15], s40 offen lds
    v_add_u32 v3, 320, v1
    v_mul_lo_u32 v4, v3, s33
    v_lshrrev_b32 v4, 16, v4
    v_mul_u32_u24 v5, 18, v4
    v_sub_u32 v5, v3, v5
    v_and_b32 v6, 0x33, v4
    v_bfe_u32 v7, v4, 2, 1
    v_lshl_or_b32 v6, v7, 3, v6
    v_bfe_u32 v7, v4, 3, 1
    v_lshl_or_b32 v6, v7, 2, v6
    v_mul_u32_u24 v6, 9216, v6
    v_lshl_add_u32 v6, v5, 4, v6
    v_add_u32 v205, s32, v6
    s_add_u32 m0, s44, 5120
    s_nop 0
    buffer_load_dwordx4 v205, s[12:15], s40 offen lds
    v_add_u32 v3, 384, v1
    v_mul_lo_u32 v4, v3, s33
    v_lshrrev_b32 v4, 16, v4
    v_mul_u32_u24 v5, 18, v4
    v_sub_u32 v5, v3, v5
    v_and_b32 v6, 0x33, v4
    v_bfe_u32 v7, v4, 2, 1
    v_lshl_or_b32 v6, v7, 3, v6
    v_bfe_u32 v7, v4, 3, 1
    v_lshl_or_b32 v6, v7, 2, v6
    v_mul_u32_u24 v6, 9216, v6
    v_lshl_add_u32 v6, v5, 4, v6
    v_add_u32 v206, s32, v6
    s_add_u32 m0, s44, 6144
    s_nop 0
    buffer_load_dwordx4 v206, s[12:15], s40 offen lds
    v_add_u32 v3, 448, v1
    v_mul_lo_u32 v4, v3, s33
    v_lshrrev_b32 v4, 16, v4
    v_mul_u32_u24 v5, 18, v4
    v_sub_u32 v5, v3, v5
    v_and_b32 v6, 0x33, v4
    v_bfe_u32 v7, v4, 2, 1
    v_lshl_or_b32 v6, v7, 3, v6
    v_bfe_u32 v7, v4, 3, 1
    v_lshl_or_b32 v6, v7, 2, v6
    v_mul_u32_u24 v6, 9216, v6
    v_lshl_add_u32 v6, v5, 4, v6
    v_add_u32 v207, s32, v6
    s_add_u32 m0, s44, 7168
    s_nop 0
    buffer_load_dwordx4 v207, s[12:15], s40 offen lds
    v_add_u32 v3, 512, v1
    v_mul_lo_u32 v4, v3, s33
    v_lshrrev_b32 v4, 16, v4
    v_mul_u32_u24 v5, 18, v4
    v_sub_u32 v5, v3, v5
    v_and_b32 v6, 0x33, v4
    v_bfe_u32 v7, v4, 2, 1
    v_lshl_or_b32 v6, v7, 3, v6
    v_bfe_u32 v7, v4, 3, 1
    v_lshl_or_b32 v6, v7, 2, v6
    v_mul_u32_u24 v6, 9216, v6
    v_lshl_add_u32 v6, v5, 4, v6
    v_add_u32 v208, s32, v6
    s_add_u32 m0, s44, 8192
    s_nop 0
    buffer_load_dwordx4 v208, s[12:15], s40 offen lds
    s_mov_b32 s41, s44
    s_mov_b32 s43, 0
    s_add_u32 s40, s40, 589824
    s_add_u32 s41, s41, 34816
    s_cmp_ge_u32 s41, 139264
    s_cselect_b32 s41, s44, s41
    s_add_u32 s43, s43, 1
    s_cmp_eq_u32 s43, 9
    s_cselect_b32 s40, 0, s40
    s_mov_b32 m0, s41
    s_nop 0
    buffer_load_dwordx4 v200, s[12:15], s40 offen lds
    s_add_u32 m0, s41, 1024
    s_nop 0
    buffer_load_dwordx4 v201, s[12:15], s40 offen lds
    s_add_u32 m0, s41, 2048
    s_nop 0
    buffer_load_dwordx4 v202, s[12:15], s40 offen lds
    s_add_u32 m0, s41, 3072
    s_nop 0
    buffer_load_dwordx4 v203, s[12:15], s40 offen lds
    s_add_u32 m0, s41, 4096
    s_nop 0
    buffer_load_dwordx4 v204, s[12:15], s40 offen lds
    s_add_u32 m0, s41, 5120
    s_nop 0
    buffer_load_dwordx4 v205, s[12:15], s40 offen lds
    s_add_u32 m0, s41, 6144
    s_nop 0
    buffer_load_dwordx4 v206, s[12:15], s40 offen lds
    s_add_u32 m0, s41, 7168
    s_nop 0
    buffer_load_dwordx4 v207, s[12:15], s40 offen lds
    s_add_u32 m0, s41, 8192
    s_nop 0
    buffer_load_dwordx4 v208, s[12:15], s40 offen lds
    s_add_u32 s40, s40, 589824
    s_add_u32 s41, s41, 34816
    s_cmp_ge_u32 s41, 139264
    s_cselect_b32 s41, s44, s41
    s_add_u32 s43, s43, 1
    s_cmp_eq_u32 s43, 9
    s_cselect_b32 s40, 0, s40
    s_waitcnt vmcnt(18)
    s_mov_b32 s3, 1
    s_branch fz_ln
fz_c0:
    s_lshl_b32 s30, s2, 2
    s_add_u32 s30, s30, s22
    v_and_b32 v3, 15, v255
    v_lshrrev_b32 v4, 4, v255
    v_lshrrev_b32 v5, 1, v3
    v_xor_b32 v5, v5, v4
    v_lshlrev_b32 v5, 4, v5
    v_lshl_add_u32 v5, v3, 7, v5
    s_lshl_b32 s32, s22, 12
    v_add_u32 v235, s32, v5
    v_xor_b32 v236, 64, v235
    v_bfe_u32 v5, v255, 2, 2
    v_and_b32 v6, 1, v4
    v_lshl_add_u32 v5, v6, 2, v5
    v_lshrrev_b32 v6, 1, v4
    v_lshl_add_u32 v5, v6, 4, v5
    v_mul_u32_u24 v5, 288, v5
    v_and_b32 v6, 3, v255
    v_lshl_add_u32 v5, v6, 3, v5
    v_add_u32 v237, 16384, v5
    v_add_u32 v232, 69632, v235
    v_add_u32 v233, 69632, v236
    v_add_u32 v234, 69632, v237
    s_mov_b32 s56, 0xbdd2d3e8
    s_mov_b32 s57, 0xbdd2d3e8
    v_mov_b32 v242, 0xc0135761
    v_mov_b32 v243, 0xc0135761
    v_mov_b32 v244, 1.0
    v_mov_b32 v245, 1.0
    v_lshlrev_b32 v246, 4, v255
    s_lshl_b32 s33, s22, 8
    s_add_u32 s33, s33, 141824
    v_lshrrev_b32 v3, 4, v255
    v_lshlrev_b32 v3, 4, v3
    v_add_u32 v247, s33, v3
    v_and_b32 v3, 31, v255
    v_lshlrev_b32 v3, 2, v3
    v_add_u32 v248, s33, v3
    s_setprio 2
    v_mul_u32_u24 v3, 43, v255
    v_lshrrev_b32 v3, 8, v3
    v_mul_u32_u24 v4, 6, v3
    v_sub_u32 v4, v255, v4
    s_lshl_b32 s31, s30, 1
    v_add_u32 v3, s31, v3
    v_mul_u32_u24 v3, 1152, v3
    v_lshl_add_u32 v3, v4, 7, v3
    s_mul_i32 s31, s30, 14
    v_add_u32 v7, s31, v255
    v_min_u32 v7, 13823, v7
    s_mov_b32 s32, 29128
    v_mul_lo_u32 v4, v7, s32
    v_lshrrev_b32 v4, 20, v4
    v_mul_u32_u24 v5, 36, v4
    v_sub_u32 v5, v7, v5
    v_mul_u32_u24 v4, 9216, v4
    v_lshl_add_u32 v4, v5, 7, v4
    v_add_u32 v4, 1774080, v4
    s_mov_b32 exec_lo, 0xfff
    s_mov_b32 exec_hi, 0x0
    global_load_dword v254, v3, s[6:7] offset:384
    s_mov_b32 exec_lo, 0x3fff
    s_mov_b32 exec_hi, 0x0
    global_load_dword v254, v4, s[8:9]
    s_mov_b64 exec, -1
    s_waitcnt vmcnt(2)
    s_mov_b32 s3, 0
fz_ln:
    s_add_u32 s16, s4, 38797312
    s_addc_u32 s17, s5, 0
    s_mov_b32 s18, 36864
    s_mov_b32 s19, 0x20000
    v_cmp_gt_u32 vcc, 36, v255
    v_lshlrev_b32 v16, 16, v8
    v_and_b32 v17, 0xffff0000, v8
    v_lshlrev_b32 v18, 16, v9
    v_and_b32 v19, 0xffff0000, v9
    v_lshlrev_b32 v20, 16, v10
    v_and_b32 v21, 0xffff0000, v10
    v_lshlrev_b32 v22, 16, v11
    v_and_b32 v23, 0xffff0000, v11
    v_lshlrev_b32 v24, 16, v12
    v_and_b32 v25, 0xffff0000, v12
    v_lshlrev_b32 v26, 16, v13
    v_and_b32 v27, 0xffff0000, v13
    v_lshlrev_b32 v28, 16, v14
    v_and_b32 v29, 0xffff0000, v14
    v_lshlrev_b32 v30, 16, v15
    v_and_b32 v31, 0xffff0000, v15
    v_pk_add_f32 v[112:113], v[16:17], v[18:19]
    v_pk_add_f32 v[114:115], v[20:21], v[22:23]
    v_pk_add_f32 v[112:113], v[112:113], v[24:25]
    v_pk_add_f32 v[114:115], v[114:115], v[26:27]
    v_pk_add_f32 v[112:113], v[112:113], v[28:29]
    v_pk_add_f32 v[114:115], v[114:115], v[30:31]
    v_pk_add_f32 v[112:113], v[112:113], v[114:115]
    v_add_f32 v112, v112, v113
    s_nop 1
    v_add_f32_dpp v112, v112, v112 row_ror:8 row_mask:0xf bank_mask:0xf
    s_nop 1
    v_add_f32_dpp v112, v112, v112 row_ror:4 row_mask:0xf bank_mask:0xf
    s_nop 1
    v_add_f32_dpp v112, v112, v112 row_ror:2 row_mask:0xf bank_mask:0xf
    s_nop 1
    v_add_f32_dpp v112, v112, v112 row_ror:1 row_mask:0xf bank_mask:0xf
    v_mov_b32 v113, v112
    s_nop 1
    v_permlane16_swap_b32 v112, v113
    v_add_f32 v112, v112, v113
    v_mov_b32 v113, v112
    s_nop 1
    v_permlane32_swap_b32 v112, v113
    v_add_f32 v112, v112, v113
    v_mul_f32 v112, 0.001736111111111111, v112
    v_cndmask_b32 v118, 0, v112, vcc
    v_pk_add_f32 v[32:33], v[16:17], v[118:119] op_sel_hi:[1,0] neg_lo:[0,1] neg_hi:[0,1]
    v_pk_add_f32 v[34:35], v[18:19], v[118:119] op_sel_hi:[1,0] neg_lo:[0,1] neg_hi:[0,1]
    v_pk_add_f32 v[36:37], v[20:21], v[118:119] op_sel_hi:[1,0] neg_lo:[0,1] neg_hi:[0,1]
    v_pk_add_f32 v[38:39], v[22:23], v[118:119] op_sel_hi:[1,0] neg_lo:[0,1] neg_hi:[0,1]
    v_pk_add_f32 v[40:41], v[24:25], v[118:119] op_sel_hi:[1,0] neg_lo:[0,1] neg_hi:[0,1]
    v_pk_add_f32 v[42:43], v[26:27], v[118:119] op_sel_hi:[1,0] neg_lo:[0,1] neg_hi:[0,1]
    v_pk_add_f32 v[44:45], v[28:29], v[118:119] op_sel_hi:[1,0] neg_lo:[0,1] neg_hi:[0,1]
    v_pk_add_f32 v[46:47], v[30:31], v[118:119] op_sel_hi:[1,0] neg_lo:[0,1] neg_hi:[0,1]
    v_pk_mul_f32 v[114:115], v[32:33], v[32:33]
    v_pk_mul_f32 v[116:117], v[34:35], v[34:35]
    v_pk_fma_f32 v[114:115], v[36:37], v[36:37], v[114:115]
    v_pk_fma_f32 v[116:117], v[38:39], v[38:39], v[116:117]
    v_pk_fma_f32 v[114:115], v[40:41], v[40:41], v[114:115]
    v_pk_fma_f32 v[116:117], v[42:43], v[42:43], v[116:117]
    v_pk_fma_f32 v[114:115], v[44:45], v[44:45], v[114:115]
    v_pk_fma_f32 v[116:117], v[46:47], v[46:47], v[116:117]
    v_pk_add_f32 v[114:115], v[114:115], v[116:117]
    v_add_f32 v114, v114, v115
    s_nop 1
    v_add_f32_dpp v114, v114, v114 row_ror:8 row_mask:0xf bank_mask:0xf
    s_nop 1
    v_add_f32_dpp v114, v114, v114 row_ror:4 row_mask:0xf bank_mask:0xf
    s_nop 1
    v_add_f32_dpp v114, v114, v114 row_ror:2 row_mask:0xf bank_mask:0xf
    s_nop 1
    v_add_f32_dpp v114, v114, v114 row_ror:1 row_mask:0xf bank_mask:0xf
    v_mov_b32 v115, v114
    s_nop 1
    v_permlane16_swap_b32 v114, v115
    v_add_f32 v114, v114, v115
    v_mov_b32 v115, v114
    s_nop 1
    v_permlane32_swap_b32 v114, v115
    v_add_f32 v114, v114, v115
    v_mul_f32 v114, 0.001736111111111111, v114
    s_add_u32 s36, s4, 28311552
    s_addc_u32 s37, s5, 0
    s_mov_b32 s38, 2359296
    s_mov_b32 s39, 0x20000
    s_waitcnt lgkmcnt(0)
    s_mul_i32 s23, s23, 0x9E3779B1
    s_add_u32 s23, s23, 0x7F4A7C15
    s_mul_i32 s31, s63, 1152
    v_cvt_pk_bf16_f32 v114, v114, v114
    v_lshlrev_b32 v114, 16, v114
    v_add_f32 v114, 1e-05, v114
    v_cvt_pk_bf16_f32 v114, v114, v114
    v_lshlrev_b32 v114, 16, v114
    v_sqrt_f32 v114, v114
    s_nop 0
    v_cvt_pk_bf16_f32 v114, v114, v114
    v_lshlrev_b32 v114, 16, v114
    v_rcp_f32 v114, v114
    v_cvt_pk_bf16_f32 v112, v112, v112
    v_lshlrev_b32 v112, 16, v112
    v_mul_f32 v112, -v112, v114
    v_pk_fma_f32 v[16:17], v[16:17], v[114:115], v[112:113] op_sel_hi:[1,0,0]
    v_pk_fma_f32 v[18:19], v[18:19], v[114:115], v[112:113] op_sel_hi:[1,0,0]
    v_pk_fma_f32 v[20:21], v[20:21], v[114:115], v[112:113] op_sel_hi:[1,0,0]
    v_pk_fma_f32 v[22:23], v[22:23], v[114:115], v[112:113] op_sel_hi:[1,0,0]
    v_pk_fma_f32 v[24:25], v[24:25], v[114:115], v[112:113] op_sel_hi:[1,0,0]
    v_pk_fma_f32 v[26:27], v[26:27], v[114:115], v[112:113] op_sel_hi:[1,0,0]
    v_pk_fma_f32 v[28:29], v[28:29], v[114:115], v[112:113] op_sel_hi:[1,0,0]
    v_pk_fma_f32 v[30:31], v[30:31], v[114:115], v[112:113] op_sel_hi:[1,0,0]
    v_cvt_pk_bf16_f32 v8, v16, v17
    v_cvt_pk_bf16_f32 v9, v18, v19
    v_cvt_pk_bf16_f32 v10, v20, v21
    v_cvt_pk_bf16_f32 v11, v22, v23
    v_cvt_pk_bf16_f32 v12, v24, v25
    v_cvt_pk_bf16_f32 v13, v26, v27
    v_cvt_pk_bf16_f32 v14, v28, v29
    v_cvt_pk_bf16_f32 v15, v30, v31
    buffer_store_dwordx4 v[8:11], v2, s[36:39], s31 offen sc1
    buffer_store_dwordx4 v[12:15], v2, s[36:39], s31 offen offset:576 sc1
    v_mov_b32 v113, s23
    v_mov_b32 v115, s23
    s_lshl_b32 s63, s63, 4
    s_cmp_eq_u32 s3, 0
    s_cbranch_scc1 fz_c1
    s_cmp_eq_u32 s3, 1
    s_cbranch_scc1 fz_l1W
    s_load_dwordx2 s[46:47], s[0:1], 88
    s_load_dwordx2 s[54:55], s[0:1], 104
    v_and_b32 v3, 15, v255
    v_lshrrev_b32 v4, 4, v255
    v_lshrrev_b32 v5, 1, v3
    v_xor_b32 v5, v5, v4
    v_lshlrev_b32 v5, 4, v5
    v_lshl_add_u32 v5, v3, 7, v5
    s_lshl_b32 s32, s57, 12
    v_add_u32 v213, s32, v5
    v_xor_b32 v214, 64, v213
    v_bfe_u32 v5, v255, 2, 2
    v_and_b32 v6, 1, v4
    v_lshl_add_u32 v5, v6, 2, v5
    v_lshrrev_b32 v6, 1, v4
    v_lshl_add_u32 v5, v6, 4, v5
    v_mul_u32_u24 v5, 288, v5
    v_and_b32 v6, 3, v255
    v_lshl_add_u32 v5, v6, 3, v5
    v_add_u32 v215, 16384, v5
    v_mov_b32 v108, 0x3f803f80
    v_mov_b32 v109, 0x3f803f80
    v_mov_b32 v110, 0x3f803f80
    v_mov_b32 v111, 0x3f803f80
    v_mov_b32 v44, 0
    v_mov_b32 v45, 0
    v_mov_b32 v46, 0
    v_mov_b32 v47, 0
    v_mov_b32 v48, 0
    v_mov_b32 v49, 0
    v_mov_b32 v50, 0
    v_mov_b32 v51, 0
    v_mov_b32 v52, 0
    v_mov_b32 v53, 0
    v_mov_b32 v54, 0
    v_mov_b32 v55, 0
    s_lshl_b32 s36, s57, 5
    v_add_u32 v215, s36, v215
    v_mov_b32 v212, v215
    s_mov_b32 s34, 0
    s_mov_b32 s35, 0
    s_add_u32 s24, s4, 38731776
    s_addc_u32 s25, s5, 0
    s_mov_b32 s26, 32768
    s_mov_b32 s27, 0x20000
    s_lshl_b32 s36, s20, 7
    s_and_b32 s37, s57, 1
    s_lshl_b32 s37, s37, 6
    s_add_u32 s36, s36, s37
    s_lshl_b32 s36, s36, 4
    v_lshlrev_b32 v124, 4, v255
    s_sub_u32 s56, 7, s22
    s_lshr_b32 s58, s56, 1
    s_xor_b32 s56, s56, s58
    s_lshl_b32 s58, s2, 1
    s_add_u32 s58, s58, s56
    s_add_u32 s59, s2, 512
    s_cmp_eq_u32 s56, 2
    s_cselect_b32 s58, s59, s58
    s_cmp_eq_u32 s56, 3
    s_cselect_b32 s58, 1000, s58
    s_lshl_b32 s59, s56, 13
    s_add_u32 s59, s59, 139264
    s_waitcnt vmcnt(10) lgkmcnt(0)
    s_barrier
    ds_read_b64_tr_b16 v[56:57], v212 offset:0
    ds_read_b64_tr_b16 v[58:59], v212 offset:2304
    ds_read_b64_tr_b16 v[60:61], v212 offset:128
    ds_read_b64_tr_b16 v[62:63], v212 offset:2432
    ds_read_b64_tr_b16 v[68:69], v212 offset:9216
    ds_read_b64_tr_b16 v[70:71], v212 offset:11520
    ds_read_b64_tr_b16 v[72:73], v212 offset:9344
    ds_read_b64_tr_b16 v[74:75], v212 offset:11648
    s_mov_b32 m0, s41
    s_nop 0
    buffer_load_dwordx4 v200, s[12:15], s40 offen sc1 lds
    s_add_u32 m0, s41, 1024
    s_nop 0
    buffer_load_dwordx4 v201, s[12:15], s40 offen sc1 lds
    s_waitcnt lgkmcnt(0)
    s_add_u32 m0, s41, 2048
    s_nop 0
    buffer_load_dwordx4 v202, s[12:15], s40 offen sc1 lds
    v_mfma_f32_16x16x32_bf16 v[44:47], v[108:111], v[56:59], v[44:47]
    s_add_u32 m0, s41, 3072
    s_nop 0
    buffer_load_dwordx4 v203, s[12:15], s40 offen sc1 lds
    v_mfma_f32_16x16x32_bf16 v[48:51], v[108:111], v[60:63], v[48:51]
    s_add_u32 m0, s41, 4096
    s_nop 0
    buffer_load_dwordx4 v204, s[12:15], s40 offen sc1 lds
    v_mfma_f32_16x16x32_bf16 v[44:47], v[108:111], v[68:71], v[44:47]
    s_add_u32 m0, s41, 5120
    s_nop 0
    buffer_load_dwordx4 v205, s[12:15], s40 offen sc1 lds
    v_mfma_f32_16x16x32_bf16 v[48:51], v[108:111], v[72:75], v[48:51]
    s_add_u32 m0, s41, 6144
    s_nop 0
    buffer_load_dwordx4 v206, s[12:15], s40 offen sc1 lds
    s_add_u32 m0, s41, 7168
    s_nop 0
    buffer_load_dwordx4 v207, s[12:15], s40 offen sc1 lds
    s_add_u32 s40, s40, 128
    s_add_u32 s41, s41, 34816
    s_cmp_ge_u32 s41, 139264
    s_cselect_b32 s41, s44, s41
    s_add_u32 s43, s43, 1
    s_cmp_eq_u32 s43, 9
    s_cselect_b32 s40, 0, s40
    s_mov_b32 m0, s41
    s_nop 0
    buffer_load_dwordx4 v200, s[12:15], s40 offen sc1 lds
    s_add_u32 m0, s41, 1024
    s_nop 0
    buffer_load_dwordx4 v201, s[12:15], s40 offen sc1 lds
    s_add_u32 m0, s41, 2048
    s_nop 0
    buffer_load_dwordx4 v202, s[12:15], s40 offen sc1 lds
    s_add_u32 m0, s41, 3072
    s_nop 0
    buffer_load_dwordx4 v203, s[12:15], s40 offen sc1 lds
    s_add_u32 m0, s41, 4096
    s_nop 0
    buffer_load_dwordx4 v204, s[12:15], s40 offen sc1 lds
    s_add_u32 m0, s41, 5120
    s_nop 0
    buffer_load_dwordx4 v205, s[12:15], s40 offen sc1 lds
    s_add_u32 m0, s41, 6144
    s_nop 0
    buffer_load_dwordx4 v206, s[12:15], s40 offen sc1 lds
    s_add_u32 m0, s41, 7168
    s_nop 0
    buffer_load_dwordx4 v207, s[12:15], s40 offen sc1 lds
    s_add_u32 s40, s40, 128
    s_add_u32 s41, s41, 34816
    s_cmp_ge_u32 s41, 139264
    s_cselect_b32 s41, s44, s41
    s_add_u32 s43, s43, 1
    s_cmp_eq_u32 s43, 9
    s_cselect_b32 s40, 0, s40
    s_add_u32 s34, s34, 34816
    s_cmp_ge_u32 s34, 139264
    s_cselect_b32 s34, 0, s34
    v_add_u32 v212, s34, v215
    s_add_u32 s35, s35, 1
fz_l1Xa:
    s_waitcnt vmcnt(16) lgkmcnt(0)
    s_barrier
    ds_read_b64_tr_b16 v[56:57], v212 offset:0
    ds_read_b64_tr_b16 v[58:59], v212 offset:2304
    ds_read_b64_tr_b16 v[60:61], v212 offset:128
    ds_read_b64_tr_b16 v[62:63], v212 offset:2432
    ds_read_b64_tr_b16 v[68:69], v212 offset:9216
    ds_read_b64_tr_b16 v[70:71], v212 offset:11520
    ds_read_b64_tr_b16 v[72:73], v212 offset:9344
    ds_read_b64_tr_b16 v[74:75], v212 offset:11648
    s_mov_b32 m0, s41
    s_nop 0
    buffer_load_dwordx4 v200, s[12:15], s40 offen sc1 lds
    s_add_u32 m0, s41, 1024
    s_nop 0
    buffer_load_dwordx4 v201, s[12:15], s40 offen sc1 lds
    s_waitcnt lgkmcnt(0)
    s_add_u32 m0, s41, 2048
    s_nop 0
    buffer_load_dwordx4 v202, s[12:15], s40 offen sc1 lds
    v_mfma_f32_16x16x32_bf16 v[44:47], v[108:111], v[56:59], v[44:47]
    s_add_u32 m0, s41, 3072
    s_nop 0
    buffer_load_dwordx4 v203, s[12:15], s40 offen sc1 lds
    v_mfma_f32_16x16x32_bf16 v[48:51], v[108:111], v[60:63], v[48:51]
    s_add_u32 m0, s41, 4096
    s_nop 0
    buffer_load_dwordx4 v204, s[12:15], s40 offen sc1 lds
    v_mfma_f32_16x16x32_bf16 v[44:47], v[108:111], v[68:71], v[44:47]
    s_add_u32 m0, s41, 5120
    s_nop 0
    buffer_load_dwordx4 v205, s[12:15], s40 offen sc1 lds
    v_mfma_f32_16x16x32_bf16 v[48:51], v[108:111], v[72:75], v[48:51]
    s_add_u32 m0, s41, 6144
    s_nop 0
    buffer_load_dwordx4 v206, s[12:15], s40 offen sc1 lds
    s_add_u32 m0, s41, 7168
    s_nop 0
    buffer_load_dwordx4 v207, s[12:15], s40 offen sc1 lds
    s_add_u32 s40, s40, 128
    s_add_u32 s41, s41, 34816
    s_cmp_ge_u32 s41, 139264
    s_cselect_b32 s41, s44, s41
    s_add_u32 s43, s43, 1
    s_cmp_eq_u32 s43, 9
    s_cselect_b32 s40, 0, s40
    s_add_u32 s34, s34, 34816
    s_cmp_ge_u32 s34, 139264
    s_cselect_b32 s34, 0, s34
    v_add_u32 v212, s34, v215
    s_add_u32 s35, s35, 1
    s_cmp_eq_u32 s35, 2
    s_cbranch_scc0 parallel_sum__ssm_conv_s4__mixer_gmlp__prompt_kernel_gr1
    v_mov_b32 v116, 0
    s_mov_b64 exec, 1
    buffer_store_dwordx4 v[112:115], v116, s[24:27], s63 offen sc1
    s_mov_b64 exec, -1
parallel_sum__ssm_conv_s4__mixer_gmlp__prompt_kernel_gr1:
    s_cmp_eq_u32 s35, 5
    s_cbranch_scc0 parallel_sum__ssm_conv_s4__mixer_gmlp__prompt_kernel_rg2
    buffer_load_dwordx4 v[120:123], v124, s[24:27], s36 offen sc1
parallel_sum__ssm_conv_s4__mixer_gmlp__prompt_kernel_rg2:
    s_cmp_lt_u32 s35, 6
    s_cbranch_scc1 fz_l1Xa
    s_mov_b32 s28, s8
    s_mov_b32 s29, s9
    s_mov_b32 s30, 5308416
    s_mov_b32 s31, 0x20000
    s_mul_i32 s33, s2, 27648
    s_cmp_lt_u32 s2, 192
    s_cselect_b32 s33, s33, 2146435072
    s_sub_u32 s37, s22, 6
    s_mul_i32 s37, s37, 54
    v_add_u32 v118, s37, v255
    v_mul_u32_u24 v119, 57, v118
    v_lshrrev_b32 v119, 11, v119
    v_mul_u32_u24 v119, 4608, v119
    v_lshl_add_u32 v118, v118, 7, v119
    s_mov_b32 exec_lo, 0xffffffff
    s_mov_b32 exec_hi, 0x3fffff
    buffer_load_dword v254, v118, s[28:31], s33 offen
    s_mov_b64 exec, -1
    s_waitcnt vmcnt(9)
    s_mov_b32 s62, 0
parallel_sum__ssm_conv_s4__mixer_gmlp__prompt_kernel_rp3:
    v_cmp_ne_u32 vcc, s23, v121
    v_cmp_ne_u32 s[60:61], s23, v123
    s_nop 0
    s_or_b64 vcc, vcc, s[60:61]
    s_cbranch_vccz parallel_sum__ssm_conv_s4__mixer_gmlp__prompt_kernel_rd4
    s_add_u32 s62, s62, 1
    s_cmp_ge_u32 s62, 16384
    s_cbranch_scc1 parallel_sum__ssm_conv_s4__mixer_gmlp__prompt_kernel_rd4
    buffer_load_dwordx4 v[120:123], v124, s[24:27], s36 offen sc1
    s_waitcnt vmcnt(0)
    s_branch parallel_sum__ssm_conv_s4__mixer_gmlp__prompt_kernel_rp3
parallel_sum__ssm_conv_s4__mixer_gmlp__prompt_kernel_rd4:
    s_add_u32 s12, s4, 28311552
    s_addc_u32 s13, s5, 0
    s_mov_b32 s14, 2359296
    s_mov_b32 s15, 0x20000
    v_lshlrev_b32 v116, 2, v255
    s_sub_u32 s33, s22, 6
    s_lshl_b32 s33, s33, 8
    s_add_u32 s33, s33, 139264
    v_add_u32 v116, s33, v116
    ds_write_b32 v116, v120
    ds_write_b32 v116, v122 offset:512
    s_waitcnt vmcnt(17) lgkmcnt(0)
    s_barrier
    ds_read_b64_tr_b16 v[56:57], v212 offset:0
    ds_read_b64_tr_b16 v[58:59], v212 offset:2304
    ds_read_b64_tr_b16 v[60:61], v212 offset:128
    ds_read_b64_tr_b16 v[62:63], v212 offset:2432
    ds_read_b64_tr_b16 v[68:69], v212 offset:9216
    ds_read_b64_tr_b16 v[70:71], v212 offset:11520
    ds_read_b64_tr_b16 v[72:73], v212 offset:9344
    ds_read_b64_tr_b16 v[74:75], v212 offset:11648
    s_mov_b32 m0, s41
    s_nop 0
    buffer_load_dwordx4 v200, s[12:15], s40 offen sc1 lds
    s_add_u32 m0, s41, 1024
    s_nop 0
    buffer_load_dwordx4 v201, s[12:15], s40 offen sc1 lds
    s_waitcnt lgkmcnt(0)
    s_add_u32 m0, s41, 2048
    s_nop 0
    buffer_load_dwordx4 v202, s[12:15], s40 offen sc1 lds
    v_mfma_f32_16x16x32_bf16 v[44:47], v[108:111], v[56:59], v[44:47]
    s_add_u32 m0, s41, 3072
    s_nop 0
    buffer_load_dwordx4 v203, s[12:15], s40 offen sc1 lds
    v_mfma_f32_16x16x32_bf16 v[48:51], v[108:111], v[60:63], v[48:51]
    s_add_u32 m0, s41, 4096
    s_nop 0
    buffer_load_dwordx4 v204, s[12:15], s40 offen sc1 lds
    v_mfma_f32_16x16x32_bf16 v[44:47], v[108:111], v[68:71], v[44:47]
    s_add_u32 m0, s41, 5120
    s_nop 0
    buffer_load_dwordx4 v205, s[12:15], s40 offen sc1 lds
    v_mfma_f32_16x16x32_bf16 v[48:51], v[108:111], v[72:75], v[48:51]
    s_add_u32 m0, s41, 6144
    s_nop 0
    buffer_load_dwordx4 v206, s[12:15], s40 offen sc1 lds
    s_add_u32 m0, s41, 7168
    s_nop 0
    buffer_load_dwordx4 v207, s[12:15], s40 offen sc1 lds
    s_add_u32 s40, s40, 128
    s_add_u32 s41, s41, 34816
    s_cmp_ge_u32 s41, 139264
    s_cselect_b32 s41, s44, s41
    s_add_u32 s43, s43, 1
    s_cmp_eq_u32 s43, 9
    s_cselect_b32 s40, 0, s40
    s_add_u32 s34, s34, 34816
    s_cmp_ge_u32 s34, 139264
    s_cselect_b32 s34, 0, s34
    v_add_u32 v212, s34, v215
    s_add_u32 s35, s35, 1
    s_mov_b32 s28, s46
    s_mov_b32 s29, s47
    s_mov_b32 s30, 8388608
    s_mov_b32 s31, 0x20000
    s_lshl_b32 s33, s2, 15
    s_sub_u32 s37, s22, 6
    s_lshl_b32 s37, s37, 10
    s_add_u32 s33, s33, s37
    v_lshrrev_b32 v118, 3, v255
    v_lshlrev_b32 v118, 12, v118
    v_and_b32 v119, 7, v255
    v_lshl_add_u32 v118, v119, 7, v118
    buffer_load_dword v254, v118, s[28:31], s33 offen offset:0
    buffer_load_dword v254, v118, s[28:31], s33 offen offset:2048
    s_waitcnt vmcnt(19) lgkmcnt(0)
    s_barrier
    ds_read_b64_tr_b16 v[56:57], v212 offset:0
    ds_read_b64_tr_b16 v[58:59], v212 offset:2304
    ds_read_b64_tr_b16 v[60:61], v212 offset:128
    ds_read_b64_tr_b16 v[62:63], v212 offset:2432
    ds_read_b64_tr_b16 v[68:69], v212 offset:9216
    ds_read_b64_tr_b16 v[70:71], v212 offset:11520
    ds_read_b64_tr_b16 v[72:73], v212 offset:9344
    ds_read_b64_tr_b16 v[74:75], v212 offset:11648
    s_waitcnt lgkmcnt(0)
    v_mfma_f32_16x16x32_bf16 v[44:47], v[108:111], v[56:59], v[44:47]
    v_mfma_f32_16x16x32_bf16 v[48:51], v[108:111], v[60:63], v[48:51]
    v_mfma_f32_16x16x32_bf16 v[44:47], v[108:111], v[68:71], v[44:47]
    v_mfma_f32_16x16x32_bf16 v[48:51], v[108:111], v[72:75], v[48:51]
    s_add_u32 s34, s34, 34816
    s_cmp_ge_u32 s34, 139264
    s_cselect_b32 s34, 0, s34
    v_add_u32 v212, s34, v215
    s_add_u32 s35, s35, 1
    s_waitcnt vmcnt(11) lgkmcnt(0)
    s_barrier
    ds_read_b64_tr_b16 v[56:57], v212 offset:0
    ds_read_b64_tr_b16 v[58:59], v212 offset:2304
    ds_read_b64_tr_b16 v[60:61], v212 offset:128
    ds_read_b64_tr_b16 v[62:63], v212 offset:2432
    ds_read_b64_tr_b16 v[68:69], v212 offset:9216
    ds_read_b64_tr_b16 v[70:71], v212 offset:11520
    ds_read_b64_tr_b16 v[72:73], v212 offset:9344
    ds_read_b64_tr_b16 v[74:75], v212 offset:11648
    s_waitcnt lgkmcnt(0)
    v_mfma_f32_16x16x32_bf16 v[44:47], v[108:111], v[56:59], v[44:47]
    v_mfma_f32_16x16x32_bf16 v[48:51], v[108:111], v[60:63], v[48:51]
    v_mfma_f32_16x16x32_bf16 v[44:47], v[108:111], v[68:71], v[44:47]
    v_mfma_f32_16x16x32_bf16 v[48:51], v[108:111], v[72:75], v[48:51]
    s_add_u32 s34, s34, 34816
    s_cmp_ge_u32 s34, 139264
    s_cselect_b32 s34, 0, s34
    v_add_u32 v212, s34, v215
    s_add_u32 s35, s35, 1
    s_lshl_b32 s33, s57, 6
    s_add_u32 s33, s33, 140288
    v_lshlrev_b32 v116, 2, v255
    v_add_u32 v116, s33, v116
    s_mov_b32 exec_lo, 0xffff
    s_mov_b32 exec_hi, 0x0
    ds_write_b32 v116, v44 offset:0
    ds_write_b32 v116, v48 offset:256
    s_mov_b64 exec, -1
    s_waitcnt lgkmcnt(0)
    s_barrier
    s_mov_b32 m0, s41
    s_nop 0
    buffer_load_dwordx4 v200, s[12:15], s40 offen sc1 lds
    s_add_u32 m0, s41, 1024
    s_nop 0
    buffer_load_dwordx4 v201, s[12:15], s40 offen sc1 lds
    s_add_u32 m0, s41, 2048
    s_nop 0
    buffer_load_dwordx4 v202, s[12:15], s40 offen sc1 lds
    s_add_u32 m0, s41, 3072
    s_nop 0
    buffer_load_dwordx4 v203, s[12:15], s40 offen sc1 lds
    s_add_u32 m0, s41, 4096
    s_nop 0
    buffer_load_dwordx4 v204, s[12:15], s40 offen sc1 lds
    s_add_u32 m0, s41, 5120
    s_nop 0
    buffer_load_dwordx4 v205, s[12:15], s40 offen sc1 lds
    s_add_u32 m0, s41, 6144
    s_nop 0
    buffer_load_dwordx4 v206, s[12:15], s40 offen sc1 lds
    s_add_u32 m0, s41, 7168
    s_nop 0
    buffer_load_dwordx4 v207, s[12:15], s40 offen sc1 lds
    s_add_u32 s40, s40, 128
    s_add_u32 s41, s41, 34816
    s_cmp_ge_u32 s41, 139264
    s_cselect_b32 s41, s44, s41
    s_add_u32 s43, s43, 1
    s_cmp_eq_u32 s43, 9
    s_cselect_b32 s40, 0, s40
    s_mov_b32 m0, s41
    s_nop 0
    buffer_load_dwordx4 v200, s[12:15], s40 offen sc1 lds
    s_add_u32 m0, s41, 1024
    s_nop 0
    buffer_load_dwordx4 v201, s[12:15], s40 offen sc1 lds
    s_add_u32 m0, s41, 2048
    s_nop 0
    buffer_load_dwordx4 v202, s[12:15], s40 offen sc1 lds
    s_add_u32 m0, s41, 3072
    s_nop 0
    buffer_load_dwordx4 v203, s[12:15], s40 offen sc1 lds
    s_add_u32 m0, s41, 4096
    s_nop 0
    buffer_load_dwordx4 v204, s[12:15], s40 offen sc1 lds
    s_add_u32 m0, s41, 5120
    s_nop 0
    buffer_load_dwordx4 v205, s[12:15], s40 offen sc1 lds
    s_add_u32 m0, s41, 6144
    s_nop 0
    buffer_load_dwordx4 v206, s[12:15], s40 offen sc1 lds
    s_add_u32 m0, s41, 7168
    s_nop 0
    buffer_load_dwordx4 v207, s[12:15], s40 offen sc1 lds
    s_add_u32 s40, s40, 128
    s_add_u32 s41, s41, 34816
    s_cmp_ge_u32 s41, 139264
    s_cselect_b32 s41, s44, s41
    s_add_u32 s43, s43, 1
    s_cmp_eq_u32 s43, 9
    s_cselect_b32 s40, 0, s40
    s_mov_b32 m0, s41
    s_nop 0
    buffer_load_dwordx4 v200, s[12:15], s40 offen sc1 lds
    s_add_u32 m0, s41, 1024
    s_nop 0
    buffer_load_dwordx4 v201, s[12:15], s40 offen sc1 lds
    s_add_u32 m0, s41, 2048
    s_nop 0
    buffer_load_dwordx4 v202, s[12:15], s40 offen sc1 lds
    s_add_u32 m0, s41, 3072
    s_nop 0
    buffer_load_dwordx4 v203, s[12:15], s40 offen sc1 lds
    s_add_u32 m0, s41, 4096
    s_nop 0
    buffer_load_dwordx4 v204, s[12:15], s40 offen sc1 lds
    s_add_u32 m0, s41, 5120
    s_nop 0
    buffer_load_dwordx4 v205, s[12:15], s40 offen sc1 lds
    s_add_u32 m0, s41, 6144
    s_nop 0
    buffer_load_dwordx4 v206, s[12:15], s40 offen sc1 lds
    s_add_u32 m0, s41, 7168
    s_nop 0
    buffer_load_dwordx4 v207, s[12:15], s40 offen sc1 lds
    s_add_u32 s40, s40, 128
    s_add_u32 s41, s41, 34816
    s_cmp_ge_u32 s41, 139264
    s_cselect_b32 s41, s44, s41
    s_add_u32 s43, s43, 1
    s_cmp_eq_u32 s43, 9
    s_cselect_b32 s40, 0, s40
    s_waitcnt vmcnt(26)
    s_barrier
    s_add_u32 s28, s4, 38141952
    s_addc_u32 s29, s5, 0
    s_mov_b32 s30, 524288
    s_mov_b32 s31, 0x20000
    v_and_b32 v116, 31, v255
    v_lshlrev_b32 v117, 2, v116
    s_lshl_b32 s33, s57, 8
    s_add_u32 s33, s33, 141824
    v_add_u32 v117, s33, v117
    ds_read_b32 v120, v117
    ds_read_b32 v122, v117 offset:128
    v_mov_b32 v121, s23
    v_mov_b32 v123, s23
    s_lshl_b32 s33, s20, 4
    s_add_u32 s33, s33, s21
    s_lshl_b32 s33, s33, 11
    s_lshl_b32 s53, s57, 9
    s_add_u32 s33, s33, s53
    v_lshlrev_b32 v116, 4, v116
    s_waitcnt lgkmcnt(0)
    s_mov_b32 exec_lo, 0xffffffff
    s_mov_b32 exec_hi, 0x0
    buffer_store_dwordx4 v[120:123], v116, s[28:31], s33 offen sc1
    s_mov_b64 exec, -1
    v_lshrrev_b32 v46, 2, v255
    v_and_b32 v47, 3, v255
    v_lshlrev_b32 v47, 2, v47
    v_lshl_add_u32 v46, v46, 4, v47
    v_add_u32 v46, s59, v46
    v_xor_b32 v150, 0, v46
    v_xor_b32 v151, 16, v46
    v_xor_b32 v152, 32, v46
    v_xor_b32 v153, 48, v46
    v_xor_b32 v154, 64, v46
    v_xor_b32 v155, 80, v46
    v_xor_b32 v156, 96, v46
    v_xor_b32 v157, 112, v46
    v_xor_b32 v158, 128, v46
    v_xor_b32 v159, 144, v46
    v_xor_b32 v160, 160, v46
    v_xor_b32 v161, 176, v46
    v_xor_b32 v162, 192, v46
    v_xor_b32 v163, 208, v46
    v_xor_b32 v164, 224, v46
    v_xor_b32 v165, 240, v46
    v_and_b32 v166, 15, v255
    v_lshrrev_b32 v167, 4, v255
    v_add_u32 v46, 0, v167
    v_xor_b32 v46, v46, v166
    v_lshlrev_b32 v46, 4, v46
    v_lshl_add_u32 v46, v166, 8, v46
    v_add_u32 v140, s59, v46
    v_add_u32 v46, 4, v167
    v_xor_b32 v46, v46, v166
    v_lshlrev_b32 v46, 4, v46
    v_lshl_add_u32 v46, v166, 8, v46
    v_add_u32 v141, s59, v46
    v_add_u32 v46, 8, v167
    v_xor_b32 v46, v46, v166
    v_lshlrev_b32 v46, 4, v46
    v_lshl_add_u32 v46, v166, 8, v46
    v_add_u32 v142, s59, v46
    v_add_u32 v46, 12, v167
    v_xor_b32 v46, v46, v166
    v_lshlrev_b32 v46, 4, v46
    v_lshl_add_u32 v46, v166, 8, v46
    v_add_u32 v143, s59, v46
    s_add_u32 s35, s35, 1
    s_waitcnt vmcnt(16)
    s_barrier
    s_mov_b32 m0, s41
    s_nop 0
    buffer_load_dwordx4 v200, s[12:15], s40 offen sc1 lds
    s_add_u32 m0, s41, 1024
    s_nop 0
    buffer_load_dwordx4 v201, s[12:15], s40 offen sc1 lds
    s_add_u32 m0, s41, 2048
    s_nop 0
    buffer_load_dwordx4 v202, s[12:15], s40 offen sc1 lds
    s_add_u32 m0, s41, 3072
    s_nop 0
    buffer_load_dwordx4 v203, s[12:15], s40 offen sc1 lds
    s_add_u32 m0, s41, 4096
    s_nop 0
    buffer_load_dwordx4 v204, s[12:15], s40 offen sc1 lds
    s_add_u32 m0, s41, 5120
    s_nop 0
    buffer_load_dwordx4 v205, s[12:15], s40 offen sc1 lds
    s_add_u32 m0, s41, 6144
    s_nop 0
    buffer_load_dwordx4 v206, s[12:15], s40 offen sc1 lds
    s_add_u32 m0, s41, 7168
    s_nop 0
    buffer_load_dwordx4 v207, s[12:15], s40 offen sc1 lds
    s_add_u32 s40, s40, 128
    s_add_u32 s41, s41, 34816
    s_cmp_ge_u32 s41, 139264
    s_cselect_b32 s41, s44, s41
    s_add_u32 s43, s43, 1
    s_cmp_eq_u32 s43, 9
    s_cselect_b32 s40, 0, s40
    v_mov_b32 v46, v166
    v_and_b32 v47, 15, v46
    v_xor_b32 v47, v47, v167
    v_lshlrev_b32 v47, 4, v47
    v_lshl_add_u32 v46, v46, 8, v47
    v_add_u32 v182, s59, v46
    v_add_u32 v46, 0, v166
    v_bfe_u32 v46, v46, 1, 1
    v_add3_u32 v46, v46, v166, 0
    v_and_b32 v46, 254, v46
    v_and_b32 v47, 15, v46
    v_xor_b32 v47, v47, v167
    v_lshlrev_b32 v47, 4, v47
    v_lshl_add_u32 v46, v46, 8, v47
    v_add_u32 v183, s59, v46
    v_add_u32 v46, 0, v166
    v_bfe_u32 v46, v46, 2, 1
    v_add3_u32 v46, v46, v166, 1
    v_and_b32 v46, 252, v46
    v_lshrrev_b32 v47, 2, v46
    v_add_u32 v47, 12, v47
    v_min_u32 v46, v46, v47
    v_and_b32 v47, 15, v46
    v_xor_b32 v47, v47, v167
    v_lshlrev_b32 v47, 4, v47
    v_lshl_add_u32 v46, v46, 8, v47
    v_add_u32 v184, s59, v46
    v_add_u32 v46, 16, v166
    v_bfe_u32 v46, v46, 2, 1
    v_add3_u32 v46, v46, v166, 17
    v_and_b32 v46, 252, v46
    v_lshrrev_b32 v47, 2, v46
    v_add_u32 v47, 12, v47
    v_min_u32 v46, v46, v47
    v_and_b32 v47, 15, v46
    v_xor_b32 v47, v47, v167
    v_lshlrev_b32 v47, 4, v47
    v_lshl_add_u32 v46, v46, 8, v47
    v_add_u32 v185, s59, v46
    s_add_u32 s35, s35, 1
    s_waitcnt vmcnt(16)
    s_barrier
    s_mov_b32 m0, s41
    s_nop 0
    buffer_load_dwordx4 v200, s[12:15], s40 offen sc1 lds
    s_add_u32 m0, s41, 1024
    s_nop 0
    buffer_load_dwordx4 v201, s[12:15], s40 offen sc1 lds
    s_add_u32 m0, s41, 2048
    s_nop 0
    buffer_load_dwordx4 v202, s[12:15], s40 offen sc1 lds
    s_add_u32 m0, s41, 3072
    s_nop 0
    buffer_load_dwordx4 v203, s[12:15], s40 offen sc1 lds
    s_add_u32 m0, s41, 4096
    s_nop 0
    buffer_load_dwordx4 v204, s[12:15], s40 offen sc1 lds
    s_add_u32 m0, s41, 5120
    s_nop 0
    buffer_load_dwordx4 v205, s[12:15], s40 offen sc1 lds
    s_add_u32 m0, s41, 6144
    s_nop 0
    buffer_load_dwordx4 v206, s[12:15], s40 offen sc1 lds
    s_add_u32 m0, s41, 7168
    s_nop 0
    buffer_load_dwordx4 v207, s[12:15], s40 offen sc1 lds
    s_add_u32 s40, s40, 128
    s_add_u32 s41, s41, 34816
    s_cmp_ge_u32 s41, 139264
    s_cselect_b32 s41, s44, s41
    s_add_u32 s43, s43, 1
    s_cmp_eq_u32 s43, 9
    s_cselect_b32 s40, 0, s40
    v_add_u32 v46, 32, v166
    v_bfe_u32 v46, v46, 2, 1
    v_add3_u32 v46, v46, v166, 33
    v_and_b32 v46, 252, v46
    v_lshrrev_b32 v47, 2, v46
    v_add_u32 v47, 12, v47
    v_min_u32 v46, v46, v47
    v_and_b32 v47, 15, v46
    v_xor_b32 v47, v47, v167
    v_lshlrev_b32 v47, 4, v47
    v_lshl_add_u32 v46, v46, 8, v47
    v_add_u32 v186, s59, v46
    v_add_u32 v46, 48, v166
    v_bfe_u32 v46, v46, 2, 1
    v_add3_u32 v46, v46, v166, 49
    v_and_b32 v46, 252, v46
    v_lshrrev_b32 v47, 2, v46
    v_add_u32 v47, 12, v47
    v_min_u32 v46, v46, v47
    v_and_b32 v47, 15, v46
    v_xor_b32 v47, v47, v167
    v_lshlrev_b32 v47, 4, v47
    v_lshl_add_u32 v46, v46, 8, v47
    v_add_u32 v187, s59, v46
    v_add_u32 v46, 0, v166
    v_bfe_u32 v46, v46, 3, 1
    v_add3_u32 v46, v46, v166, 3
    v_and_b32 v46, 248, v46
    v_lshrrev_b32 v47, 2, v46
    v_add_u32 v47, 12, v47
    v_min_u32 v46, v46, v47
    v_and_b32 v47, 15, v46
    v_xor_b32 v47, v47, v167
    v_lshlrev_b32 v47, 4, v47
    v_lshl_add_u32 v46, v46, 8, v47
    v_add_u32 v188, s59, v46
    s_add_u32 s35, s35, 1
    s_waitcnt vmcnt(16)
    s_barrier
    s_mov_b32 m0, s41
    s_nop 0
    buffer_load_dwordx4 v200, s[12:15], s40 offen sc1 lds
    s_add_u32 m0, s41, 1024
    s_nop 0
    buffer_load_dwordx4 v201, s[12:15], s40 offen sc1 lds
    s_add_u32 m0, s41, 2048
    s_nop 0
    buffer_load_dwordx4 v202, s[12:15], s40 offen sc1 lds
    s_add_u32 m0, s41, 3072
    s_nop 0
    buffer_load_dwordx4 v203, s[12:15], s40 offen sc1 lds
    s_add_u32 m0, s41, 4096
    s_nop 0
    buffer_load_dwordx4 v204, s[12:15], s40 offen sc1 lds
    s_add_u32 m0, s41, 5120
    s_nop 0
    buffer_load_dwordx4 v205, s[12:15], s40 offen sc1 lds
    s_add_u32 m0, s41, 6144
    s_nop 0
    buffer_load_dwordx4 v206, s[12:15], s40 offen sc1 lds
    s_add_u32 m0, s41, 7168
    s_nop 0
    buffer_load_dwordx4 v207, s[12:15], s40 offen sc1 lds
    s_add_u32 s40, s40, 128
    s_add_u32 s41, s41, 34816
    s_cmp_ge_u32 s41, 139264
    s_cselect_b32 s41, s44, s41
    s_add_u32 s43, s43, 1
    s_cmp_eq_u32 s43, 9
    s_cselect_b32 s40, 0, s40
    v_add_u32 v46, 16, v166
    v_bfe_u32 v46, v46, 3, 1
    v_add3_u32 v46, v46, v166, 19
    v_and_b32 v46, 248, v46
    v_lshrrev_b32 v47, 2, v46
    v_add_u32 v47, 12, v47
    v_min_u32 v46, v46, v47
    v_and_b32 v47, 15, v46
    v_xor_b32 v47, v47, v167
    v_lshlrev_b32 v47, 4, v47
    v_lshl_add_u32 v46, v46, 8, v47
    v_add_u32 v189, s59, v46
    v_add_u32 v46, 32, v166
    v_bfe_u32 v46, v46, 3, 1
    v_add3_u32 v46, v46, v166, 35
    v_and_b32 v46, 248, v46
    v_lshrrev_b32 v47, 2, v46
    v_add_u32 v47, 12, v47
    v_min_u32 v46, v46, v47
    v_and_b32 v47, 15, v46
    v_xor_b32 v47, v47, v167
    v_lshlrev_b32 v47, 4, v47
    v_lshl_add_u32 v46, v46, 8, v47
    v_add_u32 v190, s59, v46
    v_add_u32 v46, 48, v166
    v_bfe_u32 v46, v46, 3, 1
    v_add3_u32 v46, v46, v166, 51
    v_and_b32 v46, 248, v46
    v_lshrrev_b32 v47, 2, v46
    v_add_u32 v47, 12, v47
    v_min_u32 v46, v46, v47
    v_and_b32 v47, 15, v46
    v_xor_b32 v47, v47, v167
    v_lshlrev_b32 v47, 4, v47
    v_lshl_add_u32 v46, v46, 8, v47
    v_add_u32 v191, s59, v46
    s_add_u32 s35, s35, 1
    s_waitcnt vmcnt(16)
    s_barrier
    s_mov_b32 m0, s41
    s_nop 0
    buffer_load_dwordx4 v200, s[12:15], s40 offen sc1 lds
    s_add_u32 m0, s41, 1024
    s_nop 0
    buffer_load_dwordx4 v201, s[12:15], s40 offen sc1 lds
    s_add_u32 m0, s41, 2048
    s_nop 0
    buffer_load_dwordx4 v202, s[12:15], s40 offen sc1 lds
    s_add_u32 m0, s41, 3072
    s_nop 0
    buffer_load_dwordx4 v203, s[12:15], s40 offen sc1 lds
    s_add_u32 m0, s41, 4096
    s_nop 0
    buffer_load_dwordx4 v204, s[12:15], s40 offen sc1 lds
    s_add_u32 m0, s41, 5120
    s_nop 0
    buffer_load_dwordx4 v205, s[12:15], s40 offen sc1 lds
    s_add_u32 m0, s41, 6144
    s_nop 0
    buffer_load_dwordx4 v206, s[12:15], s40 offen sc1 lds
    s_add_u32 m0, s41, 7168
    s_nop 0
    buffer_load_dwordx4 v207, s[12:15], s40 offen sc1 lds
    s_add_u32 s40, s40, 128
    s_add_u32 s41, s41, 34816
    s_cmp_ge_u32 s41, 139264
    s_cselect_b32 s41, s44, s41
    s_add_u32 s43, s43, 1
    s_cmp_eq_u32 s43, 9
    s_cselect_b32 s40, 0, s40
    s_add_u32 s35, s35, 1
    s_waitcnt vmcnt(16)
    s_barrier
    s_mov_b32 m0, s41
    s_nop 0
    buffer_load_dwordx4 v200, s[12:15], s40 offen sc1 lds
    s_add_u32 m0, s41, 1024
    s_nop 0
    buffer_load_dwordx4 v201, s[12:15], s40 offen sc1 lds
    s_add_u32 m0, s41, 2048
    s_nop 0
    buffer_load_dwordx4 v202, s[12:15], s40 offen sc1 lds
    s_add_u32 m0, s41, 3072
    s_nop 0
    buffer_load_dwordx4 v203, s[12:15], s40 offen sc1 lds
    s_add_u32 m0, s41, 4096
    s_nop 0
    buffer_load_dwordx4 v204, s[12:15], s40 offen sc1 lds
    s_add_u32 m0, s41, 5120
    s_nop 0
    buffer_load_dwordx4 v205, s[12:15], s40 offen sc1 lds
    s_add_u32 m0, s41, 6144
    s_nop 0
    buffer_load_dwordx4 v206, s[12:15], s40 offen sc1 lds
    s_add_u32 m0, s41, 7168
    s_nop 0
    buffer_load_dwordx4 v207, s[12:15], s40 offen sc1 lds
    s_add_u32 s40, s40, 128
    s_add_u32 s41, s41, 34816
    s_cmp_ge_u32 s41, 139264
    s_cselect_b32 s41, s44, s41
    s_add_u32 s43, s43, 1
    s_cmp_eq_u32 s43, 9
    s_cselect_b32 s40, 0, s40
    s_add_u32 s35, s35, 1
    s_mov_b32 s28, s54
    s_mov_b32 s29, s55
    s_mov_b32 s30, 2654208
    s_mov_b32 s31, 0x20000
    s_mul_i32 s33, s2, 10368
    s_sub_u32 s37, s22, 6
    s_mul_i32 s37, s37, 5248
    s_add_u32 s33, s33, s37
    v_lshlrev_b32 v118, 7, v255
    s_mov_b32 exec_lo, 0xffffffff
    s_mov_b32 exec_hi, 0x1ff
    buffer_load_dword v254, v118, s[28:31], s33 offen
    s_mov_b64 exec, -1
    s_load_dwordx4 s[24:27], s[0:1], 8
    s_load_dwordx4 s[28:31], s[0:1], 24
    s_load_dwordx4 s[32:35], s[0:1], 40
    s_load_dwordx4 s[36:39], s[0:1], 56
    s_min_u32 s42, s58, 575
    v_lshlrev_b32 v1, 1, v255
    s_lshl_b32 s43, s42, 8
    v_add_u32 v1, s43, v1
    s_lshl_b32 s43, s42, 1
    v_mov_b32 v2, s43
    s_waitcnt lgkmcnt(0)
    global_load_ushort v170, v1, s[24:25] offset:0
    global_load_ushort v171, v1, s[26:27] offset:0
    global_load_ushort v172, v1, s[28:29] offset:0
    global_load_ushort v173, v1, s[30:31] offset:0
    global_load_ushort v174, v1, s[32:33] offset:0
    global_load_ushort v175, v1, s[34:35] offset:0
    global_load_ushort v176, v1, s[24:25] offset:128
    global_load_ushort v177, v1, s[26:27] offset:128
    global_load_ushort v178, v1, s[28:29] offset:128
    global_load_ushort v179, v1, s[30:31] offset:128
    global_load_ushort v180, v1, s[32:33] offset:128
    global_load_ushort v181, v1, s[34:35] offset:128
    global_load_ushort v196, v2, s[36:37]
    global_load_ushort v197, v2, s[38:39]
    s_waitcnt vmcnt(31)
    s_barrier
    s_add_u32 s35, s35, 1
    s_add_u32 s24, s4, 38141952
    s_addc_u32 s25, s5, 0
    s_mov_b32 s26, 524288
    s_mov_b32 s27, 0x20000
    v_and_b32 v116, 31, v255
    v_lshlrev_b32 v117, 2, v116
    v_lshlrev_b32 v116, 4, v116
    v_lshrrev_b32 v118, 5, v255
    v_lshl_add_u32 v116, v118, 14, v116
    s_lshl_b32 s52, s20, 15
    s_lshl_b32 s53, s57, 9
    s_add_u32 s52, s52, s53
    s_lshl_b32 s33, s57, 7
    s_add_u32 s33, s33, 139264
    v_add_u32 v117, s33, v117
    s_mov_b32 s62, 0
    s_add_u32 s53, s52, 0
    buffer_load_dwordx4 v[56:59], v116, s[24:27], s53 offen sc1
    s_add_u32 s53, s52, 2048
    buffer_load_dwordx4 v[60:63], v116, s[24:27], s53 offen sc1
    s_add_u32 s53, s52, 4096
    buffer_load_dwordx4 v[64:67], v116, s[24:27], s53 offen sc1
    s_add_u32 s53, s52, 6144
    buffer_load_dwordx4 v[68:71], v116, s[24:27], s53 offen sc1
    s_add_u32 s53, s52, 8192
    buffer_load_dwordx4 v[72:75], v116, s[24:27], s53 offen sc1
    s_add_u32 s53, s52, 10240
    buffer_load_dwordx4 v[76:79], v116, s[24:27], s53 offen sc1
    s_add_u32 s53, s52, 12288
    buffer_load_dwordx4 v[80:83], v116, s[24:27], s53 offen sc1
    s_add_u32 s53, s52, 14336
    buffer_load_dwordx4 v[84:87], v116, s[24:27], s53 offen sc1
    s_waitcnt vmcnt(31)
    s_barrier
    s_add_u32 s35, s35, 1
    s_waitcnt vmcnt(0)
    s_barrier
    s_add_u32 s35, s35, 1
parallel_sum__ssm_conv_s4__mixer_gmlp__prompt_kernel_sp5:
    v_xor_b32 v121, s23, v57
    v_xor_b32 v123, s23, v59
    v_or_b32 v121, v121, v123
    v_xor_b32 v123, s23, v61
    v_or_b32 v121, v121, v123
    v_xor_b32 v122, s23, v63
    v_or_b32 v121, v121, v122
    v_xor_b32 v122, s23, v65
    v_or_b32 v121, v121, v122
    v_xor_b32 v123, s23, v67
    v_or_b32 v121, v121, v123
    v_xor_b32 v123, s23, v69
    v_or_b32 v121, v121, v123
    v_xor_b32 v122, s23, v71
    v_or_b32 v121, v121, v122
    v_xor_b32 v122, s23, v73
    v_or_b32 v121, v121, v122
    v_xor_b32 v123, s23, v75
    v_or_b32 v121, v121, v123
    v_xor_b32 v123, s23, v77
    v_or_b32 v121, v121, v123
    v_xor_b32 v122, s23, v79
    v_or_b32 v121, v121, v122
    v_xor_b32 v122, s23, v81
    v_or_b32 v121, v121, v122
    v_xor_b32 v123, s23, v83
    v_or_b32 v121, v121, v123
    v_xor_b32 v123, s23, v85
    v_or_b32 v121, v121, v123
    v_xor_b32 v122, s23, v87
    v_or_b32 v121, v121, v122
    v_cmp_ne_u32 vcc, 0, v121
    s_cbranch_vccz parallel_sum__ssm_conv_s4__mixer_gmlp__prompt_kernel_spd6
    s_add_u32 s62, s62, 1
    s_cmp_ge_u32 s62, 16384
    s_cbranch_scc1 parallel_sum__ssm_conv_s4__mixer_gmlp__prompt_kernel_spd6
    s_add_u32 s53, s52, 0
    buffer_load_dwordx4 v[56:59], v116, s[24:27], s53 offen sc1
    s_add_u32 s53, s52, 2048
    buffer_load_dwordx4 v[60:63], v116, s[24:27], s53 offen sc1
    s_add_u32 s53, s52, 4096
    buffer_load_dwordx4 v[64:67], v116, s[24:27], s53 offen sc1
    s_add_u32 s53, s52, 6144
    buffer_load_dwordx4 v[68:71], v116, s[24:27], s53 offen sc1
    s_add_u32 s53, s52, 8192
    buffer_load_dwordx4 v[72:75], v116, s[24:27], s53 offen sc1
    s_add_u32 s53, s52, 10240
    buffer_load_dwordx4 v[76:79], v116, s[24:27], s53 offen sc1
    s_add_u32 s53, s52, 12288
    buffer_load_dwordx4 v[80:83], v116, s[24:27], s53 offen sc1
    s_add_u32 s53, s52, 14336
    buffer_load_dwordx4 v[84:87], v116, s[24:27], s53 offen sc1
    s_waitcnt vmcnt(0)
    s_branch parallel_sum__ssm_conv_s4__mixer_gmlp__prompt_kernel_sp5
parallel_sum__ssm_conv_s4__mixer_gmlp__prompt_kernel_spd6:
    v_add_f32 v56, v56, v60
    v_add_f32 v58, v58, v62
    v_add_f32 v56, v56, v64
    v_add_f32 v58, v58, v66
    v_add_f32 v56, v56, v68
    v_add_f32 v58, v58, v70
    v_add_f32 v56, v56, v72
    v_add_f32 v58, v58, v74
    v_add_f32 v56, v56, v76
    v_add_f32 v58, v58, v78
    v_add_f32 v56, v56, v80
    v_add_f32 v58, v58, v82
    v_add_f32 v56, v56, v84
    v_add_f32 v58, v58, v86
    v_mov_b32 v57, v56
    v_mov_b32 v59, v58
    s_nop 0
    v_permlane32_swap_b32 v56, v57
    v_permlane32_swap_b32 v58, v59
    v_add_f32 v56, v56, v57
    v_add_f32 v58, v58, v59
    v_mul_f32 v56, 0.00043402777777777775, v56
    v_mul_f32 v58, 0.00043402777777777775, v58
    v_fma_f32 v58, -v56, v56, v58
    v_max_f32 v58, 0, v58
    v_cvt_pk_bf16_f32 v58, v58, v58
    v_lshlrev_b32 v58, 16, v58
    v_add_f32 v58, 1e-05, v58
    v_cvt_pk_bf16_f32 v58, v58, v58
    v_lshlrev_b32 v58, 16, v58
    v_sqrt_f32 v58, v58
    s_nop 0
    v_cvt_pk_bf16_f32 v58, v58, v58
    v_lshlrev_b32 v58, 16, v58
    v_rcp_f32 v58, v58
    v_cvt_pk_bf16_f32 v56, v56, v56
    v_lshlrev_b32 v56, 16, v56
    v_mul_f32 v56, -v56, v58
    ds_write_b32 v117, v56
    ds_write_b32 v117, v58 offset:512
    s_waitcnt lgkmcnt(0)
    s_barrier
    s_branch fz_loader
fz_l1W:
    v_and_b32 v3, 15, v255
    v_lshrrev_b32 v4, 4, v255
    v_lshrrev_b32 v5, 1, v3
    v_xor_b32 v5, v5, v4
    v_lshlrev_b32 v5, 4, v5
    v_lshl_add_u32 v5, v3, 7, v5
    s_lshl_b32 s32, s57, 12
    v_add_u32 v213, s32, v5
    v_xor_b32 v214, 64, v213
    v_bfe_u32 v5, v255, 2, 2
    v_and_b32 v6, 1, v4
    v_lshl_add_u32 v5, v6, 2, v5
    v_lshrrev_b32 v6, 1, v4
    v_lshl_add_u32 v5, v6, 4, v5
    v_mul_u32_u24 v5, 288, v5
    v_and_b32 v6, 3, v255
    v_lshl_add_u32 v5, v6, 3, v5
    v_add_u32 v215, 16384, v5
    v_mov_b32 v108, 0x3f803f80
    v_mov_b32 v109, 0x3f803f80
    v_mov_b32 v110, 0x3f803f80
    v_mov_b32 v111, 0x3f803f80
    v_mov_b32 v44, 0
    v_mov_b32 v45, 0
    v_mov_b32 v46, 0
    v_mov_b32 v47, 0
    v_mov_b32 v48, 0
    v_mov_b32 v49, 0
    v_mov_b32 v50, 0
    v_mov_b32 v51, 0
    v_mov_b32 v52, 0
    v_mov_b32 v53, 0
    v_mov_b32 v54, 0
    v_mov_b32 v55, 0
    s_lshl_b32 s36, s57, 5
    v_add_u32 v215, s36, v215
    v_mov_b32 v212, v215
    s_mov_b32 s34, 0
    s_mov_b32 s35, 0
    s_add_u32 s24, s4, 38731776
    s_addc_u32 s25, s5, 0
    s_mov_b32 s26, 32768
    s_mov_b32 s27, 0x20000
    s_lshl_b32 s36, s20, 7
    s_and_b32 s37, s57, 1
    s_lshl_b32 s37, s37, 6
    s_add_u32 s36, s36, s37
    s_lshl_b32 s36, s36, 4
    v_lshlrev_b32 v124, 4, v255
    s_sub_u32 s56, 7, s22
    s_lshr_b32 s58, s56, 1
    s_xor_b32 s56, s56, s58
    s_lshl_b32 s58, s2, 1
    s_add_u32 s58, s58, s56
    s_add_u32 s59, s2, 512
    s_cmp_eq_u32 s56, 2
    s_cselect_b32 s58, s59, s58
    s_cmp_eq_u32 s56, 3
    s_cselect_b32 s58, 1000, s58
    s_lshl_b32 s59, s56, 13
    s_add_u32 s59, s59, 139264
    s_waitcnt vmcnt(11) lgkmcnt(0)
    s_barrier
    ds_read_b64_tr_b16 v[56:57], v212 offset:0
    ds_read_b64_tr_b16 v[58:59], v212 offset:2304
    ds_read_b64_tr_b16 v[60:61], v212 offset:128
    ds_read_b64_tr_b16 v[62:63], v212 offset:2432
    ds_read_b64_tr_b16 v[64:65], v212 offset:256
    ds_read_b64_tr_b16 v[66:67], v212 offset:2560
    ds_read_b64_tr_b16 v[68:69], v212 offset:9216
    ds_read_b64_tr_b16 v[70:71], v212 offset:11520
    ds_read_b64_tr_b16 v[72:73], v212 offset:9344
    ds_read_b64_tr_b16 v[74:75], v212 offset:11648
    ds_read_b64_tr_b16 v[76:77], v212 offset:9472
    ds_read_b64_tr_b16 v[78:79], v212 offset:11776
    s_mov_b32 m0, s41
    s_nop 0
    buffer_load_dwordx4 v200, s[12:15], s40 offen lds
    s_add_u32 m0, s41, 1024
    s_nop 0
    buffer_load_dwordx4 v201, s[12:15], s40 offen lds
    s_waitcnt lgkmcnt(0)
    s_add_u32 m0, s41, 2048
    s_nop 0
    buffer_load_dwordx4 v202, s[12:15], s40 offen lds
    v_mfma_f32_16x16x32_bf16 v[44:47], v[108:111], v[56:59], v[44:47]
    s_add_u32 m0, s41, 3072
    s_nop 0
    buffer_load_dwordx4 v203, s[12:15], s40 offen lds
    v_mfma_f32_16x16x32_bf16 v[48:51], v[108:111], v[60:63], v[48:51]
    s_add_u32 m0, s41, 4096
    s_nop 0
    buffer_load_dwordx4 v204, s[12:15], s40 offen lds
    v_mfma_f32_16x16x32_bf16 v[52:55], v[108:111], v[64:67], v[52:55]
    s_add_u32 m0, s41, 5120
    s_nop 0
    buffer_load_dwordx4 v205, s[12:15], s40 offen lds
    v_mfma_f32_16x16x32_bf16 v[44:47], v[108:111], v[68:71], v[44:47]
    s_add_u32 m0, s41, 6144
    s_nop 0
    buffer_load_dwordx4 v206, s[12:15], s40 offen lds
    v_mfma_f32_16x16x32_bf16 v[48:51], v[108:111], v[72:75], v[48:51]
    s_add_u32 m0, s41, 7168
    s_nop 0
    buffer_load_dwordx4 v207, s[12:15], s40 offen lds
    v_mfma_f32_16x16x32_bf16 v[52:55], v[108:111], v[76:79], v[52:55]
    s_add_u32 m0, s41, 8192
    s_nop 0
    buffer_load_dwordx4 v208, s[12:15], s40 offen lds
    s_add_u32 s40, s40, 589824
    s_add_u32 s41, s41, 34816
    s_cmp_ge_u32 s41, 139264
    s_cselect_b32 s41, s44, s41
    s_add_u32 s43, s43, 1
    s_cmp_eq_u32 s43, 9
    s_cselect_b32 s40, 0, s40
    s_mov_b32 m0, s41
    s_nop 0
    buffer_load_dwordx4 v200, s[12:15], s40 offen lds
    s_add_u32 m0, s41, 1024
    s_nop 0
    buffer_load_dwordx4 v201, s[12:15], s40 offen lds
    s_add_u32 m0, s41, 2048
    s_nop 0
    buffer_load_dwordx4 v202, s[12:15], s40 offen lds
    s_add_u32 m0, s41, 3072
    s_nop 0
    buffer_load_dwordx4 v203, s[12:15], s40 offen lds
    s_add_u32 m0, s41, 4096
    s_nop 0
    buffer_load_dwordx4 v204, s[12:15], s40 offen lds
    s_add_u32 m0, s41, 5120
    s_nop 0
    buffer_load_dwordx4 v205, s[12:15], s40 offen lds
    s_add_u32 m0, s41, 6144
    s_nop 0
    buffer_load_dwordx4 v206, s[12:15], s40 offen lds
    s_add_u32 m0, s41, 7168
    s_nop 0
    buffer_load_dwordx4 v207, s[12:15], s40 offen lds
    s_add_u32 m0, s41, 8192
    s_nop 0
    buffer_load_dwordx4 v208, s[12:15], s40 offen lds
    s_add_u32 s40, s40, 589824
    s_add_u32 s41, s41, 34816
    s_cmp_ge_u32 s41, 139264
    s_cselect_b32 s41, s44, s41
    s_add_u32 s43, s43, 1
    s_cmp_eq_u32 s43, 9
    s_cselect_b32 s40, 0, s40
    s_add_u32 s34, s34, 34816
    s_cmp_ge_u32 s34, 139264
    s_cselect_b32 s34, 0, s34
    v_add_u32 v212, s34, v215
    s_add_u32 s35, s35, 1
fz_l1Wa:
    s_waitcnt vmcnt(18) lgkmcnt(0)
    s_barrier
    ds_read_b64_tr_b16 v[56:57], v212 offset:0
    ds_read_b64_tr_b16 v[58:59], v212 offset:2304
    ds_read_b64_tr_b16 v[60:61], v212 offset:128
    ds_read_b64_tr_b16 v[62:63], v212 offset:2432
    ds_read_b64_tr_b16 v[64:65], v212 offset:256
    ds_read_b64_tr_b16 v[66:67], v212 offset:2560
    ds_read_b64_tr_b16 v[68:69], v212 offset:9216
    ds_read_b64_tr_b16 v[70:71], v212 offset:11520
    ds_read_b64_tr_b16 v[72:73], v212 offset:9344
    ds_read_b64_tr_b16 v[74:75], v212 offset:11648
    ds_read_b64_tr_b16 v[76:77], v212 offset:9472
    ds_read_b64_tr_b16 v[78:79], v212 offset:11776
    s_mov_b32 m0, s41
    s_nop 0
    buffer_load_dwordx4 v200, s[12:15], s40 offen lds
    s_add_u32 m0, s41, 1024
    s_nop 0
    buffer_load_dwordx4 v201, s[12:15], s40 offen lds
    s_waitcnt lgkmcnt(0)
    s_add_u32 m0, s41, 2048
    s_nop 0
    buffer_load_dwordx4 v202, s[12:15], s40 offen lds
    v_mfma_f32_16x16x32_bf16 v[44:47], v[108:111], v[56:59], v[44:47]
    s_add_u32 m0, s41, 3072
    s_nop 0
    buffer_load_dwordx4 v203, s[12:15], s40 offen lds
    v_mfma_f32_16x16x32_bf16 v[48:51], v[108:111], v[60:63], v[48:51]
    s_add_u32 m0, s41, 4096
    s_nop 0
    buffer_load_dwordx4 v204, s[12:15], s40 offen lds
    v_mfma_f32_16x16x32_bf16 v[52:55], v[108:111], v[64:67], v[52:55]
    s_add_u32 m0, s41, 5120
    s_nop 0
    buffer_load_dwordx4 v205, s[12:15], s40 offen lds
    v_mfma_f32_16x16x32_bf16 v[44:47], v[108:111], v[68:71], v[44:47]
    s_add_u32 m0, s41, 6144
    s_nop 0
    buffer_load_dwordx4 v206, s[12:15], s40 offen lds
    v_mfma_f32_16x16x32_bf16 v[48:51], v[108:111], v[72:75], v[48:51]
    s_add_u32 m0, s41, 7168
    s_nop 0
    buffer_load_dwordx4 v207, s[12:15], s40 offen lds
    v_mfma_f32_16x16x32_bf16 v[52:55], v[108:111], v[76:79], v[52:55]
    s_add_u32 m0, s41, 8192
    s_nop 0
    buffer_load_dwordx4 v208, s[12:15], s40 offen lds
    s_add_u32 s40, s40, 589824
    s_add_u32 s41, s41, 34816
    s_cmp_ge_u32 s41, 139264
    s_cselect_b32 s41, s44, s41
    s_add_u32 s43, s43, 1
    s_cmp_eq_u32 s43, 9
    s_cselect_b32 s40, 0, s40
    s_add_u32 s34, s34, 34816
    s_cmp_ge_u32 s34, 139264
    s_cselect_b32 s34, 0, s34
    v_add_u32 v212, s34, v215
    s_add_u32 s35, s35, 1
    s_cmp_eq_u32 s35, 2
    s_cbranch_scc0 parallel_sum__ssm_conv_s4__mixer_gmlp__prompt_kernel_gr7
    v_mov_b32 v116, 0
    s_mov_b64 exec, 1
    buffer_store_dwordx4 v[112:115], v116, s[24:27], s63 offen sc1
    s_mov_b64 exec, -1
parallel_sum__ssm_conv_s4__mixer_gmlp__prompt_kernel_gr7:
    s_cmp_lt_u32 s35, 6
    s_cbranch_scc1 fz_l1Wa
    s_waitcnt vmcnt(18) lgkmcnt(0)
    s_barrier
    ds_read_b64_tr_b16 v[56:57], v212 offset:0
    ds_read_b64_tr_b16 v[58:59], v212 offset:2304
    ds_read_b64_tr_b16 v[60:61], v212 offset:128
    ds_read_b64_tr_b16 v[62:63], v212 offset:2432
    ds_read_b64_tr_b16 v[64:65], v212 offset:256
    ds_read_b64_tr_b16 v[66:67], v212 offset:2560
    ds_read_b64_tr_b16 v[68:69], v212 offset:9216
    ds_read_b64_tr_b16 v[70:71], v212 offset:11520
    ds_read_b64_tr_b16 v[72:73], v212 offset:9344
    ds_read_b64_tr_b16 v[74:75], v212 offset:11648
    ds_read_b64_tr_b16 v[76:77], v212 offset:9472
    ds_read_b64_tr_b16 v[78:79], v212 offset:11776
    s_mov_b32 m0, s41
    s_nop 0
    buffer_load_dwordx4 v200, s[12:15], s40 offen lds
    s_add_u32 m0, s41, 1024
    s_nop 0
    buffer_load_dwordx4 v201, s[12:15], s40 offen lds
    s_waitcnt lgkmcnt(0)
    s_add_u32 m0, s41, 2048
    s_nop 0
    buffer_load_dwordx4 v202, s[12:15], s40 offen lds
    v_mfma_f32_16x16x32_bf16 v[44:47], v[108:111], v[56:59], v[44:47]
    s_add_u32 m0, s41, 3072
    s_nop 0
    buffer_load_dwordx4 v203, s[12:15], s40 offen lds
    v_mfma_f32_16x16x32_bf16 v[48:51], v[108:111], v[60:63], v[48:51]
    s_add_u32 m0, s41, 4096
    s_nop 0
    buffer_load_dwordx4 v204, s[12:15], s40 offen lds
    v_mfma_f32_16x16x32_bf16 v[52:55], v[108:111], v[64:67], v[52:55]
    s_add_u32 m0, s41, 5120
    s_nop 0
    buffer_load_dwordx4 v205, s[12:15], s40 offen lds
    v_mfma_f32_16x16x32_bf16 v[44:47], v[108:111], v[68:71], v[44:47]
    s_add_u32 m0, s41, 6144
    s_nop 0
    buffer_load_dwordx4 v206, s[12:15], s40 offen lds
    v_mfma_f32_16x16x32_bf16 v[48:51], v[108:111], v[72:75], v[48:51]
    s_add_u32 m0, s41, 7168
    s_nop 0
    buffer_load_dwordx4 v207, s[12:15], s40 offen lds
    v_mfma_f32_16x16x32_bf16 v[52:55], v[108:111], v[76:79], v[52:55]
    s_add_u32 m0, s41, 8192
    s_nop 0
    buffer_load_dwordx4 v208, s[12:15], s40 offen lds
    s_add_u32 s40, s40, 589824
    s_add_u32 s41, s41, 34816
    s_cmp_ge_u32 s41, 139264
    s_cselect_b32 s41, s44, s41
    s_add_u32 s43, s43, 1
    s_cmp_eq_u32 s43, 9
    s_cselect_b32 s40, 0, s40
    s_add_u32 s34, s34, 34816
    s_cmp_ge_u32 s34, 139264
    s_cselect_b32 s34, 0, s34
    v_add_u32 v212, s34, v215
    s_add_u32 s35, s35, 1
    s_waitcnt vmcnt(18) lgkmcnt(0)
    s_barrier
    ds_read_b64_tr_b16 v[56:57], v212 offset:0
    ds_read_b64_tr_b16 v[58:59], v212 offset:2304
    ds_read_b64_tr_b16 v[60:61], v212 offset:128
    ds_read_b64_tr_b16 v[62:63], v212 offset:2432
    ds_read_b64_tr_b16 v[64:65], v212 offset:256
    ds_read_b64_tr_b16 v[66:67], v212 offset:2560
    ds_read_b64_tr_b16 v[68:69], v212 offset:9216
    ds_read_b64_tr_b16 v[70:71], v212 offset:11520
    ds_read_b64_tr_b16 v[72:73], v212 offset:9344
    ds_read_b64_tr_b16 v[74:75], v212 offset:11648
    ds_read_b64_tr_b16 v[76:77], v212 offset:9472
    ds_read_b64_tr_b16 v[78:79], v212 offset:11776
    s_waitcnt lgkmcnt(0)
    v_mfma_f32_16x16x32_bf16 v[44:47], v[108:111], v[56:59], v[44:47]
    v_mfma_f32_16x16x32_bf16 v[48:51], v[108:111], v[60:63], v[48:51]
    v_mfma_f32_16x16x32_bf16 v[52:55], v[108:111], v[64:67], v[52:55]
    v_mfma_f32_16x16x32_bf16 v[44:47], v[108:111], v[68:71], v[44:47]
    v_mfma_f32_16x16x32_bf16 v[48:51], v[108:111], v[72:75], v[48:51]
    v_mfma_f32_16x16x32_bf16 v[52:55], v[108:111], v[76:79], v[52:55]
    s_add_u32 s34, s34, 34816
    s_cmp_ge_u32 s34, 139264
    s_cselect_b32 s34, 0, s34
    v_add_u32 v212, s34, v215
    s_add_u32 s35, s35, 1
    s_waitcnt vmcnt(9) lgkmcnt(0)
    s_barrier
    ds_read_b64_tr_b16 v[56:57], v212 offset:0
    ds_read_b64_tr_b16 v[58:59], v212 offset:2304
    ds_read_b64_tr_b16 v[60:61], v212 offset:128
    ds_read_b64_tr_b16 v[62:63], v212 offset:2432
    ds_read_b64_tr_b16 v[64:65], v212 offset:256
    ds_read_b64_tr_b16 v[66:67], v212 offset:2560
    ds_read_b64_tr_b16 v[68:69], v212 offset:9216
    ds_read_b64_tr_b16 v[70:71], v212 offset:11520
    ds_read_b64_tr_b16 v[72:73], v212 offset:9344
    ds_read_b64_tr_b16 v[74:75], v212 offset:11648
    ds_read_b64_tr_b16 v[76:77], v212 offset:9472
    ds_read_b64_tr_b16 v[78:79], v212 offset:11776
    s_waitcnt lgkmcnt(0)
    v_mfma_f32_16x16x32_bf16 v[44:47], v[108:111], v[56:59], v[44:47]
    v_mfma_f32_16x16x32_bf16 v[48:51], v[108:111], v[60:63], v[48:51]
    v_mfma_f32_16x16x32_bf16 v[52:55], v[108:111], v[64:67], v[52:55]
    v_mfma_f32_16x16x32_bf16 v[44:47], v[108:111], v[68:71], v[44:47]
    v_mfma_f32_16x16x32_bf16 v[48:51], v[108:111], v[72:75], v[48:51]
    v_mfma_f32_16x16x32_bf16 v[52:55], v[108:111], v[76:79], v[52:55]
    s_add_u32 s34, s34, 34816
    s_cmp_ge_u32 s34, 139264
    s_cselect_b32 s34, 0, s34
    v_add_u32 v212, s34, v215
    s_add_u32 s35, s35, 1
    s_lshl_b32 s33, s57, 6
    s_add_u32 s33, s33, 140288
    v_lshlrev_b32 v116, 2, v255
    v_add_u32 v116, s33, v116
    s_mov_b32 exec_lo, 0xffff
    s_mov_b32 exec_hi, 0x0
    ds_write_b32 v116, v44 offset:0
    ds_write_b32 v116, v48 offset:256
    ds_write_b32 v116, v52 offset:512
    s_mov_b64 exec, -1
    s_waitcnt lgkmcnt(0)
    s_barrier
    s_mov_b32 m0, s41
    s_nop 0
    buffer_load_dwordx4 v200, s[12:15], s40 offen lds
    s_add_u32 m0, s41, 1024
    s_nop 0
    buffer_load_dwordx4 v201, s[12:15], s40 offen lds
    s_add_u32 m0, s41, 2048
    s_nop 0
    buffer_load_dwordx4 v202, s[12:15], s40 offen lds
    s_add_u32 m0, s41, 3072
    s_nop 0
    buffer_load_dwordx4 v203, s[12:15], s40 offen lds
    s_add_u32 m0, s41, 4096
    s_nop 0
    buffer_load_dwordx4 v204, s[12:15], s40 offen lds
    s_add_u32 m0, s41, 5120
    s_nop 0
    buffer_load_dwordx4 v205, s[12:15], s40 offen lds
    s_add_u32 m0, s41, 6144
    s_nop 0
    buffer_load_dwordx4 v206, s[12:15], s40 offen lds
    s_add_u32 m0, s41, 7168
    s_nop 0
    buffer_load_dwordx4 v207, s[12:15], s40 offen lds
    s_add_u32 m0, s41, 8192
    s_nop 0
    buffer_load_dwordx4 v208, s[12:15], s40 offen lds
    s_add_u32 s40, s40, 589824
    s_add_u32 s41, s41, 34816
    s_cmp_ge_u32 s41, 139264
    s_cselect_b32 s41, s44, s41
    s_add_u32 s43, s43, 1
    s_cmp_eq_u32 s43, 9
    s_cselect_b32 s40, 0, s40
    s_mov_b32 m0, s41
    s_nop 0
    buffer_load_dwordx4 v200, s[12:15], s40 offen lds
    s_add_u32 m0, s41, 1024
    s_nop 0
    buffer_load_dwordx4 v201, s[12:15], s40 offen lds
    s_add_u32 m0, s41, 2048
    s_nop 0
    buffer_load_dwordx4 v202, s[12:15], s40 offen lds
    s_add_u32 m0, s41, 3072
    s_nop 0
    buffer_load_dwordx4 v203, s[12:15], s40 offen lds
    s_add_u32 m0, s41, 4096
    s_nop 0
    buffer_load_dwordx4 v204, s[12:15], s40 offen lds
    s_add_u32 m0, s41, 5120
    s_nop 0
    buffer_load_dwordx4 v205, s[12:15], s40 offen lds
    s_add_u32 m0, s41, 6144
    s_nop 0
    buffer_load_dwordx4 v206, s[12:15], s40 offen lds
    s_add_u32 m0, s41, 7168
    s_nop 0
    buffer_load_dwordx4 v207, s[12:15], s40 offen lds
    s_add_u32 m0, s41, 8192
    s_nop 0
    buffer_load_dwordx4 v208, s[12:15], s40 offen lds
    s_add_u32 s40, s40, 589824
    s_add_u32 s41, s41, 34816
    s_cmp_ge_u32 s41, 139264
    s_cselect_b32 s41, s44, s41
    s_add_u32 s43, s43, 1
    s_cmp_eq_u32 s43, 9
    s_cselect_b32 s40, 0, s40
    s_mov_b32 m0, s41
    s_nop 0
    buffer_load_dwordx4 v200, s[12:15], s40 offen lds
    s_add_u32 m0, s41, 1024
    s_nop 0
    buffer_load_dwordx4 v201, s[12:15], s40 offen lds
    s_add_u32 m0, s41, 2048
    s_nop 0
    buffer_load_dwordx4 v202, s[12:15], s40 offen lds
    s_add_u32 m0, s41, 3072
    s_nop 0
    buffer_load_dwordx4 v203, s[12:15], s40 offen lds
    s_add_u32 m0, s41, 4096
    s_nop 0
    buffer_load_dwordx4 v204, s[12:15], s40 offen lds
    s_add_u32 m0, s41, 5120
    s_nop 0
    buffer_load_dwordx4 v205, s[12:15], s40 offen lds
    s_add_u32 m0, s41, 6144
    s_nop 0
    buffer_load_dwordx4 v206, s[12:15], s40 offen lds
    s_add_u32 m0, s41, 7168
    s_nop 0
    buffer_load_dwordx4 v207, s[12:15], s40 offen lds
    s_add_u32 m0, s41, 8192
    s_nop 0
    buffer_load_dwordx4 v208, s[12:15], s40 offen lds
    s_add_u32 s40, s40, 589824
    s_add_u32 s41, s41, 34816
    s_cmp_ge_u32 s41, 139264
    s_cselect_b32 s41, s44, s41
    s_add_u32 s43, s43, 1
    s_cmp_eq_u32 s43, 9
    s_cselect_b32 s40, 0, s40
    s_add_u32 s24, s4, 28311552
    s_addc_u32 s25, s5, 0
    s_mov_b32 s26, 2359296
    s_mov_b32 s27, 0x20000
    s_lshl_b32 s36, s20, 1
    s_lshr_b32 s33, s21, 3
    s_add_u32 s36, s36, s33
    s_and_b32 s37, s21, 7
    s_lshl_b32 s33, s36, 1
    s_add_u32 s33, s33, s57
    s_mul_i32 s33, s33, 36864
    s_mul_i32 s38, s37, 144
    s_add_u32 s33, s33, s38
    s_mov_b32 s38, 7282
    s_mul_i32 s39, s57, 5120
    s_add_u32 s39, s39, 143104
    v_add_u32 v3, 0, v255
    v_mul_lo_u32 v4, v3, s38
    v_lshrrev_b32 v4, 16, v4
    v_mul_u32_u24 v5, 9, v4
    v_sub_u32 v5, v3, v5
    v_mul_u32_u24 v4, 1152, v4
    v_lshl_add_u32 v4, v5, 4, v4
    s_add_u32 m0, s39, 0
    s_nop 0
    buffer_load_dwordx4 v4, s[24:27], s33 offen sc1 lds
    v_add_u32 v3, 64, v255
    v_mul_lo_u32 v4, v3, s38
    v_lshrrev_b32 v4, 16, v4
    v_mul_u32_u24 v5, 9, v4
    v_sub_u32 v5, v3, v5
    v_mul_u32_u24 v4, 1152, v4
    v_lshl_add_u32 v4, v5, 4, v4
    s_add_u32 m0, s39, 1024
    s_nop 0
    buffer_load_dwordx4 v4, s[24:27], s33 offen sc1 lds
    v_add_u32 v3, 128, v255
    v_mul_lo_u32 v4, v3, s38
    v_lshrrev_b32 v4, 16, v4
    v_mul_u32_u24 v5, 9, v4
    v_sub_u32 v5, v3, v5
    v_mul_u32_u24 v4, 1152, v4
    v_lshl_add_u32 v4, v5, 4, v4
    s_add_u32 m0, s39, 2048
    s_nop 0
    buffer_load_dwordx4 v4, s[24:27], s33 offen sc1 lds
    v_add_u32 v3, 192, v255
    v_mul_lo_u32 v4, v3, s38
    v_lshrrev_b32 v4, 16, v4
    v_mul_u32_u24 v5, 9, v4
    v_sub_u32 v5, v3, v5
    v_mul_u32_u24 v4, 1152, v4
    v_lshl_add_u32 v4, v5, 4, v4
    s_add_u32 m0, s39, 3072
    s_nop 0
    buffer_load_dwordx4 v4, s[24:27], s33 offen sc1 lds
    v_add_u32 v3, 256, v255
    v_mul_lo_u32 v4, v3, s38
    v_lshrrev_b32 v4, 16, v4
    v_mul_u32_u24 v5, 9, v4
    v_sub_u32 v5, v3, v5
    v_mul_u32_u24 v4, 1152, v4
    v_lshl_add_u32 v4, v5, 4, v4
    s_add_u32 m0, s39, 4096
    s_nop 0
    buffer_load_dwordx4 v4, s[24:27], s33 offen sc1 lds
    s_add_u32 s24, s4, 30670848
    s_addc_u32 s25, s5, 0
    s_mov_b32 s26, 2359296
    s_mov_b32 s27, 0x20000
    v_bfe_u32 v3, v255, 2, 2
    v_lshrrev_b32 v4, 4, v255
    v_lshl_add_u32 v3, v4, 3, v3
    v_mul_u32_u24 v3, 144, v3
    v_and_b32 v5, 3, v255
    v_lshl_add_u32 v3, v5, 3, v3
    v_add_u32 v3, s39, v3
    v_and_b32 v5, 15, v255
    v_lshlrev_b32 v5, 12, v5
    v_lshl_add_u32 v5, v4, 4, v5
    s_mul_i32 s39, s37, 294912
    s_lshl_b32 s38, s36, 7
    s_add_u32 s39, s39, s38
    s_lshl_b32 s38, s57, 6
    s_add_u32 s39, s39, s38
    s_lshl_b32 s37, s37, 5
    s_add_u32 s36, s36, s37
    s_lshl_b32 s36, s36, 1
    s_add_u32 s36, s36, s57
    s_lshl_b32 s36, s36, 2
    s_add_u32 s36, s36, 24576
    s_waitcnt vmcnt(32)
    s_barrier
    s_add_u32 s28, s4, 38141952
    s_addc_u32 s29, s5, 0
    s_mov_b32 s30, 524288
    s_mov_b32 s31, 0x20000
    v_and_b32 v116, 31, v255
    v_lshlrev_b32 v117, 2, v116
    s_lshl_b32 s33, s57, 8
    s_add_u32 s33, s33, 141824
    v_add_u32 v117, s33, v117
    ds_read_b32 v120, v117
    ds_read_b32 v122, v117 offset:128
    v_mov_b32 v121, s23
    v_mov_b32 v123, s23
    s_lshl_b32 s33, s20, 4
    s_add_u32 s33, s33, s21
    s_lshl_b32 s33, s33, 11
    s_lshl_b32 s53, s57, 9
    s_add_u32 s33, s33, s53
    v_lshlrev_b32 v116, 4, v116
    s_waitcnt lgkmcnt(0)
    s_mov_b32 exec_lo, 0xffffffff
    s_mov_b32 exec_hi, 0x0
    buffer_store_dwordx4 v[120:123], v116, s[28:31], s33 offen sc1
    s_mov_b64 exec, -1
    v_lshrrev_b32 v46, 2, v255
    v_and_b32 v47, 3, v255
    v_lshlrev_b32 v47, 2, v47
    v_lshl_add_u32 v46, v46, 4, v47
    v_add_u32 v46, s59, v46
    v_xor_b32 v150, 0, v46
    v_xor_b32 v151, 16, v46
    v_xor_b32 v152, 32, v46
    v_xor_b32 v153, 48, v46
    v_xor_b32 v154, 64, v46
    v_xor_b32 v155, 80, v46
    v_xor_b32 v156, 96, v46
    v_xor_b32 v157, 112, v46
    v_xor_b32 v158, 128, v46
    v_xor_b32 v159, 144, v46
    v_xor_b32 v160, 160, v46
    v_xor_b32 v161, 176, v46
    v_xor_b32 v162, 192, v46
    v_xor_b32 v163, 208, v46
    v_xor_b32 v164, 224, v46
    v_xor_b32 v165, 240, v46
    v_and_b32 v166, 15, v255
    v_lshrrev_b32 v167, 4, v255
    v_add_u32 v46, 0, v167
    v_xor_b32 v46, v46, v166
    v_lshlrev_b32 v46, 4, v46
    v_lshl_add_u32 v46, v166, 8, v46
    v_add_u32 v140, s59, v46
    v_add_u32 v46, 4, v167
    v_xor_b32 v46, v46, v166
    v_lshlrev_b32 v46, 4, v46
    v_lshl_add_u32 v46, v166, 8, v46
    v_add_u32 v141, s59, v46
    v_add_u32 v46, 8, v167
    v_xor_b32 v46, v46, v166
    v_lshlrev_b32 v46, 4, v46
    v_lshl_add_u32 v46, v166, 8, v46
    v_add_u32 v142, s59, v46
    v_add_u32 v46, 12, v167
    v_xor_b32 v46, v46, v166
    v_lshlrev_b32 v46, 4, v46
    v_lshl_add_u32 v46, v166, 8, v46
    v_add_u32 v143, s59, v46
    s_add_u32 s35, s35, 1
    s_waitcnt vmcnt(23)
    s_barrier
    s_mov_b32 m0, s41
    s_nop 0
    buffer_load_dwordx4 v200, s[12:15], s40 offen lds
    s_add_u32 m0, s41, 1024
    s_nop 0
    buffer_load_dwordx4 v201, s[12:15], s40 offen lds
    s_add_u32 m0, s41, 2048
    s_nop 0
    buffer_load_dwordx4 v202, s[12:15], s40 offen lds
    s_add_u32 m0, s41, 3072
    s_nop 0
    buffer_load_dwordx4 v203, s[12:15], s40 offen lds
    s_add_u32 m0, s41, 4096
    s_nop 0
    buffer_load_dwordx4 v204, s[12:15], s40 offen lds
    s_add_u32 m0, s41, 5120
    s_nop 0
    buffer_load_dwordx4 v205, s[12:15], s40 offen lds
    s_add_u32 m0, s41, 6144
    s_nop 0
    buffer_load_dwordx4 v206, s[12:15], s40 offen lds
    s_add_u32 m0, s41, 7168
    s_nop 0
    buffer_load_dwordx4 v207, s[12:15], s40 offen lds
    s_add_u32 m0, s41, 8192
    s_nop 0
    buffer_load_dwordx4 v208, s[12:15], s40 offen lds
    s_add_u32 s40, s40, 589824
    s_add_u32 s41, s41, 34816
    s_cmp_ge_u32 s41, 139264
    s_cselect_b32 s41, s44, s41
    s_add_u32 s43, s43, 1
    s_cmp_eq_u32 s43, 9
    s_cselect_b32 s40, 0, s40
    s_waitcnt vmcnt(9)
    ds_read_b64_tr_b16 v[56:57], v3 offset:0
    ds_read_b64_tr_b16 v[58:59], v3 offset:576
    ds_read_b64_tr_b16 v[60:61], v3 offset:32
    ds_read_b64_tr_b16 v[62:63], v3 offset:608
    ds_read_b64_tr_b16 v[64:65], v3 offset:64
    ds_read_b64_tr_b16 v[66:67], v3 offset:640
    ds_read_b64_tr_b16 v[68:69], v3 offset:96
    ds_read_b64_tr_b16 v[70:71], v3 offset:672
    ds_read_b64_tr_b16 v[72:73], v3 offset:128
    ds_read_b64_tr_b16 v[74:75], v3 offset:704
    s_waitcnt lgkmcnt(0)
    buffer_store_dwordx4 v[56:59], v5, s[24:27], s39 offen sc1
    s_add_u32 s39, s39, 65536
    buffer_store_dwordx4 v[60:63], v5, s[24:27], s39 offen sc1
    s_add_u32 s39, s39, 65536
    buffer_store_dwordx4 v[64:67], v5, s[24:27], s39 offen sc1
    s_add_u32 s39, s39, 65536
    buffer_store_dwordx4 v[68:71], v5, s[24:27], s39 offen sc1
    s_add_u32 s39, s39, 65536
    s_mov_b32 exec_lo, 0xff00ff
    s_mov_b32 exec_hi, 0xff00ff
    buffer_store_dwordx4 v[72:75], v5, s[24:27], s39 offen sc1
    s_add_u32 s39, s39, 65536
    s_mov_b64 exec, -1
    v_mov_b32 v46, v166
    v_and_b32 v47, 15, v46
    v_xor_b32 v47, v47, v167
    v_lshlrev_b32 v47, 4, v47
    v_lshl_add_u32 v46, v46, 8, v47
    v_add_u32 v182, s59, v46
    v_add_u32 v46, 0, v166
    v_bfe_u32 v46, v46, 1, 1
    v_add3_u32 v46, v46, v166, 0
    v_and_b32 v46, 254, v46
    v_and_b32 v47, 15, v46
    v_xor_b32 v47, v47, v167
    v_lshlrev_b32 v47, 4, v47
    v_lshl_add_u32 v46, v46, 8, v47
    v_add_u32 v183, s59, v46
    v_add_u32 v46, 0, v166
    v_bfe_u32 v46, v46, 2, 1
    v_add3_u32 v46, v46, v166, 1
    v_and_b32 v46, 252, v46
    v_lshrrev_b32 v47, 2, v46
    v_add_u32 v47, 12, v47
    v_min_u32 v46, v46, v47
    v_and_b32 v47, 15, v46
    v_xor_b32 v47, v47, v167
    v_lshlrev_b32 v47, 4, v47
    v_lshl_add_u32 v46, v46, 8, v47
    v_add_u32 v184, s59, v46
    v_add_u32 v46, 16, v166
    v_bfe_u32 v46, v46, 2, 1
    v_add3_u32 v46, v46, v166, 17
    v_and_b32 v46, 252, v46
    v_lshrrev_b32 v47, 2, v46
    v_add_u32 v47, 12, v47
    v_min_u32 v46, v46, v47
    v_and_b32 v47, 15, v46
    v_xor_b32 v47, v47, v167
    v_lshlrev_b32 v47, 4, v47
    v_lshl_add_u32 v46, v46, 8, v47
    v_add_u32 v185, s59, v46
    s_add_u32 s35, s35, 1
    s_waitcnt vmcnt(18)
    s_barrier
    s_mov_b32 m0, s41
    s_nop 0
    buffer_load_dwordx4 v200, s[12:15], s40 offen lds
    s_add_u32 m0, s41, 1024
    s_nop 0
    buffer_load_dwordx4 v201, s[12:15], s40 offen lds
    s_add_u32 m0, s41, 2048
    s_nop 0
    buffer_load_dwordx4 v202, s[12:15], s40 offen lds
    s_add_u32 m0, s41, 3072
    s_nop 0
    buffer_load_dwordx4 v203, s[12:15], s40 offen lds
    s_add_u32 m0, s41, 4096
    s_nop 0
    buffer_load_dwordx4 v204, s[12:15], s40 offen lds
    s_add_u32 m0, s41, 5120
    s_nop 0
    buffer_load_dwordx4 v205, s[12:15], s40 offen lds
    s_add_u32 m0, s41, 6144
    s_nop 0
    buffer_load_dwordx4 v206, s[12:15], s40 offen lds
    s_add_u32 m0, s41, 7168
    s_nop 0
    buffer_load_dwordx4 v207, s[12:15], s40 offen lds
    s_add_u32 m0, s41, 8192
    s_nop 0
    buffer_load_dwordx4 v208, s[12:15], s40 offen lds
    s_add_u32 s40, s40, 589824
    s_add_u32 s41, s41, 34816
    s_cmp_ge_u32 s41, 139264
    s_cselect_b32 s41, s44, s41
    s_add_u32 s43, s43, 1
    s_cmp_eq_u32 s43, 9
    s_cselect_b32 s40, 0, s40
    v_add_u32 v46, 32, v166
    v_bfe_u32 v46, v46, 2, 1
    v_add3_u32 v46, v46, v166, 33
    v_and_b32 v46, 252, v46
    v_lshrrev_b32 v47, 2, v46
    v_add_u32 v47, 12, v47
    v_min_u32 v46, v46, v47
    v_and_b32 v47, 15, v46
    v_xor_b32 v47, v47, v167
    v_lshlrev_b32 v47, 4, v47
    v_lshl_add_u32 v46, v46, 8, v47
    v_add_u32 v186, s59, v46
    v_add_u32 v46, 48, v166
    v_bfe_u32 v46, v46, 2, 1
    v_add3_u32 v46, v46, v166, 49
    v_and_b32 v46, 252, v46
    v_lshrrev_b32 v47, 2, v46
    v_add_u32 v47, 12, v47
    v_min_u32 v46, v46, v47
    v_and_b32 v47, 15, v46
    v_xor_b32 v47, v47, v167
    v_lshlrev_b32 v47, 4, v47
    v_lshl_add_u32 v46, v46, 8, v47
    v_add_u32 v187, s59, v46
    v_add_u32 v46, 0, v166
    v_bfe_u32 v46, v46, 3, 1
    v_add3_u32 v46, v46, v166, 3
    v_and_b32 v46, 248, v46
    v_lshrrev_b32 v47, 2, v46
    v_add_u32 v47, 12, v47
    v_min_u32 v46, v46, v47
    v_and_b32 v47, 15, v46
    v_xor_b32 v47, v47, v167
    v_lshlrev_b32 v47, 4, v47
    v_lshl_add_u32 v46, v46, 8, v47
    v_add_u32 v188, s59, v46
    s_add_u32 s35, s35, 1
    s_waitcnt vmcnt(18)
    s_barrier
    s_mov_b32 m0, s41
    s_nop 0
    buffer_load_dwordx4 v200, s[12:15], s40 offen lds
    s_add_u32 m0, s41, 1024
    s_nop 0
    buffer_load_dwordx4 v201, s[12:15], s40 offen lds
    s_add_u32 m0, s41, 2048
    s_nop 0
    buffer_load_dwordx4 v202, s[12:15], s40 offen lds
    s_add_u32 m0, s41, 3072
    s_nop 0
    buffer_load_dwordx4 v203, s[12:15], s40 offen lds
    s_add_u32 m0, s41, 4096
    s_nop 0
    buffer_load_dwordx4 v204, s[12:15], s40 offen lds
    s_add_u32 m0, s41, 5120
    s_nop 0
    buffer_load_dwordx4 v205, s[12:15], s40 offen lds
    s_add_u32 m0, s41, 6144
    s_nop 0
    buffer_load_dwordx4 v206, s[12:15], s40 offen lds
    s_add_u32 m0, s41, 7168
    s_nop 0
    buffer_load_dwordx4 v207, s[12:15], s40 offen lds
    s_add_u32 m0, s41, 8192
    s_nop 0
    buffer_load_dwordx4 v208, s[12:15], s40 offen lds
    s_add_u32 s40, s40, 589824
    s_add_u32 s41, s41, 34816
    s_cmp_ge_u32 s41, 139264
    s_cselect_b32 s41, s44, s41
    s_add_u32 s43, s43, 1
    s_cmp_eq_u32 s43, 9
    s_cselect_b32 s40, 0, s40
    v_add_u32 v46, 16, v166
    v_bfe_u32 v46, v46, 3, 1
    v_add3_u32 v46, v46, v166, 19
    v_and_b32 v46, 248, v46
    v_lshrrev_b32 v47, 2, v46
    v_add_u32 v47, 12, v47
    v_min_u32 v46, v46, v47
    v_and_b32 v47, 15, v46
    v_xor_b32 v47, v47, v167
    v_lshlrev_b32 v47, 4, v47
    v_lshl_add_u32 v46, v46, 8, v47
    v_add_u32 v189, s59, v46
    v_add_u32 v46, 32, v166
    v_bfe_u32 v46, v46, 3, 1
    v_add3_u32 v46, v46, v166, 35
    v_and_b32 v46, 248, v46
    v_lshrrev_b32 v47, 2, v46
    v_add_u32 v47, 12, v47
    v_min_u32 v46, v46, v47
    v_and_b32 v47, 15, v46
    v_xor_b32 v47, v47, v167
    v_lshlrev_b32 v47, 4, v47
    v_lshl_add_u32 v46, v46, 8, v47
    v_add_u32 v190, s59, v46
    v_add_u32 v46, 48, v166
    v_bfe_u32 v46, v46, 3, 1
    v_add3_u32 v46, v46, v166, 51
    v_and_b32 v46, 248, v46
    v_lshrrev_b32 v47, 2, v46
    v_add_u32 v47, 12, v47
    v_min_u32 v46, v46, v47
    v_and_b32 v47, 15, v46
    v_xor_b32 v47, v47, v167
    v_lshlrev_b32 v47, 4, v47
    v_lshl_add_u32 v46, v46, 8, v47
    v_add_u32 v191, s59, v46
    s_add_u32 s35, s35, 1
    s_waitcnt vmcnt(18)
    s_barrier
    s_mov_b32 m0, s41
    s_nop 0
    buffer_load_dwordx4 v200, s[12:15], s40 offen lds
    s_add_u32 m0, s41, 1024
    s_nop 0
    buffer_load_dwordx4 v201, s[12:15], s40 offen lds
    s_add_u32 m0, s41, 2048
    s_nop 0
    buffer_load_dwordx4 v202, s[12:15], s40 offen lds
    s_add_u32 m0, s41, 3072
    s_nop 0
    buffer_load_dwordx4 v203, s[12:15], s40 offen lds
    s_add_u32 m0, s41, 4096
    s_nop 0
    buffer_load_dwordx4 v204, s[12:15], s40 offen lds
    s_add_u32 m0, s41, 5120
    s_nop 0
    buffer_load_dwordx4 v205, s[12:15], s40 offen lds
    s_add_u32 m0, s41, 6144
    s_nop 0
    buffer_load_dwordx4 v206, s[12:15], s40 offen lds
    s_add_u32 m0, s41, 7168
    s_nop 0
    buffer_load_dwordx4 v207, s[12:15], s40 offen lds
    s_add_u32 m0, s41, 8192
    s_nop 0
    buffer_load_dwordx4 v208, s[12:15], s40 offen lds
    s_add_u32 s40, s40, 589824
    s_add_u32 s41, s41, 34816
    s_cmp_ge_u32 s41, 139264
    s_cselect_b32 s41, s44, s41
    s_add_u32 s43, s43, 1
    s_cmp_eq_u32 s43, 9
    s_cselect_b32 s40, 0, s40
    s_add_u32 s35, s35, 1
    v_mov_b32 v116, 0
    v_mov_b32 v117, s23
    s_mov_b64 exec, 1
    buffer_store_dword v117, v116, s[16:19], s36 offen sc1
    s_mov_b64 exec, -1
parallel_sum__ssm_conv_s4__mixer_gmlp__prompt_kernel_xf8:
    s_waitcnt vmcnt(18)
    s_barrier
    s_mov_b32 m0, s41
    s_nop 0
    buffer_load_dwordx4 v200, s[12:15], s40 offen lds
    s_add_u32 m0, s41, 1024
    s_nop 0
    buffer_load_dwordx4 v201, s[12:15], s40 offen lds
    s_add_u32 m0, s41, 2048
    s_nop 0
    buffer_load_dwordx4 v202, s[12:15], s40 offen lds
    s_add_u32 m0, s41, 3072
    s_nop 0
    buffer_load_dwordx4 v203, s[12:15], s40 offen lds
    s_add_u32 m0, s41, 4096
    s_nop 0
    buffer_load_dwordx4 v204, s[12:15], s40 offen lds
    s_add_u32 m0, s41, 5120
    s_nop 0
    buffer_load_dwordx4 v205, s[12:15], s40 offen lds
    s_add_u32 m0, s41, 6144
    s_nop 0
    buffer_load_dwordx4 v206, s[12:15], s40 offen lds
    s_add_u32 m0, s41, 7168
    s_nop 0
    buffer_load_dwordx4 v207, s[12:15], s40 offen lds
    s_add_u32 m0, s41, 8192
    s_nop 0
    buffer_load_dwordx4 v208, s[12:15], s40 offen lds
    s_add_u32 s40, s40, 589824
    s_add_u32 s41, s41, 34816
    s_cmp_ge_u32 s41, 139264
    s_cselect_b32 s41, s44, s41
    s_add_u32 s43, s43, 1
    s_cmp_eq_u32 s43, 9
    s_cselect_b32 s40, 0, s40
    s_add_u32 s35, s35, 1
    s_load_dwordx4 s[24:27], s[0:1], 8
    s_load_dwordx4 s[28:31], s[0:1], 24
    s_load_dwordx4 s[32:35], s[0:1], 40
    s_load_dwordx4 s[36:39], s[0:1], 56
    s_min_u32 s42, s58, 575
    v_lshlrev_b32 v1, 1, v255
    s_lshl_b32 s43, s42, 8
    v_add_u32 v1, s43, v1
    s_lshl_b32 s43, s42, 1
    v_mov_b32 v2, s43
    s_waitcnt lgkmcnt(0)
    global_load_ushort v170, v1, s[24:25] offset:0
    global_load_ushort v171, v1, s[26:27] offset:0
    global_load_ushort v172, v1, s[28:29] offset:0
    global_load_ushort v173, v1, s[30:31] offset:0
    global_load_ushort v174, v1, s[32:33] offset:0
    global_load_ushort v175, v1, s[34:35] offset:0
    global_load_ushort v176, v1, s[24:25] offset:128
    global_load_ushort v177, v1, s[26:27] offset:128
    global_load_ushort v178, v1, s[28:29] offset:128
    global_load_ushort v179, v1, s[30:31] offset:128
    global_load_ushort v180, v1, s[32:33] offset:128
    global_load_ushort v181, v1, s[34:35] offset:128
    global_load_ushort v196, v2, s[36:37]
    global_load_ushort v197, v2, s[38:39]
    s_waitcnt vmcnt(32)
    s_barrier
    s_add_u32 s35, s35, 1
    s_add_u32 s24, s4, 38141952
    s_addc_u32 s25, s5, 0
    s_mov_b32 s26, 524288
    s_mov_b32 s27, 0x20000
    v_and_b32 v116, 31, v255
    v_lshlrev_b32 v117, 2, v116
    v_lshlrev_b32 v116, 4, v116
    v_lshrrev_b32 v118, 5, v255
    v_lshl_add_u32 v116, v118, 14, v116
    s_lshl_b32 s52, s20, 15
    s_lshl_b32 s53, s57, 9
    s_add_u32 s52, s52, s53
    s_lshl_b32 s33, s57, 7
    s_add_u32 s33, s33, 139264
    v_add_u32 v117, s33, v117
    s_mov_b32 s62, 0
    s_add_u32 s53, s52, 0
    buffer_load_dwordx4 v[56:59], v116, s[24:27], s53 offen sc1
    s_add_u32 s53, s52, 2048
    buffer_load_dwordx4 v[60:63], v116, s[24:27], s53 offen sc1
    s_add_u32 s53, s52, 4096
    buffer_load_dwordx4 v[64:67], v116, s[24:27], s53 offen sc1
    s_add_u32 s53, s52, 6144
    buffer_load_dwordx4 v[68:71], v116, s[24:27], s53 offen sc1
    s_add_u32 s53, s52, 8192
    buffer_load_dwordx4 v[72:75], v116, s[24:27], s53 offen sc1
    s_add_u32 s53, s52, 10240
    buffer_load_dwordx4 v[76:79], v116, s[24:27], s53 offen sc1
    s_add_u32 s53, s52, 12288
    buffer_load_dwordx4 v[80:83], v116, s[24:27], s53 offen sc1
    s_add_u32 s53, s52, 14336
    buffer_load_dwordx4 v[84:87], v116, s[24:27], s53 offen sc1
    s_waitcnt vmcnt(31)
    s_barrier
    s_add_u32 s35, s35, 1
    s_load_dwordx2 s[6:7], s[0:1], 88
    v_lshrrev_b32 v3, 3, v255
    v_and_b32 v4, 7, v255
    v_lshrrev_b32 v5, 4, v255
    v_xor_b32 v4, v4, v5
    v_and_b32 v5, 1, v4
    v_lshlrev_b32 v5, 1, v5
    v_bfe_u32 v6, v4, 1, 1
    v_and_b32 v4, 4, v4
    v_or_b32 v4, v4, v5
    v_or_b32 v4, v4, v6
    v_lshlrev_b32 v4, 4, v4
    v_lshl_add_u32 v4, v3, 12, v4
    s_lshl_b32 s33, s20, 19
    v_add_u32 v4, s33, v4
    v_xor_b32 v5, 64, v4
    s_lshl_b32 s45, s20, 8
    s_mov_b32 s40, s45
    s_mov_b32 s44, 18432
    s_mov_b32 s41, 18432
    s_mov_b32 s43, 0
    s_mov_b32 s42, -1
    v_add_u32 v220, 0, v4
    v_add_u32 v221, 32768, v5
    v_add_u32 v222, 65536, v4
    v_add_u32 v223, 98304, v5
    v_add_u32 v224, 131072, v4
    v_add_u32 v225, 163840, v5
    v_add_u32 v226, 196608, v4
    v_add_u32 v227, 229376, v5
    v_add_u32 v228, 262144, v4
    v_add_u32 v229, 294912, v5
    v_add_u32 v230, 327680, v4
    v_add_u32 v231, 360448, v5
    v_add_u32 v232, 393216, v4
    v_add_u32 v233, 425984, v5
    v_add_u32 v234, 458752, v4
    v_add_u32 v235, 491520, v5
    s_waitcnt lgkmcnt(0)
    s_mov_b32 s12, s6
    s_mov_b32 s13, s7
    s_mov_b32 s14, 8388608
    s_mov_b32 s15, 0x20000
    s_waitcnt vmcnt(0)
    s_barrier
    s_add_u32 s35, s35, 1
parallel_sum__ssm_conv_s4__mixer_gmlp__prompt_kernel_sp9:
    v_xor_b32 v121, s23, v57
    v_xor_b32 v123, s23, v59
    v_or_b32 v121, v121, v123
    v_xor_b32 v123, s23, v61
    v_or_b32 v121, v121, v123
    v_xor_b32 v122, s23, v63
    v_or_b32 v121, v121, v122
    v_xor_b32 v122, s23, v65
    v_or_b32 v121, v121, v122
    v_xor_b32 v123, s23, v67
    v_or_b32 v121, v121, v123
    v_xor_b32 v123, s23, v69
    v_or_b32 v121, v121, v123
    v_xor_b32 v122, s23, v71
    v_or_b32 v121, v121, v122
    v_xor_b32 v122, s23, v73
    v_or_b32 v121, v121, v122
    v_xor_b32 v123, s23, v75
    v_or_b32 v121, v121, v123
    v_xor_b32 v123, s23, v77
    v_or_b32 v121, v121, v123
    v_xor_b32 v122, s23, v79
    v_or_b32 v121, v121, v122
    v_xor_b32 v122, s23, v81
    v_or_b32 v121, v121, v122
    v_xor_b32 v123, s23, v83
    v_or_b32 v121, v121, v123
    v_xor_b32 v123, s23, v85
    v_or_b32 v121, v121, v123
    v_xor_b32 v122, s23, v87
    v_or_b32 v121, v121, v122
    v_cmp_ne_u32 vcc, 0, v121
    s_cbranch_vccz parallel_sum__ssm_conv_s4__mixer_gmlp__prompt_kernel_spd10
    s_add_u32 s62, s62, 1
    s_cmp_ge_u32 s62, 16384
    s_cbranch_scc1 parallel_sum__ssm_conv_s4__mixer_gmlp__prompt_kernel_spd10
    s_add_u32 s53, s52, 0
    buffer_load_dwordx4 v[56:59], v116, s[24:27], s53 offen sc1
    s_add_u32 s53, s52, 2048
    buffer_load_dwordx4 v[60:63], v116, s[24:27], s53 offen sc1
    s_add_u32 s53, s52, 4096
    buffer_load_dwordx4 v[64:67], v116, s[24:27], s53 offen sc1
    s_add_u32 s53, s52, 6144
    buffer_load_dwordx4 v[68:71], v116, s[24:27], s53 offen sc1
    s_add_u32 s53, s52, 8192
    buffer_load_dwordx4 v[72:75], v116, s[24:27], s53 offen sc1
    s_add_u32 s53, s52, 10240
    buffer_load_dwordx4 v[76:79], v116, s[24:27], s53 offen sc1
    s_add_u32 s53, s52, 12288
    buffer_load_dwordx4 v[80:83], v116, s[24:27], s53 offen sc1
    s_add_u32 s53, s52, 14336
    buffer_load_dwordx4 v[84:87], v116, s[24:27], s53 offen sc1
    s_waitcnt vmcnt(0)
    s_branch parallel_sum__ssm_conv_s4__mixer_gmlp__prompt_kernel_sp9
parallel_sum__ssm_conv_s4__mixer_gmlp__prompt_kernel_spd10:
    v_add_f32 v56, v56, v60
    v_add_f32 v58, v58, v62
    v_add_f32 v56, v56, v64
    v_add_f32 v58, v58, v66
    v_add_f32 v56, v56, v68
    v_add_f32 v58, v58, v70
    v_add_f32 v56, v56, v72
    v_add_f32 v58, v58, v74
    v_add_f32 v56, v56, v76
    v_add_f32 v58, v58, v78
    v_add_f32 v56, v56, v80
    v_add_f32 v58, v58, v82
    v_add_f32 v56, v56, v84
    v_add_f32 v58, v58, v86
    v_mov_b32 v57, v56
    v_mov_b32 v59, v58
    s_nop 0
    v_permlane32_swap_b32 v56, v57
    v_permlane32_swap_b32 v58, v59
    v_add_f32 v56, v56, v57
    v_add_f32 v58, v58, v59
    v_mul_f32 v56, 0.00043402777777777775, v56
    v_mul_f32 v58, 0.00043402777777777775, v58
    v_fma_f32 v58, -v56, v56, v58
    v_max_f32 v58, 0, v58
    v_cvt_pk_bf16_f32 v58, v58, v58
    v_lshlrev_b32 v58, 16, v58
    v_add_f32 v58, 1e-05, v58
    v_cvt_pk_bf16_f32 v58, v58, v58
    v_lshlrev_b32 v58, 16, v58
    v_sqrt_f32 v58, v58
    s_nop 0
    v_cvt_pk_bf16_f32 v58, v58, v58
    v_lshlrev_b32 v58, 16, v58
    v_rcp_f32 v58, v58
    v_cvt_pk_bf16_f32 v56, v56, v56
    v_lshlrev_b32 v56, 16, v56
    v_mul_f32 v56, -v56, v58
    ds_write_b32 v117, v56
    ds_write_b32 v117, v58 offset:512
    s_cmp_lg_u32 s22, 5
    s_cbranch_scc1 parallel_sum__ssm_conv_s4__mixer_gmlp__prompt_kernel_b011
    s_mov_b32 m0, 18432
    s_nop 0
    buffer_load_dwordx4 v220, s[12:15], s40 offen lds
    s_mov_b32 m0, 19456
    s_nop 0
    buffer_load_dwordx4 v221, s[12:15], s40 offen lds
    s_mov_b32 m0, 20480
    s_nop 0
    buffer_load_dwordx4 v222, s[12:15], s40 offen lds
    s_mov_b32 m0, 21504
    s_nop 0
    buffer_load_dwordx4 v223, s[12:15], s40 offen lds
    s_mov_b32 m0, 22528
    s_nop 0
    buffer_load_dwordx4 v224, s[12:15], s40 offen lds
    s_mov_b32 m0, 23552
    s_nop 0
    buffer_load_dwordx4 v225, s[12:15], s40 offen lds
    s_mov_b32 m0, 24576
    s_nop 0
    buffer_load_dwordx4 v226, s[12:15], s40 offen lds
    s_mov_b32 m0, 25600
    s_nop 0
    buffer_load_dwordx4 v227, s[12:15], s40 offen lds
    s_mov_b32 m0, 26624
    s_nop 0
    buffer_load_dwordx4 v228, s[12:15], s40 offen lds
    s_mov_b32 m0, 27648
    s_nop 0
    buffer_load_dwordx4 v229, s[12:15], s40 offen lds
    s_mov_b32 m0, 28672
    s_nop 0
    buffer_load_dwordx4 v230, s[12:15], s40 offen lds
    s_mov_b32 m0, 29696
    s_nop 0
    buffer_load_dwordx4 v231, s[12:15], s40 offen lds
    s_mov_b32 m0, 30720
    s_nop 0
    buffer_load_dwordx4 v232, s[12:15], s40 offen lds
    s_mov_b32 m0, 31744
    s_nop 0
    buffer_load_dwordx4 v233, s[12:15], s40 offen lds
    s_mov_b32 m0, 32768
    s_nop 0
    buffer_load_dwordx4 v234, s[12:15], s40 offen lds
    s_mov_b32 m0, 33792
    s_nop 0
    buffer_load_dwordx4 v235, s[12:15], s40 offen lds
    s_add_u32 s40, s40, 128
    s_add_u32 s43, s43, 1
    s_cmp_eq_u32 s43, 2
    s_cselect_b32 s40, 0, s40
    s_cselect_b32 s42, s45, s42
    s_cmp_eq_u32 s40, s42
    s_cselect_b32 s33, 256, 0
    s_add_u32 s40, s40, s33
    s_add_u32 s41, s41, 34816
    s_cmp_ge_u32 s41, 139264
    s_cselect_b32 s41, s44, s41
    s_waitcnt lgkmcnt(0)
    s_barrier
    s_branch fz_ld5
parallel_sum__ssm_conv_s4__mixer_gmlp__prompt_kernel_b011:
    s_waitcnt lgkmcnt(0)
    s_barrier
    s_branch fz_loader
fz_c1:
    s_add_u32 s36, s4, 38731776
    s_addc_u32 s37, s5, 0
    s_mov_b32 s38, 32768
    s_mov_b32 s39, 0x20000
    s_waitcnt lgkmcnt(0)
    s_barrier
    ds_read_b128 v[144:147], v235 offset:0
    ds_read_b128 v[148:151], v235 offset:2048
    ds_read_b64_tr_b16 v[152:153], v237 offset:0
    ds_read_b64_tr_b16 v[154:155], v237 offset:2304
    ds_read_b64_tr_b16 v[156:157], v237 offset:32
    ds_read_b64_tr_b16 v[158:159], v237 offset:2336
    ds_read_b64_tr_b16 v[160:161], v237 offset:64
    ds_read_b64_tr_b16 v[162:163], v237 offset:2368
    ds_read_b64_tr_b16 v[164:165], v237 offset:96
    ds_read_b64_tr_b16 v[166:167], v237 offset:2400
    ds_read_b64_tr_b16 v[168:169], v237 offset:128
    ds_read_b64_tr_b16 v[170:171], v237 offset:2432
    ds_read_b64_tr_b16 v[172:173], v237 offset:160
    ds_read_b64_tr_b16 v[174:175], v237 offset:2464
    ds_read_b64_tr_b16 v[176:177], v237 offset:192
    ds_read_b64_tr_b16 v[178:179], v237 offset:2496
    ds_read_b64_tr_b16 v[180:181], v237 offset:224
    ds_read_b64_tr_b16 v[182:183], v237 offset:2528
    ds_read_b64_tr_b16 v[184:185], v237 offset:256
    ds_read_b64_tr_b16 v[186:187], v237 offset:2560
    s_waitcnt lgkmcnt(0)
    v_mfma_f32_16x16x32_bf16 v[0:3], v[144:147], v[152:155], 0
    ds_read_b128 v[188:191], v236 offset:0
    ds_read_b128 v[192:195], v236 offset:2048
    v_mfma_f32_16x16x32_bf16 v[4:7], v[148:151], v[152:155], 0
    ds_read_b64_tr_b16 v[196:197], v237 offset:9216
    v_mfma_f32_16x16x32_bf16 v[8:11], v[144:147], v[156:159], 0
    ds_read_b64_tr_b16 v[198:199], v237 offset:11520
    v_mfma_f32_16x16x32_bf16 v[12:15], v[148:151], v[156:159], 0
    ds_read_b64_tr_b16 v[200:201], v237 offset:9248
    ds_read_b64_tr_b16 v[202:203], v237 offset:11552
    v_mfma_f32_16x16x32_bf16 v[16:19], v[144:147], v[160:163], 0
    ds_read_b64_tr_b16 v[204:205], v237 offset:9280
    v_mfma_f32_16x16x32_bf16 v[20:23], v[148:151], v[160:163], 0
    ds_read_b64_tr_b16 v[206:207], v237 offset:11584
    v_mfma_f32_16x16x32_bf16 v[24:27], v[144:147], v[164:167], 0
    ds_read_b64_tr_b16 v[208:209], v237 offset:9312
    ds_read_b64_tr_b16 v[210:211], v237 offset:11616
    v_mfma_f32_16x16x32_bf16 v[28:31], v[148:151], v[164:167], 0
    ds_read_b64_tr_b16 v[212:213], v237 offset:9344
    v_mfma_f32_16x16x32_bf16 v[32:35], v[144:147], v[168:171], 0
    ds_read_b64_tr_b16 v[214:215], v237 offset:11648
    v_mfma_f32_16x16x32_bf16 v[36:39], v[148:151], v[168:171], 0
    ds_read_b64_tr_b16 v[216:217], v237 offset:9376
    ds_read_b64_tr_b16 v[218:219], v237 offset:11680
    v_mfma_f32_16x16x32_bf16 v[40:43], v[144:147], v[172:175], 0
    ds_read_b64_tr_b16 v[220:221], v237 offset:9408
    v_mfma_f32_16x16x32_bf16 v[44:47], v[148:151], v[172:175], 0
    ds_read_b64_tr_b16 v[222:223], v237 offset:11712
    v_mfma_f32_16x16x32_bf16 v[48:51], v[144:147], v[176:179], 0
    ds_read_b64_tr_b16 v[224:225], v237 offset:9440
    ds_read_b64_tr_b16 v[226:227], v237 offset:11744
    v_mfma_f32_16x16x32_bf16 v[52:55], v[148:151], v[176:179], 0
    ds_read_b64_tr_b16 v[228:229], v237 offset:9472
    v_mfma_f32_16x16x32_bf16 v[56:59], v[144:147], v[180:183], 0
    ds_read_b64_tr_b16 v[230:231], v237 offset:11776
    v_mfma_f32_16x16x32_bf16 v[60:63], v[148:151], v[180:183], 0
    v_mfma_f32_16x16x32_bf16 v[64:67], v[144:147], v[184:187], 0
    v_mfma_f32_16x16x32_bf16 v[68:71], v[148:151], v[184:187], 0
    s_waitcnt lgkmcnt(0)
    s_barrier
    v_mfma_f32_16x16x32_bf16 v[0:3], v[188:191], v[196:199], v[0:3]
    ds_read_b128 v[144:147], v235 offset:34816
    ds_read_b128 v[148:151], v235 offset:36864
    v_mfma_f32_16x16x32_bf16 v[4:7], v[192:195], v[196:199], v[4:7]
    ds_read_b64_tr_b16 v[152:153], v237 offset:34816
    v_mfma_f32_16x16x32_bf16 v[8:11], v[188:191], v[200:203], v[8:11]
    ds_read_b64_tr_b16 v[154:155], v237 offset:37120
    v_mfma_f32_16x16x32_bf16 v[12:15], v[192:195], v[200:203], v[12:15]
    ds_read_b64_tr_b16 v[156:157], v237 offset:34848
    ds_read_b64_tr_b16 v[158:159], v237 offset:37152
    v_mfma_f32_16x16x32_bf16 v[16:19], v[188:191], v[204:207], v[16:19]
    ds_read_b64_tr_b16 v[160:161], v237 offset:34880
    v_mfma_f32_16x16x32_bf16 v[20:23], v[192:195], v[204:207], v[20:23]
    ds_read_b64_tr_b16 v[162:163], v237 offset:37184
    v_mfma_f32_16x16x32_bf16 v[24:27], v[188:191], v[208:211], v[24:27]
    ds_read_b64_tr_b16 v[164:165], v237 offset:34912
    ds_read_b64_tr_b16 v[166:167], v237 offset:37216
    v_mfma_f32_16x16x32_bf16 v[28:31], v[192:195], v[208:211], v[28:31]
    ds_read_b64_tr_b16 v[168:169], v237 offset:34944
    v_mfma_f32_16x16x32_bf16 v[32:35], v[188:191], v[212:215], v[32:35]
    ds_read_b64_tr_b16 v[170:171], v237 offset:37248
    v_mfma_f32_16x16x32_bf16 v[36:39], v[192:195], v[212:215], v[36:39]
    ds_read_b64_tr_b16 v[172:173], v237 offset:34976
    ds_read_b64_tr_b16 v[174:175], v237 offset:37280
    v_mfma_f32_16x16x32_bf16 v[40:43], v[188:191], v[216:219], v[40:43]
    ds_read_b64_tr_b16 v[176:177], v237 offset:35008
    v_mfma_f32_16x16x32_bf16 v[44:47], v[192:195], v[216:219], v[44:47]
    ds_read_b64_tr_b16 v[178:179], v237 offset:37312
    v_mfma_f32_16x16x32_bf16 v[48:51], v[188:191], v[220:223], v[48:51]
    ds_read_b64_tr_b16 v[180:181], v237 offset:35040
    ds_read_b64_tr_b16 v[182:183], v237 offset:37344
    v_mfma_f32_16x16x32_bf16 v[52:55], v[192:195], v[220:223], v[52:55]
    ds_read_b64_tr_b16 v[184:185], v237 offset:35072
    v_mfma_f32_16x16x32_bf16 v[56:59], v[188:191], v[224:227], v[56:59]
    ds_read_b64_tr_b16 v[186:187], v237 offset:37376
    v_mfma_f32_16x16x32_bf16 v[60:63], v[192:195], v[224:227], v[60:63]
    v_mfma_f32_16x16x32_bf16 v[64:67], v[188:191], v[228:231], v[64:67]
    v_mfma_f32_16x16x32_bf16 v[68:71], v[192:195], v[228:231], v[68:71]
    s_waitcnt lgkmcnt(0)
    v_mfma_f32_16x16x32_bf16 v[0:3], v[144:147], v[152:155], v[0:3]
    ds_read_b128 v[188:191], v236 offset:34816
    ds_read_b128 v[192:195], v236 offset:36864
    v_mfma_f32_16x16x32_bf16 v[4:7], v[148:151], v[152:155], v[4:7]
    ds_read_b64_tr_b16 v[196:197], v237 offset:44032
    v_mfma_f32_16x16x32_bf16 v[8:11], v[144:147], v[156:159], v[8:11]
    ds_read_b64_tr_b16 v[198:199], v237 offset:46336
    v_mfma_f32_16x16x32_bf16 v[12:15], v[148:151], v[156:159], v[12:15]
    ds_read_b64_tr_b16 v[200:201], v237 offset:44064
    ds_read_b64_tr_b16 v[202:203], v237 offset:46368
    v_mfma_f32_16x16x32_bf16 v[16:19], v[144:147], v[160:163], v[16:19]
    ds_read_b64_tr_b16 v[204:205], v237 offset:44096
    v_mfma_f32_16x16x32_bf16 v[20:23], v[148:151], v[160:163], v[20:23]
    ds_read_b64_tr_b16 v[206:207], v237 offset:46400
    v_mfma_f32_16x16x32_bf16 v[24:27], v[144:147], v[164:167], v[24:27]
    ds_read_b64_tr_b16 v[208:209], v237 offset:44128
    ds_read_b64_tr_b16 v[210:211], v237 offset:46432
    v_mfma_f32_16x16x32_bf16 v[28:31], v[148:151], v[164:167], v[28:31]
    ds_read_b64_tr_b16 v[212:213], v237 offset:44160
    v_mfma_f32_16x16x32_bf16 v[32:35], v[144:147], v[168:171], v[32:35]
    ds_read_b64_tr_b16 v[214:215], v237 offset:46464
    v_mfma_f32_16x16x32_bf16 v[36:39], v[148:151], v[168:171], v[36:39]
    ds_read_b64_tr_b16 v[216:217], v237 offset:44192
    ds_read_b64_tr_b16 v[218:219], v237 offset:46496
    v_mfma_f32_16x16x32_bf16 v[40:43], v[144:147], v[172:175], v[40:43]
    ds_read_b64_tr_b16 v[220:221], v237 offset:44224
    v_mfma_f32_16x16x32_bf16 v[44:47], v[148:151], v[172:175], v[44:47]
    ds_read_b64_tr_b16 v[222:223], v237 offset:46528
    v_mfma_f32_16x16x32_bf16 v[48:51], v[144:147], v[176:179], v[48:51]
    ds_read_b64_tr_b16 v[224:225], v237 offset:44256
    ds_read_b64_tr_b16 v[226:227], v237 offset:46560
    v_mfma_f32_16x16x32_bf16 v[52:55], v[148:151], v[176:179], v[52:55]
    ds_read_b64_tr_b16 v[228:229], v237 offset:44288
    v_mfma_f32_16x16x32_bf16 v[56:59], v[144:147], v[180:183], v[56:59]
    ds_read_b64_tr_b16 v[230:231], v237 offset:46592
    v_mfma_f32_16x16x32_bf16 v[60:63], v[148:151], v[180:183], v[60:63]
    v_mfma_f32_16x16x32_bf16 v[64:67], v[144:147], v[184:187], v[64:67]
    v_mfma_f32_16x16x32_bf16 v[68:71], v[148:151], v[184:187], v[68:71]
    s_waitcnt vmcnt(0)
    v_mov_b32 v249, 0
    s_mov_b64 exec, 1
    buffer_store_dwordx4 v[112:115], v249, s[36:39], s63 offen sc1
    s_mov_b64 exec, -1
    s_waitcnt lgkmcnt(0)
    s_barrier
    v_mfma_f32_16x16x32_bf16 v[0:3], v[188:191], v[196:199], v[0:3]
    ds_read_b128 v[144:147], v232 offset:0
    ds_read_b128 v[148:151], v232 offset:2048
    v_mfma_f32_16x16x32_bf16 v[4:7], v[192:195], v[196:199], v[4:7]
    ds_read_b64_tr_b16 v[152:153], v234 offset:0
    v_mfma_f32_16x16x32_bf16 v[8:11], v[188:191], v[200:203], v[8:11]
    ds_read_b64_tr_b16 v[154:155], v234 offset:2304
    v_mfma_f32_16x16x32_bf16 v[12:15], v[192:195], v[200:203], v[12:15]
    ds_read_b64_tr_b16 v[156:157], v234 offset:32
    ds_read_b64_tr_b16 v[158:159], v234 offset:2336
    v_mfma_f32_16x16x32_bf16 v[16:19], v[188:191], v[204:207], v[16:19]
    ds_read_b64_tr_b16 v[160:161], v234 offset:64
    v_mfma_f32_16x16x32_bf16 v[20:23], v[192:195], v[204:207], v[20:23]
    ds_read_b64_tr_b16 v[162:163], v234 offset:2368
    v_mfma_f32_16x16x32_bf16 v[24:27], v[188:191], v[208:211], v[24:27]
    ds_read_b64_tr_b16 v[164:165], v234 offset:96
    ds_read_b64_tr_b16 v[166:167], v234 offset:2400
    v_mfma_f32_16x16x32_bf16 v[28:31], v[192:195], v[208:211], v[28:31]
    ds_read_b64_tr_b16 v[168:169], v234 offset:128
    v_mfma_f32_16x16x32_bf16 v[32:35], v[188:191], v[212:215], v[32:35]
    ds_read_b64_tr_b16 v[170:171], v234 offset:2432
    v_mfma_f32_16x16x32_bf16 v[36:39], v[192:195], v[212:215], v[36:39]
    ds_read_b64_tr_b16 v[172:173], v234 offset:160
    ds_read_b64_tr_b16 v[174:175], v234 offset:2464
    v_mfma_f32_16x16x32_bf16 v[40:43], v[188:191], v[216:219], v[40:43]
    ds_read_b64_tr_b16 v[176:177], v234 offset:192
    v_mfma_f32_16x16x32_bf16 v[44:47], v[192:195], v[216:219], v[44:47]
    ds_read_b64_tr_b16 v[178:179], v234 offset:2496
    v_mfma_f32_16x16x32_bf16 v[48:51], v[188:191], v[220:223], v[48:51]
    ds_read_b64_tr_b16 v[180:181], v234 offset:224
    ds_read_b64_tr_b16 v[182:183], v234 offset:2528
    v_mfma_f32_16x16x32_bf16 v[52:55], v[192:195], v[220:223], v[52:55]
    ds_read_b64_tr_b16 v[184:185], v234 offset:256
    v_mfma_f32_16x16x32_bf16 v[56:59], v[188:191], v[224:227], v[56:59]
    ds_read_b64_tr_b16 v[186:187], v234 offset:2560
    v_mfma_f32_16x16x32_bf16 v[60:63], v[192:195], v[224:227], v[60:63]
    v_mfma_f32_16x16x32_bf16 v[64:67], v[188:191], v[228:231], v[64:67]
    v_mfma_f32_16x16x32_bf16 v[68:71], v[192:195], v[228:231], v[68:71]
    s_waitcnt lgkmcnt(0)
    v_mfma_f32_16x16x32_bf16 v[0:3], v[144:147], v[152:155], v[0:3]
    ds_read_b128 v[188:191], v233 offset:0
    ds_read_b128 v[192:195], v233 offset:2048
    v_mfma_f32_16x16x32_bf16 v[4:7], v[148:151], v[152:155], v[4:7]
    ds_read_b64_tr_b16 v[196:197], v234 offset:9216
    v_mfma_f32_16x16x32_bf16 v[8:11], v[144:147], v[156:159], v[8:11]
    ds_read_b64_tr_b16 v[198:199], v234 offset:11520
    v_mfma_f32_16x16x32_bf16 v[12:15], v[148:151], v[156:159], v[12:15]
    ds_read_b64_tr_b16 v[200:201], v234 offset:9248
    ds_read_b64_tr_b16 v[202:203], v234 offset:11552
    v_mfma_f32_16x16x32_bf16 v[16:19], v[144:147], v[160:163], v[16:19]
    ds_read_b64_tr_b16 v[204:205], v234 offset:9280
    v_mfma_f32_16x16x32_bf16 v[20:23], v[148:151], v[160:163], v[20:23]
    ds_read_b64_tr_b16 v[206:207], v234 offset:11584
    v_mfma_f32_16x16x32_bf16 v[24:27], v[144:147], v[164:167], v[24:27]
    ds_read_b64_tr_b16 v[208:209], v234 offset:9312
    ds_read_b64_tr_b16 v[210:211], v234 offset:11616
    v_mfma_f32_16x16x32_bf16 v[28:31], v[148:151], v[164:167], v[28:31]
    ds_read_b64_tr_b16 v[212:213], v234 offset:9344
    v_mfma_f32_16x16x32_bf16 v[32:35], v[144:147], v[168:171], v[32:35]
    ds_read_b64_tr_b16 v[214:215], v234 offset:11648
    v_mfma_f32_16x16x32_bf16 v[36:39], v[148:151], v[168:171], v[36:39]
    ds_read_b64_tr_b16 v[216:217], v234 offset:9376
    ds_read_b64_tr_b16 v[218:219], v234 offset:11680
    v_mfma_f32_16x16x32_bf16 v[40:43], v[144:147], v[172:175], v[40:43]
    ds_read_b64_tr_b16 v[220:221], v234 offset:9408
    v_mfma_f32_16x16x32_bf16 v[44:47], v[148:151], v[172:175], v[44:47]
    ds_read_b64_tr_b16 v[222:223], v234 offset:11712
    v_mfma_f32_16x16x32_bf16 v[48:51], v[144:147], v[176:179], v[48:51]
    ds_read_b64_tr_b16 v[224:225], v234 offset:9440
    ds_read_b64_tr_b16 v[226:227], v234 offset:11744
    v_mfma_f32_16x16x32_bf16 v[52:55], v[148:151], v[176:179], v[52:55]
    ds_read_b64_tr_b16 v[228:229], v234 offset:9472
    v_mfma_f32_16x16x32_bf16 v[56:59], v[144:147], v[180:183], v[56:59]
    ds_read_b64_tr_b16 v[230:231], v234 offset:11776
    v_mfma_f32_16x16x32_bf16 v[60:63], v[148:151], v[180:183], v[60:63]
    v_mfma_f32_16x16x32_bf16 v[64:67], v[144:147], v[184:187], v[64:67]
    v_mfma_f32_16x16x32_bf16 v[68:71], v[148:151], v[184:187], v[68:71]
    s_waitcnt lgkmcnt(0)
    s_barrier
    v_mfma_f32_16x16x32_bf16 v[0:3], v[188:191], v[196:199], v[0:3]
    ds_read_b128 v[144:147], v232 offset:34816
    ds_read_b128 v[148:151], v232 offset:36864
    v_mfma_f32_16x16x32_bf16 v[4:7], v[192:195], v[196:199], v[4:7]
    ds_read_b64_tr_b16 v[152:153], v234 offset:34816
    v_mfma_f32_16x16x32_bf16 v[8:11], v[188:191], v[200:203], v[8:11]
    ds_read_b64_tr_b16 v[154:155], v234 offset:37120
    v_mfma_f32_16x16x32_bf16 v[12:15], v[192:195], v[200:203], v[12:15]
    ds_read_b64_tr_b16 v[156:157], v234 offset:34848
    ds_read_b64_tr_b16 v[158:159], v234 offset:37152
    v_mfma_f32_16x16x32_bf16 v[16:19], v[188:191], v[204:207], v[16:19]
    ds_read_b64_tr_b16 v[160:161], v234 offset:34880
    v_mfma_f32_16x16x32_bf16 v[20:23], v[192:195], v[204:207], v[20:23]
    ds_read_b64_tr_b16 v[162:163], v234 offset:37184
    v_mfma_f32_16x16x32_bf16 v[24:27], v[188:191], v[208:211], v[24:27]
    ds_read_b64_tr_b16 v[164:165], v234 offset:34912
    ds_read_b64_tr_b16 v[166:167], v234 offset:37216
    v_mfma_f32_16x16x32_bf16 v[28:31], v[192:195], v[208:211], v[28:31]
    ds_read_b64_tr_b16 v[168:169], v234 offset:34944
    v_mfma_f32_16x16x32_bf16 v[32:35], v[188:191], v[212:215], v[32:35]
    ds_read_b64_tr_b16 v[170:171], v234 offset:37248
    v_mfma_f32_16x16x32_bf16 v[36:39], v[192:195], v[212:215], v[36:39]
    ds_read_b64_tr_b16 v[172:173], v234 offset:34976
    ds_read_b64_tr_b16 v[174:175], v234 offset:37280
    v_mfma_f32_16x16x32_bf16 v[40:43], v[188:191], v[216:219], v[40:43]
    ds_read_b64_tr_b16 v[176:177], v234 offset:35008
    v_mfma_f32_16x16x32_bf16 v[44:47], v[192:195], v[216:219], v[44:47]
    ds_read_b64_tr_b16 v[178:179], v234 offset:37312
    v_mfma_f32_16x16x32_bf16 v[48:51], v[188:191], v[220:223], v[48:51]
    ds_read_b64_tr_b16 v[180:181], v234 offset:35040
    ds_read_b64_tr_b16 v[182:183], v234 offset:37344
    v_mfma_f32_16x16x32_bf16 v[52:55], v[192:195], v[220:223], v[52:55]
    ds_read_b64_tr_b16 v[184:185], v234 offset:35072
    v_mfma_f32_16x16x32_bf16 v[56:59], v[188:191], v[224:227], v[56:59]
    ds_read_b64_tr_b16 v[186:187], v234 offset:37376
    v_mfma_f32_16x16x32_bf16 v[60:63], v[192:195], v[224:227], v[60:63]
    v_mfma_f32_16x16x32_bf16 v[64:67], v[188:191], v[228:231], v[64:67]
    v_mfma_f32_16x16x32_bf16 v[68:71], v[192:195], v[228:231], v[68:71]
    s_waitcnt lgkmcnt(0)
    v_mfma_f32_16x16x32_bf16 v[0:3], v[144:147], v[152:155], v[0:3]
    ds_read_b128 v[188:191], v233 offset:34816
    ds_read_b128 v[192:195], v233 offset:36864
    v_mfma_f32_16x16x32_bf16 v[4:7], v[148:151], v[152:155], v[4:7]
    ds_read_b64_tr_b16 v[196:197], v234 offset:44032
    v_mfma_f32_16x16x32_bf16 v[8:11], v[144:147], v[156:159], v[8:11]
    ds_read_b64_tr_b16 v[198:199], v234 offset:46336
    v_mfma_f32_16x16x32_bf16 v[12:15], v[148:151], v[156:159], v[12:15]
    ds_read_b64_tr_b16 v[200:201], v234 offset:44064
    ds_read_b64_tr_b16 v[202:203], v234 offset:46368
    v_mfma_f32_16x16x32_bf16 v[16:19], v[144:147], v[160:163], v[16:19]
    ds_read_b64_tr_b16 v[204:205], v234 offset:44096
    v_mfma_f32_16x16x32_bf16 v[20:23], v[148:151], v[160:163], v[20:23]
    ds_read_b64_tr_b16 v[206:207], v234 offset:46400
    v_mfma_f32_16x16x32_bf16 v[24:27], v[144:147], v[164:167], v[24:27]
    ds_read_b64_tr_b16 v[208:209], v234 offset:44128
    ds_read_b64_tr_b16 v[210:211], v234 offset:46432
    v_mfma_f32_16x16x32_bf16 v[28:31], v[148:151], v[164:167], v[28:31]
    ds_read_b64_tr_b16 v[212:213], v234 offset:44160
    v_mfma_f32_16x16x32_bf16 v[32:35], v[144:147], v[168:171], v[32:35]
    ds_read_b64_tr_b16 v[214:215], v234 offset:46464
    v_mfma_f32_16x16x32_bf16 v[36:39], v[148:151], v[168:171], v[36:39]
    ds_read_b64_tr_b16 v[216:217], v234 offset:44192
    ds_read_b64_tr_b16 v[218:219], v234 offset:46496
    v_mfma_f32_16x16x32_bf16 v[40:43], v[144:147], v[172:175], v[40:43]
    ds_read_b64_tr_b16 v[220:221], v234 offset:44224
    v_mfma_f32_16x16x32_bf16 v[44:47], v[148:151], v[172:175], v[44:47]
    ds_read_b64_tr_b16 v[222:223], v234 offset:46528
    v_mfma_f32_16x16x32_bf16 v[48:51], v[144:147], v[176:179], v[48:51]
    ds_read_b64_tr_b16 v[224:225], v234 offset:44256
    ds_read_b64_tr_b16 v[226:227], v234 offset:46560
    v_mfma_f32_16x16x32_bf16 v[52:55], v[148:151], v[176:179], v[52:55]
    ds_read_b64_tr_b16 v[228:229], v234 offset:44288
    v_mfma_f32_16x16x32_bf16 v[56:59], v[144:147], v[180:183], v[56:59]
    ds_read_b64_tr_b16 v[230:231], v234 offset:46592
    v_mfma_f32_16x16x32_bf16 v[60:63], v[148:151], v[180:183], v[60:63]
    v_mfma_f32_16x16x32_bf16 v[64:67], v[144:147], v[184:187], v[64:67]
    v_mfma_f32_16x16x32_bf16 v[68:71], v[148:151], v[184:187], v[68:71]
    s_waitcnt lgkmcnt(0)
    s_barrier
    v_mfma_f32_16x16x32_bf16 v[0:3], v[188:191], v[196:199], v[0:3]
    ds_read_b128 v[144:147], v235 offset:0
    ds_read_b128 v[148:151], v235 offset:2048
    v_mfma_f32_16x16x32_bf16 v[4:7], v[192:195], v[196:199], v[4:7]
    ds_read_b64_tr_b16 v[152:153], v237 offset:0
    v_mfma_f32_16x16x32_bf16 v[8:11], v[188:191], v[200:203], v[8:11]
    ds_read_b64_tr_b16 v[154:155], v237 offset:2304
    v_mfma_f32_16x16x32_bf16 v[12:15], v[192:195], v[200:203], v[12:15]
    ds_read_b64_tr_b16 v[156:157], v237 offset:32
    ds_read_b64_tr_b16 v[158:159], v237 offset:2336
    v_mfma_f32_16x16x32_bf16 v[16:19], v[188:191], v[204:207], v[16:19]
    ds_read_b64_tr_b16 v[160:161], v237 offset:64
    v_mfma_f32_16x16x32_bf16 v[20:23], v[192:195], v[204:207], v[20:23]
    ds_read_b64_tr_b16 v[162:163], v237 offset:2368
    v_mfma_f32_16x16x32_bf16 v[24:27], v[188:191], v[208:211], v[24:27]
    ds_read_b64_tr_b16 v[164:165], v237 offset:96
    ds_read_b64_tr_b16 v[166:167], v237 offset:2400
    v_mfma_f32_16x16x32_bf16 v[28:31], v[192:195], v[208:211], v[28:31]
    ds_read_b64_tr_b16 v[168:169], v237 offset:128
    v_mfma_f32_16x16x32_bf16 v[32:35], v[188:191], v[212:215], v[32:35]
    ds_read_b64_tr_b16 v[170:171], v237 offset:2432
    v_mfma_f32_16x16x32_bf16 v[36:39], v[192:195], v[212:215], v[36:39]
    ds_read_b64_tr_b16 v[172:173], v237 offset:160
    ds_read_b64_tr_b16 v[174:175], v237 offset:2464
    v_mfma_f32_16x16x32_bf16 v[40:43], v[188:191], v[216:219], v[40:43]
    ds_read_b64_tr_b16 v[176:177], v237 offset:192
    v_mfma_f32_16x16x32_bf16 v[44:47], v[192:195], v[216:219], v[44:47]
    ds_read_b64_tr_b16 v[178:179], v237 offset:2496
    v_mfma_f32_16x16x32_bf16 v[48:51], v[188:191], v[220:223], v[48:51]
    ds_read_b64_tr_b16 v[180:181], v237 offset:224
    ds_read_b64_tr_b16 v[182:183], v237 offset:2528
    v_mfma_f32_16x16x32_bf16 v[52:55], v[192:195], v[220:223], v[52:55]
    ds_read_b64_tr_b16 v[184:185], v237 offset:256
    v_mfma_f32_16x16x32_bf16 v[56:59], v[188:191], v[224:227], v[56:59]
    ds_read_b64_tr_b16 v[186:187], v237 offset:2560
    v_mfma_f32_16x16x32_bf16 v[60:63], v[192:195], v[224:227], v[60:63]
    v_mfma_f32_16x16x32_bf16 v[64:67], v[188:191], v[228:231], v[64:67]
    v_mfma_f32_16x16x32_bf16 v[68:71], v[192:195], v[228:231], v[68:71]
    s_waitcnt lgkmcnt(0)
    v_mfma_f32_16x16x32_bf16 v[0:3], v[144:147], v[152:155], v[0:3]
    ds_read_b128 v[188:191], v236 offset:0
    ds_read_b128 v[192:195], v236 offset:2048
    v_mfma_f32_16x16x32_bf16 v[4:7], v[148:151], v[152:155], v[4:7]
    ds_read_b64_tr_b16 v[196:197], v237 offset:9216
    v_mfma_f32_16x16x32_bf16 v[8:11], v[144:147], v[156:159], v[8:11]
    ds_read_b64_tr_b16 v[198:199], v237 offset:11520
    v_mfma_f32_16x16x32_bf16 v[12:15], v[148:151], v[156:159], v[12:15]
    ds_read_b64_tr_b16 v[200:201], v237 offset:9248
    ds_read_b64_tr_b16 v[202:203], v237 offset:11552
    v_mfma_f32_16x16x32_bf16 v[16:19], v[144:147], v[160:163], v[16:19]
    ds_read_b64_tr_b16 v[204:205], v237 offset:9280
    v_mfma_f32_16x16x32_bf16 v[20:23], v[148:151], v[160:163], v[20:23]
    ds_read_b64_tr_b16 v[206:207], v237 offset:11584
    v_mfma_f32_16x16x32_bf16 v[24:27], v[144:147], v[164:167], v[24:27]
    ds_read_b64_tr_b16 v[208:209], v237 offset:9312
    ds_read_b64_tr_b16 v[210:211], v237 offset:11616
    v_mfma_f32_16x16x32_bf16 v[28:31], v[148:151], v[164:167], v[28:31]
    ds_read_b64_tr_b16 v[212:213], v237 offset:9344
    v_mfma_f32_16x16x32_bf16 v[32:35], v[144:147], v[168:171], v[32:35]
    ds_read_b64_tr_b16 v[214:215], v237 offset:11648
    v_mfma_f32_16x16x32_bf16 v[36:39], v[148:151], v[168:171], v[36:39]
    ds_read_b64_tr_b16 v[216:217], v237 offset:9376
    ds_read_b64_tr_b16 v[218:219], v237 offset:11680
    v_mfma_f32_16x16x32_bf16 v[40:43], v[144:147], v[172:175], v[40:43]
    ds_read_b64_tr_b16 v[220:221], v237 offset:9408
    v_mfma_f32_16x16x32_bf16 v[44:47], v[148:151], v[172:175], v[44:47]
    ds_read_b64_tr_b16 v[222:223], v237 offset:11712
    v_mfma_f32_16x16x32_bf16 v[48:51], v[144:147], v[176:179], v[48:51]
    ds_read_b64_tr_b16 v[224:225], v237 offset:9440
    ds_read_b64_tr_b16 v[226:227], v237 offset:11744
    v_mfma_f32_16x16x32_bf16 v[52:55], v[148:151], v[176:179], v[52:55]
    ds_read_b64_tr_b16 v[228:229], v237 offset:9472
    v_mfma_f32_16x16x32_bf16 v[56:59], v[144:147], v[180:183], v[56:59]
    ds_read_b64_tr_b16 v[230:231], v237 offset:11776
    v_mfma_f32_16x16x32_bf16 v[60:63], v[148:151], v[180:183], v[60:63]
    v_mfma_f32_16x16x32_bf16 v[64:67], v[144:147], v[184:187], v[64:67]
    v_mfma_f32_16x16x32_bf16 v[68:71], v[148:151], v[184:187], v[68:71]
    s_waitcnt lgkmcnt(0)
    s_barrier
    v_mfma_f32_16x16x32_bf16 v[0:3], v[188:191], v[196:199], v[0:3]
    ds_read_b128 v[144:147], v235 offset:34816
    ds_read_b128 v[148:151], v235 offset:36864
    v_mfma_f32_16x16x32_bf16 v[4:7], v[192:195], v[196:199], v[4:7]
    ds_read_b64_tr_b16 v[152:153], v237 offset:34816
    v_mfma_f32_16x16x32_bf16 v[8:11], v[188:191], v[200:203], v[8:11]
    ds_read_b64_tr_b16 v[154:155], v237 offset:37120
    v_mfma_f32_16x16x32_bf16 v[12:15], v[192:195], v[200:203], v[12:15]
    ds_read_b64_tr_b16 v[156:157], v237 offset:34848
    ds_read_b64_tr_b16 v[158:159], v237 offset:37152
    v_mfma_f32_16x16x32_bf16 v[16:19], v[188:191], v[204:207], v[16:19]
    ds_read_b64_tr_b16 v[160:161], v237 offset:34880
    v_mfma_f32_16x16x32_bf16 v[20:23], v[192:195], v[204:207], v[20:23]
    ds_read_b64_tr_b16 v[162:163], v237 offset:37184
    v_mfma_f32_16x16x32_bf16 v[24:27], v[188:191], v[208:211], v[24:27]
    ds_read_b64_tr_b16 v[164:165], v237 offset:34912
    ds_read_b64_tr_b16 v[166:167], v237 offset:37216
    v_mfma_f32_16x16x32_bf16 v[28:31], v[192:195], v[208:211], v[28:31]
    ds_read_b64_tr_b16 v[168:169], v237 offset:34944
    v_mfma_f32_16x16x32_bf16 v[32:35], v[188:191], v[212:215], v[32:35]
    ds_read_b64_tr_b16 v[170:171], v237 offset:37248
    v_mfma_f32_16x16x32_bf16 v[36:39], v[192:195], v[212:215], v[36:39]
    ds_read_b64_tr_b16 v[172:173], v237 offset:34976
    ds_read_b64_tr_b16 v[174:175], v237 offset:37280
    v_mfma_f32_16x16x32_bf16 v[40:43], v[188:191], v[216:219], v[40:43]
    ds_read_b64_tr_b16 v[176:177], v237 offset:35008
    v_mfma_f32_16x16x32_bf16 v[44:47], v[192:195], v[216:219], v[44:47]
    ds_read_b64_tr_b16 v[178:179], v237 offset:37312
    v_mfma_f32_16x16x32_bf16 v[48:51], v[188:191], v[220:223], v[48:51]
    ds_read_b64_tr_b16 v[180:181], v237 offset:35040
    ds_read_b64_tr_b16 v[182:183], v237 offset:37344
    v_mfma_f32_16x16x32_bf16 v[52:55], v[192:195], v[220:223], v[52:55]
    ds_read_b64_tr_b16 v[184:185], v237 offset:35072
    v_mfma_f32_16x16x32_bf16 v[56:59], v[188:191], v[224:227], v[56:59]
    ds_read_b64_tr_b16 v[186:187], v237 offset:37376
    v_mfma_f32_16x16x32_bf16 v[60:63], v[192:195], v[224:227], v[60:63]
    v_mfma_f32_16x16x32_bf16 v[64:67], v[188:191], v[228:231], v[64:67]
    v_mfma_f32_16x16x32_bf16 v[68:71], v[192:195], v[228:231], v[68:71]
    s_waitcnt lgkmcnt(0)
    v_mfma_f32_16x16x32_bf16 v[0:3], v[144:147], v[152:155], v[0:3]
    ds_read_b128 v[188:191], v236 offset:34816
    ds_read_b128 v[192:195], v236 offset:36864
    v_mfma_f32_16x16x32_bf16 v[4:7], v[148:151], v[152:155], v[4:7]
    ds_read_b64_tr_b16 v[196:197], v237 offset:44032
    v_mfma_f32_16x16x32_bf16 v[8:11], v[144:147], v[156:159], v[8:11]
    ds_read_b64_tr_b16 v[198:199], v237 offset:46336
    v_mfma_f32_16x16x32_bf16 v[12:15], v[148:151], v[156:159], v[12:15]
    ds_read_b64_tr_b16 v[200:201], v237 offset:44064
    ds_read_b64_tr_b16 v[202:203], v237 offset:46368
    v_mfma_f32_16x16x32_bf16 v[16:19], v[144:147], v[160:163], v[16:19]
    ds_read_b64_tr_b16 v[204:205], v237 offset:44096
    v_mfma_f32_16x16x32_bf16 v[20:23], v[148:151], v[160:163], v[20:23]
    ds_read_b64_tr_b16 v[206:207], v237 offset:46400
    v_mfma_f32_16x16x32_bf16 v[24:27], v[144:147], v[164:167], v[24:27]
    ds_read_b64_tr_b16 v[208:209], v237 offset:44128
    ds_read_b64_tr_b16 v[210:211], v237 offset:46432
    v_mfma_f32_16x16x32_bf16 v[28:31], v[148:151], v[164:167], v[28:31]
    ds_read_b64_tr_b16 v[212:213], v237 offset:44160
    v_mfma_f32_16x16x32_bf16 v[32:35], v[144:147], v[168:171], v[32:35]
    ds_read_b64_tr_b16 v[214:215], v237 offset:46464
    v_mfma_f32_16x16x32_bf16 v[36:39], v[148:151], v[168:171], v[36:39]
    ds_read_b64_tr_b16 v[216:217], v237 offset:44192
    ds_read_b64_tr_b16 v[218:219], v237 offset:46496
    v_mfma_f32_16x16x32_bf16 v[40:43], v[144:147], v[172:175], v[40:43]
    ds_read_b64_tr_b16 v[220:221], v237 offset:44224
    v_mfma_f32_16x16x32_bf16 v[44:47], v[148:151], v[172:175], v[44:47]
    ds_read_b64_tr_b16 v[222:223], v237 offset:46528
    v_mfma_f32_16x16x32_bf16 v[48:51], v[144:147], v[176:179], v[48:51]
    ds_read_b64_tr_b16 v[224:225], v237 offset:44256
    ds_read_b64_tr_b16 v[226:227], v237 offset:46560
    v_mfma_f32_16x16x32_bf16 v[52:55], v[148:151], v[176:179], v[52:55]
    ds_read_b64_tr_b16 v[228:229], v237 offset:44288
    v_mfma_f32_16x16x32_bf16 v[56:59], v[144:147], v[180:183], v[56:59]
    ds_read_b64_tr_b16 v[230:231], v237 offset:46592
    v_mfma_f32_16x16x32_bf16 v[60:63], v[148:151], v[180:183], v[60:63]
    v_mfma_f32_16x16x32_bf16 v[64:67], v[144:147], v[184:187], v[64:67]
    v_mfma_f32_16x16x32_bf16 v[68:71], v[148:151], v[184:187], v[68:71]
    s_waitcnt lgkmcnt(0)
    s_barrier
    v_mfma_f32_16x16x32_bf16 v[0:3], v[188:191], v[196:199], v[0:3]
    ds_read_b128 v[144:147], v232 offset:0
    ds_read_b128 v[148:151], v232 offset:2048
    v_mfma_f32_16x16x32_bf16 v[4:7], v[192:195], v[196:199], v[4:7]
    ds_read_b64_tr_b16 v[152:153], v234 offset:0
    v_mfma_f32_16x16x32_bf16 v[8:11], v[188:191], v[200:203], v[8:11]
    ds_read_b64_tr_b16 v[154:155], v234 offset:2304
    v_mfma_f32_16x16x32_bf16 v[12:15], v[192:195], v[200:203], v[12:15]
    ds_read_b64_tr_b16 v[156:157], v234 offset:32
    ds_read_b64_tr_b16 v[158:159], v234 offset:2336
    v_mfma_f32_16x16x32_bf16 v[16:19], v[188:191], v[204:207], v[16:19]
    ds_read_b64_tr_b16 v[160:161], v234 offset:64
    v_mfma_f32_16x16x32_bf16 v[20:23], v[192:195], v[204:207], v[20:23]
    ds_read_b64_tr_b16 v[162:163], v234 offset:2368
    v_mfma_f32_16x16x32_bf16 v[24:27], v[188:191], v[208:211], v[24:27]
    ds_read_b64_tr_b16 v[164:165], v234 offset:96
    ds_read_b64_tr_b16 v[166:167], v234 offset:2400
    v_mfma_f32_16x16x32_bf16 v[28:31], v[192:195], v[208:211], v[28:31]
    ds_read_b64_tr_b16 v[168:169], v234 offset:128
    v_mfma_f32_16x16x32_bf16 v[32:35], v[188:191], v[212:215], v[32:35]
    ds_read_b64_tr_b16 v[170:171], v234 offset:2432
    v_mfma_f32_16x16x32_bf16 v[36:39], v[192:195], v[212:215], v[36:39]
    ds_read_b64_tr_b16 v[172:173], v234 offset:160
    ds_read_b64_tr_b16 v[174:175], v234 offset:2464
    v_mfma_f32_16x16x32_bf16 v[40:43], v[188:191], v[216:219], v[40:43]
    ds_read_b64_tr_b16 v[176:177], v234 offset:192
    v_mfma_f32_16x16x32_bf16 v[44:47], v[192:195], v[216:219], v[44:47]
    ds_read_b64_tr_b16 v[178:179], v234 offset:2496
    v_mfma_f32_16x16x32_bf16 v[48:51], v[188:191], v[220:223], v[48:51]
    ds_read_b64_tr_b16 v[180:181], v234 offset:224
    ds_read_b64_tr_b16 v[182:183], v234 offset:2528
    v_mfma_f32_16x16x32_bf16 v[52:55], v[192:195], v[220:223], v[52:55]
    ds_read_b64_tr_b16 v[184:185], v234 offset:256
    v_mfma_f32_16x16x32_bf16 v[56:59], v[188:191], v[224:227], v[56:59]
    ds_read_b64_tr_b16 v[186:187], v234 offset:2560
    v_mfma_f32_16x16x32_bf16 v[60:63], v[192:195], v[224:227], v[60:63]
    v_mfma_f32_16x16x32_bf16 v[64:67], v[188:191], v[228:231], v[64:67]
    v_mfma_f32_16x16x32_bf16 v[68:71], v[192:195], v[228:231], v[68:71]
    s_waitcnt lgkmcnt(0)
    v_mfma_f32_16x16x32_bf16 v[0:3], v[144:147], v[152:155], v[0:3]
    ds_read_b128 v[188:191], v233 offset:0
    ds_read_b128 v[192:195], v233 offset:2048
    v_mfma_f32_16x16x32_bf16 v[4:7], v[148:151], v[152:155], v[4:7]
    ds_read_b64_tr_b16 v[196:197], v234 offset:9216
    v_mfma_f32_16x16x32_bf16 v[8:11], v[144:147], v[156:159], v[8:11]
    ds_read_b64_tr_b16 v[198:199], v234 offset:11520
    v_mfma_f32_16x16x32_bf16 v[12:15], v[148:151], v[156:159], v[12:15]
    ds_read_b64_tr_b16 v[200:201], v234 offset:9248
    ds_read_b64_tr_b16 v[202:203], v234 offset:11552
    v_mfma_f32_16x16x32_bf16 v[16:19], v[144:147], v[160:163], v[16:19]
    ds_read_b64_tr_b16 v[204:205], v234 offset:9280
    v_mfma_f32_16x16x32_bf16 v[20:23], v[148:151], v[160:163], v[20:23]
    ds_read_b64_tr_b16 v[206:207], v234 offset:11584
    v_mfma_f32_16x16x32_bf16 v[24:27], v[144:147], v[164:167], v[24:27]
    ds_read_b64_tr_b16 v[208:209], v234 offset:9312
    ds_read_b64_tr_b16 v[210:211], v234 offset:11616
    v_mfma_f32_16x16x32_bf16 v[28:31], v[148:151], v[164:167], v[28:31]
    ds_read_b64_tr_b16 v[212:213], v234 offset:9344
    v_mfma_f32_16x16x32_bf16 v[32:35], v[144:147], v[168:171], v[32:35]
    ds_read_b64_tr_b16 v[214:215], v234 offset:11648
    v_mfma_f32_16x16x32_bf16 v[36:39], v[148:151], v[168:171], v[36:39]
    ds_read_b64_tr_b16 v[216:217], v234 offset:9376
    ds_read_b64_tr_b16 v[218:219], v234 offset:11680
    v_mfma_f32_16x16x32_bf16 v[40:43], v[144:147], v[172:175], v[40:43]
    ds_read_b64_tr_b16 v[220:221], v234 offset:9408
    v_mfma_f32_16x16x32_bf16 v[44:47], v[148:151], v[172:175], v[44:47]
    ds_read_b64_tr_b16 v[222:223], v234 offset:11712
    v_mfma_f32_16x16x32_bf16 v[48:51], v[144:147], v[176:179], v[48:51]
    ds_read_b64_tr_b16 v[224:225], v234 offset:9440
    ds_read_b64_tr_b16 v[226:227], v234 offset:11744
    v_mfma_f32_16x16x32_bf16 v[52:55], v[148:151], v[176:179], v[52:55]
    ds_read_b64_tr_b16 v[228:229], v234 offset:9472
    v_mfma_f32_16x16x32_bf16 v[56:59], v[144:147], v[180:183], v[56:59]
    ds_read_b64_tr_b16 v[230:231], v234 offset:11776
    v_mfma_f32_16x16x32_bf16 v[60:63], v[148:151], v[180:183], v[60:63]
    v_mfma_f32_16x16x32_bf16 v[64:67], v[144:147], v[184:187], v[64:67]
    v_mfma_f32_16x16x32_bf16 v[68:71], v[148:151], v[184:187], v[68:71]
    s_waitcnt lgkmcnt(0)
    s_barrier
    v_mfma_f32_16x16x32_bf16 v[0:3], v[188:191], v[196:199], v[0:3]
    ds_read_b128 v[144:147], v232 offset:34816
    ds_read_b128 v[148:151], v232 offset:36864
    v_mfma_f32_16x16x32_bf16 v[4:7], v[192:195], v[196:199], v[4:7]
    ds_read_b64_tr_b16 v[152:153], v234 offset:34816
    v_mfma_f32_16x16x32_bf16 v[8:11], v[188:191], v[200:203], v[8:11]
    ds_read_b64_tr_b16 v[154:155], v234 offset:37120
    v_mfma_f32_16x16x32_bf16 v[12:15], v[192:195], v[200:203], v[12:15]
    ds_read_b64_tr_b16 v[156:157], v234 offset:34848
    ds_read_b64_tr_b16 v[158:159], v234 offset:37152
    v_mfma_f32_16x16x32_bf16 v[16:19], v[188:191], v[204:207], v[16:19]
    ds_read_b64_tr_b16 v[160:161], v234 offset:34880
    v_mfma_f32_16x16x32_bf16 v[20:23], v[192:195], v[204:207], v[20:23]
    ds_read_b64_tr_b16 v[162:163], v234 offset:37184
    v_mfma_f32_16x16x32_bf16 v[24:27], v[188:191], v[208:211], v[24:27]
    ds_read_b64_tr_b16 v[164:165], v234 offset:34912
    ds_read_b64_tr_b16 v[166:167], v234 offset:37216
    v_mfma_f32_16x16x32_bf16 v[28:31], v[192:195], v[208:211], v[28:31]
    ds_read_b64_tr_b16 v[168:169], v234 offset:34944
    v_mfma_f32_16x16x32_bf16 v[32:35], v[188:191], v[212:215], v[32:35]
    ds_read_b64_tr_b16 v[170:171], v234 offset:37248
    v_mfma_f32_16x16x32_bf16 v[36:39], v[192:195], v[212:215], v[36:39]
    ds_read_b64_tr_b16 v[172:173], v234 offset:34976
    ds_read_b64_tr_b16 v[174:175], v234 offset:37280
    v_mfma_f32_16x16x32_bf16 v[40:43], v[188:191], v[216:219], v[40:43]
    ds_read_b64_tr_b16 v[176:177], v234 offset:35008
    v_mfma_f32_16x16x32_bf16 v[44:47], v[192:195], v[216:219], v[44:47]
    ds_read_b64_tr_b16 v[178:179], v234 offset:37312
    v_mfma_f32_16x16x32_bf16 v[48:51], v[188:191], v[220:223], v[48:51]
    ds_read_b64_tr_b16 v[180:181], v234 offset:35040
    ds_read_b64_tr_b16 v[182:183], v234 offset:37344
    v_mfma_f32_16x16x32_bf16 v[52:55], v[192:195], v[220:223], v[52:55]
    ds_read_b64_tr_b16 v[184:185], v234 offset:35072
    v_mfma_f32_16x16x32_bf16 v[56:59], v[188:191], v[224:227], v[56:59]
    ds_read_b64_tr_b16 v[186:187], v234 offset:37376
    v_mfma_f32_16x16x32_bf16 v[60:63], v[192:195], v[224:227], v[60:63]
    v_mfma_f32_16x16x32_bf16 v[64:67], v[188:191], v[228:231], v[64:67]
    v_mfma_f32_16x16x32_bf16 v[68:71], v[192:195], v[228:231], v[68:71]
    s_waitcnt lgkmcnt(0)
    v_mfma_f32_16x16x32_bf16 v[0:3], v[144:147], v[152:155], v[0:3]
    ds_read_b128 v[188:191], v233 offset:34816
    ds_read_b128 v[192:195], v233 offset:36864
    v_mfma_f32_16x16x32_bf16 v[4:7], v[148:151], v[152:155], v[4:7]
    ds_read_b64_tr_b16 v[196:197], v234 offset:44032
    v_mfma_f32_16x16x32_bf16 v[8:11], v[144:147], v[156:159], v[8:11]
    ds_read_b64_tr_b16 v[198:199], v234 offset:46336
    v_mfma_f32_16x16x32_bf16 v[12:15], v[148:151], v[156:159], v[12:15]
    ds_read_b64_tr_b16 v[200:201], v234 offset:44064
    ds_read_b64_tr_b16 v[202:203], v234 offset:46368
    v_mfma_f32_16x16x32_bf16 v[16:19], v[144:147], v[160:163], v[16:19]
    ds_read_b64_tr_b16 v[204:205], v234 offset:44096
    v_mfma_f32_16x16x32_bf16 v[20:23], v[148:151], v[160:163], v[20:23]
    ds_read_b64_tr_b16 v[206:207], v234 offset:46400
    v_mfma_f32_16x16x32_bf16 v[24:27], v[144:147], v[164:167], v[24:27]
    ds_read_b64_tr_b16 v[208:209], v234 offset:44128
    ds_read_b64_tr_b16 v[210:211], v234 offset:46432
    v_mfma_f32_16x16x32_bf16 v[28:31], v[148:151], v[164:167], v[28:31]
    ds_read_b64_tr_b16 v[212:213], v234 offset:44160
    v_mfma_f32_16x16x32_bf16 v[32:35], v[144:147], v[168:171], v[32:35]
    ds_read_b64_tr_b16 v[214:215], v234 offset:46464
    v_mfma_f32_16x16x32_bf16 v[36:39], v[148:151], v[168:171], v[36:39]
    ds_read_b64_tr_b16 v[216:217], v234 offset:44192
    ds_read_b64_tr_b16 v[218:219], v234 offset:46496
    v_mfma_f32_16x16x32_bf16 v[40:43], v[144:147], v[172:175], v[40:43]
    ds_read_b64_tr_b16 v[220:221], v234 offset:44224
    v_mfma_f32_16x16x32_bf16 v[44:47], v[148:151], v[172:175], v[44:47]
    ds_read_b64_tr_b16 v[222:223], v234 offset:46528
    v_mfma_f32_16x16x32_bf16 v[48:51], v[144:147], v[176:179], v[48:51]
    ds_read_b64_tr_b16 v[224:225], v234 offset:44256
    ds_read_b64_tr_b16 v[226:227], v234 offset:46560
    v_mfma_f32_16x16x32_bf16 v[52:55], v[148:151], v[176:179], v[52:55]
    ds_read_b64_tr_b16 v[228:229], v234 offset:44288
    v_mfma_f32_16x16x32_bf16 v[56:59], v[144:147], v[180:183], v[56:59]
    ds_read_b64_tr_b16 v[230:231], v234 offset:46592
    v_mfma_f32_16x16x32_bf16 v[60:63], v[148:151], v[180:183], v[60:63]
    v_mfma_f32_16x16x32_bf16 v[64:67], v[144:147], v[184:187], v[64:67]
    v_mfma_f32_16x16x32_bf16 v[68:71], v[148:151], v[184:187], v[68:71]
    s_waitcnt lgkmcnt(0)
    s_barrier
    v_mfma_f32_16x16x32_bf16 v[0:3], v[188:191], v[196:199], v[0:3]
    ds_read_b128 v[144:147], v235 offset:0
    ds_read_b128 v[148:151], v235 offset:2048
    v_mfma_f32_16x16x32_bf16 v[4:7], v[192:195], v[196:199], v[4:7]
    ds_read_b64_tr_b16 v[152:153], v237 offset:0
    v_mfma_f32_16x16x32_bf16 v[8:11], v[188:191], v[200:203], v[8:11]
    ds_read_b64_tr_b16 v[154:155], v237 offset:2304
    v_mfma_f32_16x16x32_bf16 v[12:15], v[192:195], v[200:203], v[12:15]
    ds_read_b64_tr_b16 v[156:157], v237 offset:32
    ds_read_b64_tr_b16 v[158:159], v237 offset:2336
    v_mfma_f32_16x16x32_bf16 v[16:19], v[188:191], v[204:207], v[16:19]
    ds_read_b64_tr_b16 v[160:161], v237 offset:64
    v_mfma_f32_16x16x32_bf16 v[20:23], v[192:195], v[204:207], v[20:23]
    ds_read_b64_tr_b16 v[162:163], v237 offset:2368
    v_mfma_f32_16x16x32_bf16 v[24:27], v[188:191], v[208:211], v[24:27]
    ds_read_b64_tr_b16 v[164:165], v237 offset:96
    ds_read_b64_tr_b16 v[166:167], v237 offset:2400
    v_mfma_f32_16x16x32_bf16 v[28:31], v[192:195], v[208:211], v[28:31]
    ds_read_b64_tr_b16 v[168:169], v237 offset:128
    v_mfma_f32_16x16x32_bf16 v[32:35], v[188:191], v[212:215], v[32:35]
    ds_read_b64_tr_b16 v[170:171], v237 offset:2432
    v_mfma_f32_16x16x32_bf16 v[36:39], v[192:195], v[212:215], v[36:39]
    ds_read_b64_tr_b16 v[172:173], v237 offset:160
    ds_read_b64_tr_b16 v[174:175], v237 offset:2464
    v_mfma_f32_16x16x32_bf16 v[40:43], v[188:191], v[216:219], v[40:43]
    ds_read_b64_tr_b16 v[176:177], v237 offset:192
    v_mfma_f32_16x16x32_bf16 v[44:47], v[192:195], v[216:219], v[44:47]
    ds_read_b64_tr_b16 v[178:179], v237 offset:2496
    v_mfma_f32_16x16x32_bf16 v[48:51], v[188:191], v[220:223], v[48:51]
    ds_read_b64_tr_b16 v[180:181], v237 offset:224
    ds_read_b64_tr_b16 v[182:183], v237 offset:2528
    v_mfma_f32_16x16x32_bf16 v[52:55], v[192:195], v[220:223], v[52:55]
    ds_read_b64_tr_b16 v[184:185], v237 offset:256
    v_mfma_f32_16x16x32_bf16 v[56:59], v[188:191], v[224:227], v[56:59]
    ds_read_b64_tr_b16 v[186:187], v237 offset:2560
    v_mfma_f32_16x16x32_bf16 v[60:63], v[192:195], v[224:227], v[60:63]
    v_mfma_f32_16x16x32_bf16 v[64:67], v[188:191], v[228:231], v[64:67]
    v_mfma_f32_16x16x32_bf16 v[68:71], v[192:195], v[228:231], v[68:71]
    s_waitcnt lgkmcnt(0)
    v_mfma_f32_16x16x32_bf16 v[0:3], v[144:147], v[152:155], v[0:3]
    ds_read_b128 v[188:191], v236 offset:0
    ds_read_b128 v[192:195], v236 offset:2048
    v_mfma_f32_16x16x32_bf16 v[4:7], v[148:151], v[152:155], v[4:7]
    ds_read_b64_tr_b16 v[196:197], v237 offset:9216
    v_mfma_f32_16x16x32_bf16 v[8:11], v[144:147], v[156:159], v[8:11]
    ds_read_b64_tr_b16 v[198:199], v237 offset:11520
    v_mfma_f32_16x16x32_bf16 v[12:15], v[148:151], v[156:159], v[12:15]
    ds_read_b64_tr_b16 v[200:201], v237 offset:9248
    ds_read_b64_tr_b16 v[202:203], v237 offset:11552
    v_mfma_f32_16x16x32_bf16 v[16:19], v[144:147], v[160:163], v[16:19]
    ds_read_b64_tr_b16 v[204:205], v237 offset:9280
    v_mfma_f32_16x16x32_bf16 v[20:23], v[148:151], v[160:163], v[20:23]
    ds_read_b64_tr_b16 v[206:207], v237 offset:11584
    v_mfma_f32_16x16x32_bf16 v[24:27], v[144:147], v[164:167], v[24:27]
    ds_read_b64_tr_b16 v[208:209], v237 offset:9312
    ds_read_b64_tr_b16 v[210:211], v237 offset:11616
    v_mfma_f32_16x16x32_bf16 v[28:31], v[148:151], v[164:167], v[28:31]
    ds_read_b64_tr_b16 v[212:213], v237 offset:9344
    v_mfma_f32_16x16x32_bf16 v[32:35], v[144:147], v[168:171], v[32:35]
    ds_read_b64_tr_b16 v[214:215], v237 offset:11648
    v_mfma_f32_16x16x32_bf16 v[36:39], v[148:151], v[168:171], v[36:39]
    ds_read_b64_tr_b16 v[216:217], v237 offset:9376
    ds_read_b64_tr_b16 v[218:219], v237 offset:11680
    v_mfma_f32_16x16x32_bf16 v[40:43], v[144:147], v[172:175], v[40:43]
    ds_read_b64_tr_b16 v[220:221], v237 offset:9408
    v_mfma_f32_16x16x32_bf16 v[44:47], v[148:151], v[172:175], v[44:47]
    ds_read_b64_tr_b16 v[222:223], v237 offset:11712
    v_mfma_f32_16x16x32_bf16 v[48:51], v[144:147], v[176:179], v[48:51]
    ds_read_b64_tr_b16 v[224:225], v237 offset:9440
    ds_read_b64_tr_b16 v[226:227], v237 offset:11744
    v_mfma_f32_16x16x32_bf16 v[52:55], v[148:151], v[176:179], v[52:55]
    ds_read_b64_tr_b16 v[228:229], v237 offset:9472
    v_mfma_f32_16x16x32_bf16 v[56:59], v[144:147], v[180:183], v[56:59]
    ds_read_b64_tr_b16 v[230:231], v237 offset:11776
    v_mfma_f32_16x16x32_bf16 v[60:63], v[148:151], v[180:183], v[60:63]
    v_mfma_f32_16x16x32_bf16 v[64:67], v[144:147], v[184:187], v[64:67]
    v_mfma_f32_16x16x32_bf16 v[68:71], v[148:151], v[184:187], v[68:71]
    s_waitcnt lgkmcnt(0)
    v_mfma_f32_16x16x32_bf16 v[0:3], v[188:191], v[196:199], v[0:3]
    v_mfma_f32_16x16x32_bf16 v[4:7], v[192:195], v[196:199], v[4:7]
    v_mfma_f32_16x16x32_bf16 v[8:11], v[188:191], v[200:203], v[8:11]
    v_mfma_f32_16x16x32_bf16 v[12:15], v[192:195], v[200:203], v[12:15]
    v_mfma_f32_16x16x32_bf16 v[16:19], v[188:191], v[204:207], v[16:19]
    v_mfma_f32_16x16x32_bf16 v[20:23], v[192:195], v[204:207], v[20:23]
    v_mfma_f32_16x16x32_bf16 v[24:27], v[188:191], v[208:211], v[24:27]
    v_mfma_f32_16x16x32_bf16 v[28:31], v[192:195], v[208:211], v[28:31]
    v_mfma_f32_16x16x32_bf16 v[32:35], v[188:191], v[212:215], v[32:35]
    v_mfma_f32_16x16x32_bf16 v[36:39], v[192:195], v[212:215], v[36:39]
    v_mfma_f32_16x16x32_bf16 v[40:43], v[188:191], v[216:219], v[40:43]
    v_mfma_f32_16x16x32_bf16 v[44:47], v[192:195], v[216:219], v[44:47]
    v_mfma_f32_16x16x32_bf16 v[48:51], v[188:191], v[220:223], v[48:51]
    v_mfma_f32_16x16x32_bf16 v[52:55], v[192:195], v[220:223], v[52:55]
    v_mfma_f32_16x16x32_bf16 v[56:59], v[188:191], v[224:227], v[56:59]
    v_mfma_f32_16x16x32_bf16 v[60:63], v[192:195], v[224:227], v[60:63]
    v_mfma_f32_16x16x32_bf16 v[64:67], v[188:191], v[228:231], v[64:67]
    v_mfma_f32_16x16x32_bf16 v[68:71], v[192:195], v[228:231], v[68:71]
    v_and_b32 v196, 15, v255
    v_lshlrev_b32 v196, 2, v196
    v_add_u32 v197, 140288, v196
    s_lshl_b32 s33, s22, 7
    s_add_u32 s33, s33, 139264
    v_add_u32 v196, s33, v196
    v_lshrrev_b32 v198, 4, v255
    v_lshlrev_b32 v198, 4, v198
    v_add_u32 v198, s33, v198
    s_barrier
    ds_read_b128 v[144:147], v198
    ds_read_b128 v[148:151], v198 offset:64
    ds_read_b128 v[152:155], v198 offset:512
    ds_read_b128 v[156:159], v198 offset:576
    ds_read_b32 v160, v197 offset:0
    ds_read_b32 v164, v197 offset:64
    ds_read_b32 v168, v197 offset:128
    ds_read_b32 v172, v197 offset:192
    ds_read_b32 v176, v197 offset:256
    ds_read_b32 v180, v197 offset:320
    ds_read_b32 v184, v197 offset:384
    ds_read_b32 v188, v197 offset:448
    ds_read_b32 v192, v197 offset:512
    s_waitcnt lgkmcnt(0)
    v_pk_mul_f32 v[196:197], v[144:145], v[160:161] op_sel_hi:[1,0]
    v_pk_mul_f32 v[198:199], v[146:147], v[160:161] op_sel_hi:[1,0]
    v_pk_mul_f32 v[200:201], v[148:149], v[160:161] op_sel_hi:[1,0]
    v_pk_mul_f32 v[202:203], v[150:151], v[160:161] op_sel_hi:[1,0]
    v_pk_fma_f32 v[0:1], v[0:1], v[152:153], v[196:197]
    v_pk_fma_f32 v[2:3], v[2:3], v[154:155], v[198:199]
    v_pk_fma_f32 v[4:5], v[4:5], v[156:157], v[200:201]
    v_pk_fma_f32 v[6:7], v[6:7], v[158:159], v[202:203]
    v_pk_mul_f32 v[196:197], v[0:1], v[0:1]
    v_pk_mul_f32 v[198:199], v[2:3], v[2:3]
    v_pk_mul_f32 v[200:201], v[4:5], v[4:5]
    v_pk_mul_f32 v[202:203], v[6:7], v[6:7]
    v_pk_fma_f32 v[196:197], v[196:197], s[56:57], v[242:243]
    v_pk_fma_f32 v[198:199], v[198:199], s[56:57], v[242:243]
    v_pk_fma_f32 v[200:201], v[200:201], s[56:57], v[242:243]
    v_pk_fma_f32 v[202:203], v[202:203], s[56:57], v[242:243]
    v_pk_mul_f32 v[196:197], v[196:197], v[0:1]
    v_pk_mul_f32 v[198:199], v[198:199], v[2:3]
    v_pk_mul_f32 v[200:201], v[200:201], v[4:5]
    v_pk_mul_f32 v[202:203], v[202:203], v[6:7]
    v_exp_f32 v196, v196
    v_exp_f32 v197, v197
    v_exp_f32 v198, v198
    v_exp_f32 v199, v199
    v_exp_f32 v200, v200
    v_exp_f32 v201, v201
    v_exp_f32 v202, v202
    v_exp_f32 v203, v203
    v_pk_add_f32 v[196:197], v[196:197], v[244:245]
    v_pk_add_f32 v[198:199], v[198:199], v[244:245]
    v_pk_add_f32 v[200:201], v[200:201], v[244:245]
    v_pk_add_f32 v[202:203], v[202:203], v[244:245]
    v_rcp_f32 v196, v196
    v_rcp_f32 v197, v197
    v_rcp_f32 v198, v198
    v_rcp_f32 v199, v199
    v_rcp_f32 v200, v200
    v_rcp_f32 v201, v201
    v_rcp_f32 v202, v202
    v_rcp_f32 v203, v203
    v_pk_mul_f32 v[0:1], v[0:1], v[196:197]
    v_pk_mul_f32 v[2:3], v[2:3], v[198:199]
    v_pk_mul_f32 v[4:5], v[4:5], v[200:201]
    v_pk_mul_f32 v[6:7], v[6:7], v[202:203]
    v_pk_mul_f32 v[220:221], v[0:1], v[0:1]
    v_mov_b32 v212, v0
    v_mov_b32 v213, v1
    v_pk_mul_f32 v[222:223], v[2:3], v[2:3]
    v_mov_b32 v214, v2
    v_mov_b32 v215, v3
    v_pk_mul_f32 v[224:225], v[4:5], v[4:5]
    v_mov_b32 v216, v4
    v_mov_b32 v217, v5
    v_pk_mul_f32 v[226:227], v[6:7], v[6:7]
    v_mov_b32 v218, v6
    v_mov_b32 v219, v7
    v_pk_mul_f32 v[196:197], v[144:145], v[164:165] op_sel_hi:[1,0]
    v_pk_mul_f32 v[198:199], v[146:147], v[164:165] op_sel_hi:[1,0]
    v_pk_mul_f32 v[200:201], v[148:149], v[164:165] op_sel_hi:[1,0]
    v_pk_mul_f32 v[202:203], v[150:151], v[164:165] op_sel_hi:[1,0]
    v_pk_fma_f32 v[8:9], v[8:9], v[152:153], v[196:197]
    v_pk_fma_f32 v[10:11], v[10:11], v[154:155], v[198:199]
    v_pk_fma_f32 v[12:13], v[12:13], v[156:157], v[200:201]
    v_pk_fma_f32 v[14:15], v[14:15], v[158:159], v[202:203]
    v_pk_mul_f32 v[196:197], v[8:9], v[8:9]
    v_pk_mul_f32 v[198:199], v[10:11], v[10:11]
    v_pk_mul_f32 v[200:201], v[12:13], v[12:13]
    v_pk_mul_f32 v[202:203], v[14:15], v[14:15]
    v_pk_fma_f32 v[196:197], v[196:197], s[56:57], v[242:243]
    v_pk_fma_f32 v[198:199], v[198:199], s[56:57], v[242:243]
    v_pk_fma_f32 v[200:201], v[200:201], s[56:57], v[242:243]
    v_pk_fma_f32 v[202:203], v[202:203], s[56:57], v[242:243]
    v_pk_mul_f32 v[196:197], v[196:197], v[8:9]
    v_pk_mul_f32 v[198:199], v[198:199], v[10:11]
    v_pk_mul_f32 v[200:201], v[200:201], v[12:13]
    v_pk_mul_f32 v[202:203], v[202:203], v[14:15]
    v_exp_f32 v196, v196
    v_exp_f32 v197, v197
    v_exp_f32 v198, v198
    v_exp_f32 v199, v199
    v_exp_f32 v200, v200
    v_exp_f32 v201, v201
    v_exp_f32 v202, v202
    v_exp_f32 v203, v203
    v_pk_add_f32 v[196:197], v[196:197], v[244:245]
    v_pk_add_f32 v[198:199], v[198:199], v[244:245]
    v_pk_add_f32 v[200:201], v[200:201], v[244:245]
    v_pk_add_f32 v[202:203], v[202:203], v[244:245]
    v_rcp_f32 v196, v196
    v_rcp_f32 v197, v197
    v_rcp_f32 v198, v198
    v_rcp_f32 v199, v199
    v_rcp_f32 v200, v200
    v_rcp_f32 v201, v201
    v_rcp_f32 v202, v202
    v_rcp_f32 v203, v203
    v_pk_mul_f32 v[8:9], v[8:9], v[196:197]
    v_pk_mul_f32 v[10:11], v[10:11], v[198:199]
    v_pk_mul_f32 v[12:13], v[12:13], v[200:201]
    v_pk_mul_f32 v[14:15], v[14:15], v[202:203]
    v_pk_fma_f32 v[220:221], v[8:9], v[8:9], v[220:221]
    v_pk_add_f32 v[212:213], v[212:213], v[8:9]
    v_pk_fma_f32 v[222:223], v[10:11], v[10:11], v[222:223]
    v_pk_add_f32 v[214:215], v[214:215], v[10:11]
    v_pk_fma_f32 v[224:225], v[12:13], v[12:13], v[224:225]
    v_pk_add_f32 v[216:217], v[216:217], v[12:13]
    v_pk_fma_f32 v[226:227], v[14:15], v[14:15], v[226:227]
    v_pk_add_f32 v[218:219], v[218:219], v[14:15]
    v_pk_mul_f32 v[196:197], v[144:145], v[168:169] op_sel_hi:[1,0]
    v_pk_mul_f32 v[198:199], v[146:147], v[168:169] op_sel_hi:[1,0]
    v_pk_mul_f32 v[200:201], v[148:149], v[168:169] op_sel_hi:[1,0]
    v_pk_mul_f32 v[202:203], v[150:151], v[168:169] op_sel_hi:[1,0]
    v_pk_fma_f32 v[16:17], v[16:17], v[152:153], v[196:197]
    v_pk_fma_f32 v[18:19], v[18:19], v[154:155], v[198:199]
    v_pk_fma_f32 v[20:21], v[20:21], v[156:157], v[200:201]
    v_pk_fma_f32 v[22:23], v[22:23], v[158:159], v[202:203]
    v_pk_mul_f32 v[196:197], v[16:17], v[16:17]
    v_pk_mul_f32 v[198:199], v[18:19], v[18:19]
    v_pk_mul_f32 v[200:201], v[20:21], v[20:21]
    v_pk_mul_f32 v[202:203], v[22:23], v[22:23]
    v_pk_fma_f32 v[196:197], v[196:197], s[56:57], v[242:243]
    v_pk_fma_f32 v[198:199], v[198:199], s[56:57], v[242:243]
    v_pk_fma_f32 v[200:201], v[200:201], s[56:57], v[242:243]
    v_pk_fma_f32 v[202:203], v[202:203], s[56:57], v[242:243]
    v_pk_mul_f32 v[196:197], v[196:197], v[16:17]
    v_pk_mul_f32 v[198:199], v[198:199], v[18:19]
    v_pk_mul_f32 v[200:201], v[200:201], v[20:21]
    v_pk_mul_f32 v[202:203], v[202:203], v[22:23]
    v_exp_f32 v196, v196
    v_exp_f32 v197, v197
    v_exp_f32 v198, v198
    v_exp_f32 v199, v199
    v_exp_f32 v200, v200
    v_exp_f32 v201, v201
    v_exp_f32 v202, v202
    v_exp_f32 v203, v203
    v_pk_add_f32 v[196:197], v[196:197], v[244:245]
    v_pk_add_f32 v[198:199], v[198:199], v[244:245]
    v_pk_add_f32 v[200:201], v[200:201], v[244:245]
    v_pk_add_f32 v[202:203], v[202:203], v[244:245]
    v_rcp_f32 v196, v196
    v_rcp_f32 v197, v197
    v_rcp_f32 v198, v198
    v_rcp_f32 v199, v199
    v_rcp_f32 v200, v200
    v_rcp_f32 v201, v201
    v_rcp_f32 v202, v202
    v_rcp_f32 v203, v203
    v_pk_mul_f32 v[16:17], v[16:17], v[196:197]
    v_pk_mul_f32 v[18:19], v[18:19], v[198:199]
    v_pk_mul_f32 v[20:21], v[20:21], v[200:201]
    v_pk_mul_f32 v[22:23], v[22:23], v[202:203]
    v_pk_fma_f32 v[220:221], v[16:17], v[16:17], v[220:221]
    v_pk_add_f32 v[212:213], v[212:213], v[16:17]
    v_pk_fma_f32 v[222:223], v[18:19], v[18:19], v[222:223]
    v_pk_add_f32 v[214:215], v[214:215], v[18:19]
    v_pk_fma_f32 v[224:225], v[20:21], v[20:21], v[224:225]
    v_pk_add_f32 v[216:217], v[216:217], v[20:21]
    v_pk_fma_f32 v[226:227], v[22:23], v[22:23], v[226:227]
    v_pk_add_f32 v[218:219], v[218:219], v[22:23]
    v_pk_mul_f32 v[196:197], v[144:145], v[172:173] op_sel_hi:[1,0]
    v_pk_mul_f32 v[198:199], v[146:147], v[172:173] op_sel_hi:[1,0]
    v_pk_mul_f32 v[200:201], v[148:149], v[172:173] op_sel_hi:[1,0]
    v_pk_mul_f32 v[202:203], v[150:151], v[172:173] op_sel_hi:[1,0]
    v_pk_fma_f32 v[24:25], v[24:25], v[152:153], v[196:197]
    v_pk_fma_f32 v[26:27], v[26:27], v[154:155], v[198:199]
    v_pk_fma_f32 v[28:29], v[28:29], v[156:157], v[200:201]
    v_pk_fma_f32 v[30:31], v[30:31], v[158:159], v[202:203]
    v_pk_mul_f32 v[196:197], v[24:25], v[24:25]
    v_pk_mul_f32 v[198:199], v[26:27], v[26:27]
    v_pk_mul_f32 v[200:201], v[28:29], v[28:29]
    v_pk_mul_f32 v[202:203], v[30:31], v[30:31]
    v_pk_fma_f32 v[196:197], v[196:197], s[56:57], v[242:243]
    v_pk_fma_f32 v[198:199], v[198:199], s[56:57], v[242:243]
    v_pk_fma_f32 v[200:201], v[200:201], s[56:57], v[242:243]
    v_pk_fma_f32 v[202:203], v[202:203], s[56:57], v[242:243]
    v_pk_mul_f32 v[196:197], v[196:197], v[24:25]
    v_pk_mul_f32 v[198:199], v[198:199], v[26:27]
    v_pk_mul_f32 v[200:201], v[200:201], v[28:29]
    v_pk_mul_f32 v[202:203], v[202:203], v[30:31]
    v_exp_f32 v196, v196
    v_exp_f32 v197, v197
    v_exp_f32 v198, v198
    v_exp_f32 v199, v199
    v_exp_f32 v200, v200
    v_exp_f32 v201, v201
    v_exp_f32 v202, v202
    v_exp_f32 v203, v203
    v_pk_add_f32 v[196:197], v[196:197], v[244:245]
    v_pk_add_f32 v[198:199], v[198:199], v[244:245]
    v_pk_add_f32 v[200:201], v[200:201], v[244:245]
    v_pk_add_f32 v[202:203], v[202:203], v[244:245]
    v_rcp_f32 v196, v196
    v_rcp_f32 v197, v197
    v_rcp_f32 v198, v198
    v_rcp_f32 v199, v199
    v_rcp_f32 v200, v200
    v_rcp_f32 v201, v201
    v_rcp_f32 v202, v202
    v_rcp_f32 v203, v203
    v_pk_mul_f32 v[24:25], v[24:25], v[196:197]
    v_pk_mul_f32 v[26:27], v[26:27], v[198:199]
    v_pk_mul_f32 v[28:29], v[28:29], v[200:201]
    v_pk_mul_f32 v[30:31], v[30:31], v[202:203]
    v_pk_fma_f32 v[220:221], v[24:25], v[24:25], v[220:221]
    v_pk_add_f32 v[212:213], v[212:213], v[24:25]
    v_pk_fma_f32 v[222:223], v[26:27], v[26:27], v[222:223]
    v_pk_add_f32 v[214:215], v[214:215], v[26:27]
    v_pk_fma_f32 v[224:225], v[28:29], v[28:29], v[224:225]
    v_pk_add_f32 v[216:217], v[216:217], v[28:29]
    v_pk_fma_f32 v[226:227], v[30:31], v[30:31], v[226:227]
    v_pk_add_f32 v[218:219], v[218:219], v[30:31]
    v_pk_mul_f32 v[196:197], v[144:145], v[176:177] op_sel_hi:[1,0]
    v_pk_mul_f32 v[198:199], v[146:147], v[176:177] op_sel_hi:[1,0]
    v_pk_mul_f32 v[200:201], v[148:149], v[176:177] op_sel_hi:[1,0]
    v_pk_mul_f32 v[202:203], v[150:151], v[176:177] op_sel_hi:[1,0]
    v_pk_fma_f32 v[32:33], v[32:33], v[152:153], v[196:197]
    v_pk_fma_f32 v[34:35], v[34:35], v[154:155], v[198:199]
    v_pk_fma_f32 v[36:37], v[36:37], v[156:157], v[200:201]
    v_pk_fma_f32 v[38:39], v[38:39], v[158:159], v[202:203]
    v_pk_mul_f32 v[196:197], v[32:33], v[32:33]
    v_pk_mul_f32 v[198:199], v[34:35], v[34:35]
    v_pk_mul_f32 v[200:201], v[36:37], v[36:37]
    v_pk_mul_f32 v[202:203], v[38:39], v[38:39]
    v_pk_fma_f32 v[196:197], v[196:197], s[56:57], v[242:243]
    v_pk_fma_f32 v[198:199], v[198:199], s[56:57], v[242:243]
    v_pk_fma_f32 v[200:201], v[200:201], s[56:57], v[242:243]
    v_pk_fma_f32 v[202:203], v[202:203], s[56:57], v[242:243]
    v_pk_mul_f32 v[196:197], v[196:197], v[32:33]
    v_pk_mul_f32 v[198:199], v[198:199], v[34:35]
    v_pk_mul_f32 v[200:201], v[200:201], v[36:37]
    v_pk_mul_f32 v[202:203], v[202:203], v[38:39]
    v_exp_f32 v196, v196
    v_exp_f32 v197, v197
    v_exp_f32 v198, v198
    v_exp_f32 v199, v199
    v_exp_f32 v200, v200
    v_exp_f32 v201, v201
    v_exp_f32 v202, v202
    v_exp_f32 v203, v203
    v_pk_add_f32 v[196:197], v[196:197], v[244:245]
    v_pk_add_f32 v[198:199], v[198:199], v[244:245]
    v_pk_add_f32 v[200:201], v[200:201], v[244:245]
    v_pk_add_f32 v[202:203], v[202:203], v[244:245]
    v_rcp_f32 v196, v196
    v_rcp_f32 v197, v197
    v_rcp_f32 v198, v198
    v_rcp_f32 v199, v199
    v_rcp_f32 v200, v200
    v_rcp_f32 v201, v201
    v_rcp_f32 v202, v202
    v_rcp_f32 v203, v203
    v_pk_mul_f32 v[32:33], v[32:33], v[196:197]
    v_pk_mul_f32 v[34:35], v[34:35], v[198:199]
    v_pk_mul_f32 v[36:37], v[36:37], v[200:201]
    v_pk_mul_f32 v[38:39], v[38:39], v[202:203]
    v_pk_fma_f32 v[220:221], v[32:33], v[32:33], v[220:221]
    v_pk_add_f32 v[212:213], v[212:213], v[32:33]
    v_pk_fma_f32 v[222:223], v[34:35], v[34:35], v[222:223]
    v_pk_add_f32 v[214:215], v[214:215], v[34:35]
    v_pk_fma_f32 v[224:225], v[36:37], v[36:37], v[224:225]
    v_pk_add_f32 v[216:217], v[216:217], v[36:37]
    v_pk_fma_f32 v[226:227], v[38:39], v[38:39], v[226:227]
    v_pk_add_f32 v[218:219], v[218:219], v[38:39]
    v_pk_mul_f32 v[196:197], v[144:145], v[180:181] op_sel_hi:[1,0]
    v_pk_mul_f32 v[198:199], v[146:147], v[180:181] op_sel_hi:[1,0]
    v_pk_mul_f32 v[200:201], v[148:149], v[180:181] op_sel_hi:[1,0]
    v_pk_mul_f32 v[202:203], v[150:151], v[180:181] op_sel_hi:[1,0]
    v_pk_fma_f32 v[40:41], v[40:41], v[152:153], v[196:197]
    v_pk_fma_f32 v[42:43], v[42:43], v[154:155], v[198:199]
    v_pk_fma_f32 v[44:45], v[44:45], v[156:157], v[200:201]
    v_pk_fma_f32 v[46:47], v[46:47], v[158:159], v[202:203]
    v_pk_mul_f32 v[196:197], v[40:41], v[40:41]
    v_pk_mul_f32 v[198:199], v[42:43], v[42:43]
    v_pk_mul_f32 v[200:201], v[44:45], v[44:45]
    v_pk_mul_f32 v[202:203], v[46:47], v[46:47]
    v_pk_fma_f32 v[196:197], v[196:197], s[56:57], v[242:243]
    v_pk_fma_f32 v[198:199], v[198:199], s[56:57], v[242:243]
    v_pk_fma_f32 v[200:201], v[200:201], s[56:57], v[242:243]
    v_pk_fma_f32 v[202:203], v[202:203], s[56:57], v[242:243]
    v_pk_mul_f32 v[196:197], v[196:197], v[40:41]
    v_pk_mul_f32 v[198:199], v[198:199], v[42:43]
    v_pk_mul_f32 v[200:201], v[200:201], v[44:45]
    v_pk_mul_f32 v[202:203], v[202:203], v[46:47]
    v_exp_f32 v196, v196
    v_exp_f32 v197, v197
    v_exp_f32 v198, v198
    v_exp_f32 v199, v199
    v_exp_f32 v200, v200
    v_exp_f32 v201, v201
    v_exp_f32 v202, v202
    v_exp_f32 v203, v203
    v_pk_add_f32 v[196:197], v[196:197], v[244:245]
    v_pk_add_f32 v[198:199], v[198:199], v[244:245]
    v_pk_add_f32 v[200:201], v[200:201], v[244:245]
    v_pk_add_f32 v[202:203], v[202:203], v[244:245]
    v_rcp_f32 v196, v196
    v_rcp_f32 v197, v197
    v_rcp_f32 v198, v198
    v_rcp_f32 v199, v199
    v_rcp_f32 v200, v200
    v_rcp_f32 v201, v201
    v_rcp_f32 v202, v202
    v_rcp_f32 v203, v203
    v_pk_mul_f32 v[40:41], v[40:41], v[196:197]
    v_pk_mul_f32 v[42:43], v[42:43], v[198:199]
    v_pk_mul_f32 v[44:45], v[44:45], v[200:201]
    v_pk_mul_f32 v[46:47], v[46:47], v[202:203]
    v_pk_fma_f32 v[220:221], v[40:41], v[40:41], v[220:221]
    v_pk_add_f32 v[212:213], v[212:213], v[40:41]
    v_pk_fma_f32 v[222:223], v[42:43], v[42:43], v[222:223]
    v_pk_add_f32 v[214:215], v[214:215], v[42:43]
    v_pk_fma_f32 v[224:225], v[44:45], v[44:45], v[224:225]
    v_pk_add_f32 v[216:217], v[216:217], v[44:45]
    v_pk_fma_f32 v[226:227], v[46:47], v[46:47], v[226:227]
    v_pk_add_f32 v[218:219], v[218:219], v[46:47]
    v_pk_mul_f32 v[196:197], v[144:145], v[184:185] op_sel_hi:[1,0]
    v_pk_mul_f32 v[198:199], v[146:147], v[184:185] op_sel_hi:[1,0]
    v_pk_mul_f32 v[200:201], v[148:149], v[184:185] op_sel_hi:[1,0]
    v_pk_mul_f32 v[202:203], v[150:151], v[184:185] op_sel_hi:[1,0]
    v_pk_fma_f32 v[48:49], v[48:49], v[152:153], v[196:197]
    v_pk_fma_f32 v[50:51], v[50:51], v[154:155], v[198:199]
    v_pk_fma_f32 v[52:53], v[52:53], v[156:157], v[200:201]
    v_pk_fma_f32 v[54:55], v[54:55], v[158:159], v[202:203]
    v_pk_mul_f32 v[196:197], v[48:49], v[48:49]
    v_pk_mul_f32 v[198:199], v[50:51], v[50:51]
    v_pk_mul_f32 v[200:201], v[52:53], v[52:53]
    v_pk_mul_f32 v[202:203], v[54:55], v[54:55]
    v_pk_fma_f32 v[196:197], v[196:197], s[56:57], v[242:243]
    v_pk_fma_f32 v[198:199], v[198:199], s[56:57], v[242:243]
    v_pk_fma_f32 v[200:201], v[200:201], s[56:57], v[242:243]
    v_pk_fma_f32 v[202:203], v[202:203], s[56:57], v[242:243]
    v_pk_mul_f32 v[196:197], v[196:197], v[48:49]
    v_pk_mul_f32 v[198:199], v[198:199], v[50:51]
    v_pk_mul_f32 v[200:201], v[200:201], v[52:53]
    v_pk_mul_f32 v[202:203], v[202:203], v[54:55]
    v_exp_f32 v196, v196
    v_exp_f32 v197, v197
    v_exp_f32 v198, v198
    v_exp_f32 v199, v199
    v_exp_f32 v200, v200
    v_exp_f32 v201, v201
    v_exp_f32 v202, v202
    v_exp_f32 v203, v203
    v_pk_add_f32 v[196:197], v[196:197], v[244:245]
    v_pk_add_f32 v[198:199], v[198:199], v[244:245]
    v_pk_add_f32 v[200:201], v[200:201], v[244:245]
    v_pk_add_f32 v[202:203], v[202:203], v[244:245]
    v_rcp_f32 v196, v196
    v_rcp_f32 v197, v197
    v_rcp_f32 v198, v198
    v_rcp_f32 v199, v199
    v_rcp_f32 v200, v200
    v_rcp_f32 v201, v201
    v_rcp_f32 v202, v202
    v_rcp_f32 v203, v203
    v_pk_mul_f32 v[48:49], v[48:49], v[196:197]
    v_pk_mul_f32 v[50:51], v[50:51], v[198:199]
    v_pk_mul_f32 v[52:53], v[52:53], v[200:201]
    v_pk_mul_f32 v[54:55], v[54:55], v[202:203]
    v_pk_fma_f32 v[220:221], v[48:49], v[48:49], v[220:221]
    v_pk_add_f32 v[212:213], v[212:213], v[48:49]
    v_pk_fma_f32 v[222:223], v[50:51], v[50:51], v[222:223]
    v_pk_add_f32 v[214:215], v[214:215], v[50:51]
    v_pk_fma_f32 v[224:225], v[52:53], v[52:53], v[224:225]
    v_pk_add_f32 v[216:217], v[216:217], v[52:53]
    v_pk_fma_f32 v[226:227], v[54:55], v[54:55], v[226:227]
    v_pk_add_f32 v[218:219], v[218:219], v[54:55]
    v_pk_mul_f32 v[196:197], v[144:145], v[188:189] op_sel_hi:[1,0]
    v_pk_mul_f32 v[198:199], v[146:147], v[188:189] op_sel_hi:[1,0]
    v_pk_mul_f32 v[200:201], v[148:149], v[188:189] op_sel_hi:[1,0]
    v_pk_mul_f32 v[202:203], v[150:151], v[188:189] op_sel_hi:[1,0]
    v_pk_fma_f32 v[56:57], v[56:57], v[152:153], v[196:197]
    v_pk_fma_f32 v[58:59], v[58:59], v[154:155], v[198:199]
    v_pk_fma_f32 v[60:61], v[60:61], v[156:157], v[200:201]
    v_pk_fma_f32 v[62:63], v[62:63], v[158:159], v[202:203]
    v_pk_mul_f32 v[196:197], v[56:57], v[56:57]
    v_pk_mul_f32 v[198:199], v[58:59], v[58:59]
    v_pk_mul_f32 v[200:201], v[60:61], v[60:61]
    v_pk_mul_f32 v[202:203], v[62:63], v[62:63]
    v_pk_fma_f32 v[196:197], v[196:197], s[56:57], v[242:243]
    v_pk_fma_f32 v[198:199], v[198:199], s[56:57], v[242:243]
    v_pk_fma_f32 v[200:201], v[200:201], s[56:57], v[242:243]
    v_pk_fma_f32 v[202:203], v[202:203], s[56:57], v[242:243]
    v_pk_mul_f32 v[196:197], v[196:197], v[56:57]
    v_pk_mul_f32 v[198:199], v[198:199], v[58:59]
    v_pk_mul_f32 v[200:201], v[200:201], v[60:61]
    v_pk_mul_f32 v[202:203], v[202:203], v[62:63]
    v_exp_f32 v196, v196
    v_exp_f32 v197, v197
    v_exp_f32 v198, v198
    v_exp_f32 v199, v199
    v_exp_f32 v200, v200
    v_exp_f32 v201, v201
    v_exp_f32 v202, v202
    v_exp_f32 v203, v203
    v_pk_add_f32 v[196:197], v[196:197], v[244:245]
    v_pk_add_f32 v[198:199], v[198:199], v[244:245]
    v_pk_add_f32 v[200:201], v[200:201], v[244:245]
    v_pk_add_f32 v[202:203], v[202:203], v[244:245]
    v_rcp_f32 v196, v196
    v_rcp_f32 v197, v197
    v_rcp_f32 v198, v198
    v_rcp_f32 v199, v199
    v_rcp_f32 v200, v200
    v_rcp_f32 v201, v201
    v_rcp_f32 v202, v202
    v_rcp_f32 v203, v203
    v_pk_mul_f32 v[56:57], v[56:57], v[196:197]
    v_pk_mul_f32 v[58:59], v[58:59], v[198:199]
    v_pk_mul_f32 v[60:61], v[60:61], v[200:201]
    v_pk_mul_f32 v[62:63], v[62:63], v[202:203]
    v_pk_fma_f32 v[220:221], v[56:57], v[56:57], v[220:221]
    v_pk_add_f32 v[212:213], v[212:213], v[56:57]
    v_pk_fma_f32 v[222:223], v[58:59], v[58:59], v[222:223]
    v_pk_add_f32 v[214:215], v[214:215], v[58:59]
    v_pk_fma_f32 v[224:225], v[60:61], v[60:61], v[224:225]
    v_pk_add_f32 v[216:217], v[216:217], v[60:61]
    v_pk_fma_f32 v[226:227], v[62:63], v[62:63], v[226:227]
    v_pk_add_f32 v[218:219], v[218:219], v[62:63]
    v_pk_mul_f32 v[196:197], v[144:145], v[192:193] op_sel_hi:[1,0]
    v_pk_mul_f32 v[198:199], v[146:147], v[192:193] op_sel_hi:[1,0]
    v_pk_mul_f32 v[200:201], v[148:149], v[192:193] op_sel_hi:[1,0]
    v_pk_mul_f32 v[202:203], v[150:151], v[192:193] op_sel_hi:[1,0]
    v_pk_fma_f32 v[64:65], v[64:65], v[152:153], v[196:197]
    v_pk_fma_f32 v[66:67], v[66:67], v[154:155], v[198:199]
    v_pk_fma_f32 v[68:69], v[68:69], v[156:157], v[200:201]
    v_pk_fma_f32 v[70:71], v[70:71], v[158:159], v[202:203]
    v_pk_mul_f32 v[196:197], v[64:65], v[64:65]
    v_pk_mul_f32 v[198:199], v[66:67], v[66:67]
    v_pk_mul_f32 v[200:201], v[68:69], v[68:69]
    v_pk_mul_f32 v[202:203], v[70:71], v[70:71]
    v_pk_fma_f32 v[196:197], v[196:197], s[56:57], v[242:243]
    v_pk_fma_f32 v[198:199], v[198:199], s[56:57], v[242:243]
    v_pk_fma_f32 v[200:201], v[200:201], s[56:57], v[242:243]
    v_pk_fma_f32 v[202:203], v[202:203], s[56:57], v[242:243]
    v_pk_mul_f32 v[196:197], v[196:197], v[64:65]
    v_pk_mul_f32 v[198:199], v[198:199], v[66:67]
    v_pk_mul_f32 v[200:201], v[200:201], v[68:69]
    v_pk_mul_f32 v[202:203], v[202:203], v[70:71]
    v_exp_f32 v196, v196
    v_exp_f32 v197, v197
    v_exp_f32 v198, v198
    v_exp_f32 v199, v199
    v_exp_f32 v200, v200
    v_exp_f32 v201, v201
    v_exp_f32 v202, v202
    v_exp_f32 v203, v203
    v_pk_add_f32 v[196:197], v[196:197], v[244:245]
    v_pk_add_f32 v[198:199], v[198:199], v[244:245]
    v_pk_add_f32 v[200:201], v[200:201], v[244:245]
    v_pk_add_f32 v[202:203], v[202:203], v[244:245]
    v_rcp_f32 v196, v196
    v_rcp_f32 v197, v197
    v_rcp_f32 v198, v198
    v_rcp_f32 v199, v199
    v_rcp_f32 v200, v200
    v_rcp_f32 v201, v201
    v_rcp_f32 v202, v202
    v_rcp_f32 v203, v203
    v_pk_mul_f32 v[64:65], v[64:65], v[196:197]
    v_pk_mul_f32 v[66:67], v[66:67], v[198:199]
    v_pk_mul_f32 v[68:69], v[68:69], v[200:201]
    v_pk_mul_f32 v[70:71], v[70:71], v[202:203]
    v_pk_fma_f32 v[220:221], v[64:65], v[64:65], v[220:221]
    v_pk_add_f32 v[212:213], v[212:213], v[64:65]
    v_pk_fma_f32 v[222:223], v[66:67], v[66:67], v[222:223]
    v_pk_add_f32 v[214:215], v[214:215], v[66:67]
    v_pk_fma_f32 v[224:225], v[68:69], v[68:69], v[224:225]
    v_pk_add_f32 v[216:217], v[216:217], v[68:69]
    v_pk_fma_f32 v[226:227], v[70:71], v[70:71], v[226:227]
    v_pk_add_f32 v[218:219], v[218:219], v[70:71]
    v_add_f32_dpp v212, v212, v212 row_ror:8 row_mask:0xf bank_mask:0xf
    v_add_f32_dpp v213, v213, v213 row_ror:8 row_mask:0xf bank_mask:0xf
    v_add_f32_dpp v214, v214, v214 row_ror:8 row_mask:0xf bank_mask:0xf
    v_add_f32_dpp v215, v215, v215 row_ror:8 row_mask:0xf bank_mask:0xf
    v_add_f32_dpp v216, v216, v216 row_ror:8 row_mask:0xf bank_mask:0xf
    v_add_f32_dpp v217, v217, v217 row_ror:8 row_mask:0xf bank_mask:0xf
    v_add_f32_dpp v218, v218, v218 row_ror:8 row_mask:0xf bank_mask:0xf
    v_add_f32_dpp v219, v219, v219 row_ror:8 row_mask:0xf bank_mask:0xf
    v_add_f32_dpp v220, v220, v220 row_ror:8 row_mask:0xf bank_mask:0xf
    v_add_f32_dpp v221, v221, v221 row_ror:8 row_mask:0xf bank_mask:0xf
    v_add_f32_dpp v222, v222, v222 row_ror:8 row_mask:0xf bank_mask:0xf
    v_add_f32_dpp v223, v223, v223 row_ror:8 row_mask:0xf bank_mask:0xf
    v_add_f32_dpp v224, v224, v224 row_ror:8 row_mask:0xf bank_mask:0xf
    v_add_f32_dpp v225, v225, v225 row_ror:8 row_mask:0xf bank_mask:0xf
    v_add_f32_dpp v226, v226, v226 row_ror:8 row_mask:0xf bank_mask:0xf
    v_add_f32_dpp v227, v227, v227 row_ror:8 row_mask:0xf bank_mask:0xf
    v_add_f32_dpp v212, v212, v212 row_ror:4 row_mask:0xf bank_mask:0xf
    v_add_f32_dpp v213, v213, v213 row_ror:4 row_mask:0xf bank_mask:0xf
    v_add_f32_dpp v214, v214, v214 row_ror:4 row_mask:0xf bank_mask:0xf
    v_add_f32_dpp v215, v215, v215 row_ror:4 row_mask:0xf bank_mask:0xf
    v_add_f32_dpp v216, v216, v216 row_ror:4 row_mask:0xf bank_mask:0xf
    v_add_f32_dpp v217, v217, v217 row_ror:4 row_mask:0xf bank_mask:0xf
    v_add_f32_dpp v218, v218, v218 row_ror:4 row_mask:0xf bank_mask:0xf
    v_add_f32_dpp v219, v219, v219 row_ror:4 row_mask:0xf bank_mask:0xf
    v_add_f32_dpp v220, v220, v220 row_ror:4 row_mask:0xf bank_mask:0xf
    v_add_f32_dpp v221, v221, v221 row_ror:4 row_mask:0xf bank_mask:0xf
    v_add_f32_dpp v222, v222, v222 row_ror:4 row_mask:0xf bank_mask:0xf
    v_add_f32_dpp v223, v223, v223 row_ror:4 row_mask:0xf bank_mask:0xf
    v_add_f32_dpp v224, v224, v224 row_ror:4 row_mask:0xf bank_mask:0xf
    v_add_f32_dpp v225, v225, v225 row_ror:4 row_mask:0xf bank_mask:0xf
    v_add_f32_dpp v226, v226, v226 row_ror:4 row_mask:0xf bank_mask:0xf
    v_add_f32_dpp v227, v227, v227 row_ror:4 row_mask:0xf bank_mask:0xf
    v_add_f32_dpp v212, v212, v212 row_ror:2 row_mask:0xf bank_mask:0xf
    v_add_f32_dpp v213, v213, v213 row_ror:2 row_mask:0xf bank_mask:0xf
    v_add_f32_dpp v214, v214, v214 row_ror:2 row_mask:0xf bank_mask:0xf
    v_add_f32_dpp v215, v215, v215 row_ror:2 row_mask:0xf bank_mask:0xf
    v_add_f32_dpp v216, v216, v216 row_ror:2 row_mask:0xf bank_mask:0xf
    v_add_f32_dpp v217, v217, v217 row_ror:2 row_mask:0xf bank_mask:0xf
    v_add_f32_dpp v218, v218, v218 row_ror:2 row_mask:0xf bank_mask:0xf
    v_add_f32_dpp v219, v219, v219 row_ror:2 row_mask:0xf bank_mask:0xf
    v_add_f32_dpp v220, v220, v220 row_ror:2 row_mask:0xf bank_mask:0xf
    v_add_f32_dpp v221, v221, v221 row_ror:2 row_mask:0xf bank_mask:0xf
    v_add_f32_dpp v222, v222, v222 row_ror:2 row_mask:0xf bank_mask:0xf
    v_add_f32_dpp v223, v223, v223 row_ror:2 row_mask:0xf bank_mask:0xf
    v_add_f32_dpp v224, v224, v224 row_ror:2 row_mask:0xf bank_mask:0xf
    v_add_f32_dpp v225, v225, v225 row_ror:2 row_mask:0xf bank_mask:0xf
    v_add_f32_dpp v226, v226, v226 row_ror:2 row_mask:0xf bank_mask:0xf
    v_add_f32_dpp v227, v227, v227 row_ror:2 row_mask:0xf bank_mask:0xf
    v_add_f32_dpp v212, v212, v212 row_ror:1 row_mask:0xf bank_mask:0xf
    v_add_f32_dpp v213, v213, v213 row_ror:1 row_mask:0xf bank_mask:0xf
    v_add_f32_dpp v214, v214, v214 row_ror:1 row_mask:0xf bank_mask:0xf
    v_add_f32_dpp v215, v215, v215 row_ror:1 row_mask:0xf bank_mask:0xf
    v_add_f32_dpp v216, v216, v216 row_ror:1 row_mask:0xf bank_mask:0xf
    v_add_f32_dpp v217, v217, v217 row_ror:1 row_mask:0xf bank_mask:0xf
    v_add_f32_dpp v218, v218, v218 row_ror:1 row_mask:0xf bank_mask:0xf
    v_add_f32_dpp v219, v219, v219 row_ror:1 row_mask:0xf bank_mask:0xf
    v_add_f32_dpp v220, v220, v220 row_ror:1 row_mask:0xf bank_mask:0xf
    v_add_f32_dpp v221, v221, v221 row_ror:1 row_mask:0xf bank_mask:0xf
    v_add_f32_dpp v222, v222, v222 row_ror:1 row_mask:0xf bank_mask:0xf
    v_add_f32_dpp v223, v223, v223 row_ror:1 row_mask:0xf bank_mask:0xf
    v_add_f32_dpp v224, v224, v224 row_ror:1 row_mask:0xf bank_mask:0xf
    v_add_f32_dpp v225, v225, v225 row_ror:1 row_mask:0xf bank_mask:0xf
    v_add_f32_dpp v226, v226, v226 row_ror:1 row_mask:0xf bank_mask:0xf
    v_add_f32_dpp v227, v227, v227 row_ror:1 row_mask:0xf bank_mask:0xf
    s_mov_b32 exec_lo, 0x10001
    s_mov_b32 exec_hi, 0x10001
    ds_write_b128 v247, v[212:215]
    ds_write_b128 v247, v[216:219] offset:64
    ds_write_b128 v247, v[220:223] offset:128
    ds_write_b128 v247, v[224:227] offset:192
    s_mov_b64 exec, -1
    s_waitcnt lgkmcnt(0)
    s_barrier
    ds_read_b128 v[144:147], v235 offset:34816
    ds_read_b128 v[148:151], v235 offset:36864
    ds_read_b64_tr_b16 v[152:153], v237 offset:34816
    ds_read_b64_tr_b16 v[154:155], v237 offset:37120
    ds_read_b64_tr_b16 v[156:157], v237 offset:34848
    ds_read_b64_tr_b16 v[158:159], v237 offset:37152
    ds_read_b64_tr_b16 v[160:161], v237 offset:34880
    ds_read_b64_tr_b16 v[162:163], v237 offset:37184
    ds_read_b64_tr_b16 v[164:165], v237 offset:34912
    ds_read_b64_tr_b16 v[166:167], v237 offset:37216
    ds_read_b64_tr_b16 v[168:169], v237 offset:34944
    ds_read_b64_tr_b16 v[170:171], v237 offset:37248
    ds_read_b64_tr_b16 v[172:173], v237 offset:34976
    ds_read_b64_tr_b16 v[174:175], v237 offset:37280
    ds_read_b64_tr_b16 v[176:177], v237 offset:35008
    ds_read_b64_tr_b16 v[178:179], v237 offset:37312
    ds_read_b64_tr_b16 v[180:181], v237 offset:35040
    ds_read_b64_tr_b16 v[182:183], v237 offset:37344
    ds_read_b64_tr_b16 v[184:185], v237 offset:35072
    ds_read_b64_tr_b16 v[186:187], v237 offset:37376
    s_waitcnt lgkmcnt(0)
    v_mfma_f32_16x16x32_bf16 v[72:75], v[152:155], v[144:147], 0
    ds_read_b128 v[188:191], v236 offset:34816
    ds_read_b128 v[192:195], v236 offset:36864
    v_mfma_f32_16x16x32_bf16 v[76:79], v[152:155], v[148:151], 0
    ds_read_b64_tr_b16 v[196:197], v237 offset:44032
    v_mfma_f32_16x16x32_bf16 v[80:83], v[156:159], v[144:147], 0
    ds_read_b64_tr_b16 v[198:199], v237 offset:46336
    v_mfma_f32_16x16x32_bf16 v[84:87], v[156:159], v[148:151], 0
    ds_read_b64_tr_b16 v[200:201], v237 offset:44064
    ds_read_b64_tr_b16 v[202:203], v237 offset:46368
    v_mfma_f32_16x16x32_bf16 v[88:91], v[160:163], v[144:147], 0
    ds_read_b64_tr_b16 v[204:205], v237 offset:44096
    v_mfma_f32_16x16x32_bf16 v[92:95], v[160:163], v[148:151], 0
    ds_read_b64_tr_b16 v[206:207], v237 offset:46400
    v_mfma_f32_16x16x32_bf16 v[96:99], v[164:167], v[144:147], 0
    ds_read_b64_tr_b16 v[208:209], v237 offset:44128
    ds_read_b64_tr_b16 v[210:211], v237 offset:46432
    v_mfma_f32_16x16x32_bf16 v[100:103], v[164:167], v[148:151], 0
    ds_read_b64_tr_b16 v[212:213], v237 offset:44160
    v_mfma_f32_16x16x32_bf16 v[104:107], v[168:171], v[144:147], 0
    ds_read_b64_tr_b16 v[214:215], v237 offset:46464
    v_mfma_f32_16x16x32_bf16 v[108:111], v[168:171], v[148:151], 0
    ds_read_b64_tr_b16 v[216:217], v237 offset:44192
    ds_read_b64_tr_b16 v[218:219], v237 offset:46496
    v_mfma_f32_16x16x32_bf16 v[112:115], v[172:175], v[144:147], 0
    ds_read_b64_tr_b16 v[220:221], v237 offset:44224
    v_mfma_f32_16x16x32_bf16 v[116:119], v[172:175], v[148:151], 0
    ds_read_b64_tr_b16 v[222:223], v237 offset:46528
    v_mfma_f32_16x16x32_bf16 v[120:123], v[176:179], v[144:147], 0
    ds_read_b64_tr_b16 v[224:225], v237 offset:44256
    ds_read_b64_tr_b16 v[226:227], v237 offset:46560
    v_mfma_f32_16x16x32_bf16 v[124:127], v[176:179], v[148:151], 0
    ds_read_b64_tr_b16 v[228:229], v237 offset:44288
    v_mfma_f32_16x16x32_bf16 v[128:131], v[180:183], v[144:147], 0
    ds_read_b64_tr_b16 v[230:231], v237 offset:46592
    v_mfma_f32_16x16x32_bf16 v[132:135], v[180:183], v[148:151], 0
    v_mfma_f32_16x16x32_bf16 v[136:139], v[184:187], v[144:147], 0
    v_mfma_f32_16x16x32_bf16 v[140:143], v[184:187], v[148:151], 0
    s_waitcnt lgkmcnt(0)
    s_barrier
    v_mfma_f32_16x16x32_bf16 v[72:75], v[196:199], v[188:191], v[72:75]
    ds_read_b128 v[144:147], v232 offset:0
    ds_read_b128 v[148:151], v232 offset:2048
    v_mfma_f32_16x16x32_bf16 v[76:79], v[196:199], v[192:195], v[76:79]
    ds_read_b64_tr_b16 v[152:153], v234 offset:0
    v_mfma_f32_16x16x32_bf16 v[80:83], v[200:203], v[188:191], v[80:83]
    ds_read_b64_tr_b16 v[154:155], v234 offset:2304
    v_mfma_f32_16x16x32_bf16 v[84:87], v[200:203], v[192:195], v[84:87]
    ds_read_b64_tr_b16 v[156:157], v234 offset:32
    ds_read_b64_tr_b16 v[158:159], v234 offset:2336
    v_mfma_f32_16x16x32_bf16 v[88:91], v[204:207], v[188:191], v[88:91]
    ds_read_b64_tr_b16 v[160:161], v234 offset:64
    v_mfma_f32_16x16x32_bf16 v[92:95], v[204:207], v[192:195], v[92:95]
    ds_read_b64_tr_b16 v[162:163], v234 offset:2368
    v_mfma_f32_16x16x32_bf16 v[96:99], v[208:211], v[188:191], v[96:99]
    ds_read_b64_tr_b16 v[164:165], v234 offset:96
    ds_read_b64_tr_b16 v[166:167], v234 offset:2400
    v_mfma_f32_16x16x32_bf16 v[100:103], v[208:211], v[192:195], v[100:103]
    ds_read_b64_tr_b16 v[168:169], v234 offset:128
    v_mfma_f32_16x16x32_bf16 v[104:107], v[212:215], v[188:191], v[104:107]
    ds_read_b64_tr_b16 v[170:171], v234 offset:2432
    v_mfma_f32_16x16x32_bf16 v[108:111], v[212:215], v[192:195], v[108:111]
    ds_read_b64_tr_b16 v[172:173], v234 offset:160
    ds_read_b64_tr_b16 v[174:175], v234 offset:2464
    v_mfma_f32_16x16x32_bf16 v[112:115], v[216:219], v[188:191], v[112:115]
    ds_read_b64_tr_b16 v[176:177], v234 offset:192
    v_mfma_f32_16x16x32_bf16 v[116:119], v[216:219], v[192:195], v[116:119]
    ds_read_b64_tr_b16 v[178:179], v234 offset:2496
    v_mfma_f32_16x16x32_bf16 v[120:123], v[220:223], v[188:191], v[120:123]
    ds_read_b64_tr_b16 v[180:181], v234 offset:224
    ds_read_b64_tr_b16 v[182:183], v234 offset:2528
    v_mfma_f32_16x16x32_bf16 v[124:127], v[220:223], v[192:195], v[124:127]
    ds_read_b64_tr_b16 v[184:185], v234 offset:256
    v_mfma_f32_16x16x32_bf16 v[128:131], v[224:227], v[188:191], v[128:131]
    ds_read_b64_tr_b16 v[186:187], v234 offset:2560
    v_mfma_f32_16x16x32_bf16 v[132:135], v[224:227], v[192:195], v[132:135]
    v_mfma_f32_16x16x32_bf16 v[136:139], v[228:231], v[188:191], v[136:139]
    v_mfma_f32_16x16x32_bf16 v[140:143], v[228:231], v[192:195], v[140:143]
    s_waitcnt lgkmcnt(0)
    v_mfma_f32_16x16x32_bf16 v[72:75], v[152:155], v[144:147], v[72:75]
    ds_read_b128 v[188:191], v233 offset:0
    ds_read_b128 v[192:195], v233 offset:2048
    v_mfma_f32_16x16x32_bf16 v[76:79], v[152:155], v[148:151], v[76:79]
    ds_read_b64_tr_b16 v[196:197], v234 offset:9216
    v_mfma_f32_16x16x32_bf16 v[80:83], v[156:159], v[144:147], v[80:83]
    ds_read_b64_tr_b16 v[198:199], v234 offset:11520
    v_mfma_f32_16x16x32_bf16 v[84:87], v[156:159], v[148:151], v[84:87]
    ds_read_b64_tr_b16 v[200:201], v234 offset:9248
    ds_read_b64_tr_b16 v[202:203], v234 offset:11552
    v_mfma_f32_16x16x32_bf16 v[88:91], v[160:163], v[144:147], v[88:91]
    ds_read_b64_tr_b16 v[204:205], v234 offset:9280
    v_mfma_f32_16x16x32_bf16 v[92:95], v[160:163], v[148:151], v[92:95]
    ds_read_b64_tr_b16 v[206:207], v234 offset:11584
    v_mfma_f32_16x16x32_bf16 v[96:99], v[164:167], v[144:147], v[96:99]
    ds_read_b64_tr_b16 v[208:209], v234 offset:9312
    ds_read_b64_tr_b16 v[210:211], v234 offset:11616
    v_mfma_f32_16x16x32_bf16 v[100:103], v[164:167], v[148:151], v[100:103]
    ds_read_b64_tr_b16 v[212:213], v234 offset:9344
    v_mfma_f32_16x16x32_bf16 v[104:107], v[168:171], v[144:147], v[104:107]
    ds_read_b64_tr_b16 v[214:215], v234 offset:11648
    v_mfma_f32_16x16x32_bf16 v[108:111], v[168:171], v[148:151], v[108:111]
    ds_read_b64_tr_b16 v[216:217], v234 offset:9376
    ds_read_b64_tr_b16 v[218:219], v234 offset:11680
    v_mfma_f32_16x16x32_bf16 v[112:115], v[172:175], v[144:147], v[112:115]
    ds_read_b64_tr_b16 v[220:221], v234 offset:9408
    v_mfma_f32_16x16x32_bf16 v[116:119], v[172:175], v[148:151], v[116:119]
    ds_read_b64_tr_b16 v[222:223], v234 offset:11712
    v_mfma_f32_16x16x32_bf16 v[120:123], v[176:179], v[144:147], v[120:123]
    ds_read_b64_tr_b16 v[224:225], v234 offset:9440
    ds_read_b64_tr_b16 v[226:227], v234 offset:11744
    v_mfma_f32_16x16x32_bf16 v[124:127], v[176:179], v[148:151], v[124:127]
    ds_read_b64_tr_b16 v[228:229], v234 offset:9472
    v_mfma_f32_16x16x32_bf16 v[128:131], v[180:183], v[144:147], v[128:131]
    ds_read_b64_tr_b16 v[230:231], v234 offset:11776
    v_mfma_f32_16x16x32_bf16 v[132:135], v[180:183], v[148:151], v[132:135]
    v_mfma_f32_16x16x32_bf16 v[136:139], v[184:187], v[144:147], v[136:139]
    v_mfma_f32_16x16x32_bf16 v[140:143], v[184:187], v[148:151], v[140:143]
    s_waitcnt lgkmcnt(0)
    s_barrier
    v_mfma_f32_16x16x32_bf16 v[72:75], v[196:199], v[188:191], v[72:75]
    ds_read_b128 v[144:147], v232 offset:34816
    ds_read_b128 v[148:151], v232 offset:36864
    v_mfma_f32_16x16x32_bf16 v[76:79], v[196:199], v[192:195], v[76:79]
    ds_read_b64_tr_b16 v[152:153], v234 offset:34816
    v_mfma_f32_16x16x32_bf16 v[80:83], v[200:203], v[188:191], v[80:83]
    ds_read_b64_tr_b16 v[154:155], v234 offset:37120
    v_mfma_f32_16x16x32_bf16 v[84:87], v[200:203], v[192:195], v[84:87]
    ds_read_b64_tr_b16 v[156:157], v234 offset:34848
    ds_read_b64_tr_b16 v[158:159], v234 offset:37152
    v_mfma_f32_16x16x32_bf16 v[88:91], v[204:207], v[188:191], v[88:91]
    ds_read_b64_tr_b16 v[160:161], v234 offset:34880
    v_mfma_f32_16x16x32_bf16 v[92:95], v[204:207], v[192:195], v[92:95]
    ds_read_b64_tr_b16 v[162:163], v234 offset:37184
    v_mfma_f32_16x16x32_bf16 v[96:99], v[208:211], v[188:191], v[96:99]
    ds_read_b64_tr_b16 v[164:165], v234 offset:34912
    ds_read_b64_tr_b16 v[166:167], v234 offset:37216
    v_mfma_f32_16x16x32_bf16 v[100:103], v[208:211], v[192:195], v[100:103]
    ds_read_b64_tr_b16 v[168:169], v234 offset:34944
    v_mfma_f32_16x16x32_bf16 v[104:107], v[212:215], v[188:191], v[104:107]
    ds_read_b64_tr_b16 v[170:171], v234 offset:37248
    v_mfma_f32_16x16x32_bf16 v[108:111], v[212:215], v[192:195], v[108:111]
    ds_read_b64_tr_b16 v[172:173], v234 offset:34976
    ds_read_b64_tr_b16 v[174:175], v234 offset:37280
    v_mfma_f32_16x16x32_bf16 v[112:115], v[216:219], v[188:191], v[112:115]
    ds_read_b64_tr_b16 v[176:177], v234 offset:35008
    v_mfma_f32_16x16x32_bf16 v[116:119], v[216:219], v[192:195], v[116:119]
    ds_read_b64_tr_b16 v[178:179], v234 offset:37312
    v_mfma_f32_16x16x32_bf16 v[120:123], v[220:223], v[188:191], v[120:123]
    ds_read_b64_tr_b16 v[180:181], v234 offset:35040
    ds_read_b64_tr_b16 v[182:183], v234 offset:37344
    v_mfma_f32_16x16x32_bf16 v[124:127], v[220:223], v[192:195], v[124:127]
    ds_read_b64_tr_b16 v[184:185], v234 offset:35072
    v_mfma_f32_16x16x32_bf16 v[128:131], v[224:227], v[188:191], v[128:131]
    ds_read_b64_tr_b16 v[186:187], v234 offset:37376
    v_mfma_f32_16x16x32_bf16 v[132:135], v[224:227], v[192:195], v[132:135]
    v_mfma_f32_16x16x32_bf16 v[136:139], v[228:231], v[188:191], v[136:139]
    v_mfma_f32_16x16x32_bf16 v[140:143], v[228:231], v[192:195], v[140:143]
    s_waitcnt lgkmcnt(0)
    v_mfma_f32_16x16x32_bf16 v[72:75], v[152:155], v[144:147], v[72:75]
    ds_read_b128 v[188:191], v233 offset:34816
    ds_read_b128 v[192:195], v233 offset:36864
    v_mfma_f32_16x16x32_bf16 v[76:79], v[152:155], v[148:151], v[76:79]
    ds_read_b64_tr_b16 v[196:197], v234 offset:44032
    v_mfma_f32_16x16x32_bf16 v[80:83], v[156:159], v[144:147], v[80:83]
    ds_read_b64_tr_b16 v[198:199], v234 offset:46336
    v_mfma_f32_16x16x32_bf16 v[84:87], v[156:159], v[148:151], v[84:87]
    ds_read_b64_tr_b16 v[200:201], v234 offset:44064
    ds_read_b64_tr_b16 v[202:203], v234 offset:46368
    v_mfma_f32_16x16x32_bf16 v[88:91], v[160:163], v[144:147], v[88:91]
    ds_read_b64_tr_b16 v[204:205], v234 offset:44096
    v_mfma_f32_16x16x32_bf16 v[92:95], v[160:163], v[148:151], v[92:95]
    ds_read_b64_tr_b16 v[206:207], v234 offset:46400
    v_mfma_f32_16x16x32_bf16 v[96:99], v[164:167], v[144:147], v[96:99]
    ds_read_b64_tr_b16 v[208:209], v234 offset:44128
    ds_read_b64_tr_b16 v[210:211], v234 offset:46432
    v_mfma_f32_16x16x32_bf16 v[100:103], v[164:167], v[148:151], v[100:103]
    ds_read_b64_tr_b16 v[212:213], v234 offset:44160
    v_mfma_f32_16x16x32_bf16 v[104:107], v[168:171], v[144:147], v[104:107]
    ds_read_b64_tr_b16 v[214:215], v234 offset:46464
    v_mfma_f32_16x16x32_bf16 v[108:111], v[168:171], v[148:151], v[108:111]
    ds_read_b64_tr_b16 v[216:217], v234 offset:44192
    ds_read_b64_tr_b16 v[218:219], v234 offset:46496
    v_mfma_f32_16x16x32_bf16 v[112:115], v[172:175], v[144:147], v[112:115]
    ds_read_b64_tr_b16 v[220:221], v234 offset:44224
    v_mfma_f32_16x16x32_bf16 v[116:119], v[172:175], v[148:151], v[116:119]
    ds_read_b64_tr_b16 v[222:223], v234 offset:46528
    v_mfma_f32_16x16x32_bf16 v[120:123], v[176:179], v[144:147], v[120:123]
    ds_read_b64_tr_b16 v[224:225], v234 offset:44256
    ds_read_b64_tr_b16 v[226:227], v234 offset:46560
    v_mfma_f32_16x16x32_bf16 v[124:127], v[176:179], v[148:151], v[124:127]
    ds_read_b64_tr_b16 v[228:229], v234 offset:44288
    v_mfma_f32_16x16x32_bf16 v[128:131], v[180:183], v[144:147], v[128:131]
    ds_read_b64_tr_b16 v[230:231], v234 offset:46592
    v_mfma_f32_16x16x32_bf16 v[132:135], v[180:183], v[148:151], v[132:135]
    v_mfma_f32_16x16x32_bf16 v[136:139], v[184:187], v[144:147], v[136:139]
    v_mfma_f32_16x16x32_bf16 v[140:143], v[184:187], v[148:151], v[140:143]
    s_waitcnt lgkmcnt(0)
    s_barrier
    v_mfma_f32_16x16x32_bf16 v[72:75], v[196:199], v[188:191], v[72:75]
    ds_read_b128 v[144:147], v235 offset:0
    ds_read_b128 v[148:151], v235 offset:2048
    v_mfma_f32_16x16x32_bf16 v[76:79], v[196:199], v[192:195], v[76:79]
    ds_read_b64_tr_b16 v[152:153], v237 offset:0
    v_mfma_f32_16x16x32_bf16 v[80:83], v[200:203], v[188:191], v[80:83]
    ds_read_b64_tr_b16 v[154:155], v237 offset:2304
    v_mfma_f32_16x16x32_bf16 v[84:87], v[200:203], v[192:195], v[84:87]
    ds_read_b64_tr_b16 v[156:157], v237 offset:32
    ds_read_b64_tr_b16 v[158:159], v237 offset:2336
    v_mfma_f32_16x16x32_bf16 v[88:91], v[204:207], v[188:191], v[88:91]
    ds_read_b64_tr_b16 v[160:161], v237 offset:64
    v_mfma_f32_16x16x32_bf16 v[92:95], v[204:207], v[192:195], v[92:95]
    ds_read_b64_tr_b16 v[162:163], v237 offset:2368
    v_mfma_f32_16x16x32_bf16 v[96:99], v[208:211], v[188:191], v[96:99]
    ds_read_b64_tr_b16 v[164:165], v237 offset:96
    ds_read_b64_tr_b16 v[166:167], v237 offset:2400
    v_mfma_f32_16x16x32_bf16 v[100:103], v[208:211], v[192:195], v[100:103]
    ds_read_b64_tr_b16 v[168:169], v237 offset:128
    v_mfma_f32_16x16x32_bf16 v[104:107], v[212:215], v[188:191], v[104:107]
    ds_read_b64_tr_b16 v[170:171], v237 offset:2432
    v_mfma_f32_16x16x32_bf16 v[108:111], v[212:215], v[192:195], v[108:111]
    ds_read_b64_tr_b16 v[172:173], v237 offset:160
    ds_read_b64_tr_b16 v[174:175], v237 offset:2464
    v_mfma_f32_16x16x32_bf16 v[112:115], v[216:219], v[188:191], v[112:115]
    ds_read_b64_tr_b16 v[176:177], v237 offset:192
    v_mfma_f32_16x16x32_bf16 v[116:119], v[216:219], v[192:195], v[116:119]
    ds_read_b64_tr_b16 v[178:179], v237 offset:2496
    v_mfma_f32_16x16x32_bf16 v[120:123], v[220:223], v[188:191], v[120:123]
    ds_read_b64_tr_b16 v[180:181], v237 offset:224
    ds_read_b64_tr_b16 v[182:183], v237 offset:2528
    v_mfma_f32_16x16x32_bf16 v[124:127], v[220:223], v[192:195], v[124:127]
    ds_read_b64_tr_b16 v[184:185], v237 offset:256
    v_mfma_f32_16x16x32_bf16 v[128:131], v[224:227], v[188:191], v[128:131]
    ds_read_b64_tr_b16 v[186:187], v237 offset:2560
    v_mfma_f32_16x16x32_bf16 v[132:135], v[224:227], v[192:195], v[132:135]
    v_mfma_f32_16x16x32_bf16 v[136:139], v[228:231], v[188:191], v[136:139]
    v_mfma_f32_16x16x32_bf16 v[140:143], v[228:231], v[192:195], v[140:143]
    s_waitcnt lgkmcnt(0)
    v_mfma_f32_16x16x32_bf16 v[72:75], v[152:155], v[144:147], v[72:75]
    ds_read_b128 v[188:191], v236 offset:0
    ds_read_b128 v[192:195], v236 offset:2048
    v_mfma_f32_16x16x32_bf16 v[76:79], v[152:155], v[148:151], v[76:79]
    ds_read_b64_tr_b16 v[196:197], v237 offset:9216
    v_mfma_f32_16x16x32_bf16 v[80:83], v[156:159], v[144:147], v[80:83]
    ds_read_b64_tr_b16 v[198:199], v237 offset:11520
    v_mfma_f32_16x16x32_bf16 v[84:87], v[156:159], v[148:151], v[84:87]
    ds_read_b64_tr_b16 v[200:201], v237 offset:9248
    ds_read_b64_tr_b16 v[202:203], v237 offset:11552
    v_mfma_f32_16x16x32_bf16 v[88:91], v[160:163], v[144:147], v[88:91]
    ds_read_b64_tr_b16 v[204:205], v237 offset:9280
    v_mfma_f32_16x16x32_bf16 v[92:95], v[160:163], v[148:151], v[92:95]
    ds_read_b64_tr_b16 v[206:207], v237 offset:11584
    v_mfma_f32_16x16x32_bf16 v[96:99], v[164:167], v[144:147], v[96:99]
    ds_read_b64_tr_b16 v[208:209], v237 offset:9312
    ds_read_b64_tr_b16 v[210:211], v237 offset:11616
    v_mfma_f32_16x16x32_bf16 v[100:103], v[164:167], v[148:151], v[100:103]
    ds_read_b64_tr_b16 v[212:213], v237 offset:9344
    v_mfma_f32_16x16x32_bf16 v[104:107], v[168:171], v[144:147], v[104:107]
    ds_read_b64_tr_b16 v[214:215], v237 offset:11648
    v_mfma_f32_16x16x32_bf16 v[108:111], v[168:171], v[148:151], v[108:111]
    ds_read_b64_tr_b16 v[216:217], v237 offset:9376
    ds_read_b64_tr_b16 v[218:219], v237 offset:11680
    v_mfma_f32_16x16x32_bf16 v[112:115], v[172:175], v[144:147], v[112:115]
    ds_read_b64_tr_b16 v[220:221], v237 offset:9408
    v_mfma_f32_16x16x32_bf16 v[116:119], v[172:175], v[148:151], v[116:119]
    ds_read_b64_tr_b16 v[222:223], v237 offset:11712
    v_mfma_f32_16x16x32_bf16 v[120:123], v[176:179], v[144:147], v[120:123]
    ds_read_b64_tr_b16 v[224:225], v237 offset:9440
    ds_read_b64_tr_b16 v[226:227], v237 offset:11744
    v_mfma_f32_16x16x32_bf16 v[124:127], v[176:179], v[148:151], v[124:127]
    ds_read_b64_tr_b16 v[228:229], v237 offset:9472
    v_mfma_f32_16x16x32_bf16 v[128:131], v[180:183], v[144:147], v[128:131]
    ds_read_b64_tr_b16 v[230:231], v237 offset:11776
    v_mfma_f32_16x16x32_bf16 v[132:135], v[180:183], v[148:151], v[132:135]
    v_mfma_f32_16x16x32_bf16 v[136:139], v[184:187], v[144:147], v[136:139]
    v_mfma_f32_16x16x32_bf16 v[140:143], v[184:187], v[148:151], v[140:143]
    s_waitcnt lgkmcnt(0)
    s_barrier
    v_mfma_f32_16x16x32_bf16 v[72:75], v[196:199], v[188:191], v[72:75]
    ds_read_b128 v[144:147], v235 offset:34816
    ds_read_b128 v[148:151], v235 offset:36864
    v_mfma_f32_16x16x32_bf16 v[76:79], v[196:199], v[192:195], v[76:79]
    ds_read_b64_tr_b16 v[152:153], v237 offset:34816
    v_mfma_f32_16x16x32_bf16 v[80:83], v[200:203], v[188:191], v[80:83]
    ds_read_b64_tr_b16 v[154:155], v237 offset:37120
    v_mfma_f32_16x16x32_bf16 v[84:87], v[200:203], v[192:195], v[84:87]
    ds_read_b64_tr_b16 v[156:157], v237 offset:34848
    ds_read_b64_tr_b16 v[158:159], v237 offset:37152
    v_mfma_f32_16x16x32_bf16 v[88:91], v[204:207], v[188:191], v[88:91]
    ds_read_b64_tr_b16 v[160:161], v237 offset:34880
    v_mfma_f32_16x16x32_bf16 v[92:95], v[204:207], v[192:195], v[92:95]
    ds_read_b64_tr_b16 v[162:163], v237 offset:37184
    v_mfma_f32_16x16x32_bf16 v[96:99], v[208:211], v[188:191], v[96:99]
    ds_read_b64_tr_b16 v[164:165], v237 offset:34912
    ds_read_b64_tr_b16 v[166:167], v237 offset:37216
    v_mfma_f32_16x16x32_bf16 v[100:103], v[208:211], v[192:195], v[100:103]
    ds_read_b64_tr_b16 v[168:169], v237 offset:34944
    v_mfma_f32_16x16x32_bf16 v[104:107], v[212:215], v[188:191], v[104:107]
    ds_read_b64_tr_b16 v[170:171], v237 offset:37248
    v_mfma_f32_16x16x32_bf16 v[108:111], v[212:215], v[192:195], v[108:111]
    ds_read_b64_tr_b16 v[172:173], v237 offset:34976
    ds_read_b64_tr_b16 v[174:175], v237 offset:37280
    v_mfma_f32_16x16x32_bf16 v[112:115], v[216:219], v[188:191], v[112:115]
    ds_read_b64_tr_b16 v[176:177], v237 offset:35008
    v_mfma_f32_16x16x32_bf16 v[116:119], v[216:219], v[192:195], v[116:119]
    ds_read_b64_tr_b16 v[178:179], v237 offset:37312
    v_mfma_f32_16x16x32_bf16 v[120:123], v[220:223], v[188:191], v[120:123]
    ds_read_b64_tr_b16 v[180:181], v237 offset:35040
    ds_read_b64_tr_b16 v[182:183], v237 offset:37344
    v_mfma_f32_16x16x32_bf16 v[124:127], v[220:223], v[192:195], v[124:127]
    ds_read_b64_tr_b16 v[184:185], v237 offset:35072
    v_mfma_f32_16x16x32_bf16 v[128:131], v[224:227], v[188:191], v[128:131]
    ds_read_b64_tr_b16 v[186:187], v237 offset:37376
    v_mfma_f32_16x16x32_bf16 v[132:135], v[224:227], v[192:195], v[132:135]
    v_mfma_f32_16x16x32_bf16 v[136:139], v[228:231], v[188:191], v[136:139]
    v_mfma_f32_16x16x32_bf16 v[140:143], v[228:231], v[192:195], v[140:143]
    s_waitcnt lgkmcnt(0)
    v_mfma_f32_16x16x32_bf16 v[72:75], v[152:155], v[144:147], v[72:75]
    ds_read_b128 v[188:191], v236 offset:34816
    ds_read_b128 v[192:195], v236 offset:36864
    v_mfma_f32_16x16x32_bf16 v[76:79], v[152:155], v[148:151], v[76:79]
    ds_read_b64_tr_b16 v[196:197], v237 offset:44032
    v_mfma_f32_16x16x32_bf16 v[80:83], v[156:159], v[144:147], v[80:83]
    ds_read_b64_tr_b16 v[198:199], v237 offset:46336
    v_mfma_f32_16x16x32_bf16 v[84:87], v[156:159], v[148:151], v[84:87]
    ds_read_b64_tr_b16 v[200:201], v237 offset:44064
    ds_read_b64_tr_b16 v[202:203], v237 offset:46368
    v_mfma_f32_16x16x32_bf16 v[88:91], v[160:163], v[144:147], v[88:91]
    ds_read_b64_tr_b16 v[204:205], v237 offset:44096
    v_mfma_f32_16x16x32_bf16 v[92:95], v[160:163], v[148:151], v[92:95]
    ds_read_b64_tr_b16 v[206:207], v237 offset:46400
    v_mfma_f32_16x16x32_bf16 v[96:99], v[164:167], v[144:147], v[96:99]
    ds_read_b64_tr_b16 v[208:209], v237 offset:44128
    ds_read_b64_tr_b16 v[210:211], v237 offset:46432
    v_mfma_f32_16x16x32_bf16 v[100:103], v[164:167], v[148:151], v[100:103]
    ds_read_b64_tr_b16 v[212:213], v237 offset:44160
    v_mfma_f32_16x16x32_bf16 v[104:107], v[168:171], v[144:147], v[104:107]
    ds_read_b64_tr_b16 v[214:215], v237 offset:46464
    v_mfma_f32_16x16x32_bf16 v[108:111], v[168:171], v[148:151], v[108:111]
    ds_read_b64_tr_b16 v[216:217], v237 offset:44192
    ds_read_b64_tr_b16 v[218:219], v237 offset:46496
    v_mfma_f32_16x16x32_bf16 v[112:115], v[172:175], v[144:147], v[112:115]
    ds_read_b64_tr_b16 v[220:221], v237 offset:44224
    v_mfma_f32_16x16x32_bf16 v[116:119], v[172:175], v[148:151], v[116:119]
    ds_read_b64_tr_b16 v[222:223], v237 offset:46528
    v_mfma_f32_16x16x32_bf16 v[120:123], v[176:179], v[144:147], v[120:123]
    ds_read_b64_tr_b16 v[224:225], v237 offset:44256
    ds_read_b64_tr_b16 v[226:227], v237 offset:46560
    v_mfma_f32_16x16x32_bf16 v[124:127], v[176:179], v[148:151], v[124:127]
    ds_read_b64_tr_b16 v[228:229], v237 offset:44288
    v_mfma_f32_16x16x32_bf16 v[128:131], v[180:183], v[144:147], v[128:131]
    ds_read_b64_tr_b16 v[230:231], v237 offset:46592
    v_mfma_f32_16x16x32_bf16 v[132:135], v[180:183], v[148:151], v[132:135]
    v_mfma_f32_16x16x32_bf16 v[136:139], v[184:187], v[144:147], v[136:139]
    v_mfma_f32_16x16x32_bf16 v[140:143], v[184:187], v[148:151], v[140:143]
    s_waitcnt lgkmcnt(0)
    s_barrier
    v_mfma_f32_16x16x32_bf16 v[72:75], v[196:199], v[188:191], v[72:75]
    ds_read_b128 v[144:147], v232 offset:0
    ds_read_b128 v[148:151], v232 offset:2048
    v_mfma_f32_16x16x32_bf16 v[76:79], v[196:199], v[192:195], v[76:79]
    ds_read_b64_tr_b16 v[152:153], v234 offset:0
    v_mfma_f32_16x16x32_bf16 v[80:83], v[200:203], v[188:191], v[80:83]
    ds_read_b64_tr_b16 v[154:155], v234 offset:2304
    v_mfma_f32_16x16x32_bf16 v[84:87], v[200:203], v[192:195], v[84:87]
    ds_read_b64_tr_b16 v[156:157], v234 offset:32
    ds_read_b64_tr_b16 v[158:159], v234 offset:2336
    v_mfma_f32_16x16x32_bf16 v[88:91], v[204:207], v[188:191], v[88:91]
    ds_read_b64_tr_b16 v[160:161], v234 offset:64
    v_mfma_f32_16x16x32_bf16 v[92:95], v[204:207], v[192:195], v[92:95]
    ds_read_b64_tr_b16 v[162:163], v234 offset:2368
    v_mfma_f32_16x16x32_bf16 v[96:99], v[208:211], v[188:191], v[96:99]
    ds_read_b64_tr_b16 v[164:165], v234 offset:96
    ds_read_b64_tr_b16 v[166:167], v234 offset:2400
    v_mfma_f32_16x16x32_bf16 v[100:103], v[208:211], v[192:195], v[100:103]
    ds_read_b64_tr_b16 v[168:169], v234 offset:128
    v_mfma_f32_16x16x32_bf16 v[104:107], v[212:215], v[188:191], v[104:107]
    ds_read_b64_tr_b16 v[170:171], v234 offset:2432
    v_mfma_f32_16x16x32_bf16 v[108:111], v[212:215], v[192:195], v[108:111]
    ds_read_b64_tr_b16 v[172:173], v234 offset:160
    ds_read_b64_tr_b16 v[174:175], v234 offset:2464
    v_mfma_f32_16x16x32_bf16 v[112:115], v[216:219], v[188:191], v[112:115]
    ds_read_b64_tr_b16 v[176:177], v234 offset:192
    v_mfma_f32_16x16x32_bf16 v[116:119], v[216:219], v[192:195], v[116:119]
    ds_read_b64_tr_b16 v[178:179], v234 offset:2496
    v_mfma_f32_16x16x32_bf16 v[120:123], v[220:223], v[188:191], v[120:123]
    ds_read_b64_tr_b16 v[180:181], v234 offset:224
    ds_read_b64_tr_b16 v[182:183], v234 offset:2528
    v_mfma_f32_16x16x32_bf16 v[124:127], v[220:223], v[192:195], v[124:127]
    ds_read_b64_tr_b16 v[184:185], v234 offset:256
    v_mfma_f32_16x16x32_bf16 v[128:131], v[224:227], v[188:191], v[128:131]
    ds_read_b64_tr_b16 v[186:187], v234 offset:2560
    v_mfma_f32_16x16x32_bf16 v[132:135], v[224:227], v[192:195], v[132:135]
    v_mfma_f32_16x16x32_bf16 v[136:139], v[228:231], v[188:191], v[136:139]
    v_mfma_f32_16x16x32_bf16 v[140:143], v[228:231], v[192:195], v[140:143]
    s_waitcnt lgkmcnt(0)
    v_mfma_f32_16x16x32_bf16 v[72:75], v[152:155], v[144:147], v[72:75]
    ds_read_b128 v[188:191], v233 offset:0
    ds_read_b128 v[192:195], v233 offset:2048
    v_mfma_f32_16x16x32_bf16 v[76:79], v[152:155], v[148:151], v[76:79]
    ds_read_b64_tr_b16 v[196:197], v234 offset:9216
    v_mfma_f32_16x16x32_bf16 v[80:83], v[156:159], v[144:147], v[80:83]
    ds_read_b64_tr_b16 v[198:199], v234 offset:11520
    v_mfma_f32_16x16x32_bf16 v[84:87], v[156:159], v[148:151], v[84:87]
    ds_read_b64_tr_b16 v[200:201], v234 offset:9248
    ds_read_b64_tr_b16 v[202:203], v234 offset:11552
    v_mfma_f32_16x16x32_bf16 v[88:91], v[160:163], v[144:147], v[88:91]
    ds_read_b64_tr_b16 v[204:205], v234 offset:9280
    v_mfma_f32_16x16x32_bf16 v[92:95], v[160:163], v[148:151], v[92:95]
    ds_read_b64_tr_b16 v[206:207], v234 offset:11584
    v_mfma_f32_16x16x32_bf16 v[96:99], v[164:167], v[144:147], v[96:99]
    ds_read_b64_tr_b16 v[208:209], v234 offset:9312
    ds_read_b64_tr_b16 v[210:211], v234 offset:11616
    v_mfma_f32_16x16x32_bf16 v[100:103], v[164:167], v[148:151], v[100:103]
    ds_read_b64_tr_b16 v[212:213], v234 offset:9344
    v_mfma_f32_16x16x32_bf16 v[104:107], v[168:171], v[144:147], v[104:107]
    ds_read_b64_tr_b16 v[214:215], v234 offset:11648
    v_mfma_f32_16x16x32_bf16 v[108:111], v[168:171], v[148:151], v[108:111]
    ds_read_b64_tr_b16 v[216:217], v234 offset:9376
    ds_read_b64_tr_b16 v[218:219], v234 offset:11680
    v_mfma_f32_16x16x32_bf16 v[112:115], v[172:175], v[144:147], v[112:115]
    ds_read_b64_tr_b16 v[220:221], v234 offset:9408
    v_mfma_f32_16x16x32_bf16 v[116:119], v[172:175], v[148:151], v[116:119]
    ds_read_b64_tr_b16 v[222:223], v234 offset:11712
    v_mfma_f32_16x16x32_bf16 v[120:123], v[176:179], v[144:147], v[120:123]
    ds_read_b64_tr_b16 v[224:225], v234 offset:9440
    ds_read_b64_tr_b16 v[226:227], v234 offset:11744
    v_mfma_f32_16x16x32_bf16 v[124:127], v[176:179], v[148:151], v[124:127]
    ds_read_b64_tr_b16 v[228:229], v234 offset:9472
    v_mfma_f32_16x16x32_bf16 v[128:131], v[180:183], v[144:147], v[128:131]
    ds_read_b64_tr_b16 v[230:231], v234 offset:11776
    v_mfma_f32_16x16x32_bf16 v[132:135], v[180:183], v[148:151], v[132:135]
    v_mfma_f32_16x16x32_bf16 v[136:139], v[184:187], v[144:147], v[136:139]
    v_mfma_f32_16x16x32_bf16 v[140:143], v[184:187], v[148:151], v[140:143]
    s_waitcnt lgkmcnt(0)
    s_barrier
    v_mfma_f32_16x16x32_bf16 v[72:75], v[196:199], v[188:191], v[72:75]
    ds_read_b128 v[144:147], v232 offset:34816
    ds_read_b128 v[148:151], v232 offset:36864
    v_mfma_f32_16x16x32_bf16 v[76:79], v[196:199], v[192:195], v[76:79]
    ds_read_b64_tr_b16 v[152:153], v234 offset:34816
    v_mfma_f32_16x16x32_bf16 v[80:83], v[200:203], v[188:191], v[80:83]
    ds_read_b64_tr_b16 v[154:155], v234 offset:37120
    v_mfma_f32_16x16x32_bf16 v[84:87], v[200:203], v[192:195], v[84:87]
    ds_read_b64_tr_b16 v[156:157], v234 offset:34848
    ds_read_b64_tr_b16 v[158:159], v234 offset:37152
    v_mfma_f32_16x16x32_bf16 v[88:91], v[204:207], v[188:191], v[88:91]
    ds_read_b64_tr_b16 v[160:161], v234 offset:34880
    v_mfma_f32_16x16x32_bf16 v[92:95], v[204:207], v[192:195], v[92:95]
    ds_read_b64_tr_b16 v[162:163], v234 offset:37184
    v_mfma_f32_16x16x32_bf16 v[96:99], v[208:211], v[188:191], v[96:99]
    ds_read_b64_tr_b16 v[164:165], v234 offset:34912
    ds_read_b64_tr_b16 v[166:167], v234 offset:37216
    v_mfma_f32_16x16x32_bf16 v[100:103], v[208:211], v[192:195], v[100:103]
    ds_read_b64_tr_b16 v[168:169], v234 offset:34944
    v_mfma_f32_16x16x32_bf16 v[104:107], v[212:215], v[188:191], v[104:107]
    ds_read_b64_tr_b16 v[170:171], v234 offset:37248
    v_mfma_f32_16x16x32_bf16 v[108:111], v[212:215], v[192:195], v[108:111]
    ds_read_b64_tr_b16 v[172:173], v234 offset:34976
    ds_read_b64_tr_b16 v[174:175], v234 offset:37280
    v_mfma_f32_16x16x32_bf16 v[112:115], v[216:219], v[188:191], v[112:115]
    ds_read_b64_tr_b16 v[176:177], v234 offset:35008
    v_mfma_f32_16x16x32_bf16 v[116:119], v[216:219], v[192:195], v[116:119]
    ds_read_b64_tr_b16 v[178:179], v234 offset:37312
    v_mfma_f32_16x16x32_bf16 v[120:123], v[220:223], v[188:191], v[120:123]
    ds_read_b64_tr_b16 v[180:181], v234 offset:35040
    ds_read_b64_tr_b16 v[182:183], v234 offset:37344
    v_mfma_f32_16x16x32_bf16 v[124:127], v[220:223], v[192:195], v[124:127]
    ds_read_b64_tr_b16 v[184:185], v234 offset:35072
    v_mfma_f32_16x16x32_bf16 v[128:131], v[224:227], v[188:191], v[128:131]
    ds_read_b64_tr_b16 v[186:187], v234 offset:37376
    v_mfma_f32_16x16x32_bf16 v[132:135], v[224:227], v[192:195], v[132:135]
    v_mfma_f32_16x16x32_bf16 v[136:139], v[228:231], v[188:191], v[136:139]
    v_mfma_f32_16x16x32_bf16 v[140:143], v[228:231], v[192:195], v[140:143]
    s_waitcnt lgkmcnt(0)
    v_mfma_f32_16x16x32_bf16 v[72:75], v[152:155], v[144:147], v[72:75]
    ds_read_b128 v[188:191], v233 offset:34816
    ds_read_b128 v[192:195], v233 offset:36864
    v_mfma_f32_16x16x32_bf16 v[76:79], v[152:155], v[148:151], v[76:79]
    ds_read_b64_tr_b16 v[196:197], v234 offset:44032
    v_mfma_f32_16x16x32_bf16 v[80:83], v[156:159], v[144:147], v[80:83]
    ds_read_b64_tr_b16 v[198:199], v234 offset:46336
    v_mfma_f32_16x16x32_bf16 v[84:87], v[156:159], v[148:151], v[84:87]
    ds_read_b64_tr_b16 v[200:201], v234 offset:44064
    ds_read_b64_tr_b16 v[202:203], v234 offset:46368
    v_mfma_f32_16x16x32_bf16 v[88:91], v[160:163], v[144:147], v[88:91]
    ds_read_b64_tr_b16 v[204:205], v234 offset:44096
    v_mfma_f32_16x16x32_bf16 v[92:95], v[160:163], v[148:151], v[92:95]
    ds_read_b64_tr_b16 v[206:207], v234 offset:46400
    v_mfma_f32_16x16x32_bf16 v[96:99], v[164:167], v[144:147], v[96:99]
    ds_read_b64_tr_b16 v[208:209], v234 offset:44128
    ds_read_b64_tr_b16 v[210:211], v234 offset:46432
    v_mfma_f32_16x16x32_bf16 v[100:103], v[164:167], v[148:151], v[100:103]
    ds_read_b64_tr_b16 v[212:213], v234 offset:44160
    v_mfma_f32_16x16x32_bf16 v[104:107], v[168:171], v[144:147], v[104:107]
    ds_read_b64_tr_b16 v[214:215], v234 offset:46464
    v_mfma_f32_16x16x32_bf16 v[108:111], v[168:171], v[148:151], v[108:111]
    ds_read_b64_tr_b16 v[216:217], v234 offset:44192
    ds_read_b64_tr_b16 v[218:219], v234 offset:46496
    v_mfma_f32_16x16x32_bf16 v[112:115], v[172:175], v[144:147], v[112:115]
    ds_read_b64_tr_b16 v[220:221], v234 offset:44224
    v_mfma_f32_16x16x32_bf16 v[116:119], v[172:175], v[148:151], v[116:119]
    ds_read_b64_tr_b16 v[222:223], v234 offset:46528
    v_mfma_f32_16x16x32_bf16 v[120:123], v[176:179], v[144:147], v[120:123]
    ds_read_b64_tr_b16 v[224:225], v234 offset:44256
    ds_read_b64_tr_b16 v[226:227], v234 offset:46560
    v_mfma_f32_16x16x32_bf16 v[124:127], v[176:179], v[148:151], v[124:127]
    ds_read_b64_tr_b16 v[228:229], v234 offset:44288
    v_mfma_f32_16x16x32_bf16 v[128:131], v[180:183], v[144:147], v[128:131]
    ds_read_b64_tr_b16 v[230:231], v234 offset:46592
    v_mfma_f32_16x16x32_bf16 v[132:135], v[180:183], v[148:151], v[132:135]
    v_mfma_f32_16x16x32_bf16 v[136:139], v[184:187], v[144:147], v[136:139]
    v_mfma_f32_16x16x32_bf16 v[140:143], v[184:187], v[148:151], v[140:143]
    s_waitcnt lgkmcnt(0)
    s_barrier
    v_mfma_f32_16x16x32_bf16 v[72:75], v[196:199], v[188:191], v[72:75]
    ds_read_b128 v[144:147], v235 offset:0
    ds_read_b128 v[148:151], v235 offset:2048
    v_mfma_f32_16x16x32_bf16 v[76:79], v[196:199], v[192:195], v[76:79]
    ds_read_b64_tr_b16 v[152:153], v237 offset:0
    v_mfma_f32_16x16x32_bf16 v[80:83], v[200:203], v[188:191], v[80:83]
    ds_read_b64_tr_b16 v[154:155], v237 offset:2304
    v_mfma_f32_16x16x32_bf16 v[84:87], v[200:203], v[192:195], v[84:87]
    ds_read_b64_tr_b16 v[156:157], v237 offset:32
    ds_read_b64_tr_b16 v[158:159], v237 offset:2336
    v_mfma_f32_16x16x32_bf16 v[88:91], v[204:207], v[188:191], v[88:91]
    ds_read_b64_tr_b16 v[160:161], v237 offset:64
    v_mfma_f32_16x16x32_bf16 v[92:95], v[204:207], v[192:195], v[92:95]
    ds_read_b64_tr_b16 v[162:163], v237 offset:2368
    v_mfma_f32_16x16x32_bf16 v[96:99], v[208:211], v[188:191], v[96:99]
    ds_read_b64_tr_b16 v[164:165], v237 offset:96
    ds_read_b64_tr_b16 v[166:167], v237 offset:2400
    v_mfma_f32_16x16x32_bf16 v[100:103], v[208:211], v[192:195], v[100:103]
    ds_read_b64_tr_b16 v[168:169], v237 offset:128
    v_mfma_f32_16x16x32_bf16 v[104:107], v[212:215], v[188:191], v[104:107]
    ds_read_b64_tr_b16 v[170:171], v237 offset:2432
    v_mfma_f32_16x16x32_bf16 v[108:111], v[212:215], v[192:195], v[108:111]
    ds_read_b64_tr_b16 v[172:173], v237 offset:160
    ds_read_b64_tr_b16 v[174:175], v237 offset:2464
    v_mfma_f32_16x16x32_bf16 v[112:115], v[216:219], v[188:191], v[112:115]
    ds_read_b64_tr_b16 v[176:177], v237 offset:192
    v_mfma_f32_16x16x32_bf16 v[116:119], v[216:219], v[192:195], v[116:119]
    ds_read_b64_tr_b16 v[178:179], v237 offset:2496
    v_mfma_f32_16x16x32_bf16 v[120:123], v[220:223], v[188:191], v[120:123]
    ds_read_b64_tr_b16 v[180:181], v237 offset:224
    ds_read_b64_tr_b16 v[182:183], v237 offset:2528
    v_mfma_f32_16x16x32_bf16 v[124:127], v[220:223], v[192:195], v[124:127]
    ds_read_b64_tr_b16 v[184:185], v237 offset:256
    v_mfma_f32_16x16x32_bf16 v[128:131], v[224:227], v[188:191], v[128:131]
    ds_read_b64_tr_b16 v[186:187], v237 offset:2560
    v_mfma_f32_16x16x32_bf16 v[132:135], v[224:227], v[192:195], v[132:135]
    v_mfma_f32_16x16x32_bf16 v[136:139], v[228:231], v[188:191], v[136:139]
    v_mfma_f32_16x16x32_bf16 v[140:143], v[228:231], v[192:195], v[140:143]
    s_waitcnt lgkmcnt(0)
    v_mfma_f32_16x16x32_bf16 v[72:75], v[152:155], v[144:147], v[72:75]
    ds_read_b128 v[188:191], v236 offset:0
    ds_read_b128 v[192:195], v236 offset:2048
    v_mfma_f32_16x16x32_bf16 v[76:79], v[152:155], v[148:151], v[76:79]
    ds_read_b64_tr_b16 v[196:197], v237 offset:9216
    v_mfma_f32_16x16x32_bf16 v[80:83], v[156:159], v[144:147], v[80:83]
    ds_read_b64_tr_b16 v[198:199], v237 offset:11520
    v_mfma_f32_16x16x32_bf16 v[84:87], v[156:159], v[148:151], v[84:87]
    ds_read_b64_tr_b16 v[200:201], v237 offset:9248
    ds_read_b64_tr_b16 v[202:203], v237 offset:11552
    v_mfma_f32_16x16x32_bf16 v[88:91], v[160:163], v[144:147], v[88:91]
    ds_read_b64_tr_b16 v[204:205], v237 offset:9280
    v_mfma_f32_16x16x32_bf16 v[92:95], v[160:163], v[148:151], v[92:95]
    ds_read_b64_tr_b16 v[206:207], v237 offset:11584
    v_mfma_f32_16x16x32_bf16 v[96:99], v[164:167], v[144:147], v[96:99]
    ds_read_b64_tr_b16 v[208:209], v237 offset:9312
    ds_read_b64_tr_b16 v[210:211], v237 offset:11616
    v_mfma_f32_16x16x32_bf16 v[100:103], v[164:167], v[148:151], v[100:103]
    ds_read_b64_tr_b16 v[212:213], v237 offset:9344
    v_mfma_f32_16x16x32_bf16 v[104:107], v[168:171], v[144:147], v[104:107]
    ds_read_b64_tr_b16 v[214:215], v237 offset:11648
    v_mfma_f32_16x16x32_bf16 v[108:111], v[168:171], v[148:151], v[108:111]
    ds_read_b64_tr_b16 v[216:217], v237 offset:9376
    ds_read_b64_tr_b16 v[218:219], v237 offset:11680
    v_mfma_f32_16x16x32_bf16 v[112:115], v[172:175], v[144:147], v[112:115]
    ds_read_b64_tr_b16 v[220:221], v237 offset:9408
    v_mfma_f32_16x16x32_bf16 v[116:119], v[172:175], v[148:151], v[116:119]
    ds_read_b64_tr_b16 v[222:223], v237 offset:11712
    v_mfma_f32_16x16x32_bf16 v[120:123], v[176:179], v[144:147], v[120:123]
    ds_read_b64_tr_b16 v[224:225], v237 offset:9440
    ds_read_b64_tr_b16 v[226:227], v237 offset:11744
    v_mfma_f32_16x16x32_bf16 v[124:127], v[176:179], v[148:151], v[124:127]
    ds_read_b64_tr_b16 v[228:229], v237 offset:9472
    v_mfma_f32_16x16x32_bf16 v[128:131], v[180:183], v[144:147], v[128:131]
    ds_read_b64_tr_b16 v[230:231], v237 offset:11776
    v_mfma_f32_16x16x32_bf16 v[132:135], v[180:183], v[148:151], v[132:135]
    v_mfma_f32_16x16x32_bf16 v[136:139], v[184:187], v[144:147], v[136:139]
    v_mfma_f32_16x16x32_bf16 v[140:143], v[184:187], v[148:151], v[140:143]
    s_waitcnt lgkmcnt(0)
    s_barrier
    v_mfma_f32_16x16x32_bf16 v[72:75], v[196:199], v[188:191], v[72:75]
    ds_read_b128 v[144:147], v235 offset:34816
    ds_read_b128 v[148:151], v235 offset:36864
    v_mfma_f32_16x16x32_bf16 v[76:79], v[196:199], v[192:195], v[76:79]
    ds_read_b64_tr_b16 v[152:153], v237 offset:34816
    v_mfma_f32_16x16x32_bf16 v[80:83], v[200:203], v[188:191], v[80:83]
    ds_read_b64_tr_b16 v[154:155], v237 offset:37120
    v_mfma_f32_16x16x32_bf16 v[84:87], v[200:203], v[192:195], v[84:87]
    ds_read_b64_tr_b16 v[156:157], v237 offset:34848
    ds_read_b64_tr_b16 v[158:159], v237 offset:37152
    v_mfma_f32_16x16x32_bf16 v[88:91], v[204:207], v[188:191], v[88:91]
    ds_read_b64_tr_b16 v[160:161], v237 offset:34880
    v_mfma_f32_16x16x32_bf16 v[92:95], v[204:207], v[192:195], v[92:95]
    ds_read_b64_tr_b16 v[162:163], v237 offset:37184
    v_mfma_f32_16x16x32_bf16 v[96:99], v[208:211], v[188:191], v[96:99]
    ds_read_b64_tr_b16 v[164:165], v237 offset:34912
    ds_read_b64_tr_b16 v[166:167], v237 offset:37216
    v_mfma_f32_16x16x32_bf16 v[100:103], v[208:211], v[192:195], v[100:103]
    ds_read_b64_tr_b16 v[168:169], v237 offset:34944
    v_mfma_f32_16x16x32_bf16 v[104:107], v[212:215], v[188:191], v[104:107]
    ds_read_b64_tr_b16 v[170:171], v237 offset:37248
    v_mfma_f32_16x16x32_bf16 v[108:111], v[212:215], v[192:195], v[108:111]
    ds_read_b64_tr_b16 v[172:173], v237 offset:34976
    ds_read_b64_tr_b16 v[174:175], v237 offset:37280
    v_mfma_f32_16x16x32_bf16 v[112:115], v[216:219], v[188:191], v[112:115]
    ds_read_b64_tr_b16 v[176:177], v237 offset:35008
    v_mfma_f32_16x16x32_bf16 v[116:119], v[216:219], v[192:195], v[116:119]
    ds_read_b64_tr_b16 v[178:179], v237 offset:37312
    v_mfma_f32_16x16x32_bf16 v[120:123], v[220:223], v[188:191], v[120:123]
    ds_read_b64_tr_b16 v[180:181], v237 offset:35040
    ds_read_b64_tr_b16 v[182:183], v237 offset:37344
    v_mfma_f32_16x16x32_bf16 v[124:127], v[220:223], v[192:195], v[124:127]
    ds_read_b64_tr_b16 v[184:185], v237 offset:35072
    v_mfma_f32_16x16x32_bf16 v[128:131], v[224:227], v[188:191], v[128:131]
    ds_read_b64_tr_b16 v[186:187], v237 offset:37376
    v_mfma_f32_16x16x32_bf16 v[132:135], v[224:227], v[192:195], v[132:135]
    v_mfma_f32_16x16x32_bf16 v[136:139], v[228:231], v[188:191], v[136:139]
    v_mfma_f32_16x16x32_bf16 v[140:143], v[228:231], v[192:195], v[140:143]
    s_waitcnt lgkmcnt(0)
    v_mfma_f32_16x16x32_bf16 v[72:75], v[152:155], v[144:147], v[72:75]
    ds_read_b128 v[188:191], v236 offset:34816
    ds_read_b128 v[192:195], v236 offset:36864
    v_mfma_f32_16x16x32_bf16 v[76:79], v[152:155], v[148:151], v[76:79]
    ds_read_b64_tr_b16 v[196:197], v237 offset:44032
    v_mfma_f32_16x16x32_bf16 v[80:83], v[156:159], v[144:147], v[80:83]
    ds_read_b64_tr_b16 v[198:199], v237 offset:46336
    v_mfma_f32_16x16x32_bf16 v[84:87], v[156:159], v[148:151], v[84:87]
    ds_read_b64_tr_b16 v[200:201], v237 offset:44064
    ds_read_b64_tr_b16 v[202:203], v237 offset:46368
    v_mfma_f32_16x16x32_bf16 v[88:91], v[160:163], v[144:147], v[88:91]
    ds_read_b64_tr_b16 v[204:205], v237 offset:44096
    v_mfma_f32_16x16x32_bf16 v[92:95], v[160:163], v[148:151], v[92:95]
    ds_read_b64_tr_b16 v[206:207], v237 offset:46400
    v_mfma_f32_16x16x32_bf16 v[96:99], v[164:167], v[144:147], v[96:99]
    ds_read_b64_tr_b16 v[208:209], v237 offset:44128
    ds_read_b64_tr_b16 v[210:211], v237 offset:46432
    v_mfma_f32_16x16x32_bf16 v[100:103], v[164:167], v[148:151], v[100:103]
    ds_read_b64_tr_b16 v[212:213], v237 offset:44160
    v_mfma_f32_16x16x32_bf16 v[104:107], v[168:171], v[144:147], v[104:107]
    ds_read_b64_tr_b16 v[214:215], v237 offset:46464
    v_mfma_f32_16x16x32_bf16 v[108:111], v[168:171], v[148:151], v[108:111]
    ds_read_b64_tr_b16 v[216:217], v237 offset:44192
    ds_read_b64_tr_b16 v[218:219], v237 offset:46496
    v_mfma_f32_16x16x32_bf16 v[112:115], v[172:175], v[144:147], v[112:115]
    ds_read_b64_tr_b16 v[220:221], v237 offset:44224
    v_mfma_f32_16x16x32_bf16 v[116:119], v[172:175], v[148:151], v[116:119]
    ds_read_b64_tr_b16 v[222:223], v237 offset:46528
    v_mfma_f32_16x16x32_bf16 v[120:123], v[176:179], v[144:147], v[120:123]
    ds_read_b64_tr_b16 v[224:225], v237 offset:44256
    ds_read_b64_tr_b16 v[226:227], v237 offset:46560
    v_mfma_f32_16x16x32_bf16 v[124:127], v[176:179], v[148:151], v[124:127]
    ds_read_b64_tr_b16 v[228:229], v237 offset:44288
    v_mfma_f32_16x16x32_bf16 v[128:131], v[180:183], v[144:147], v[128:131]
    ds_read_b64_tr_b16 v[230:231], v237 offset:46592
    v_mfma_f32_16x16x32_bf16 v[132:135], v[180:183], v[148:151], v[132:135]
    v_mfma_f32_16x16x32_bf16 v[136:139], v[184:187], v[144:147], v[136:139]
    v_mfma_f32_16x16x32_bf16 v[140:143], v[184:187], v[148:151], v[140:143]
    s_waitcnt lgkmcnt(0)
    v_mfma_f32_16x16x32_bf16 v[72:75], v[196:199], v[188:191], v[72:75]
    v_mfma_f32_16x16x32_bf16 v[76:79], v[196:199], v[192:195], v[76:79]
    v_mfma_f32_16x16x32_bf16 v[80:83], v[200:203], v[188:191], v[80:83]
    v_mfma_f32_16x16x32_bf16 v[84:87], v[200:203], v[192:195], v[84:87]
    v_mfma_f32_16x16x32_bf16 v[88:91], v[204:207], v[188:191], v[88:91]
    v_mfma_f32_16x16x32_bf16 v[92:95], v[204:207], v[192:195], v[92:95]
    v_mfma_f32_16x16x32_bf16 v[96:99], v[208:211], v[188:191], v[96:99]
    v_mfma_f32_16x16x32_bf16 v[100:103], v[208:211], v[192:195], v[100:103]
    v_mfma_f32_16x16x32_bf16 v[104:107], v[212:215], v[188:191], v[104:107]
    v_mfma_f32_16x16x32_bf16 v[108:111], v[212:215], v[192:195], v[108:111]
    v_mfma_f32_16x16x32_bf16 v[112:115], v[216:219], v[188:191], v[112:115]
    v_mfma_f32_16x16x32_bf16 v[116:119], v[216:219], v[192:195], v[116:119]
    v_mfma_f32_16x16x32_bf16 v[120:123], v[220:223], v[188:191], v[120:123]
    v_mfma_f32_16x16x32_bf16 v[124:127], v[220:223], v[192:195], v[124:127]
    v_mfma_f32_16x16x32_bf16 v[128:131], v[224:227], v[188:191], v[128:131]
    v_mfma_f32_16x16x32_bf16 v[132:135], v[224:227], v[192:195], v[132:135]
    v_mfma_f32_16x16x32_bf16 v[136:139], v[228:231], v[188:191], v[136:139]
    v_mfma_f32_16x16x32_bf16 v[140:143], v[228:231], v[192:195], v[140:143]
    v_lshrrev_b32 v249, 4, v255
    v_lshlrev_b32 v249, 4, v249
    s_lshl_b32 s33, s22, 7
    s_add_u32 s33, s33, 139264
    v_add_u32 v249, s33, v249
    s_mov_b32 s36, s4
    s_mov_b32 s37, s5
    s_mov_b32 s38, 9437184
    s_mov_b32 s39, 0x20000
    s_mul_i32 s32, s21, 576
    s_lshl_b32 s33, s20, 2
    s_add_u32 s33, s33, s22
    s_add_u32 s32, s32, s33
    s_lshl_b32 s32, s32, 10
    s_lshl_b32 s34, s21, 6
    s_add_u32 s34, s34, s33
    s_lshl_b32 s34, s34, 2
    s_add_u32 s34, s34, 8192
    s_lshr_b32 s33, s22, 1
    s_mul_i32 s33, s33, 34816
    s_and_b32 s53, s22, 1
    s_lshl_b32 s53, s53, 10
    s_add_u32 s33, s33, s53
    v_add_u32 v250, s33, v246
    s_barrier
    ds_read_b128 v[148:151], v249
    ds_read_b128 v[152:155], v249 offset:64
    ds_read_b128 v[156:159], v249 offset:512
    ds_read_b128 v[160:163], v249 offset:576
    s_waitcnt lgkmcnt(0)
    v_pk_fma_f32 v[0:1], v[0:1], v[156:157], v[148:149]
    v_pk_fma_f32 v[2:3], v[2:3], v[158:159], v[150:151]
    v_cvt_pk_bf16_f32 v164, v0, v1
    v_cvt_pk_bf16_f32 v165, v2, v3
    v_pk_fma_f32 v[4:5], v[4:5], v[160:161], v[152:153]
    v_pk_fma_f32 v[6:7], v[6:7], v[162:163], v[154:155]
    v_cvt_pk_bf16_f32 v166, v4, v5
    v_cvt_pk_bf16_f32 v167, v6, v7
    s_nop 0
    v_permlane16_swap_b32 v164, v166
    v_permlane16_swap_b32 v165, v167
    buffer_store_dwordx4 v[164:167], v246, s[36:39], s32 offen sc1
    s_add_u32 s32, s32, 65536
    ds_write_b128 v250, v[164:167] offset:0
    v_pk_fma_f32 v[8:9], v[8:9], v[156:157], v[148:149]
    v_pk_fma_f32 v[10:11], v[10:11], v[158:159], v[150:151]
    v_cvt_pk_bf16_f32 v168, v8, v9
    v_cvt_pk_bf16_f32 v169, v10, v11
    v_pk_fma_f32 v[12:13], v[12:13], v[160:161], v[152:153]
    v_pk_fma_f32 v[14:15], v[14:15], v[162:163], v[154:155]
    v_cvt_pk_bf16_f32 v170, v12, v13
    v_cvt_pk_bf16_f32 v171, v14, v15
    s_nop 0
    v_permlane16_swap_b32 v168, v170
    v_permlane16_swap_b32 v169, v171
    buffer_store_dwordx4 v[168:171], v246, s[36:39], s32 offen sc1
    s_add_u32 s32, s32, 65536
    ds_write_b128 v250, v[168:171] offset:2048
    v_pk_fma_f32 v[16:17], v[16:17], v[156:157], v[148:149]
    v_pk_fma_f32 v[18:19], v[18:19], v[158:159], v[150:151]
    v_cvt_pk_bf16_f32 v172, v16, v17
    v_cvt_pk_bf16_f32 v173, v18, v19
    v_pk_fma_f32 v[20:21], v[20:21], v[160:161], v[152:153]
    v_pk_fma_f32 v[22:23], v[22:23], v[162:163], v[154:155]
    v_cvt_pk_bf16_f32 v174, v20, v21
    v_cvt_pk_bf16_f32 v175, v22, v23
    s_nop 0
    v_permlane16_swap_b32 v172, v174
    v_permlane16_swap_b32 v173, v175
    buffer_store_dwordx4 v[172:175], v246, s[36:39], s32 offen sc1
    s_add_u32 s32, s32, 65536
    ds_write_b128 v250, v[172:175] offset:4096
    v_pk_fma_f32 v[24:25], v[24:25], v[156:157], v[148:149]
    v_pk_fma_f32 v[26:27], v[26:27], v[158:159], v[150:151]
    v_cvt_pk_bf16_f32 v176, v24, v25
    v_cvt_pk_bf16_f32 v177, v26, v27
    v_pk_fma_f32 v[28:29], v[28:29], v[160:161], v[152:153]
    v_pk_fma_f32 v[30:31], v[30:31], v[162:163], v[154:155]
    v_cvt_pk_bf16_f32 v178, v28, v29
    v_cvt_pk_bf16_f32 v179, v30, v31
    s_nop 0
    v_permlane16_swap_b32 v176, v178
    v_permlane16_swap_b32 v177, v179
    buffer_store_dwordx4 v[176:179], v246, s[36:39], s32 offen sc1
    s_add_u32 s32, s32, 65536
    ds_write_b128 v250, v[176:179] offset:6144
    v_pk_fma_f32 v[32:33], v[32:33], v[156:157], v[148:149]
    v_pk_fma_f32 v[34:35], v[34:35], v[158:159], v[150:151]
    v_cvt_pk_bf16_f32 v164, v32, v33
    v_cvt_pk_bf16_f32 v165, v34, v35
    v_pk_fma_f32 v[36:37], v[36:37], v[160:161], v[152:153]
    v_pk_fma_f32 v[38:39], v[38:39], v[162:163], v[154:155]
    v_cvt_pk_bf16_f32 v166, v36, v37
    v_cvt_pk_bf16_f32 v167, v38, v39
    s_nop 0
    v_permlane16_swap_b32 v164, v166
    v_permlane16_swap_b32 v165, v167
    buffer_store_dwordx4 v[164:167], v246, s[36:39], s32 offen sc1
    s_add_u32 s32, s32, 65536
    ds_write_b128 v250, v[164:167] offset:8192
    v_pk_fma_f32 v[40:41], v[40:41], v[156:157], v[148:149]
    v_pk_fma_f32 v[42:43], v[42:43], v[158:159], v[150:151]
    v_cvt_pk_bf16_f32 v168, v40, v41
    v_cvt_pk_bf16_f32 v169, v42, v43
    v_pk_fma_f32 v[44:45], v[44:45], v[160:161], v[152:153]
    v_pk_fma_f32 v[46:47], v[46:47], v[162:163], v[154:155]
    v_cvt_pk_bf16_f32 v170, v44, v45
    v_cvt_pk_bf16_f32 v171, v46, v47
    s_nop 0
    v_permlane16_swap_b32 v168, v170
    v_permlane16_swap_b32 v169, v171
    buffer_store_dwordx4 v[168:171], v246, s[36:39], s32 offen sc1
    s_add_u32 s32, s32, 65536
    ds_write_b128 v250, v[168:171] offset:10240
    v_pk_fma_f32 v[48:49], v[48:49], v[156:157], v[148:149]
    v_pk_fma_f32 v[50:51], v[50:51], v[158:159], v[150:151]
    v_cvt_pk_bf16_f32 v172, v48, v49
    v_cvt_pk_bf16_f32 v173, v50, v51
    v_pk_fma_f32 v[52:53], v[52:53], v[160:161], v[152:153]
    v_pk_fma_f32 v[54:55], v[54:55], v[162:163], v[154:155]
    v_cvt_pk_bf16_f32 v174, v52, v53
    v_cvt_pk_bf16_f32 v175, v54, v55
    s_nop 0
    v_permlane16_swap_b32 v172, v174
    v_permlane16_swap_b32 v173, v175
    buffer_store_dwordx4 v[172:175], v246, s[36:39], s32 offen sc1
    s_add_u32 s32, s32, 65536
    ds_write_b128 v250, v[172:175] offset:12288
    v_pk_fma_f32 v[56:57], v[56:57], v[156:157], v[148:149]
    v_pk_fma_f32 v[58:59], v[58:59], v[158:159], v[150:151]
    v_cvt_pk_bf16_f32 v176, v56, v57
    v_cvt_pk_bf16_f32 v177, v58, v59
    v_pk_fma_f32 v[60:61], v[60:61], v[160:161], v[152:153]
    v_pk_fma_f32 v[62:63], v[62:63], v[162:163], v[154:155]
    v_cvt_pk_bf16_f32 v178, v60, v61
    v_cvt_pk_bf16_f32 v179, v62, v63
    s_nop 0
    v_permlane16_swap_b32 v176, v178
    v_permlane16_swap_b32 v177, v179
    buffer_store_dwordx4 v[176:179], v246, s[36:39], s32 offen sc1
    s_add_u32 s32, s32, 65536
    ds_write_b128 v250, v[176:179] offset:14336
    v_pk_fma_f32 v[64:65], v[64:65], v[156:157], v[148:149]
    v_pk_fma_f32 v[66:67], v[66:67], v[158:159], v[150:151]
    v_cvt_pk_bf16_f32 v164, v64, v65
    v_cvt_pk_bf16_f32 v165, v66, v67
    v_pk_fma_f32 v[68:69], v[68:69], v[160:161], v[152:153]
    v_pk_fma_f32 v[70:71], v[70:71], v[162:163], v[154:155]
    v_cvt_pk_bf16_f32 v166, v68, v69
    v_cvt_pk_bf16_f32 v167, v70, v71
    s_nop 0
    v_permlane16_swap_b32 v164, v166
    v_permlane16_swap_b32 v165, v167
    buffer_store_dwordx4 v[164:167], v246, s[36:39], s32 offen sc1
    s_add_u32 s32, s32, 65536
    ds_write_b128 v250, v[164:167] offset:16384
    s_mov_b32 s48, s34
    s_branch fz_cons
fz_cons:
    s_load_dwordx2 s[8:9], s[0:1], 96
    s_lshl_b32 s30, s20, 3
    s_lshl_b32 s31, s22, 1
    s_add_u32 s30, s30, s31
    s_lshl_b32 s31, s30, 4
    s_add_u32 s31, s31, s21
    s_mul_i32 s31, s31, 4608
    s_add_u32 s32, s31, 73728
    v_and_b32 v3, 15, v255
    v_lshrrev_b32 v236, 4, v255
    v_lshrrev_b32 v239, 1, v3
    v_xor_b32 v236, v236, v239
    v_lshlrev_b32 v236, 4, v236
    v_lshl_add_u32 v236, v3, 7, v236
    s_lshl_b32 s34, s22, 12
    s_add_u32 s34, s34, 18432
    v_add_u32 v236, s34, v236
    v_xor_b32 v239, 64, v236
    v_lshlrev_b32 v235, 4, v255
    v_add_u32 v232, 69632, v235
    v_add_u32 v233, 69632, v236
    v_add_u32 v234, 69632, v239
    s_lshl_b32 s34, s30, 4
    v_add_u32 v3, s34, v3
    v_lshlrev_b32 v3, 1, v3
    v_mov_b32 v252, 0xbdd2d3e8
    s_waitcnt lgkmcnt(0)
    global_load_ushort v253, v3, s[8:9]
    global_load_ushort v251, v3, s[8:9] offset:32
    s_mov_b32 s34, 0
    s_setprio 2
    s_lshl_b32 s28, s20, 1
    s_lshr_b32 s10, s22, 1
    s_add_u32 s28, s28, s10
    s_lshl_b32 s28, s28, 4
    s_add_u32 s28, s28, s21
    s_lshl_b32 s28, s28, 1
    s_and_b32 s10, s22, 1
    s_add_u32 s28, s28, s10
    s_lshl_b32 s28, s28, 2
    s_add_u32 s28, s28, 16384
    s_load_dwordx2 s[6:7], s[0:1], 0
    s_load_dwordx2 s[8:9], s[0:1], 112
    s_add_u32 s29, s21, s22
    s_and_b32 s29, s29, 15
    s_and_b32 s20, s2, 7
    s_lshl_b32 s20, s20, 2
    s_lshr_b32 s21, s2, 6
    s_add_u32 s20, s20, s21
    s_lshr_b32 s21, s2, 3
    s_and_b32 s21, s21, 7
    s_add_u32 s24, s4, 35389440
    s_addc_u32 s25, s5, 0
    s_mov_b32 s26, 2654208
    s_mov_b32 s27, 0x20000
    s_add_u32 s36, s4, 33030144
    s_addc_u32 s37, s5, 0
    s_mov_b32 s38, 2359296
    s_mov_b32 s39, 0x20000
    v_lshlrev_b32 v242, 4, v255
    v_lshlrev_b32 v243, 3, v255
    v_lshrrev_b32 v4, 4, v255
    v_and_b32 v5, 7, v255
    v_lshl_add_u32 v5, v4, 3, v5
    v_and_b32 v6, 8, v255
    v_cmp_eq_u32 vcc, 0, v6
    v_lshlrev_b32 v6, 4, v5
    v_lshlrev_b32 v7, 3, v5
    v_mov_b32 v8, 2146435072
    v_cndmask_b32 v244, v8, v6, vcc
    v_cndmask_b32 v245, v8, v7, vcc
    s_mul_i32 s57, s20, 294912
    s_mul_i32 s58, s21, 331776
    v_lshrrev_b32 v4, 3, v255
    v_lshl_add_u32 v4, v4, 2, s29
    v_and_b32 v4, 15, v4
    v_lshlrev_b32 v237, 5, v4
    v_and_b32 v5, 7, v255
    v_lshl_add_u32 v237, v5, 2, v237
    s_lshl_b32 s10, s21, 9
    s_add_u32 s10, s10, 20480
    v_add_u32 v237, s10, v237
    v_lshrrev_b32 v4, 1, v255
    v_lshl_add_u32 v4, v4, 2, s29
    v_and_b32 v4, 15, v4
    v_and_b32 v5, 1, v255
    v_lshlrev_b32 v5, 2, v5
    v_lshl_add_u32 v250, v4, 3, v5
    s_lshl_b32 s11, s20, 7
    s_add_u32 s11, s11, 16384
    v_add_u32 v250, s11, v250
    s_waitcnt lgkmcnt(0)
    s_mov_b32 s40, s6
    s_mov_b32 s41, s7
    s_mov_b32 s42, 2359296
    s_mov_b32 s43, 0x20000
    s_mov_b32 s44, s8
    s_mov_b32 s45, s9
    s_mov_b32 s46, 2359296
    s_mov_b32 s47, 0x20000
    s_mul_i32 s50, s29, 4608
    s_add_u32 s50, s50, s57
    s_add_u32 s51, s50, 73728
    s_add_u32 s52, s50, 147456
    s_add_u32 s63, s50, 221184
    s_mul_i32 s54, s29, 20736
    s_add_u32 s54, s54, s58
    s_barrier
    ds_read_b128 v[144:147], v236 offset:0
    ds_read_b128 v[148:151], v236 offset:2048
    ds_read_b128 v[152:155], v235 offset:0
    ds_read_b128 v[156:159], v235 offset:2048
    ds_read_b128 v[160:163], v235 offset:4096
    ds_read_b128 v[164:167], v235 offset:6144
    ds_read_b128 v[168:171], v235 offset:8192
    ds_read_b128 v[172:175], v235 offset:10240
    ds_read_b128 v[176:179], v235 offset:12288
    ds_read_b128 v[180:183], v235 offset:14336
    ds_read_b128 v[184:187], v235 offset:16384
    v_mul_f32 v240, v72, v72
    v_mul_f32 v241, v73, v73
    v_fmaak_f32 v240, v252, v240, 0xc0135761
    v_fmaak_f32 v241, v252, v241, 0xc0135761
    v_mul_f32 v240, v240, v72
    v_mul_f32 v241, v241, v73
    v_exp_f32 v240, v240
    v_exp_f32 v241, v241
    v_add_f32 v240, 1.0, v240
    v_add_f32 v241, 1.0, v241
    v_rcp_f32 v240, v240
    v_rcp_f32 v241, v241
    v_mul_f32 v72, v72, v240
    v_mul_f32 v73, v73, v241
    v_cvt_pk_bf16_f32 v72, v72, v73
    v_mul_f32 v246, v74, v74
    v_mul_f32 v247, v75, v75
    v_fmaak_f32 v246, v252, v246, 0xc0135761
    v_fmaak_f32 v247, v252, v247, 0xc0135761
    v_mul_f32 v246, v246, v74
    v_mul_f32 v247, v247, v75
    v_exp_f32 v246, v246
    v_exp_f32 v247, v247
    s_waitcnt lgkmcnt(0)
    v_mfma_f32_16x16x32_bf16 v[0:3], v[152:155], v[144:147], 0
    ds_read_b128 v[188:191], v239 offset:0
    v_add_f32 v246, 1.0, v246
    v_mfma_f32_16x16x32_bf16 v[4:7], v[152:155], v[148:151], 0
    ds_read_b128 v[192:195], v239 offset:2048
    v_add_f32 v247, 1.0, v247
    v_mfma_f32_16x16x32_bf16 v[8:11], v[156:159], v[144:147], 0
    ds_read_b128 v[196:199], v235 offset:1024
    v_rcp_f32 v246, v246
    v_mfma_f32_16x16x32_bf16 v[12:15], v[156:159], v[148:151], 0
    ds_read_b128 v[200:203], v235 offset:3072
    v_rcp_f32 v247, v247
    v_mul_f32 v74, v74, v246
    v_mfma_f32_16x16x32_bf16 v[16:19], v[160:163], v[144:147], 0
    ds_read_b128 v[204:207], v235 offset:5120
    v_mul_f32 v75, v75, v247
    v_mfma_f32_16x16x32_bf16 v[20:23], v[160:163], v[148:151], 0
    ds_read_b128 v[208:211], v235 offset:7168
    v_cvt_pk_bf16_f32 v74, v74, v75
    v_mfma_f32_16x16x32_bf16 v[24:27], v[164:167], v[144:147], 0
    ds_read_b128 v[212:215], v235 offset:9216
    v_mul_f32 v248, v76, v76
    v_mfma_f32_16x16x32_bf16 v[28:31], v[164:167], v[148:151], 0
    ds_read_b128 v[216:219], v235 offset:11264
    v_mul_f32 v249, v77, v77
    v_fmaak_f32 v248, v252, v248, 0xc0135761
    v_mfma_f32_16x16x32_bf16 v[32:35], v[168:171], v[144:147], 0
    ds_read_b128 v[220:223], v235 offset:13312
    v_fmaak_f32 v249, v252, v249, 0xc0135761
    v_mfma_f32_16x16x32_bf16 v[36:39], v[168:171], v[148:151], 0
    ds_read_b128 v[224:227], v235 offset:15360
    v_mul_f32 v248, v248, v76
    v_mfma_f32_16x16x32_bf16 v[40:43], v[172:175], v[144:147], 0
    ds_read_b128 v[228:231], v235 offset:17408
    v_mul_f32 v249, v249, v77
    v_exp_f32 v248, v248
    v_mfma_f32_16x16x32_bf16 v[44:47], v[172:175], v[148:151], 0
    v_exp_f32 v249, v249
    v_mfma_f32_16x16x32_bf16 v[48:51], v[176:179], v[144:147], 0
    v_add_f32 v248, 1.0, v248
    v_mfma_f32_16x16x32_bf16 v[52:55], v[176:179], v[148:151], 0
    v_add_f32 v249, 1.0, v249
    v_mfma_f32_16x16x32_bf16 v[56:59], v[180:183], v[144:147], 0
    v_rcp_f32 v248, v248
    v_rcp_f32 v249, v249
    v_mfma_f32_16x16x32_bf16 v[60:63], v[180:183], v[148:151], 0
    v_mul_f32 v76, v76, v248
    v_mfma_f32_16x16x32_bf16 v[64:67], v[184:187], v[144:147], 0
    v_mul_f32 v77, v77, v249
    v_mfma_f32_16x16x32_bf16 v[68:71], v[184:187], v[148:151], 0
    v_cvt_pk_bf16_f32 v76, v76, v77
    v_mul_f32 v240, v78, v78
    v_mov_b32 v238, 0
    v_mov_b32 v254, s23
    s_waitcnt vmcnt(2)
    s_mov_b64 exec, 1
    buffer_store_dword v254, v238, s[16:19], s48 offen sc1
    s_mov_b64 exec, -1
    s_waitcnt lgkmcnt(0)
    s_barrier
    v_mfma_f32_16x16x32_bf16 v[0:3], v[196:199], v[188:191], v[0:3]
    ds_read_b128 v[144:147], v236 offset:34816
    v_mul_f32 v241, v79, v79
    v_mfma_f32_16x16x32_bf16 v[4:7], v[196:199], v[192:195], v[4:7]
    ds_read_b128 v[148:151], v236 offset:36864
    v_fmaak_f32 v240, v252, v240, 0xc0135761
    v_mfma_f32_16x16x32_bf16 v[8:11], v[200:203], v[188:191], v[8:11]
    ds_read_b128 v[152:155], v235 offset:34816
    v_fmaak_f32 v241, v252, v241, 0xc0135761
    v_mfma_f32_16x16x32_bf16 v[12:15], v[200:203], v[192:195], v[12:15]
    ds_read_b128 v[156:159], v235 offset:36864
    v_mul_f32 v240, v240, v78
    v_mul_f32 v241, v241, v79
    v_mfma_f32_16x16x32_bf16 v[16:19], v[204:207], v[188:191], v[16:19]
    ds_read_b128 v[160:163], v235 offset:38912
    v_exp_f32 v240, v240
    v_mfma_f32_16x16x32_bf16 v[20:23], v[204:207], v[192:195], v[20:23]
    ds_read_b128 v[164:167], v235 offset:40960
    v_exp_f32 v241, v241
    v_mfma_f32_16x16x32_bf16 v[24:27], v[208:211], v[188:191], v[24:27]
    ds_read_b128 v[168:171], v235 offset:43008
    v_add_f32 v240, 1.0, v240
    v_mfma_f32_16x16x32_bf16 v[28:31], v[208:211], v[192:195], v[28:31]
    ds_read_b128 v[172:175], v235 offset:45056
    v_add_f32 v241, 1.0, v241
    v_rcp_f32 v240, v240
    v_mfma_f32_16x16x32_bf16 v[32:35], v[212:215], v[188:191], v[32:35]
    ds_read_b128 v[176:179], v235 offset:47104
    v_rcp_f32 v241, v241
    v_mfma_f32_16x16x32_bf16 v[36:39], v[212:215], v[192:195], v[36:39]
    ds_read_b128 v[180:183], v235 offset:49152
    v_mul_f32 v78, v78, v240
    v_mfma_f32_16x16x32_bf16 v[40:43], v[216:219], v[188:191], v[40:43]
    ds_read_b128 v[184:187], v235 offset:51200
    v_mul_f32 v79, v79, v241
    v_cvt_pk_bf16_f32 v78, v78, v79
    v_mfma_f32_16x16x32_bf16 v[44:47], v[216:219], v[192:195], v[44:47]
    v_mul_f32 v246, v80, v80
    v_mfma_f32_16x16x32_bf16 v[48:51], v[220:223], v[188:191], v[48:51]
    v_mul_f32 v247, v81, v81
    v_mfma_f32_16x16x32_bf16 v[52:55], v[220:223], v[192:195], v[52:55]
    v_fmaak_f32 v246, v252, v246, 0xc0135761
    v_mfma_f32_16x16x32_bf16 v[56:59], v[224:227], v[188:191], v[56:59]
    v_fmaak_f32 v247, v252, v247, 0xc0135761
    v_mul_f32 v246, v246, v80
    v_mfma_f32_16x16x32_bf16 v[60:63], v[224:227], v[192:195], v[60:63]
    v_mul_f32 v247, v247, v81
    v_mfma_f32_16x16x32_bf16 v[64:67], v[228:231], v[188:191], v[64:67]
    v_exp_f32 v246, v246
    v_mfma_f32_16x16x32_bf16 v[68:71], v[228:231], v[192:195], v[68:71]
    v_exp_f32 v247, v247
    v_add_f32 v246, 1.0, v246
    s_waitcnt lgkmcnt(0)
    v_mfma_f32_16x16x32_bf16 v[0:3], v[152:155], v[144:147], v[0:3]
    ds_read_b128 v[188:191], v239 offset:34816
    v_add_f32 v247, 1.0, v247
    v_mfma_f32_16x16x32_bf16 v[4:7], v[152:155], v[148:151], v[4:7]
    ds_read_b128 v[192:195], v239 offset:36864
    v_rcp_f32 v246, v246
    v_mfma_f32_16x16x32_bf16 v[8:11], v[156:159], v[144:147], v[8:11]
    ds_read_b128 v[196:199], v235 offset:35840
    v_rcp_f32 v247, v247
    v_mfma_f32_16x16x32_bf16 v[12:15], v[156:159], v[148:151], v[12:15]
    ds_read_b128 v[200:203], v235 offset:37888
    v_mul_f32 v80, v80, v246
    v_mul_f32 v81, v81, v247
    v_mfma_f32_16x16x32_bf16 v[16:19], v[160:163], v[144:147], v[16:19]
    ds_read_b128 v[204:207], v235 offset:39936
    v_cvt_pk_bf16_f32 v80, v80, v81
    v_mfma_f32_16x16x32_bf16 v[20:23], v[160:163], v[148:151], v[20:23]
    ds_read_b128 v[208:211], v235 offset:41984
    v_mul_f32 v248, v82, v82
    v_mfma_f32_16x16x32_bf16 v[24:27], v[164:167], v[144:147], v[24:27]
    ds_read_b128 v[212:215], v235 offset:44032
    v_mul_f32 v249, v83, v83
    v_mfma_f32_16x16x32_bf16 v[28:31], v[164:167], v[148:151], v[28:31]
    ds_read_b128 v[216:219], v235 offset:46080
    v_fmaak_f32 v248, v252, v248, 0xc0135761
    v_fmaak_f32 v249, v252, v249, 0xc0135761
    v_mfma_f32_16x16x32_bf16 v[32:35], v[168:171], v[144:147], v[32:35]
    ds_read_b128 v[220:223], v235 offset:48128
    v_mul_f32 v248, v248, v82
    v_mfma_f32_16x16x32_bf16 v[36:39], v[168:171], v[148:151], v[36:39]
    ds_read_b128 v[224:227], v235 offset:50176
    v_mul_f32 v249, v249, v83
    v_mfma_f32_16x16x32_bf16 v[40:43], v[172:175], v[144:147], v[40:43]
    ds_read_b128 v[228:231], v235 offset:52224
    v_exp_f32 v248, v248
    v_exp_f32 v249, v249
    v_mfma_f32_16x16x32_bf16 v[44:47], v[172:175], v[148:151], v[44:47]
    v_add_f32 v248, 1.0, v248
    v_mfma_f32_16x16x32_bf16 v[48:51], v[176:179], v[144:147], v[48:51]
    v_add_f32 v249, 1.0, v249
    v_mfma_f32_16x16x32_bf16 v[52:55], v[176:179], v[148:151], v[52:55]
    v_rcp_f32 v248, v248
    v_mfma_f32_16x16x32_bf16 v[56:59], v[180:183], v[144:147], v[56:59]
    v_rcp_f32 v249, v249
    v_mul_f32 v82, v82, v248
    v_mfma_f32_16x16x32_bf16 v[60:63], v[180:183], v[148:151], v[60:63]
    v_mul_f32 v83, v83, v249
    v_mfma_f32_16x16x32_bf16 v[64:67], v[184:187], v[144:147], v[64:67]
    v_cvt_pk_bf16_f32 v82, v82, v83
    v_mfma_f32_16x16x32_bf16 v[68:71], v[184:187], v[148:151], v[68:71]
    v_mul_f32 v240, v84, v84
    v_mul_f32 v241, v85, v85
    s_waitcnt lgkmcnt(0)
    s_barrier
    v_mfma_f32_16x16x32_bf16 v[0:3], v[196:199], v[188:191], v[0:3]
    ds_read_b128 v[144:147], v233 offset:0
    v_fmaak_f32 v240, v252, v240, 0xc0135761
    v_mfma_f32_16x16x32_bf16 v[4:7], v[196:199], v[192:195], v[4:7]
    ds_read_b128 v[148:151], v233 offset:2048
    v_fmaak_f32 v241, v252, v241, 0xc0135761
    v_mfma_f32_16x16x32_bf16 v[8:11], v[200:203], v[188:191], v[8:11]
    ds_read_b128 v[152:155], v232 offset:0
    v_mul_f32 v240, v240, v84
    v_mfma_f32_16x16x32_bf16 v[12:15], v[200:203], v[192:195], v[12:15]
    ds_read_b128 v[156:159], v232 offset:2048
    v_mul_f32 v241, v241, v85
    v_exp_f32 v240, v240
    v_mfma_f32_16x16x32_bf16 v[16:19], v[204:207], v[188:191], v[16:19]
    ds_read_b128 v[160:163], v232 offset:4096
    v_exp_f32 v241, v241
    v_mfma_f32_16x16x32_bf16 v[20:23], v[204:207], v[192:195], v[20:23]
    ds_read_b128 v[164:167], v232 offset:6144
    v_add_f32 v240, 1.0, v240
    v_mfma_f32_16x16x32_bf16 v[24:27], v[208:211], v[188:191], v[24:27]
    ds_read_b128 v[168:171], v232 offset:8192
    v_add_f32 v241, 1.0, v241
    v_mfma_f32_16x16x32_bf16 v[28:31], v[208:211], v[192:195], v[28:31]
    ds_read_b128 v[172:175], v232 offset:10240
    v_rcp_f32 v240, v240
    v_rcp_f32 v241, v241
    v_mfma_f32_16x16x32_bf16 v[32:35], v[212:215], v[188:191], v[32:35]
    ds_read_b128 v[176:179], v232 offset:12288
    v_mul_f32 v84, v84, v240
    v_mfma_f32_16x16x32_bf16 v[36:39], v[212:215], v[192:195], v[36:39]
    ds_read_b128 v[180:183], v232 offset:14336
    v_mul_f32 v85, v85, v241
    v_mfma_f32_16x16x32_bf16 v[40:43], v[216:219], v[188:191], v[40:43]
    ds_read_b128 v[184:187], v232 offset:16384
    v_cvt_pk_bf16_f32 v84, v84, v85
    v_mul_f32 v246, v86, v86
    v_mfma_f32_16x16x32_bf16 v[44:47], v[216:219], v[192:195], v[44:47]
    v_mul_f32 v247, v87, v87
    v_mfma_f32_16x16x32_bf16 v[48:51], v[220:223], v[188:191], v[48:51]
    v_fmaak_f32 v246, v252, v246, 0xc0135761
    v_mfma_f32_16x16x32_bf16 v[52:55], v[220:223], v[192:195], v[52:55]
    v_fmaak_f32 v247, v252, v247, 0xc0135761
    v_mfma_f32_16x16x32_bf16 v[56:59], v[224:227], v[188:191], v[56:59]
    v_mul_f32 v246, v246, v86
    v_mul_f32 v247, v247, v87
    v_mfma_f32_16x16x32_bf16 v[60:63], v[224:227], v[192:195], v[60:63]
    v_exp_f32 v246, v246
    v_mfma_f32_16x16x32_bf16 v[64:67], v[228:231], v[188:191], v[64:67]
    v_exp_f32 v247, v247
    v_mfma_f32_16x16x32_bf16 v[68:71], v[228:231], v[192:195], v[68:71]
    v_add_f32 v246, 1.0, v246
    v_add_f32 v247, 1.0, v247
    s_waitcnt lgkmcnt(0)
    v_mfma_f32_16x16x32_bf16 v[0:3], v[152:155], v[144:147], v[0:3]
    ds_read_b128 v[188:191], v234 offset:0
    v_rcp_f32 v246, v246
    v_mfma_f32_16x16x32_bf16 v[4:7], v[152:155], v[148:151], v[4:7]
    ds_read_b128 v[192:195], v234 offset:2048
    v_rcp_f32 v247, v247
    v_mfma_f32_16x16x32_bf16 v[8:11], v[156:159], v[144:147], v[8:11]
    ds_read_b128 v[196:199], v232 offset:1024
    v_mul_f32 v86, v86, v246
    v_mfma_f32_16x16x32_bf16 v[12:15], v[156:159], v[148:151], v[12:15]
    ds_read_b128 v[200:203], v232 offset:3072
    v_mul_f32 v87, v87, v247
    v_cvt_pk_bf16_f32 v86, v86, v87
    v_mfma_f32_16x16x32_bf16 v[16:19], v[160:163], v[144:147], v[16:19]
    ds_read_b128 v[204:207], v232 offset:5120
    v_mul_f32 v248, v88, v88
    v_mfma_f32_16x16x32_bf16 v[20:23], v[160:163], v[148:151], v[20:23]
    ds_read_b128 v[208:211], v232 offset:7168
    v_mul_f32 v249, v89, v89
    v_mfma_f32_16x16x32_bf16 v[24:27], v[164:167], v[144:147], v[24:27]
    ds_read_b128 v[212:215], v232 offset:9216
    v_fmaak_f32 v248, v252, v248, 0xc0135761
    v_mfma_f32_16x16x32_bf16 v[28:31], v[164:167], v[148:151], v[28:31]
    ds_read_b128 v[216:219], v232 offset:11264
    v_fmaak_f32 v249, v252, v249, 0xc0135761
    v_mul_f32 v248, v248, v88
    v_mfma_f32_16x16x32_bf16 v[32:35], v[168:171], v[144:147], v[32:35]
    ds_read_b128 v[220:223], v232 offset:13312
    v_mul_f32 v249, v249, v89
    v_mfma_f32_16x16x32_bf16 v[36:39], v[168:171], v[148:151], v[36:39]
    ds_read_b128 v[224:227], v232 offset:15360
    v_exp_f32 v248, v248
    v_mfma_f32_16x16x32_bf16 v[40:43], v[172:175], v[144:147], v[40:43]
    ds_read_b128 v[228:231], v232 offset:17408
    v_exp_f32 v249, v249
    v_add_f32 v248, 1.0, v248
    v_mfma_f32_16x16x32_bf16 v[44:47], v[172:175], v[148:151], v[44:47]
    v_add_f32 v249, 1.0, v249
    v_mfma_f32_16x16x32_bf16 v[48:51], v[176:179], v[144:147], v[48:51]
    v_rcp_f32 v248, v248
    v_mfma_f32_16x16x32_bf16 v[52:55], v[176:179], v[148:151], v[52:55]
    v_rcp_f32 v249, v249
    v_mfma_f32_16x16x32_bf16 v[56:59], v[180:183], v[144:147], v[56:59]
    v_mul_f32 v88, v88, v248
    v_mul_f32 v89, v89, v249
    v_mfma_f32_16x16x32_bf16 v[60:63], v[180:183], v[148:151], v[60:63]
    v_cvt_pk_bf16_f32 v88, v88, v89
    v_mfma_f32_16x16x32_bf16 v[64:67], v[184:187], v[144:147], v[64:67]
    v_mul_f32 v240, v90, v90
    v_mfma_f32_16x16x32_bf16 v[68:71], v[184:187], v[148:151], v[68:71]
    v_mul_f32 v241, v91, v91
    v_fmaak_f32 v240, v252, v240, 0xc0135761
    s_waitcnt lgkmcnt(0)
    s_barrier
    v_mfma_f32_16x16x32_bf16 v[0:3], v[196:199], v[188:191], v[0:3]
    ds_read_b128 v[144:147], v233 offset:34816
    v_fmaak_f32 v241, v252, v241, 0xc0135761
    v_mfma_f32_16x16x32_bf16 v[4:7], v[196:199], v[192:195], v[4:7]
    ds_read_b128 v[148:151], v233 offset:36864
    v_mul_f32 v240, v240, v90
    v_mfma_f32_16x16x32_bf16 v[8:11], v[200:203], v[188:191], v[8:11]
    ds_read_b128 v[152:155], v232 offset:34816
    v_mul_f32 v241, v241, v91
    v_mfma_f32_16x16x32_bf16 v[12:15], v[200:203], v[192:195], v[12:15]
    ds_read_b128 v[156:159], v232 offset:36864
    v_exp_f32 v240, v240
    v_exp_f32 v241, v241
    v_mfma_f32_16x16x32_bf16 v[16:19], v[204:207], v[188:191], v[16:19]
    ds_read_b128 v[160:163], v232 offset:38912
    v_add_f32 v240, 1.0, v240
    v_mfma_f32_16x16x32_bf16 v[20:23], v[204:207], v[192:195], v[20:23]
    ds_read_b128 v[164:167], v232 offset:40960
    v_add_f32 v241, 1.0, v241
    v_mfma_f32_16x16x32_bf16 v[24:27], v[208:211], v[188:191], v[24:27]
    ds_read_b128 v[168:171], v232 offset:43008
    v_rcp_f32 v240, v240
    v_mfma_f32_16x16x32_bf16 v[28:31], v[208:211], v[192:195], v[28:31]
    ds_read_b128 v[172:175], v232 offset:45056
    v_rcp_f32 v241, v241
    v_mul_f32 v90, v90, v240
    v_mfma_f32_16x16x32_bf16 v[32:35], v[212:215], v[188:191], v[32:35]
    ds_read_b128 v[176:179], v232 offset:47104
    v_mul_f32 v91, v91, v241
    v_mfma_f32_16x16x32_bf16 v[36:39], v[212:215], v[192:195], v[36:39]
    ds_read_b128 v[180:183], v232 offset:49152
    v_cvt_pk_bf16_f32 v90, v90, v91
    v_mfma_f32_16x16x32_bf16 v[40:43], v[216:219], v[188:191], v[40:43]
    ds_read_b128 v[184:187], v232 offset:51200
    v_mul_f32 v246, v92, v92
    v_mul_f32 v247, v93, v93
    v_mfma_f32_16x16x32_bf16 v[44:47], v[216:219], v[192:195], v[44:47]
    v_fmaak_f32 v246, v252, v246, 0xc0135761
    v_mfma_f32_16x16x32_bf16 v[48:51], v[220:223], v[188:191], v[48:51]
    v_fmaak_f32 v247, v252, v247, 0xc0135761
    v_mfma_f32_16x16x32_bf16 v[52:55], v[220:223], v[192:195], v[52:55]
    v_mul_f32 v246, v246, v92
    v_mfma_f32_16x16x32_bf16 v[56:59], v[224:227], v[188:191], v[56:59]
    v_mul_f32 v247, v247, v93
    v_exp_f32 v246, v246
    v_mfma_f32_16x16x32_bf16 v[60:63], v[224:227], v[192:195], v[60:63]
    v_exp_f32 v247, v247
    v_mfma_f32_16x16x32_bf16 v[64:67], v[228:231], v[188:191], v[64:67]
    v_add_f32 v246, 1.0, v246
    v_mfma_f32_16x16x32_bf16 v[68:71], v[228:231], v[192:195], v[68:71]
    v_add_f32 v247, 1.0, v247
    v_rcp_f32 v246, v246
    s_waitcnt lgkmcnt(0)
    v_mfma_f32_16x16x32_bf16 v[0:3], v[152:155], v[144:147], v[0:3]
    ds_read_b128 v[188:191], v234 offset:34816
    v_rcp_f32 v247, v247
    v_mfma_f32_16x16x32_bf16 v[4:7], v[152:155], v[148:151], v[4:7]
    ds_read_b128 v[192:195], v234 offset:36864
    v_mul_f32 v92, v92, v246
    v_mfma_f32_16x16x32_bf16 v[8:11], v[156:159], v[144:147], v[8:11]
    ds_read_b128 v[196:199], v232 offset:35840
    v_mul_f32 v93, v93, v247
    v_mfma_f32_16x16x32_bf16 v[12:15], v[156:159], v[148:151], v[12:15]
    ds_read_b128 v[200:203], v232 offset:37888
    v_cvt_pk_bf16_f32 v92, v92, v93
    v_mul_f32 v248, v94, v94
    v_mfma_f32_16x16x32_bf16 v[16:19], v[160:163], v[144:147], v[16:19]
    ds_read_b128 v[204:207], v232 offset:39936
    v_mul_f32 v249, v95, v95
    v_mfma_f32_16x16x32_bf16 v[20:23], v[160:163], v[148:151], v[20:23]
    ds_read_b128 v[208:211], v232 offset:41984
    v_fmaak_f32 v248, v252, v248, 0xc0135761
    v_mfma_f32_16x16x32_bf16 v[24:27], v[164:167], v[144:147], v[24:27]
    ds_read_b128 v[212:215], v232 offset:44032
    v_fmaak_f32 v249, v252, v249, 0xc0135761
    v_mfma_f32_16x16x32_bf16 v[28:31], v[164:167], v[148:151], v[28:31]
    ds_read_b128 v[216:219], v232 offset:46080
    v_mul_f32 v248, v248, v94
    v_mul_f32 v249, v249, v95
    v_mfma_f32_16x16x32_bf16 v[32:35], v[168:171], v[144:147], v[32:35]
    ds_read_b128 v[220:223], v232 offset:48128
    v_exp_f32 v248, v248
    v_mfma_f32_16x16x32_bf16 v[36:39], v[168:171], v[148:151], v[36:39]
    ds_read_b128 v[224:227], v232 offset:50176
    v_exp_f32 v249, v249
    v_mfma_f32_16x16x32_bf16 v[40:43], v[172:175], v[144:147], v[40:43]
    ds_read_b128 v[228:231], v232 offset:52224
    v_add_f32 v248, 1.0, v248
    v_add_f32 v249, 1.0, v249
    v_mfma_f32_16x16x32_bf16 v[44:47], v[172:175], v[148:151], v[44:47]
    v_rcp_f32 v248, v248
    v_mfma_f32_16x16x32_bf16 v[48:51], v[176:179], v[144:147], v[48:51]
    v_rcp_f32 v249, v249
    v_mfma_f32_16x16x32_bf16 v[52:55], v[176:179], v[148:151], v[52:55]
    v_mul_f32 v94, v94, v248
    v_mfma_f32_16x16x32_bf16 v[56:59], v[180:183], v[144:147], v[56:59]
    v_mul_f32 v95, v95, v249
    v_cvt_pk_bf16_f32 v94, v94, v95
    v_mfma_f32_16x16x32_bf16 v[60:63], v[180:183], v[148:151], v[60:63]
    v_mul_f32 v240, v96, v96
    v_mfma_f32_16x16x32_bf16 v[64:67], v[184:187], v[144:147], v[64:67]
    v_mul_f32 v241, v97, v97
    v_mfma_f32_16x16x32_bf16 v[68:71], v[184:187], v[148:151], v[68:71]
    v_fmaak_f32 v240, v252, v240, 0xc0135761
    v_fmaak_f32 v241, v252, v241, 0xc0135761
    s_waitcnt lgkmcnt(0)
    s_barrier
    v_mfma_f32_16x16x32_bf16 v[0:3], v[196:199], v[188:191], v[0:3]
    ds_read_b128 v[144:147], v236 offset:0
    v_mul_f32 v240, v240, v96
    v_mfma_f32_16x16x32_bf16 v[4:7], v[196:199], v[192:195], v[4:7]
    ds_read_b128 v[148:151], v236 offset:2048
    v_mul_f32 v241, v241, v97
    v_mfma_f32_16x16x32_bf16 v[8:11], v[200:203], v[188:191], v[8:11]
    ds_read_b128 v[152:155], v235 offset:0
    v_exp_f32 v240, v240
    v_mfma_f32_16x16x32_bf16 v[12:15], v[200:203], v[192:195], v[12:15]
    ds_read_b128 v[156:159], v235 offset:2048
    v_exp_f32 v241, v241
    v_add_f32 v240, 1.0, v240
    v_mfma_f32_16x16x32_bf16 v[16:19], v[204:207], v[188:191], v[16:19]
    ds_read_b128 v[160:163], v235 offset:4096
    v_add_f32 v241, 1.0, v241
    v_mfma_f32_16x16x32_bf16 v[20:23], v[204:207], v[192:195], v[20:23]
    ds_read_b128 v[164:167], v235 offset:6144
    v_rcp_f32 v240, v240
    v_mfma_f32_16x16x32_bf16 v[24:27], v[208:211], v[188:191], v[24:27]
    ds_read_b128 v[168:171], v235 offset:8192
    v_rcp_f32 v241, v241
    v_mfma_f32_16x16x32_bf16 v[28:31], v[208:211], v[192:195], v[28:31]
    ds_read_b128 v[172:175], v235 offset:10240
    v_mul_f32 v96, v96, v240
    v_mul_f32 v97, v97, v241
    v_mfma_f32_16x16x32_bf16 v[32:35], v[212:215], v[188:191], v[32:35]
    ds_read_b128 v[176:179], v235 offset:12288
    v_cvt_pk_bf16_f32 v96, v96, v97
    v_mfma_f32_16x16x32_bf16 v[36:39], v[212:215], v[192:195], v[36:39]
    ds_read_b128 v[180:183], v235 offset:14336
    v_mul_f32 v246, v98, v98
    v_mfma_f32_16x16x32_bf16 v[40:43], v[216:219], v[188:191], v[40:43]
    ds_read_b128 v[184:187], v235 offset:16384
    v_mul_f32 v247, v99, v99
    v_fmaak_f32 v246, v252, v246, 0xc0135761
    v_mfma_f32_16x16x32_bf16 v[44:47], v[216:219], v[192:195], v[44:47]
    v_fmaak_f32 v247, v252, v247, 0xc0135761
    v_mfma_f32_16x16x32_bf16 v[48:51], v[220:223], v[188:191], v[48:51]
    v_mul_f32 v246, v246, v98
    v_mfma_f32_16x16x32_bf16 v[52:55], v[220:223], v[192:195], v[52:55]
    v_mul_f32 v247, v247, v99
    v_mfma_f32_16x16x32_bf16 v[56:59], v[224:227], v[188:191], v[56:59]
    v_exp_f32 v246, v246
    v_exp_f32 v247, v247
    v_mfma_f32_16x16x32_bf16 v[60:63], v[224:227], v[192:195], v[60:63]
    v_add_f32 v246, 1.0, v246
    v_mfma_f32_16x16x32_bf16 v[64:67], v[228:231], v[188:191], v[64:67]
    v_add_f32 v247, 1.0, v247
    v_mfma_f32_16x16x32_bf16 v[68:71], v[228:231], v[192:195], v[68:71]
    v_rcp_f32 v246, v246
    v_rcp_f32 v247, v247
    s_waitcnt lgkmcnt(0)
    v_mfma_f32_16x16x32_bf16 v[0:3], v[152:155], v[144:147], v[0:3]
    ds_read_b128 v[188:191], v239 offset:0
    v_mul_f32 v98, v98, v246
    v_mfma_f32_16x16x32_bf16 v[4:7], v[152:155], v[148:151], v[4:7]
    ds_read_b128 v[192:195], v239 offset:2048
    v_mul_f32 v99, v99, v247
    v_mfma_f32_16x16x32_bf16 v[8:11], v[156:159], v[144:147], v[8:11]
    ds_read_b128 v[196:199], v235 offset:1024
    v_cvt_pk_bf16_f32 v98, v98, v99
    v_mfma_f32_16x16x32_bf16 v[12:15], v[156:159], v[148:151], v[12:15]
    ds_read_b128 v[200:203], v235 offset:3072
    v_mul_f32 v248, v100, v100
    v_mul_f32 v249, v101, v101
    v_mfma_f32_16x16x32_bf16 v[16:19], v[160:163], v[144:147], v[16:19]
    ds_read_b128 v[204:207], v235 offset:5120
    v_fmaak_f32 v248, v252, v248, 0xc0135761
    v_mfma_f32_16x16x32_bf16 v[20:23], v[160:163], v[148:151], v[20:23]
    ds_read_b128 v[208:211], v235 offset:7168
    v_fmaak_f32 v249, v252, v249, 0xc0135761
    v_mfma_f32_16x16x32_bf16 v[24:27], v[164:167], v[144:147], v[24:27]
    ds_read_b128 v[212:215], v235 offset:9216
    v_mul_f32 v248, v248, v100
    v_mfma_f32_16x16x32_bf16 v[28:31], v[164:167], v[148:151], v[28:31]
    ds_read_b128 v[216:219], v235 offset:11264
    v_mul_f32 v249, v249, v101
    v_exp_f32 v248, v248
    v_mfma_f32_16x16x32_bf16 v[32:35], v[168:171], v[144:147], v[32:35]
    ds_read_b128 v[220:223], v235 offset:13312
    v_exp_f32 v249, v249
    v_mfma_f32_16x16x32_bf16 v[36:39], v[168:171], v[148:151], v[36:39]
    ds_read_b128 v[224:227], v235 offset:15360
    v_add_f32 v248, 1.0, v248
    v_mfma_f32_16x16x32_bf16 v[40:43], v[172:175], v[144:147], v[40:43]
    ds_read_b128 v[228:231], v235 offset:17408
    v_add_f32 v249, 1.0, v249
    v_rcp_f32 v248, v248
    v_mfma_f32_16x16x32_bf16 v[44:47], v[172:175], v[148:151], v[44:47]
    v_rcp_f32 v249, v249
    v_mfma_f32_16x16x32_bf16 v[48:51], v[176:179], v[144:147], v[48:51]
    v_mul_f32 v100, v100, v248
    v_mfma_f32_16x16x32_bf16 v[52:55], v[176:179], v[148:151], v[52:55]
    v_mul_f32 v101, v101, v249
    v_mfma_f32_16x16x32_bf16 v[56:59], v[180:183], v[144:147], v[56:59]
    v_cvt_pk_bf16_f32 v100, v100, v101
    v_mul_f32 v240, v102, v102
    v_mfma_f32_16x16x32_bf16 v[60:63], v[180:183], v[148:151], v[60:63]
    v_mul_f32 v241, v103, v103
    v_mfma_f32_16x16x32_bf16 v[64:67], v[184:187], v[144:147], v[64:67]
    v_fmaak_f32 v240, v252, v240, 0xc0135761
    v_mfma_f32_16x16x32_bf16 v[68:71], v[184:187], v[148:151], v[68:71]
    v_fmaak_f32 v241, v252, v241, 0xc0135761
    v_mul_f32 v240, v240, v102
    s_waitcnt lgkmcnt(0)
    s_barrier
    v_mfma_f32_16x16x32_bf16 v[0:3], v[196:199], v[188:191], v[0:3]
    ds_read_b128 v[144:147], v236 offset:34816
    v_mul_f32 v241, v241, v103
    v_mfma_f32_16x16x32_bf16 v[4:7], v[196:199], v[192:195], v[4:7]
    ds_read_b128 v[148:151], v236 offset:36864
    v_exp_f32 v240, v240
    v_mfma_f32_16x16x32_bf16 v[8:11], v[200:203], v[188:191], v[8:11]
    ds_read_b128 v[152:155], v235 offset:34816
    v_exp_f32 v241, v241
    v_mfma_f32_16x16x32_bf16 v[12:15], v[200:203], v[192:195], v[12:15]
    ds_read_b128 v[156:159], v235 offset:36864
    v_add_f32 v240, 1.0, v240
    v_add_f32 v241, 1.0, v241
    v_mfma_f32_16x16x32_bf16 v[16:19], v[204:207], v[188:191], v[16:19]
    ds_read_b128 v[160:163], v235 offset:38912
    v_rcp_f32 v240, v240
    v_mfma_f32_16x16x32_bf16 v[20:23], v[204:207], v[192:195], v[20:23]
    ds_read_b128 v[164:167], v235 offset:40960
    v_rcp_f32 v241, v241
    v_mfma_f32_16x16x32_bf16 v[24:27], v[208:211], v[188:191], v[24:27]
    ds_read_b128 v[168:171], v235 offset:43008
    v_mul_f32 v102, v102, v240
    v_mfma_f32_16x16x32_bf16 v[28:31], v[208:211], v[192:195], v[28:31]
    ds_read_b128 v[172:175], v235 offset:45056
    v_mul_f32 v103, v103, v241
    v_cvt_pk_bf16_f32 v102, v102, v103
    v_mfma_f32_16x16x32_bf16 v[32:35], v[212:215], v[188:191], v[32:35]
    ds_read_b128 v[176:179], v235 offset:47104
    v_mul_f32 v246, v104, v104
    v_mfma_f32_16x16x32_bf16 v[36:39], v[212:215], v[192:195], v[36:39]
    ds_read_b128 v[180:183], v235 offset:49152
    v_mul_f32 v247, v105, v105
    v_mfma_f32_16x16x32_bf16 v[40:43], v[216:219], v[188:191], v[40:43]
    ds_read_b128 v[184:187], v235 offset:51200
    v_fmaak_f32 v246, v252, v246, 0xc0135761
    v_fmaak_f32 v247, v252, v247, 0xc0135761
    v_mfma_f32_16x16x32_bf16 v[44:47], v[216:219], v[192:195], v[44:47]
    v_mul_f32 v246, v246, v104
    v_mfma_f32_16x16x32_bf16 v[48:51], v[220:223], v[188:191], v[48:51]
    v_mul_f32 v247, v247, v105
    v_mfma_f32_16x16x32_bf16 v[52:55], v[220:223], v[192:195], v[52:55]
    v_exp_f32 v246, v246
    v_mfma_f32_16x16x32_bf16 v[56:59], v[224:227], v[188:191], v[56:59]
    v_exp_f32 v247, v247
    v_add_f32 v246, 1.0, v246
    v_mfma_f32_16x16x32_bf16 v[60:63], v[224:227], v[192:195], v[60:63]
    v_add_f32 v247, 1.0, v247
    v_mfma_f32_16x16x32_bf16 v[64:67], v[228:231], v[188:191], v[64:67]
    v_rcp_f32 v246, v246
    v_mfma_f32_16x16x32_bf16 v[68:71], v[228:231], v[192:195], v[68:71]
    v_rcp_f32 v247, v247
    v_mul_f32 v104, v104, v246
    s_waitcnt lgkmcnt(0)
    v_mfma_f32_16x16x32_bf16 v[0:3], v[152:155], v[144:147], v[0:3]
    ds_read_b128 v[188:191], v239 offset:34816
    v_mul_f32 v105, v105, v247
    v_mfma_f32_16x16x32_bf16 v[4:7], v[152:155], v[148:151], v[4:7]
    ds_read_b128 v[192:195], v239 offset:36864
    v_cvt_pk_bf16_f32 v104, v104, v105
    v_mfma_f32_16x16x32_bf16 v[8:11], v[156:159], v[144:147], v[8:11]
    ds_read_b128 v[196:199], v235 offset:35840
    v_mul_f32 v248, v106, v106
    v_mfma_f32_16x16x32_bf16 v[12:15], v[156:159], v[148:151], v[12:15]
    ds_read_b128 v[200:203], v235 offset:37888
    v_mul_f32 v249, v107, v107
    v_fmaak_f32 v248, v252, v248, 0xc0135761
    v_mfma_f32_16x16x32_bf16 v[16:19], v[160:163], v[144:147], v[16:19]
    ds_read_b128 v[204:207], v235 offset:39936
    v_fmaak_f32 v249, v252, v249, 0xc0135761
    v_mfma_f32_16x16x32_bf16 v[20:23], v[160:163], v[148:151], v[20:23]
    ds_read_b128 v[208:211], v235 offset:41984
    v_mul_f32 v248, v248, v106
    v_mfma_f32_16x16x32_bf16 v[24:27], v[164:167], v[144:147], v[24:27]
    ds_read_b128 v[212:215], v235 offset:44032
    v_mul_f32 v249, v249, v107
    v_mfma_f32_16x16x32_bf16 v[28:31], v[164:167], v[148:151], v[28:31]
    ds_read_b128 v[216:219], v235 offset:46080
    v_exp_f32 v248, v248
    v_exp_f32 v249, v249
    v_mfma_f32_16x16x32_bf16 v[32:35], v[168:171], v[144:147], v[32:35]
    ds_read_b128 v[220:223], v235 offset:48128
    v_add_f32 v248, 1.0, v248
    v_mfma_f32_16x16x32_bf16 v[36:39], v[168:171], v[148:151], v[36:39]
    ds_read_b128 v[224:227], v235 offset:50176
    v_add_f32 v249, 1.0, v249
    v_mfma_f32_16x16x32_bf16 v[40:43], v[172:175], v[144:147], v[40:43]
    ds_read_b128 v[228:231], v235 offset:52224
    v_rcp_f32 v248, v248
    v_rcp_f32 v249, v249
    v_mfma_f32_16x16x32_bf16 v[44:47], v[172:175], v[148:151], v[44:47]
    v_mul_f32 v106, v106, v248
    v_mfma_f32_16x16x32_bf16 v[48:51], v[176:179], v[144:147], v[48:51]
    v_mul_f32 v107, v107, v249
    v_mfma_f32_16x16x32_bf16 v[52:55], v[176:179], v[148:151], v[52:55]
    v_cvt_pk_bf16_f32 v106, v106, v107
    v_mfma_f32_16x16x32_bf16 v[56:59], v[180:183], v[144:147], v[56:59]
    v_mul_f32 v240, v108, v108
    v_mul_f32 v241, v109, v109
    v_mfma_f32_16x16x32_bf16 v[60:63], v[180:183], v[148:151], v[60:63]
    v_fmaak_f32 v240, v252, v240, 0xc0135761
    v_mfma_f32_16x16x32_bf16 v[64:67], v[184:187], v[144:147], v[64:67]
    v_fmaak_f32 v241, v252, v241, 0xc0135761
    v_mfma_f32_16x16x32_bf16 v[68:71], v[184:187], v[148:151], v[68:71]
    v_mul_f32 v240, v240, v108
    v_mul_f32 v241, v241, v109
    s_waitcnt lgkmcnt(0)
    s_barrier
    v_mfma_f32_16x16x32_bf16 v[0:3], v[196:199], v[188:191], v[0:3]
    ds_read_b128 v[144:147], v233 offset:0
    v_exp_f32 v240, v240
    v_mfma_f32_16x16x32_bf16 v[4:7], v[196:199], v[192:195], v[4:7]
    ds_read_b128 v[148:151], v233 offset:2048
    v_exp_f32 v241, v241
    v_mfma_f32_16x16x32_bf16 v[8:11], v[200:203], v[188:191], v[8:11]
    ds_read_b128 v[152:155], v232 offset:0
    v_add_f32 v240, 1.0, v240
    v_mfma_f32_16x16x32_bf16 v[12:15], v[200:203], v[192:195], v[12:15]
    ds_read_b128 v[156:159], v232 offset:2048
    v_add_f32 v241, 1.0, v241
    v_rcp_f32 v240, v240
    v_mfma_f32_16x16x32_bf16 v[16:19], v[204:207], v[188:191], v[16:19]
    ds_read_b128 v[160:163], v232 offset:4096
    v_rcp_f32 v241, v241
    v_mfma_f32_16x16x32_bf16 v[20:23], v[204:207], v[192:195], v[20:23]
    ds_read_b128 v[164:167], v232 offset:6144
    v_mul_f32 v108, v108, v240
    v_mfma_f32_16x16x32_bf16 v[24:27], v[208:211], v[188:191], v[24:27]
    ds_read_b128 v[168:171], v232 offset:8192
    v_mul_f32 v109, v109, v241
    v_mfma_f32_16x16x32_bf16 v[28:31], v[208:211], v[192:195], v[28:31]
    ds_read_b128 v[172:175], v232 offset:10240
    v_cvt_pk_bf16_f32 v108, v108, v109
    v_mul_f32 v246, v110, v110
    v_mfma_f32_16x16x32_bf16 v[32:35], v[212:215], v[188:191], v[32:35]
    ds_read_b128 v[176:179], v232 offset:12288
    v_mul_f32 v247, v111, v111
    v_mfma_f32_16x16x32_bf16 v[36:39], v[212:215], v[192:195], v[36:39]
    ds_read_b128 v[180:183], v232 offset:14336
    v_fmaak_f32 v246, v252, v246, 0xc0135761
    v_mfma_f32_16x16x32_bf16 v[40:43], v[216:219], v[188:191], v[40:43]
    ds_read_b128 v[184:187], v232 offset:16384
    v_fmaak_f32 v247, v252, v247, 0xc0135761
    v_mul_f32 v246, v246, v110
    v_mfma_f32_16x16x32_bf16 v[44:47], v[216:219], v[192:195], v[44:47]
    v_mul_f32 v247, v247, v111
    v_mfma_f32_16x16x32_bf16 v[48:51], v[220:223], v[188:191], v[48:51]
    v_exp_f32 v246, v246
    v_mfma_f32_16x16x32_bf16 v[52:55], v[220:223], v[192:195], v[52:55]
    v_exp_f32 v247, v247
    v_mfma_f32_16x16x32_bf16 v[56:59], v[224:227], v[188:191], v[56:59]
    v_add_f32 v246, 1.0, v246
    v_add_f32 v247, 1.0, v247
    v_mfma_f32_16x16x32_bf16 v[60:63], v[224:227], v[192:195], v[60:63]
    v_rcp_f32 v246, v246
    v_mfma_f32_16x16x32_bf16 v[64:67], v[228:231], v[188:191], v[64:67]
    v_rcp_f32 v247, v247
    v_mfma_f32_16x16x32_bf16 v[68:71], v[228:231], v[192:195], v[68:71]
    v_mul_f32 v110, v110, v246
    v_mul_f32 v111, v111, v247
    s_waitcnt lgkmcnt(0)
    v_mfma_f32_16x16x32_bf16 v[0:3], v[152:155], v[144:147], v[0:3]
    ds_read_b128 v[188:191], v234 offset:0
    v_cvt_pk_bf16_f32 v110, v110, v111
    v_mfma_f32_16x16x32_bf16 v[4:7], v[152:155], v[148:151], v[4:7]
    ds_read_b128 v[192:195], v234 offset:2048
    v_mul_f32 v248, v112, v112
    v_mfma_f32_16x16x32_bf16 v[8:11], v[156:159], v[144:147], v[8:11]
    ds_read_b128 v[196:199], v232 offset:1024
    v_mul_f32 v249, v113, v113
    v_mfma_f32_16x16x32_bf16 v[12:15], v[156:159], v[148:151], v[12:15]
    ds_read_b128 v[200:203], v232 offset:3072
    v_fmaak_f32 v248, v252, v248, 0xc0135761
    v_fmaak_f32 v249, v252, v249, 0xc0135761
    v_mfma_f32_16x16x32_bf16 v[16:19], v[160:163], v[144:147], v[16:19]
    ds_read_b128 v[204:207], v232 offset:5120
    v_mul_f32 v248, v248, v112
    v_mfma_f32_16x16x32_bf16 v[20:23], v[160:163], v[148:151], v[20:23]
    ds_read_b128 v[208:211], v232 offset:7168
    v_mul_f32 v249, v249, v113
    v_mfma_f32_16x16x32_bf16 v[24:27], v[164:167], v[144:147], v[24:27]
    ds_read_b128 v[212:215], v232 offset:9216
    v_exp_f32 v248, v248
    v_mfma_f32_16x16x32_bf16 v[28:31], v[164:167], v[148:151], v[28:31]
    ds_read_b128 v[216:219], v232 offset:11264
    v_exp_f32 v249, v249
    v_add_f32 v248, 1.0, v248
    v_mfma_f32_16x16x32_bf16 v[32:35], v[168:171], v[144:147], v[32:35]
    ds_read_b128 v[220:223], v232 offset:13312
    v_add_f32 v249, 1.0, v249
    v_mfma_f32_16x16x32_bf16 v[36:39], v[168:171], v[148:151], v[36:39]
    ds_read_b128 v[224:227], v232 offset:15360
    v_rcp_f32 v248, v248
    v_mfma_f32_16x16x32_bf16 v[40:43], v[172:175], v[144:147], v[40:43]
    ds_read_b128 v[228:231], v232 offset:17408
    v_rcp_f32 v249, v249
    v_mul_f32 v112, v112, v248
    v_mfma_f32_16x16x32_bf16 v[44:47], v[172:175], v[148:151], v[44:47]
    v_mul_f32 v113, v113, v249
    v_mfma_f32_16x16x32_bf16 v[48:51], v[176:179], v[144:147], v[48:51]
    v_cvt_pk_bf16_f32 v112, v112, v113
    v_mfma_f32_16x16x32_bf16 v[52:55], v[176:179], v[148:151], v[52:55]
    v_mul_f32 v240, v114, v114
    v_mfma_f32_16x16x32_bf16 v[56:59], v[180:183], v[144:147], v[56:59]
    v_mul_f32 v241, v115, v115
    v_fmaak_f32 v240, v252, v240, 0xc0135761
    v_mfma_f32_16x16x32_bf16 v[60:63], v[180:183], v[148:151], v[60:63]
    v_fmaak_f32 v241, v252, v241, 0xc0135761
    v_mfma_f32_16x16x32_bf16 v[64:67], v[184:187], v[144:147], v[64:67]
    v_mul_f32 v240, v240, v114
    v_mfma_f32_16x16x32_bf16 v[68:71], v[184:187], v[148:151], v[68:71]
    v_mul_f32 v241, v241, v115
    v_exp_f32 v240, v240
    s_waitcnt lgkmcnt(0)
    s_barrier
    v_mfma_f32_16x16x32_bf16 v[0:3], v[196:199], v[188:191], v[0:3]
    ds_read_b128 v[144:147], v233 offset:34816
    v_exp_f32 v241, v241
    v_mfma_f32_16x16x32_bf16 v[4:7], v[196:199], v[192:195], v[4:7]
    ds_read_b128 v[148:151], v233 offset:36864
    v_add_f32 v240, 1.0, v240
    v_mfma_f32_16x16x32_bf16 v[8:11], v[200:203], v[188:191], v[8:11]
    ds_read_b128 v[152:155], v232 offset:34816
    v_add_f32 v241, 1.0, v241
    v_mfma_f32_16x16x32_bf16 v[12:15], v[200:203], v[192:195], v[12:15]
    ds_read_b128 v[156:159], v232 offset:36864
    v_rcp_f32 v240, v240
    v_rcp_f32 v241, v241
    v_mfma_f32_16x16x32_bf16 v[16:19], v[204:207], v[188:191], v[16:19]
    ds_read_b128 v[160:163], v232 offset:38912
    v_mul_f32 v114, v114, v240
    v_mfma_f32_16x16x32_bf16 v[20:23], v[204:207], v[192:195], v[20:23]
    ds_read_b128 v[164:167], v232 offset:40960
    v_mul_f32 v115, v115, v241
    v_mfma_f32_16x16x32_bf16 v[24:27], v[208:211], v[188:191], v[24:27]
    ds_read_b128 v[168:171], v232 offset:43008
    v_cvt_pk_bf16_f32 v114, v114, v115
    v_mfma_f32_16x16x32_bf16 v[28:31], v[208:211], v[192:195], v[28:31]
    ds_read_b128 v[172:175], v232 offset:45056
    v_mul_f32 v246, v116, v116
    v_mul_f32 v247, v117, v117
    v_mfma_f32_16x16x32_bf16 v[32:35], v[212:215], v[188:191], v[32:35]
    ds_read_b128 v[176:179], v232 offset:47104
    v_fmaak_f32 v246, v252, v246, 0xc0135761
    v_mfma_f32_16x16x32_bf16 v[36:39], v[212:215], v[192:195], v[36:39]
    ds_read_b128 v[180:183], v232 offset:49152
    v_fmaak_f32 v247, v252, v247, 0xc0135761
    v_mfma_f32_16x16x32_bf16 v[40:43], v[216:219], v[188:191], v[40:43]
    ds_read_b128 v[184:187], v232 offset:51200
    v_mul_f32 v246, v246, v116
    v_mul_f32 v247, v247, v117
    v_mfma_f32_16x16x32_bf16 v[44:47], v[216:219], v[192:195], v[44:47]
    v_exp_f32 v246, v246
    v_mfma_f32_16x16x32_bf16 v[48:51], v[220:223], v[188:191], v[48:51]
    v_exp_f32 v247, v247
    v_mfma_f32_16x16x32_bf16 v[52:55], v[220:223], v[192:195], v[52:55]
    v_add_f32 v246, 1.0, v246
    v_mfma_f32_16x16x32_bf16 v[56:59], v[224:227], v[188:191], v[56:59]
    v_add_f32 v247, 1.0, v247
    v_rcp_f32 v246, v246
    v_mfma_f32_16x16x32_bf16 v[60:63], v[224:227], v[192:195], v[60:63]
    v_rcp_f32 v247, v247
    v_mfma_f32_16x16x32_bf16 v[64:67], v[228:231], v[188:191], v[64:67]
    v_mul_f32 v116, v116, v246
    v_mfma_f32_16x16x32_bf16 v[68:71], v[228:231], v[192:195], v[68:71]
    v_mul_f32 v117, v117, v247
    v_cvt_pk_bf16_f32 v116, v116, v117
    s_waitcnt lgkmcnt(0)
    v_mfma_f32_16x16x32_bf16 v[0:3], v[152:155], v[144:147], v[0:3]
    ds_read_b128 v[188:191], v234 offset:34816
    v_mul_f32 v248, v118, v118
    v_mfma_f32_16x16x32_bf16 v[4:7], v[152:155], v[148:151], v[4:7]
    ds_read_b128 v[192:195], v234 offset:36864
    v_mul_f32 v249, v119, v119
    v_mfma_f32_16x16x32_bf16 v[8:11], v[156:159], v[144:147], v[8:11]
    ds_read_b128 v[196:199], v232 offset:35840
    v_fmaak_f32 v248, v252, v248, 0xc0135761
    v_mfma_f32_16x16x32_bf16 v[12:15], v[156:159], v[148:151], v[12:15]
    ds_read_b128 v[200:203], v232 offset:37888
    v_fmaak_f32 v249, v252, v249, 0xc0135761
    v_mul_f32 v248, v248, v118
    v_mfma_f32_16x16x32_bf16 v[16:19], v[160:163], v[144:147], v[16:19]
    ds_read_b128 v[204:207], v232 offset:39936
    v_mul_f32 v249, v249, v119
    v_mfma_f32_16x16x32_bf16 v[20:23], v[160:163], v[148:151], v[20:23]
    ds_read_b128 v[208:211], v232 offset:41984
    v_exp_f32 v248, v248
    v_mfma_f32_16x16x32_bf16 v[24:27], v[164:167], v[144:147], v[24:27]
    ds_read_b128 v[212:215], v232 offset:44032
    v_exp_f32 v249, v249
    v_mfma_f32_16x16x32_bf16 v[28:31], v[164:167], v[148:151], v[28:31]
    ds_read_b128 v[216:219], v232 offset:46080
    v_add_f32 v248, 1.0, v248
    v_add_f32 v249, 1.0, v249
    v_mfma_f32_16x16x32_bf16 v[32:35], v[168:171], v[144:147], v[32:35]
    ds_read_b128 v[220:223], v232 offset:48128
    v_rcp_f32 v248, v248
    v_mfma_f32_16x16x32_bf16 v[36:39], v[168:171], v[148:151], v[36:39]
    ds_read_b128 v[224:227], v232 offset:50176
    v_rcp_f32 v249, v249
    v_mfma_f32_16x16x32_bf16 v[40:43], v[172:175], v[144:147], v[40:43]
    ds_read_b128 v[228:231], v232 offset:52224
    v_mul_f32 v118, v118, v248
    v_mul_f32 v119, v119, v249
    v_mfma_f32_16x16x32_bf16 v[44:47], v[172:175], v[148:151], v[44:47]
    v_cvt_pk_bf16_f32 v118, v118, v119
    v_mfma_f32_16x16x32_bf16 v[48:51], v[176:179], v[144:147], v[48:51]
    v_mul_f32 v240, v120, v120
    v_mfma_f32_16x16x32_bf16 v[52:55], v[176:179], v[148:151], v[52:55]
    v_mul_f32 v241, v121, v121
    v_mfma_f32_16x16x32_bf16 v[56:59], v[180:183], v[144:147], v[56:59]
    v_fmaak_f32 v240, v252, v240, 0xc0135761
    v_fmaak_f32 v241, v252, v241, 0xc0135761
    v_mfma_f32_16x16x32_bf16 v[60:63], v[180:183], v[148:151], v[60:63]
    v_mul_f32 v240, v240, v120
    v_mfma_f32_16x16x32_bf16 v[64:67], v[184:187], v[144:147], v[64:67]
    v_mul_f32 v241, v241, v121
    v_mfma_f32_16x16x32_bf16 v[68:71], v[184:187], v[148:151], v[68:71]
    v_exp_f32 v240, v240
    v_exp_f32 v241, v241
    s_waitcnt lgkmcnt(0)
    s_barrier
    v_mfma_f32_16x16x32_bf16 v[0:3], v[196:199], v[188:191], v[0:3]
    ds_read_b128 v[144:147], v236 offset:0
    v_add_f32 v240, 1.0, v240
    v_mfma_f32_16x16x32_bf16 v[4:7], v[196:199], v[192:195], v[4:7]
    ds_read_b128 v[148:151], v236 offset:2048
    v_add_f32 v241, 1.0, v241
    v_mfma_f32_16x16x32_bf16 v[8:11], v[200:203], v[188:191], v[8:11]
    ds_read_b128 v[152:155], v235 offset:0
    v_rcp_f32 v240, v240
    v_mfma_f32_16x16x32_bf16 v[12:15], v[200:203], v[192:195], v[12:15]
    ds_read_b128 v[156:159], v235 offset:2048
    v_rcp_f32 v241, v241
    v_mul_f32 v120, v120, v240
    v_mfma_f32_16x16x32_bf16 v[16:19], v[204:207], v[188:191], v[16:19]
    ds_read_b128 v[160:163], v235 offset:4096
    v_mul_f32 v121, v121, v241
    v_mfma_f32_16x16x32_bf16 v[20:23], v[204:207], v[192:195], v[20:23]
    ds_read_b128 v[164:167], v235 offset:6144
    v_cvt_pk_bf16_f32 v120, v120, v121
    v_mfma_f32_16x16x32_bf16 v[24:27], v[208:211], v[188:191], v[24:27]
    ds_read_b128 v[168:171], v235 offset:8192
    v_mul_f32 v246, v122, v122
    v_mfma_f32_16x16x32_bf16 v[28:31], v[208:211], v[192:195], v[28:31]
    ds_read_b128 v[172:175], v235 offset:10240
    v_mul_f32 v247, v123, v123
    v_fmaak_f32 v246, v252, v246, 0xc0135761
    v_mfma_f32_16x16x32_bf16 v[32:35], v[212:215], v[188:191], v[32:35]
    ds_read_b128 v[176:179], v235 offset:12288
    v_fmaak_f32 v247, v252, v247, 0xc0135761
    v_mfma_f32_16x16x32_bf16 v[36:39], v[212:215], v[192:195], v[36:39]
    ds_read_b128 v[180:183], v235 offset:14336
    v_mul_f32 v246, v246, v122
    v_mfma_f32_16x16x32_bf16 v[40:43], v[216:219], v[188:191], v[40:43]
    ds_read_b128 v[184:187], v235 offset:16384
    v_mul_f32 v247, v247, v123
    v_exp_f32 v246, v246
    v_mfma_f32_16x16x32_bf16 v[44:47], v[216:219], v[192:195], v[44:47]
    v_exp_f32 v247, v247
    v_mfma_f32_16x16x32_bf16 v[48:51], v[220:223], v[188:191], v[48:51]
    v_add_f32 v246, 1.0, v246
    v_mfma_f32_16x16x32_bf16 v[52:55], v[220:223], v[192:195], v[52:55]
    v_add_f32 v247, 1.0, v247
    v_mfma_f32_16x16x32_bf16 v[56:59], v[224:227], v[188:191], v[56:59]
    v_rcp_f32 v246, v246
    v_rcp_f32 v247, v247
    v_mfma_f32_16x16x32_bf16 v[60:63], v[224:227], v[192:195], v[60:63]
    v_mul_f32 v122, v122, v246
    v_mfma_f32_16x16x32_bf16 v[64:67], v[228:231], v[188:191], v[64:67]
    v_mul_f32 v123, v123, v247
    v_mfma_f32_16x16x32_bf16 v[68:71], v[228:231], v[192:195], v[68:71]
    v_cvt_pk_bf16_f32 v122, v122, v123
    v_mul_f32 v248, v124, v124
    s_waitcnt lgkmcnt(0)
    v_mfma_f32_16x16x32_bf16 v[0:3], v[152:155], v[144:147], v[0:3]
    ds_read_b128 v[188:191], v239 offset:0
    v_mul_f32 v249, v125, v125
    v_mfma_f32_16x16x32_bf16 v[4:7], v[152:155], v[148:151], v[4:7]
    ds_read_b128 v[192:195], v239 offset:2048
    v_fmaak_f32 v248, v252, v248, 0xc0135761
    v_mfma_f32_16x16x32_bf16 v[8:11], v[156:159], v[144:147], v[8:11]
    ds_read_b128 v[196:199], v235 offset:1024
    v_fmaak_f32 v249, v252, v249, 0xc0135761
    v_mfma_f32_16x16x32_bf16 v[12:15], v[156:159], v[148:151], v[12:15]
    ds_read_b128 v[200:203], v235 offset:3072
    v_mul_f32 v248, v248, v124
    v_mul_f32 v249, v249, v125
    v_mfma_f32_16x16x32_bf16 v[16:19], v[160:163], v[144:147], v[16:19]
    ds_read_b128 v[204:207], v235 offset:5120
    v_exp_f32 v248, v248
    v_mfma_f32_16x16x32_bf16 v[20:23], v[160:163], v[148:151], v[20:23]
    ds_read_b128 v[208:211], v235 offset:7168
    v_exp_f32 v249, v249
    v_mfma_f32_16x16x32_bf16 v[24:27], v[164:167], v[144:147], v[24:27]
    ds_read_b128 v[212:215], v235 offset:9216
    v_add_f32 v248, 1.0, v248
    v_mfma_f32_16x16x32_bf16 v[28:31], v[164:167], v[148:151], v[28:31]
    ds_read_b128 v[216:219], v235 offset:11264
    v_add_f32 v249, 1.0, v249
    v_rcp_f32 v248, v248
    v_mfma_f32_16x16x32_bf16 v[32:35], v[168:171], v[144:147], v[32:35]
    ds_read_b128 v[220:223], v235 offset:13312
    v_rcp_f32 v249, v249
    v_mfma_f32_16x16x32_bf16 v[36:39], v[168:171], v[148:151], v[36:39]
    ds_read_b128 v[224:227], v235 offset:15360
    v_mul_f32 v124, v124, v248
    v_mfma_f32_16x16x32_bf16 v[40:43], v[172:175], v[144:147], v[40:43]
    ds_read_b128 v[228:231], v235 offset:17408
    v_mul_f32 v125, v125, v249
    v_cvt_pk_bf16_f32 v124, v124, v125
    v_mfma_f32_16x16x32_bf16 v[44:47], v[172:175], v[148:151], v[44:47]
    v_mul_f32 v240, v126, v126
    v_mfma_f32_16x16x32_bf16 v[48:51], v[176:179], v[144:147], v[48:51]
    v_mul_f32 v241, v127, v127
    v_mfma_f32_16x16x32_bf16 v[52:55], v[176:179], v[148:151], v[52:55]
    v_fmaak_f32 v240, v252, v240, 0xc0135761
    v_mfma_f32_16x16x32_bf16 v[56:59], v[180:183], v[144:147], v[56:59]
    v_fmaak_f32 v241, v252, v241, 0xc0135761
    v_mul_f32 v240, v240, v126
    v_mfma_f32_16x16x32_bf16 v[60:63], v[180:183], v[148:151], v[60:63]
    v_mul_f32 v241, v241, v127
    v_mfma_f32_16x16x32_bf16 v[64:67], v[184:187], v[144:147], v[64:67]
    v_exp_f32 v240, v240
    v_mfma_f32_16x16x32_bf16 v[68:71], v[184:187], v[148:151], v[68:71]
    v_exp_f32 v241, v241
    v_add_f32 v240, 1.0, v240
    s_waitcnt lgkmcnt(0)
    s_barrier
    v_mfma_f32_16x16x32_bf16 v[0:3], v[196:199], v[188:191], v[0:3]
    ds_read_b128 v[144:147], v236 offset:34816
    v_add_f32 v241, 1.0, v241
    v_mfma_f32_16x16x32_bf16 v[4:7], v[196:199], v[192:195], v[4:7]
    ds_read_b128 v[148:151], v236 offset:36864
    v_rcp_f32 v240, v240
    v_mfma_f32_16x16x32_bf16 v[8:11], v[200:203], v[188:191], v[8:11]
    ds_read_b128 v[152:155], v235 offset:34816
    v_rcp_f32 v241, v241
    v_mfma_f32_16x16x32_bf16 v[12:15], v[200:203], v[192:195], v[12:15]
    ds_read_b128 v[156:159], v235 offset:36864
    v_mul_f32 v126, v126, v240
    v_mul_f32 v127, v127, v241
    v_mfma_f32_16x16x32_bf16 v[16:19], v[204:207], v[188:191], v[16:19]
    ds_read_b128 v[160:163], v235 offset:38912
    v_cvt_pk_bf16_f32 v126, v126, v127
    v_mfma_f32_16x16x32_bf16 v[20:23], v[204:207], v[192:195], v[20:23]
    ds_read_b128 v[164:167], v235 offset:40960
    v_mul_f32 v246, v128, v128
    v_mfma_f32_16x16x32_bf16 v[24:27], v[208:211], v[188:191], v[24:27]
    ds_read_b128 v[168:171], v235 offset:43008
    v_mul_f32 v247, v129, v129
    v_mfma_f32_16x16x32_bf16 v[28:31], v[208:211], v[192:195], v[28:31]
    ds_read_b128 v[172:175], v235 offset:45056
    v_fmaak_f32 v246, v252, v246, 0xc0135761
    v_fmaak_f32 v247, v252, v247, 0xc0135761
    v_mfma_f32_16x16x32_bf16 v[32:35], v[212:215], v[188:191], v[32:35]
    ds_read_b128 v[176:179], v235 offset:47104
    v_mul_f32 v246, v246, v128
    v_mfma_f32_16x16x32_bf16 v[36:39], v[212:215], v[192:195], v[36:39]
    ds_read_b128 v[180:183], v235 offset:49152
    v_mul_f32 v247, v247, v129
    v_mfma_f32_16x16x32_bf16 v[40:43], v[216:219], v[188:191], v[40:43]
    ds_read_b128 v[184:187], v235 offset:51200
    v_exp_f32 v246, v246
    v_exp_f32 v247, v247
    v_mfma_f32_16x16x32_bf16 v[44:47], v[216:219], v[192:195], v[44:47]
    v_add_f32 v246, 1.0, v246
    v_mfma_f32_16x16x32_bf16 v[48:51], v[220:223], v[188:191], v[48:51]
    v_add_f32 v247, 1.0, v247
    v_mfma_f32_16x16x32_bf16 v[52:55], v[220:223], v[192:195], v[52:55]
    v_rcp_f32 v246, v246
    v_mfma_f32_16x16x32_bf16 v[56:59], v[224:227], v[188:191], v[56:59]
    v_rcp_f32 v247, v247
    v_mul_f32 v128, v128, v246
    v_mfma_f32_16x16x32_bf16 v[60:63], v[224:227], v[192:195], v[60:63]
    v_mul_f32 v129, v129, v247
    v_mfma_f32_16x16x32_bf16 v[64:67], v[228:231], v[188:191], v[64:67]
    v_cvt_pk_bf16_f32 v128, v128, v129
    v_mfma_f32_16x16x32_bf16 v[68:71], v[228:231], v[192:195], v[68:71]
    v_mul_f32 v248, v130, v130
    v_mul_f32 v249, v131, v131
    s_waitcnt lgkmcnt(0)
    v_mfma_f32_16x16x32_bf16 v[0:3], v[152:155], v[144:147], v[0:3]
    ds_read_b128 v[188:191], v239 offset:34816
    v_fmaak_f32 v248, v252, v248, 0xc0135761
    v_mfma_f32_16x16x32_bf16 v[4:7], v[152:155], v[148:151], v[4:7]
    ds_read_b128 v[192:195], v239 offset:36864
    v_fmaak_f32 v249, v252, v249, 0xc0135761
    v_mfma_f32_16x16x32_bf16 v[8:11], v[156:159], v[144:147], v[8:11]
    ds_read_b128 v[196:199], v235 offset:35840
    v_mul_f32 v248, v248, v130
    v_mfma_f32_16x16x32_bf16 v[12:15], v[156:159], v[148:151], v[12:15]
    ds_read_b128 v[200:203], v235 offset:37888
    v_mul_f32 v249, v249, v131
    v_exp_f32 v248, v248
    v_mfma_f32_16x16x32_bf16 v[16:19], v[160:163], v[144:147], v[16:19]
    ds_read_b128 v[204:207], v235 offset:39936
    v_exp_f32 v249, v249
    v_mfma_f32_16x16x32_bf16 v[20:23], v[160:163], v[148:151], v[20:23]
    ds_read_b128 v[208:211], v235 offset:41984
    v_add_f32 v248, 1.0, v248
    v_mfma_f32_16x16x32_bf16 v[24:27], v[164:167], v[144:147], v[24:27]
    ds_read_b128 v[212:215], v235 offset:44032
    v_add_f32 v249, 1.0, v249
    v_mfma_f32_16x16x32_bf16 v[28:31], v[164:167], v[148:151], v[28:31]
    ds_read_b128 v[216:219], v235 offset:46080
    v_rcp_f32 v248, v248
    v_rcp_f32 v249, v249
    v_mfma_f32_16x16x32_bf16 v[32:35], v[168:171], v[144:147], v[32:35]
    ds_read_b128 v[220:223], v235 offset:48128
    v_mul_f32 v130, v130, v248
    v_mfma_f32_16x16x32_bf16 v[36:39], v[168:171], v[148:151], v[36:39]
    ds_read_b128 v[224:227], v235 offset:50176
    v_mul_f32 v131, v131, v249
    v_mfma_f32_16x16x32_bf16 v[40:43], v[172:175], v[144:147], v[40:43]
    ds_read_b128 v[228:231], v235 offset:52224
    v_cvt_pk_bf16_f32 v130, v130, v131
    v_mul_f32 v240, v132, v132
    v_mfma_f32_16x16x32_bf16 v[44:47], v[172:175], v[148:151], v[44:47]
    v_mul_f32 v241, v133, v133
    v_mfma_f32_16x16x32_bf16 v[48:51], v[176:179], v[144:147], v[48:51]
    v_fmaak_f32 v240, v252, v240, 0xc0135761
    v_mfma_f32_16x16x32_bf16 v[52:55], v[176:179], v[148:151], v[52:55]
    v_fmaak_f32 v241, v252, v241, 0xc0135761
    v_mfma_f32_16x16x32_bf16 v[56:59], v[180:183], v[144:147], v[56:59]
    v_mul_f32 v240, v240, v132
    v_mul_f32 v241, v241, v133
    v_mfma_f32_16x16x32_bf16 v[60:63], v[180:183], v[148:151], v[60:63]
    v_exp_f32 v240, v240
    v_mfma_f32_16x16x32_bf16 v[64:67], v[184:187], v[144:147], v[64:67]
    v_exp_f32 v241, v241
    v_mfma_f32_16x16x32_bf16 v[68:71], v[184:187], v[148:151], v[68:71]
    v_add_f32 v240, 1.0, v240
    v_add_f32 v241, 1.0, v241
    s_waitcnt lgkmcnt(0)
    s_barrier
    v_mfma_f32_16x16x32_bf16 v[0:3], v[196:199], v[188:191], v[0:3]
    ds_read_b128 v[144:147], v233 offset:0
    v_rcp_f32 v240, v240
    v_mfma_f32_16x16x32_bf16 v[4:7], v[196:199], v[192:195], v[4:7]
    ds_read_b128 v[148:151], v233 offset:2048
    v_rcp_f32 v241, v241
    v_mfma_f32_16x16x32_bf16 v[8:11], v[200:203], v[188:191], v[8:11]
    ds_read_b128 v[152:155], v232 offset:0
    v_mul_f32 v132, v132, v240
    v_mfma_f32_16x16x32_bf16 v[12:15], v[200:203], v[192:195], v[12:15]
    ds_read_b128 v[156:159], v232 offset:2048
    v_mul_f32 v133, v133, v241
    v_cvt_pk_bf16_f32 v132, v132, v133
    v_mfma_f32_16x16x32_bf16 v[16:19], v[204:207], v[188:191], v[16:19]
    ds_read_b128 v[160:163], v232 offset:4096
    v_mul_f32 v246, v134, v134
    v_mfma_f32_16x16x32_bf16 v[20:23], v[204:207], v[192:195], v[20:23]
    ds_read_b128 v[164:167], v232 offset:6144
    v_mul_f32 v247, v135, v135
    v_mfma_f32_16x16x32_bf16 v[24:27], v[208:211], v[188:191], v[24:27]
    ds_read_b128 v[168:171], v232 offset:8192
    v_fmaak_f32 v246, v252, v246, 0xc0135761
    v_mfma_f32_16x16x32_bf16 v[28:31], v[208:211], v[192:195], v[28:31]
    ds_read_b128 v[172:175], v232 offset:10240
    v_fmaak_f32 v247, v252, v247, 0xc0135761
    v_mul_f32 v246, v246, v134
    v_mfma_f32_16x16x32_bf16 v[32:35], v[212:215], v[188:191], v[32:35]
    ds_read_b128 v[176:179], v232 offset:12288
    v_mul_f32 v247, v247, v135
    v_mfma_f32_16x16x32_bf16 v[36:39], v[212:215], v[192:195], v[36:39]
    ds_read_b128 v[180:183], v232 offset:14336
    v_exp_f32 v246, v246
    v_mfma_f32_16x16x32_bf16 v[40:43], v[216:219], v[188:191], v[40:43]
    ds_read_b128 v[184:187], v232 offset:16384
    v_exp_f32 v247, v247
    v_add_f32 v246, 1.0, v246
    v_mfma_f32_16x16x32_bf16 v[44:47], v[216:219], v[192:195], v[44:47]
    v_add_f32 v247, 1.0, v247
    v_mfma_f32_16x16x32_bf16 v[48:51], v[220:223], v[188:191], v[48:51]
    v_rcp_f32 v246, v246
    v_mfma_f32_16x16x32_bf16 v[52:55], v[220:223], v[192:195], v[52:55]
    v_rcp_f32 v247, v247
    v_mfma_f32_16x16x32_bf16 v[56:59], v[224:227], v[188:191], v[56:59]
    v_mul_f32 v134, v134, v246
    v_mul_f32 v135, v135, v247
    v_mfma_f32_16x16x32_bf16 v[60:63], v[224:227], v[192:195], v[60:63]
    v_cvt_pk_bf16_f32 v134, v134, v135
    v_mfma_f32_16x16x32_bf16 v[64:67], v[228:231], v[188:191], v[64:67]
    v_mul_f32 v248, v136, v136
    v_mfma_f32_16x16x32_bf16 v[68:71], v[228:231], v[192:195], v[68:71]
    v_mul_f32 v249, v137, v137
    v_fmaak_f32 v248, v252, v248, 0xc0135761
    s_waitcnt lgkmcnt(0)
    v_mfma_f32_16x16x32_bf16 v[0:3], v[152:155], v[144:147], v[0:3]
    ds_read_b128 v[188:191], v234 offset:0
    v_fmaak_f32 v249, v252, v249, 0xc0135761
    v_mfma_f32_16x16x32_bf16 v[4:7], v[152:155], v[148:151], v[4:7]
    ds_read_b128 v[192:195], v234 offset:2048
    v_mul_f32 v248, v248, v136
    v_mfma_f32_16x16x32_bf16 v[8:11], v[156:159], v[144:147], v[8:11]
    ds_read_b128 v[196:199], v232 offset:1024
    v_mul_f32 v249, v249, v137
    v_mfma_f32_16x16x32_bf16 v[12:15], v[156:159], v[148:151], v[12:15]
    ds_read_b128 v[200:203], v232 offset:3072
    v_exp_f32 v248, v248
    v_exp_f32 v249, v249
    v_mfma_f32_16x16x32_bf16 v[16:19], v[160:163], v[144:147], v[16:19]
    ds_read_b128 v[204:207], v232 offset:5120
    v_add_f32 v248, 1.0, v248
    v_mfma_f32_16x16x32_bf16 v[20:23], v[160:163], v[148:151], v[20:23]
    ds_read_b128 v[208:211], v232 offset:7168
    v_add_f32 v249, 1.0, v249
    v_mfma_f32_16x16x32_bf16 v[24:27], v[164:167], v[144:147], v[24:27]
    ds_read_b128 v[212:215], v232 offset:9216
    v_rcp_f32 v248, v248
    v_mfma_f32_16x16x32_bf16 v[28:31], v[164:167], v[148:151], v[28:31]
    ds_read_b128 v[216:219], v232 offset:11264
    v_rcp_f32 v249, v249
    v_mul_f32 v136, v136, v248
    v_mfma_f32_16x16x32_bf16 v[32:35], v[168:171], v[144:147], v[32:35]
    ds_read_b128 v[220:223], v232 offset:13312
    v_mul_f32 v137, v137, v249
    v_mfma_f32_16x16x32_bf16 v[36:39], v[168:171], v[148:151], v[36:39]
    ds_read_b128 v[224:227], v232 offset:15360
    v_cvt_pk_bf16_f32 v136, v136, v137
    v_mfma_f32_16x16x32_bf16 v[40:43], v[172:175], v[144:147], v[40:43]
    ds_read_b128 v[228:231], v232 offset:17408
    v_mul_f32 v240, v138, v138
    v_mul_f32 v241, v139, v139
    v_mfma_f32_16x16x32_bf16 v[44:47], v[172:175], v[148:151], v[44:47]
    v_fmaak_f32 v240, v252, v240, 0xc0135761
    v_mfma_f32_16x16x32_bf16 v[48:51], v[176:179], v[144:147], v[48:51]
    v_fmaak_f32 v241, v252, v241, 0xc0135761
    v_mfma_f32_16x16x32_bf16 v[52:55], v[176:179], v[148:151], v[52:55]
    v_mul_f32 v240, v240, v138
    v_mfma_f32_16x16x32_bf16 v[56:59], v[180:183], v[144:147], v[56:59]
    v_mul_f32 v241, v241, v139
    v_exp_f32 v240, v240
    v_mfma_f32_16x16x32_bf16 v[60:63], v[180:183], v[148:151], v[60:63]
    v_exp_f32 v241, v241
    v_mfma_f32_16x16x32_bf16 v[64:67], v[184:187], v[144:147], v[64:67]
    v_add_f32 v240, 1.0, v240
    v_mfma_f32_16x16x32_bf16 v[68:71], v[184:187], v[148:151], v[68:71]
    v_add_f32 v241, 1.0, v241
    v_rcp_f32 v240, v240
    s_waitcnt lgkmcnt(0)
    s_barrier
    v_mfma_f32_16x16x32_bf16 v[0:3], v[196:199], v[188:191], v[0:3]
    ds_read_b128 v[144:147], v233 offset:34816
    v_rcp_f32 v241, v241
    v_mfma_f32_16x16x32_bf16 v[4:7], v[196:199], v[192:195], v[4:7]
    ds_read_b128 v[148:151], v233 offset:36864
    v_mul_f32 v138, v138, v240
    v_mfma_f32_16x16x32_bf16 v[8:11], v[200:203], v[188:191], v[8:11]
    ds_read_b128 v[152:155], v232 offset:34816
    v_mul_f32 v139, v139, v241
    v_mfma_f32_16x16x32_bf16 v[12:15], v[200:203], v[192:195], v[12:15]
    ds_read_b128 v[156:159], v232 offset:36864
    v_cvt_pk_bf16_f32 v138, v138, v139
    v_mul_f32 v246, v140, v140
    v_mfma_f32_16x16x32_bf16 v[16:19], v[204:207], v[188:191], v[16:19]
    ds_read_b128 v[160:163], v232 offset:38912
    v_mul_f32 v247, v141, v141
    v_mfma_f32_16x16x32_bf16 v[20:23], v[204:207], v[192:195], v[20:23]
    ds_read_b128 v[164:167], v232 offset:40960
    v_fmaak_f32 v246, v252, v246, 0xc0135761
    v_mfma_f32_16x16x32_bf16 v[24:27], v[208:211], v[188:191], v[24:27]
    ds_read_b128 v[168:171], v232 offset:43008
    v_fmaak_f32 v247, v252, v247, 0xc0135761
    v_mfma_f32_16x16x32_bf16 v[28:31], v[208:211], v[192:195], v[28:31]
    ds_read_b128 v[172:175], v232 offset:45056
    v_mul_f32 v246, v246, v140
    v_mul_f32 v247, v247, v141
    v_mfma_f32_16x16x32_bf16 v[32:35], v[212:215], v[188:191], v[32:35]
    ds_read_b128 v[176:179], v232 offset:47104
    v_exp_f32 v246, v246
    v_mfma_f32_16x16x32_bf16 v[36:39], v[212:215], v[192:195], v[36:39]
    ds_read_b128 v[180:183], v232 offset:49152
    v_exp_f32 v247, v247
    v_mfma_f32_16x16x32_bf16 v[40:43], v[216:219], v[188:191], v[40:43]
    ds_read_b128 v[184:187], v232 offset:51200
    v_add_f32 v246, 1.0, v246
    v_add_f32 v247, 1.0, v247
    v_mfma_f32_16x16x32_bf16 v[44:47], v[216:219], v[192:195], v[44:47]
    v_rcp_f32 v246, v246
    v_mfma_f32_16x16x32_bf16 v[48:51], v[220:223], v[188:191], v[48:51]
    v_rcp_f32 v247, v247
    v_mfma_f32_16x16x32_bf16 v[52:55], v[220:223], v[192:195], v[52:55]
    v_mul_f32 v140, v140, v246
    v_mfma_f32_16x16x32_bf16 v[56:59], v[224:227], v[188:191], v[56:59]
    v_mul_f32 v141, v141, v247
    v_cvt_pk_bf16_f32 v140, v140, v141
    v_mfma_f32_16x16x32_bf16 v[60:63], v[224:227], v[192:195], v[60:63]
    v_mul_f32 v248, v142, v142
    v_mfma_f32_16x16x32_bf16 v[64:67], v[228:231], v[188:191], v[64:67]
    v_mul_f32 v249, v143, v143
    v_mfma_f32_16x16x32_bf16 v[68:71], v[228:231], v[192:195], v[68:71]
    v_fmaak_f32 v248, v252, v248, 0xc0135761
    v_fmaak_f32 v249, v252, v249, 0xc0135761
    s_waitcnt lgkmcnt(0)
    v_mfma_f32_16x16x32_bf16 v[0:3], v[152:155], v[144:147], v[0:3]
    ds_read_b128 v[188:191], v234 offset:34816
    v_mfma_f32_16x16x32_bf16 v[4:7], v[152:155], v[148:151], v[4:7]
    ds_read_b128 v[192:195], v234 offset:36864
    v_mul_f32 v248, v248, v142
    v_mfma_f32_16x16x32_bf16 v[8:11], v[156:159], v[144:147], v[8:11]
    ds_read_b128 v[196:199], v232 offset:35840
    v_mfma_f32_16x16x32_bf16 v[12:15], v[156:159], v[148:151], v[12:15]
    ds_read_b128 v[200:203], v232 offset:37888
    v_mul_f32 v249, v249, v143
    v_mfma_f32_16x16x32_bf16 v[16:19], v[160:163], v[144:147], v[16:19]
    ds_read_b128 v[204:207], v232 offset:39936
    v_exp_f32 v248, v248
    v_mfma_f32_16x16x32_bf16 v[20:23], v[160:163], v[148:151], v[20:23]
    ds_read_b128 v[208:211], v232 offset:41984
    v_mfma_f32_16x16x32_bf16 v[24:27], v[164:167], v[144:147], v[24:27]
    ds_read_b128 v[212:215], v232 offset:44032
    v_exp_f32 v249, v249
    v_mfma_f32_16x16x32_bf16 v[28:31], v[164:167], v[148:151], v[28:31]
    ds_read_b128 v[216:219], v232 offset:46080
    v_mfma_f32_16x16x32_bf16 v[32:35], v[168:171], v[144:147], v[32:35]
    ds_read_b128 v[220:223], v232 offset:48128
    v_add_f32 v248, 1.0, v248
    v_mfma_f32_16x16x32_bf16 v[36:39], v[168:171], v[148:151], v[36:39]
    ds_read_b128 v[224:227], v232 offset:50176
    v_add_f32 v249, 1.0, v249
    v_mfma_f32_16x16x32_bf16 v[40:43], v[172:175], v[144:147], v[40:43]
    ds_read_b128 v[228:231], v232 offset:52224
    v_mfma_f32_16x16x32_bf16 v[44:47], v[172:175], v[148:151], v[44:47]
    v_rcp_f32 v248, v248
    v_mfma_f32_16x16x32_bf16 v[48:51], v[176:179], v[144:147], v[48:51]
    v_mfma_f32_16x16x32_bf16 v[52:55], v[176:179], v[148:151], v[52:55]
    v_rcp_f32 v249, v249
    v_mfma_f32_16x16x32_bf16 v[56:59], v[180:183], v[144:147], v[56:59]
    v_mul_f32 v142, v142, v248
    v_mfma_f32_16x16x32_bf16 v[60:63], v[180:183], v[148:151], v[60:63]
    v_mfma_f32_16x16x32_bf16 v[64:67], v[184:187], v[144:147], v[64:67]
    v_mul_f32 v143, v143, v249
    v_mfma_f32_16x16x32_bf16 v[68:71], v[184:187], v[148:151], v[68:71]
    v_cvt_pk_bf16_f32 v142, v142, v143
    s_waitcnt lgkmcnt(0)
    s_barrier
    s_mov_b32 s35, 12
fz_cloop:
    v_mfma_f32_16x16x32_bf16 v[0:3], v[196:199], v[188:191], v[0:3]
    ds_read_b128 v[144:147], v236 offset:0
    v_mfma_f32_16x16x32_bf16 v[4:7], v[196:199], v[192:195], v[4:7]
    ds_read_b128 v[148:151], v236 offset:2048
    v_mfma_f32_16x16x32_bf16 v[8:11], v[200:203], v[188:191], v[8:11]
    ds_read_b128 v[152:155], v235 offset:0
    v_mfma_f32_16x16x32_bf16 v[12:15], v[200:203], v[192:195], v[12:15]
    ds_read_b128 v[156:159], v235 offset:2048
    v_mfma_f32_16x16x32_bf16 v[16:19], v[204:207], v[188:191], v[16:19]
    ds_read_b128 v[160:163], v235 offset:4096
    v_mfma_f32_16x16x32_bf16 v[20:23], v[204:207], v[192:195], v[20:23]
    ds_read_b128 v[164:167], v235 offset:6144
    v_mfma_f32_16x16x32_bf16 v[24:27], v[208:211], v[188:191], v[24:27]
    ds_read_b128 v[168:171], v235 offset:8192
    v_mfma_f32_16x16x32_bf16 v[28:31], v[208:211], v[192:195], v[28:31]
    ds_read_b128 v[172:175], v235 offset:10240
    v_mfma_f32_16x16x32_bf16 v[32:35], v[212:215], v[188:191], v[32:35]
    ds_read_b128 v[176:179], v235 offset:12288
    v_mfma_f32_16x16x32_bf16 v[36:39], v[212:215], v[192:195], v[36:39]
    ds_read_b128 v[180:183], v235 offset:14336
    v_mfma_f32_16x16x32_bf16 v[40:43], v[216:219], v[188:191], v[40:43]
    ds_read_b128 v[184:187], v235 offset:16384
    v_mfma_f32_16x16x32_bf16 v[44:47], v[216:219], v[192:195], v[44:47]
    v_mfma_f32_16x16x32_bf16 v[48:51], v[220:223], v[188:191], v[48:51]
    v_mfma_f32_16x16x32_bf16 v[52:55], v[220:223], v[192:195], v[52:55]
    v_mfma_f32_16x16x32_bf16 v[56:59], v[224:227], v[188:191], v[56:59]
    v_mfma_f32_16x16x32_bf16 v[60:63], v[224:227], v[192:195], v[60:63]
    v_mfma_f32_16x16x32_bf16 v[64:67], v[228:231], v[188:191], v[64:67]
    v_mfma_f32_16x16x32_bf16 v[68:71], v[228:231], v[192:195], v[68:71]
    s_waitcnt lgkmcnt(0)
    v_mfma_f32_16x16x32_bf16 v[0:3], v[152:155], v[144:147], v[0:3]
    ds_read_b128 v[188:191], v239 offset:0
    v_mfma_f32_16x16x32_bf16 v[4:7], v[152:155], v[148:151], v[4:7]
    ds_read_b128 v[192:195], v239 offset:2048
    v_mfma_f32_16x16x32_bf16 v[8:11], v[156:159], v[144:147], v[8:11]
    ds_read_b128 v[196:199], v235 offset:1024
    v_mfma_f32_16x16x32_bf16 v[12:15], v[156:159], v[148:151], v[12:15]
    ds_read_b128 v[200:203], v235 offset:3072
    v_mfma_f32_16x16x32_bf16 v[16:19], v[160:163], v[144:147], v[16:19]
    ds_read_b128 v[204:207], v235 offset:5120
    v_mfma_f32_16x16x32_bf16 v[20:23], v[160:163], v[148:151], v[20:23]
    ds_read_b128 v[208:211], v235 offset:7168
    v_mfma_f32_16x16x32_bf16 v[24:27], v[164:167], v[144:147], v[24:27]
    ds_read_b128 v[212:215], v235 offset:9216
    v_mfma_f32_16x16x32_bf16 v[28:31], v[164:167], v[148:151], v[28:31]
    ds_read_b128 v[216:219], v235 offset:11264
    v_mfma_f32_16x16x32_bf16 v[32:35], v[168:171], v[144:147], v[32:35]
    ds_read_b128 v[220:223], v235 offset:13312
    v_mfma_f32_16x16x32_bf16 v[36:39], v[168:171], v[148:151], v[36:39]
    ds_read_b128 v[224:227], v235 offset:15360
    v_mfma_f32_16x16x32_bf16 v[40:43], v[172:175], v[144:147], v[40:43]
    ds_read_b128 v[228:231], v235 offset:17408
    v_mfma_f32_16x16x32_bf16 v[44:47], v[172:175], v[148:151], v[44:47]
    v_mfma_f32_16x16x32_bf16 v[48:51], v[176:179], v[144:147], v[48:51]
    v_mfma_f32_16x16x32_bf16 v[52:55], v[176:179], v[148:151], v[52:55]
    v_mfma_f32_16x16x32_bf16 v[56:59], v[180:183], v[144:147], v[56:59]
    v_mfma_f32_16x16x32_bf16 v[60:63], v[180:183], v[148:151], v[60:63]
    v_mfma_f32_16x16x32_bf16 v[64:67], v[184:187], v[144:147], v[64:67]
    v_mfma_f32_16x16x32_bf16 v[68:71], v[184:187], v[148:151], v[68:71]
    s_waitcnt lgkmcnt(0)
    s_barrier
    v_mfma_f32_16x16x32_bf16 v[0:3], v[196:199], v[188:191], v[0:3]
    ds_read_b128 v[144:147], v236 offset:34816
    v_mfma_f32_16x16x32_bf16 v[4:7], v[196:199], v[192:195], v[4:7]
    ds_read_b128 v[148:151], v236 offset:36864
    v_mfma_f32_16x16x32_bf16 v[8:11], v[200:203], v[188:191], v[8:11]
    ds_read_b128 v[152:155], v235 offset:34816
    v_mfma_f32_16x16x32_bf16 v[12:15], v[200:203], v[192:195], v[12:15]
    ds_read_b128 v[156:159], v235 offset:36864
    v_mfma_f32_16x16x32_bf16 v[16:19], v[204:207], v[188:191], v[16:19]
    ds_read_b128 v[160:163], v235 offset:38912
    v_mfma_f32_16x16x32_bf16 v[20:23], v[204:207], v[192:195], v[20:23]
    ds_read_b128 v[164:167], v235 offset:40960
    v_mfma_f32_16x16x32_bf16 v[24:27], v[208:211], v[188:191], v[24:27]
    ds_read_b128 v[168:171], v235 offset:43008
    v_mfma_f32_16x16x32_bf16 v[28:31], v[208:211], v[192:195], v[28:31]
    ds_read_b128 v[172:175], v235 offset:45056
    v_mfma_f32_16x16x32_bf16 v[32:35], v[212:215], v[188:191], v[32:35]
    ds_read_b128 v[176:179], v235 offset:47104
    v_mfma_f32_16x16x32_bf16 v[36:39], v[212:215], v[192:195], v[36:39]
    ds_read_b128 v[180:183], v235 offset:49152
    v_mfma_f32_16x16x32_bf16 v[40:43], v[216:219], v[188:191], v[40:43]
    ds_read_b128 v[184:187], v235 offset:51200
    v_mfma_f32_16x16x32_bf16 v[44:47], v[216:219], v[192:195], v[44:47]
    v_mfma_f32_16x16x32_bf16 v[48:51], v[220:223], v[188:191], v[48:51]
    v_mfma_f32_16x16x32_bf16 v[52:55], v[220:223], v[192:195], v[52:55]
    v_mfma_f32_16x16x32_bf16 v[56:59], v[224:227], v[188:191], v[56:59]
    v_mfma_f32_16x16x32_bf16 v[60:63], v[224:227], v[192:195], v[60:63]
    v_mfma_f32_16x16x32_bf16 v[64:67], v[228:231], v[188:191], v[64:67]
    v_mfma_f32_16x16x32_bf16 v[68:71], v[228:231], v[192:195], v[68:71]
    s_waitcnt lgkmcnt(0)
    v_mfma_f32_16x16x32_bf16 v[0:3], v[152:155], v[144:147], v[0:3]
    ds_read_b128 v[188:191], v239 offset:34816
    v_mfma_f32_16x16x32_bf16 v[4:7], v[152:155], v[148:151], v[4:7]
    ds_read_b128 v[192:195], v239 offset:36864
    v_mfma_f32_16x16x32_bf16 v[8:11], v[156:159], v[144:147], v[8:11]
    ds_read_b128 v[196:199], v235 offset:35840
    v_mfma_f32_16x16x32_bf16 v[12:15], v[156:159], v[148:151], v[12:15]
    ds_read_b128 v[200:203], v235 offset:37888
    v_mfma_f32_16x16x32_bf16 v[16:19], v[160:163], v[144:147], v[16:19]
    ds_read_b128 v[204:207], v235 offset:39936
    v_mfma_f32_16x16x32_bf16 v[20:23], v[160:163], v[148:151], v[20:23]
    ds_read_b128 v[208:211], v235 offset:41984
    v_mfma_f32_16x16x32_bf16 v[24:27], v[164:167], v[144:147], v[24:27]
    ds_read_b128 v[212:215], v235 offset:44032
    v_mfma_f32_16x16x32_bf16 v[28:31], v[164:167], v[148:151], v[28:31]
    ds_read_b128 v[216:219], v235 offset:46080
    v_mfma_f32_16x16x32_bf16 v[32:35], v[168:171], v[144:147], v[32:35]
    ds_read_b128 v[220:223], v235 offset:48128
    v_mfma_f32_16x16x32_bf16 v[36:39], v[168:171], v[148:151], v[36:39]
    ds_read_b128 v[224:227], v235 offset:50176
    v_mfma_f32_16x16x32_bf16 v[40:43], v[172:175], v[144:147], v[40:43]
    ds_read_b128 v[228:231], v235 offset:52224
    v_mfma_f32_16x16x32_bf16 v[44:47], v[172:175], v[148:151], v[44:47]
    v_mfma_f32_16x16x32_bf16 v[48:51], v[176:179], v[144:147], v[48:51]
    v_mfma_f32_16x16x32_bf16 v[52:55], v[176:179], v[148:151], v[52:55]
    v_mfma_f32_16x16x32_bf16 v[56:59], v[180:183], v[144:147], v[56:59]
    v_mfma_f32_16x16x32_bf16 v[60:63], v[180:183], v[148:151], v[60:63]
    v_mfma_f32_16x16x32_bf16 v[64:67], v[184:187], v[144:147], v[64:67]
    v_mfma_f32_16x16x32_bf16 v[68:71], v[184:187], v[148:151], v[68:71]
    s_waitcnt lgkmcnt(0)
    s_barrier
    v_mfma_f32_16x16x32_bf16 v[0:3], v[196:199], v[188:191], v[0:3]
    ds_read_b128 v[144:147], v233 offset:0
    v_mfma_f32_16x16x32_bf16 v[4:7], v[196:199], v[192:195], v[4:7]
    ds_read_b128 v[148:151], v233 offset:2048
    v_mfma_f32_16x16x32_bf16 v[8:11], v[200:203], v[188:191], v[8:11]
    ds_read_b128 v[152:155], v232 offset:0
    v_mfma_f32_16x16x32_bf16 v[12:15], v[200:203], v[192:195], v[12:15]
    ds_read_b128 v[156:159], v232 offset:2048
    v_mfma_f32_16x16x32_bf16 v[16:19], v[204:207], v[188:191], v[16:19]
    ds_read_b128 v[160:163], v232 offset:4096
    v_mfma_f32_16x16x32_bf16 v[20:23], v[204:207], v[192:195], v[20:23]
    ds_read_b128 v[164:167], v232 offset:6144
    v_mfma_f32_16x16x32_bf16 v[24:27], v[208:211], v[188:191], v[24:27]
    ds_read_b128 v[168:171], v232 offset:8192
    v_mfma_f32_16x16x32_bf16 v[28:31], v[208:211], v[192:195], v[28:31]
    ds_read_b128 v[172:175], v232 offset:10240
    v_mfma_f32_16x16x32_bf16 v[32:35], v[212:215], v[188:191], v[32:35]
    ds_read_b128 v[176:179], v232 offset:12288
    v_mfma_f32_16x16x32_bf16 v[36:39], v[212:215], v[192:195], v[36:39]
    ds_read_b128 v[180:183], v232 offset:14336
    v_mfma_f32_16x16x32_bf16 v[40:43], v[216:219], v[188:191], v[40:43]
    ds_read_b128 v[184:187], v232 offset:16384
    v_mfma_f32_16x16x32_bf16 v[44:47], v[216:219], v[192:195], v[44:47]
    v_mfma_f32_16x16x32_bf16 v[48:51], v[220:223], v[188:191], v[48:51]
    v_mfma_f32_16x16x32_bf16 v[52:55], v[220:223], v[192:195], v[52:55]
    v_mfma_f32_16x16x32_bf16 v[56:59], v[224:227], v[188:191], v[56:59]
    v_mfma_f32_16x16x32_bf16 v[60:63], v[224:227], v[192:195], v[60:63]
    v_mfma_f32_16x16x32_bf16 v[64:67], v[228:231], v[188:191], v[64:67]
    v_mfma_f32_16x16x32_bf16 v[68:71], v[228:231], v[192:195], v[68:71]
    s_waitcnt lgkmcnt(0)
    v_mfma_f32_16x16x32_bf16 v[0:3], v[152:155], v[144:147], v[0:3]
    ds_read_b128 v[188:191], v234 offset:0
    v_mfma_f32_16x16x32_bf16 v[4:7], v[152:155], v[148:151], v[4:7]
    ds_read_b128 v[192:195], v234 offset:2048
    v_mfma_f32_16x16x32_bf16 v[8:11], v[156:159], v[144:147], v[8:11]
    ds_read_b128 v[196:199], v232 offset:1024
    v_mfma_f32_16x16x32_bf16 v[12:15], v[156:159], v[148:151], v[12:15]
    ds_read_b128 v[200:203], v232 offset:3072
    v_mfma_f32_16x16x32_bf16 v[16:19], v[160:163], v[144:147], v[16:19]
    ds_read_b128 v[204:207], v232 offset:5120
    v_mfma_f32_16x16x32_bf16 v[20:23], v[160:163], v[148:151], v[20:23]
    ds_read_b128 v[208:211], v232 offset:7168
    v_mfma_f32_16x16x32_bf16 v[24:27], v[164:167], v[144:147], v[24:27]
    ds_read_b128 v[212:215], v232 offset:9216
    v_mfma_f32_16x16x32_bf16 v[28:31], v[164:167], v[148:151], v[28:31]
    ds_read_b128 v[216:219], v232 offset:11264
    v_mfma_f32_16x16x32_bf16 v[32:35], v[168:171], v[144:147], v[32:35]
    ds_read_b128 v[220:223], v232 offset:13312
    v_mfma_f32_16x16x32_bf16 v[36:39], v[168:171], v[148:151], v[36:39]
    ds_read_b128 v[224:227], v232 offset:15360
    v_mfma_f32_16x16x32_bf16 v[40:43], v[172:175], v[144:147], v[40:43]
    ds_read_b128 v[228:231], v232 offset:17408
    v_mfma_f32_16x16x32_bf16 v[44:47], v[172:175], v[148:151], v[44:47]
    v_mfma_f32_16x16x32_bf16 v[48:51], v[176:179], v[144:147], v[48:51]
    v_mfma_f32_16x16x32_bf16 v[52:55], v[176:179], v[148:151], v[52:55]
    v_mfma_f32_16x16x32_bf16 v[56:59], v[180:183], v[144:147], v[56:59]
    v_mfma_f32_16x16x32_bf16 v[60:63], v[180:183], v[148:151], v[60:63]
    v_mfma_f32_16x16x32_bf16 v[64:67], v[184:187], v[144:147], v[64:67]
    v_mfma_f32_16x16x32_bf16 v[68:71], v[184:187], v[148:151], v[68:71]
    s_waitcnt lgkmcnt(0)
    s_barrier
    v_mfma_f32_16x16x32_bf16 v[0:3], v[196:199], v[188:191], v[0:3]
    ds_read_b128 v[144:147], v233 offset:34816
    v_mfma_f32_16x16x32_bf16 v[4:7], v[196:199], v[192:195], v[4:7]
    ds_read_b128 v[148:151], v233 offset:36864
    v_mfma_f32_16x16x32_bf16 v[8:11], v[200:203], v[188:191], v[8:11]
    ds_read_b128 v[152:155], v232 offset:34816
    v_mfma_f32_16x16x32_bf16 v[12:15], v[200:203], v[192:195], v[12:15]
    ds_read_b128 v[156:159], v232 offset:36864
    v_mfma_f32_16x16x32_bf16 v[16:19], v[204:207], v[188:191], v[16:19]
    ds_read_b128 v[160:163], v232 offset:38912
    v_mfma_f32_16x16x32_bf16 v[20:23], v[204:207], v[192:195], v[20:23]
    ds_read_b128 v[164:167], v232 offset:40960
    v_mfma_f32_16x16x32_bf16 v[24:27], v[208:211], v[188:191], v[24:27]
    ds_read_b128 v[168:171], v232 offset:43008
    v_mfma_f32_16x16x32_bf16 v[28:31], v[208:211], v[192:195], v[28:31]
    ds_read_b128 v[172:175], v232 offset:45056
    v_mfma_f32_16x16x32_bf16 v[32:35], v[212:215], v[188:191], v[32:35]
    ds_read_b128 v[176:179], v232 offset:47104
    v_mfma_f32_16x16x32_bf16 v[36:39], v[212:215], v[192:195], v[36:39]
    ds_read_b128 v[180:183], v232 offset:49152
    v_mfma_f32_16x16x32_bf16 v[40:43], v[216:219], v[188:191], v[40:43]
    ds_read_b128 v[184:187], v232 offset:51200
    v_mfma_f32_16x16x32_bf16 v[44:47], v[216:219], v[192:195], v[44:47]
    v_mfma_f32_16x16x32_bf16 v[48:51], v[220:223], v[188:191], v[48:51]
    v_mfma_f32_16x16x32_bf16 v[52:55], v[220:223], v[192:195], v[52:55]
    v_mfma_f32_16x16x32_bf16 v[56:59], v[224:227], v[188:191], v[56:59]
    v_mfma_f32_16x16x32_bf16 v[60:63], v[224:227], v[192:195], v[60:63]
    v_mfma_f32_16x16x32_bf16 v[64:67], v[228:231], v[188:191], v[64:67]
    v_mfma_f32_16x16x32_bf16 v[68:71], v[228:231], v[192:195], v[68:71]
    s_waitcnt lgkmcnt(0)
    v_mfma_f32_16x16x32_bf16 v[0:3], v[152:155], v[144:147], v[0:3]
    ds_read_b128 v[188:191], v234 offset:34816
    v_mfma_f32_16x16x32_bf16 v[4:7], v[152:155], v[148:151], v[4:7]
    ds_read_b128 v[192:195], v234 offset:36864
    v_mfma_f32_16x16x32_bf16 v[8:11], v[156:159], v[144:147], v[8:11]
    ds_read_b128 v[196:199], v232 offset:35840
    v_mfma_f32_16x16x32_bf16 v[12:15], v[156:159], v[148:151], v[12:15]
    ds_read_b128 v[200:203], v232 offset:37888
    v_mfma_f32_16x16x32_bf16 v[16:19], v[160:163], v[144:147], v[16:19]
    ds_read_b128 v[204:207], v232 offset:39936
    v_mfma_f32_16x16x32_bf16 v[20:23], v[160:163], v[148:151], v[20:23]
    ds_read_b128 v[208:211], v232 offset:41984
    v_mfma_f32_16x16x32_bf16 v[24:27], v[164:167], v[144:147], v[24:27]
    ds_read_b128 v[212:215], v232 offset:44032
    v_mfma_f32_16x16x32_bf16 v[28:31], v[164:167], v[148:151], v[28:31]
    ds_read_b128 v[216:219], v232 offset:46080
    v_mfma_f32_16x16x32_bf16 v[32:35], v[168:171], v[144:147], v[32:35]
    ds_read_b128 v[220:223], v232 offset:48128
    v_mfma_f32_16x16x32_bf16 v[36:39], v[168:171], v[148:151], v[36:39]
    ds_read_b128 v[224:227], v232 offset:50176
    v_mfma_f32_16x16x32_bf16 v[40:43], v[172:175], v[144:147], v[40:43]
    ds_read_b128 v[228:231], v232 offset:52224
    v_mfma_f32_16x16x32_bf16 v[44:47], v[172:175], v[148:151], v[44:47]
    s_add_u32 s35, s35, 4
    v_mfma_f32_16x16x32_bf16 v[48:51], v[176:179], v[144:147], v[48:51]
    s_cmp_lt_u32 s35, 28
    v_mfma_f32_16x16x32_bf16 v[52:55], v[176:179], v[148:151], v[52:55]
    v_mfma_f32_16x16x32_bf16 v[56:59], v[180:183], v[144:147], v[56:59]
    v_mfma_f32_16x16x32_bf16 v[60:63], v[180:183], v[148:151], v[60:63]
    v_mfma_f32_16x16x32_bf16 v[64:67], v[184:187], v[144:147], v[64:67]
    v_mfma_f32_16x16x32_bf16 v[68:71], v[184:187], v[148:151], v[68:71]
    s_waitcnt lgkmcnt(0)
    s_barrier
    s_cbranch_scc1 fz_cloop
    v_mfma_f32_16x16x32_bf16 v[0:3], v[196:199], v[188:191], v[0:3]
    ds_read_b128 v[144:147], v236 offset:0
    v_mfma_f32_16x16x32_bf16 v[4:7], v[196:199], v[192:195], v[4:7]
    ds_read_b128 v[148:151], v236 offset:2048
    v_mfma_f32_16x16x32_bf16 v[8:11], v[200:203], v[188:191], v[8:11]
    ds_read_b128 v[152:155], v235 offset:0
    v_mfma_f32_16x16x32_bf16 v[12:15], v[200:203], v[192:195], v[12:15]
    ds_read_b128 v[156:159], v235 offset:2048
    v_mfma_f32_16x16x32_bf16 v[16:19], v[204:207], v[188:191], v[16:19]
    ds_read_b128 v[160:163], v235 offset:4096
    v_mfma_f32_16x16x32_bf16 v[20:23], v[204:207], v[192:195], v[20:23]
    ds_read_b128 v[164:167], v235 offset:6144
    v_mfma_f32_16x16x32_bf16 v[24:27], v[208:211], v[188:191], v[24:27]
    ds_read_b128 v[168:171], v235 offset:8192
    v_mfma_f32_16x16x32_bf16 v[28:31], v[208:211], v[192:195], v[28:31]
    ds_read_b128 v[172:175], v235 offset:10240
    v_mfma_f32_16x16x32_bf16 v[32:35], v[212:215], v[188:191], v[32:35]
    ds_read_b128 v[176:179], v235 offset:12288
    v_mfma_f32_16x16x32_bf16 v[36:39], v[212:215], v[192:195], v[36:39]
    ds_read_b128 v[180:183], v235 offset:14336
    v_mfma_f32_16x16x32_bf16 v[40:43], v[216:219], v[188:191], v[40:43]
    ds_read_b128 v[184:187], v235 offset:16384
    v_mfma_f32_16x16x32_bf16 v[44:47], v[216:219], v[192:195], v[44:47]
    v_mfma_f32_16x16x32_bf16 v[48:51], v[220:223], v[188:191], v[48:51]
    v_mfma_f32_16x16x32_bf16 v[52:55], v[220:223], v[192:195], v[52:55]
    v_mfma_f32_16x16x32_bf16 v[56:59], v[224:227], v[188:191], v[56:59]
    v_mfma_f32_16x16x32_bf16 v[60:63], v[224:227], v[192:195], v[60:63]
    v_mfma_f32_16x16x32_bf16 v[64:67], v[228:231], v[188:191], v[64:67]
    v_mfma_f32_16x16x32_bf16 v[68:71], v[228:231], v[192:195], v[68:71]
    s_waitcnt lgkmcnt(0)
    v_mfma_f32_16x16x32_bf16 v[0:3], v[152:155], v[144:147], v[0:3]
    ds_read_b128 v[188:191], v239 offset:0
    v_mfma_f32_16x16x32_bf16 v[4:7], v[152:155], v[148:151], v[4:7]
    ds_read_b128 v[192:195], v239 offset:2048
    v_mfma_f32_16x16x32_bf16 v[8:11], v[156:159], v[144:147], v[8:11]
    ds_read_b128 v[196:199], v235 offset:1024
    v_mfma_f32_16x16x32_bf16 v[12:15], v[156:159], v[148:151], v[12:15]
    ds_read_b128 v[200:203], v235 offset:3072
    v_mfma_f32_16x16x32_bf16 v[16:19], v[160:163], v[144:147], v[16:19]
    ds_read_b128 v[204:207], v235 offset:5120
    v_mfma_f32_16x16x32_bf16 v[20:23], v[160:163], v[148:151], v[20:23]
    ds_read_b128 v[208:211], v235 offset:7168
    v_mfma_f32_16x16x32_bf16 v[24:27], v[164:167], v[144:147], v[24:27]
    ds_read_b128 v[212:215], v235 offset:9216
    v_mfma_f32_16x16x32_bf16 v[28:31], v[164:167], v[148:151], v[28:31]
    ds_read_b128 v[216:219], v235 offset:11264
    v_mfma_f32_16x16x32_bf16 v[32:35], v[168:171], v[144:147], v[32:35]
    ds_read_b128 v[220:223], v235 offset:13312
    v_mfma_f32_16x16x32_bf16 v[36:39], v[168:171], v[148:151], v[36:39]
    ds_read_b128 v[224:227], v235 offset:15360
    v_mfma_f32_16x16x32_bf16 v[40:43], v[172:175], v[144:147], v[40:43]
    ds_read_b128 v[228:231], v235 offset:17408
    v_mfma_f32_16x16x32_bf16 v[44:47], v[172:175], v[148:151], v[44:47]
    buffer_load_dword v238, v237, s[16:19], 0 offen sc1
    v_mfma_f32_16x16x32_bf16 v[48:51], v[176:179], v[144:147], v[48:51]
    v_mfma_f32_16x16x32_bf16 v[52:55], v[176:179], v[148:151], v[52:55]
    v_mfma_f32_16x16x32_bf16 v[56:59], v[180:183], v[144:147], v[56:59]
    v_mfma_f32_16x16x32_bf16 v[60:63], v[180:183], v[148:151], v[60:63]
    v_mfma_f32_16x16x32_bf16 v[64:67], v[184:187], v[144:147], v[64:67]
    v_mfma_f32_16x16x32_bf16 v[68:71], v[184:187], v[148:151], v[68:71]
    s_waitcnt lgkmcnt(0)
    s_barrier
    v_mfma_f32_16x16x32_bf16 v[0:3], v[196:199], v[188:191], v[0:3]
    ds_read_b128 v[144:147], v236 offset:34816
    v_mfma_f32_16x16x32_bf16 v[4:7], v[196:199], v[192:195], v[4:7]
    ds_read_b128 v[148:151], v236 offset:36864
    v_mfma_f32_16x16x32_bf16 v[8:11], v[200:203], v[188:191], v[8:11]
    ds_read_b128 v[152:155], v235 offset:34816
    v_mfma_f32_16x16x32_bf16 v[12:15], v[200:203], v[192:195], v[12:15]
    ds_read_b128 v[156:159], v235 offset:36864
    v_mfma_f32_16x16x32_bf16 v[16:19], v[204:207], v[188:191], v[16:19]
    ds_read_b128 v[160:163], v235 offset:38912
    v_mfma_f32_16x16x32_bf16 v[20:23], v[204:207], v[192:195], v[20:23]
    ds_read_b128 v[164:167], v235 offset:40960
    v_mfma_f32_16x16x32_bf16 v[24:27], v[208:211], v[188:191], v[24:27]
    ds_read_b128 v[168:171], v235 offset:43008
    v_mfma_f32_16x16x32_bf16 v[28:31], v[208:211], v[192:195], v[28:31]
    ds_read_b128 v[172:175], v235 offset:45056
    v_mfma_f32_16x16x32_bf16 v[32:35], v[212:215], v[188:191], v[32:35]
    ds_read_b128 v[176:179], v235 offset:47104
    v_mfma_f32_16x16x32_bf16 v[36:39], v[212:215], v[192:195], v[36:39]
    ds_read_b128 v[180:183], v235 offset:49152
    v_mfma_f32_16x16x32_bf16 v[40:43], v[216:219], v[188:191], v[40:43]
    ds_read_b128 v[184:187], v235 offset:51200
    v_mfma_f32_16x16x32_bf16 v[44:47], v[216:219], v[192:195], v[44:47]
    v_mfma_f32_16x16x32_bf16 v[48:51], v[220:223], v[188:191], v[48:51]
    v_mfma_f32_16x16x32_bf16 v[52:55], v[220:223], v[192:195], v[52:55]
    v_mfma_f32_16x16x32_bf16 v[56:59], v[224:227], v[188:191], v[56:59]
    v_mfma_f32_16x16x32_bf16 v[60:63], v[224:227], v[192:195], v[60:63]
    v_mfma_f32_16x16x32_bf16 v[64:67], v[228:231], v[188:191], v[64:67]
    v_mfma_f32_16x16x32_bf16 v[68:71], v[228:231], v[192:195], v[68:71]
    s_waitcnt lgkmcnt(0)
    v_mfma_f32_16x16x32_bf16 v[0:3], v[152:155], v[144:147], v[0:3]
    ds_read_b128 v[188:191], v239 offset:34816
    v_mfma_f32_16x16x32_bf16 v[4:7], v[152:155], v[148:151], v[4:7]
    ds_read_b128 v[192:195], v239 offset:36864
    v_mfma_f32_16x16x32_bf16 v[8:11], v[156:159], v[144:147], v[8:11]
    ds_read_b128 v[196:199], v235 offset:35840
    v_mfma_f32_16x16x32_bf16 v[12:15], v[156:159], v[148:151], v[12:15]
    ds_read_b128 v[200:203], v235 offset:37888
    v_mfma_f32_16x16x32_bf16 v[16:19], v[160:163], v[144:147], v[16:19]
    ds_read_b128 v[204:207], v235 offset:39936
    v_mfma_f32_16x16x32_bf16 v[20:23], v[160:163], v[148:151], v[20:23]
    ds_read_b128 v[208:211], v235 offset:41984
    v_mfma_f32_16x16x32_bf16 v[24:27], v[164:167], v[144:147], v[24:27]
    ds_read_b128 v[212:215], v235 offset:44032
    v_mfma_f32_16x16x32_bf16 v[28:31], v[164:167], v[148:151], v[28:31]
    ds_read_b128 v[216:219], v235 offset:46080
    v_mfma_f32_16x16x32_bf16 v[32:35], v[168:171], v[144:147], v[32:35]
    ds_read_b128 v[220:223], v235 offset:48128
    v_mfma_f32_16x16x32_bf16 v[36:39], v[168:171], v[148:151], v[36:39]
    ds_read_b128 v[224:227], v235 offset:50176
    v_mfma_f32_16x16x32_bf16 v[40:43], v[172:175], v[144:147], v[40:43]
    ds_read_b128 v[228:231], v235 offset:52224
    v_mfma_f32_16x16x32_bf16 v[44:47], v[172:175], v[148:151], v[44:47]
    v_mfma_f32_16x16x32_bf16 v[48:51], v[176:179], v[144:147], v[48:51]
    v_mfma_f32_16x16x32_bf16 v[52:55], v[176:179], v[148:151], v[52:55]
    v_mfma_f32_16x16x32_bf16 v[56:59], v[180:183], v[144:147], v[56:59]
    v_mfma_f32_16x16x32_bf16 v[60:63], v[180:183], v[148:151], v[60:63]
    v_mfma_f32_16x16x32_bf16 v[64:67], v[184:187], v[144:147], v[64:67]
    v_mfma_f32_16x16x32_bf16 v[68:71], v[184:187], v[148:151], v[68:71]
    s_waitcnt lgkmcnt(0)
    s_barrier
    v_mfma_f32_16x16x32_bf16 v[0:3], v[196:199], v[188:191], v[0:3]
    ds_read_b128 v[144:147], v233 offset:0
    v_mfma_f32_16x16x32_bf16 v[4:7], v[196:199], v[192:195], v[4:7]
    ds_read_b128 v[148:151], v233 offset:2048
    v_mfma_f32_16x16x32_bf16 v[8:11], v[200:203], v[188:191], v[8:11]
    ds_read_b128 v[152:155], v232 offset:0
    v_mfma_f32_16x16x32_bf16 v[12:15], v[200:203], v[192:195], v[12:15]
    ds_read_b128 v[156:159], v232 offset:2048
    v_mfma_f32_16x16x32_bf16 v[16:19], v[204:207], v[188:191], v[16:19]
    ds_read_b128 v[160:163], v232 offset:4096
    v_mfma_f32_16x16x32_bf16 v[20:23], v[204:207], v[192:195], v[20:23]
    ds_read_b128 v[164:167], v232 offset:6144
    v_mfma_f32_16x16x32_bf16 v[24:27], v[208:211], v[188:191], v[24:27]
    ds_read_b128 v[168:171], v232 offset:8192
    v_mfma_f32_16x16x32_bf16 v[28:31], v[208:211], v[192:195], v[28:31]
    ds_read_b128 v[172:175], v232 offset:10240
    v_mfma_f32_16x16x32_bf16 v[32:35], v[212:215], v[188:191], v[32:35]
    ds_read_b128 v[176:179], v232 offset:12288
    v_mfma_f32_16x16x32_bf16 v[36:39], v[212:215], v[192:195], v[36:39]
    ds_read_b128 v[180:183], v232 offset:14336
    v_mfma_f32_16x16x32_bf16 v[40:43], v[216:219], v[188:191], v[40:43]
    ds_read_b128 v[184:187], v232 offset:16384
    v_mfma_f32_16x16x32_bf16 v[44:47], v[216:219], v[192:195], v[44:47]
    v_mfma_f32_16x16x32_bf16 v[48:51], v[220:223], v[188:191], v[48:51]
    v_mfma_f32_16x16x32_bf16 v[52:55], v[220:223], v[192:195], v[52:55]
    v_mfma_f32_16x16x32_bf16 v[56:59], v[224:227], v[188:191], v[56:59]
    v_mfma_f32_16x16x32_bf16 v[60:63], v[224:227], v[192:195], v[60:63]
    v_mfma_f32_16x16x32_bf16 v[64:67], v[228:231], v[188:191], v[64:67]
    v_mfma_f32_16x16x32_bf16 v[68:71], v[228:231], v[192:195], v[68:71]
    s_waitcnt lgkmcnt(0)
    v_mfma_f32_16x16x32_bf16 v[0:3], v[152:155], v[144:147], v[0:3]
    ds_read_b128 v[188:191], v234 offset:0
    v_mfma_f32_16x16x32_bf16 v[4:7], v[152:155], v[148:151], v[4:7]
    ds_read_b128 v[192:195], v234 offset:2048
    v_mfma_f32_16x16x32_bf16 v[8:11], v[156:159], v[144:147], v[8:11]
    ds_read_b128 v[196:199], v232 offset:1024
    v_mfma_f32_16x16x32_bf16 v[12:15], v[156:159], v[148:151], v[12:15]
    ds_read_b128 v[200:203], v232 offset:3072
    v_mfma_f32_16x16x32_bf16 v[16:19], v[160:163], v[144:147], v[16:19]
    ds_read_b128 v[204:207], v232 offset:5120
    v_mfma_f32_16x16x32_bf16 v[20:23], v[160:163], v[148:151], v[20:23]
    ds_read_b128 v[208:211], v232 offset:7168
    v_mfma_f32_16x16x32_bf16 v[24:27], v[164:167], v[144:147], v[24:27]
    ds_read_b128 v[212:215], v232 offset:9216
    v_mfma_f32_16x16x32_bf16 v[28:31], v[164:167], v[148:151], v[28:31]
    ds_read_b128 v[216:219], v232 offset:11264
    v_mfma_f32_16x16x32_bf16 v[32:35], v[168:171], v[144:147], v[32:35]
    ds_read_b128 v[220:223], v232 offset:13312
    v_mfma_f32_16x16x32_bf16 v[36:39], v[168:171], v[148:151], v[36:39]
    ds_read_b128 v[224:227], v232 offset:15360
    v_mfma_f32_16x16x32_bf16 v[40:43], v[172:175], v[144:147], v[40:43]
    ds_read_b128 v[228:231], v232 offset:17408
    v_mfma_f32_16x16x32_bf16 v[44:47], v[172:175], v[148:151], v[44:47]
    v_mfma_f32_16x16x32_bf16 v[48:51], v[176:179], v[144:147], v[48:51]
    v_mfma_f32_16x16x32_bf16 v[52:55], v[176:179], v[148:151], v[52:55]
    v_mfma_f32_16x16x32_bf16 v[56:59], v[180:183], v[144:147], v[56:59]
    v_mfma_f32_16x16x32_bf16 v[60:63], v[180:183], v[148:151], v[60:63]
    v_mfma_f32_16x16x32_bf16 v[64:67], v[184:187], v[144:147], v[64:67]
    v_mfma_f32_16x16x32_bf16 v[68:71], v[184:187], v[148:151], v[68:71]
    s_waitcnt lgkmcnt(0)
    s_barrier
    v_mfma_f32_16x16x32_bf16 v[0:3], v[196:199], v[188:191], v[0:3]
    ds_read_b128 v[144:147], v233 offset:34816
    v_mfma_f32_16x16x32_bf16 v[4:7], v[196:199], v[192:195], v[4:7]
    ds_read_b128 v[148:151], v233 offset:36864
    v_mfma_f32_16x16x32_bf16 v[8:11], v[200:203], v[188:191], v[8:11]
    ds_read_b128 v[152:155], v232 offset:34816
    v_mfma_f32_16x16x32_bf16 v[12:15], v[200:203], v[192:195], v[12:15]
    ds_read_b128 v[156:159], v232 offset:36864
    v_mfma_f32_16x16x32_bf16 v[16:19], v[204:207], v[188:191], v[16:19]
    ds_read_b128 v[160:163], v232 offset:38912
    v_mfma_f32_16x16x32_bf16 v[20:23], v[204:207], v[192:195], v[20:23]
    ds_read_b128 v[164:167], v232 offset:40960
    v_mfma_f32_16x16x32_bf16 v[24:27], v[208:211], v[188:191], v[24:27]
    ds_read_b128 v[168:171], v232 offset:43008
    v_mfma_f32_16x16x32_bf16 v[28:31], v[208:211], v[192:195], v[28:31]
    ds_read_b128 v[172:175], v232 offset:45056
    v_mfma_f32_16x16x32_bf16 v[32:35], v[212:215], v[188:191], v[32:35]
    ds_read_b128 v[176:179], v232 offset:47104
    v_mfma_f32_16x16x32_bf16 v[36:39], v[212:215], v[192:195], v[36:39]
    ds_read_b128 v[180:183], v232 offset:49152
    v_mfma_f32_16x16x32_bf16 v[40:43], v[216:219], v[188:191], v[40:43]
    ds_read_b128 v[184:187], v232 offset:51200
    v_mfma_f32_16x16x32_bf16 v[44:47], v[216:219], v[192:195], v[44:47]
    v_mfma_f32_16x16x32_bf16 v[48:51], v[220:223], v[188:191], v[48:51]
    v_mfma_f32_16x16x32_bf16 v[52:55], v[220:223], v[192:195], v[52:55]
    v_mfma_f32_16x16x32_bf16 v[56:59], v[224:227], v[188:191], v[56:59]
    v_mfma_f32_16x16x32_bf16 v[60:63], v[224:227], v[192:195], v[60:63]
    v_mfma_f32_16x16x32_bf16 v[64:67], v[228:231], v[188:191], v[64:67]
    v_mfma_f32_16x16x32_bf16 v[68:71], v[228:231], v[192:195], v[68:71]
    s_waitcnt lgkmcnt(0)
    v_mfma_f32_16x16x32_bf16 v[0:3], v[152:155], v[144:147], v[0:3]
    ds_read_b128 v[188:191], v234 offset:34816
    v_mfma_f32_16x16x32_bf16 v[4:7], v[152:155], v[148:151], v[4:7]
    ds_read_b128 v[192:195], v234 offset:36864
    v_mfma_f32_16x16x32_bf16 v[8:11], v[156:159], v[144:147], v[8:11]
    ds_read_b128 v[196:199], v232 offset:35840
    v_mfma_f32_16x16x32_bf16 v[12:15], v[156:159], v[148:151], v[12:15]
    ds_read_b128 v[200:203], v232 offset:37888
    v_mfma_f32_16x16x32_bf16 v[16:19], v[160:163], v[144:147], v[16:19]
    ds_read_b128 v[204:207], v232 offset:39936
    v_mfma_f32_16x16x32_bf16 v[20:23], v[160:163], v[148:151], v[20:23]
    ds_read_b128 v[208:211], v232 offset:41984
    v_mfma_f32_16x16x32_bf16 v[24:27], v[164:167], v[144:147], v[24:27]
    ds_read_b128 v[212:215], v232 offset:44032
    v_mfma_f32_16x16x32_bf16 v[28:31], v[164:167], v[148:151], v[28:31]
    ds_read_b128 v[216:219], v232 offset:46080
    v_mfma_f32_16x16x32_bf16 v[32:35], v[168:171], v[144:147], v[32:35]
    ds_read_b128 v[220:223], v232 offset:48128
    v_mfma_f32_16x16x32_bf16 v[36:39], v[168:171], v[148:151], v[36:39]
    ds_read_b128 v[224:227], v232 offset:50176
    v_mfma_f32_16x16x32_bf16 v[40:43], v[172:175], v[144:147], v[40:43]
    ds_read_b128 v[228:231], v232 offset:52224
    v_mfma_f32_16x16x32_bf16 v[44:47], v[172:175], v[148:151], v[44:47]
    v_mfma_f32_16x16x32_bf16 v[48:51], v[176:179], v[144:147], v[48:51]
    v_mfma_f32_16x16x32_bf16 v[52:55], v[176:179], v[148:151], v[52:55]
    v_mfma_f32_16x16x32_bf16 v[56:59], v[180:183], v[144:147], v[56:59]
    v_mfma_f32_16x16x32_bf16 v[60:63], v[180:183], v[148:151], v[60:63]
    v_mfma_f32_16x16x32_bf16 v[64:67], v[184:187], v[144:147], v[64:67]
    v_mfma_f32_16x16x32_bf16 v[68:71], v[184:187], v[148:151], v[68:71]
    s_waitcnt lgkmcnt(0)
    s_barrier
    v_mfma_f32_16x16x32_bf16 v[0:3], v[196:199], v[188:191], v[0:3]
    v_mfma_f32_16x16x32_bf16 v[4:7], v[196:199], v[192:195], v[4:7]
    v_mfma_f32_16x16x32_bf16 v[8:11], v[200:203], v[188:191], v[8:11]
    v_mfma_f32_16x16x32_bf16 v[12:15], v[200:203], v[192:195], v[12:15]
    v_mfma_f32_16x16x32_bf16 v[16:19], v[204:207], v[188:191], v[16:19]
    v_mfma_f32_16x16x32_bf16 v[20:23], v[204:207], v[192:195], v[20:23]
    v_mfma_f32_16x16x32_bf16 v[24:27], v[208:211], v[188:191], v[24:27]
    v_mfma_f32_16x16x32_bf16 v[28:31], v[208:211], v[192:195], v[28:31]
    v_mfma_f32_16x16x32_bf16 v[32:35], v[212:215], v[188:191], v[32:35]
    v_mfma_f32_16x16x32_bf16 v[36:39], v[212:215], v[192:195], v[36:39]
    v_mfma_f32_16x16x32_bf16 v[40:43], v[216:219], v[188:191], v[40:43]
    v_mfma_f32_16x16x32_bf16 v[44:47], v[216:219], v[192:195], v[44:47]
    v_mfma_f32_16x16x32_bf16 v[48:51], v[220:223], v[188:191], v[48:51]
    v_mfma_f32_16x16x32_bf16 v[52:55], v[220:223], v[192:195], v[52:55]
    v_mfma_f32_16x16x32_bf16 v[56:59], v[224:227], v[188:191], v[56:59]
    v_mfma_f32_16x16x32_bf16 v[60:63], v[224:227], v[192:195], v[60:63]
    v_mfma_f32_16x16x32_bf16 v[64:67], v[228:231], v[188:191], v[64:67]
    v_mfma_f32_16x16x32_bf16 v[68:71], v[228:231], v[192:195], v[68:71]
    s_add_u32 s12, s4, 18874368
    s_addc_u32 s13, s5, 0
    s_mov_b32 s14, 9437184
    s_mov_b32 s15, 0x20000
    s_mov_b32 s62, 0
    s_mov_b32 exec_lo, 0x1f1f1f1f
    s_mov_b32 exec_hi, 0x0
parallel_sum__ssm_conv_s4__mixer_gmlp__prompt_kernel_wf12:
    s_waitcnt vmcnt(0)
    v_cmp_ne_u32 vcc, s23, v238
    s_cbranch_vccz parallel_sum__ssm_conv_s4__mixer_gmlp__prompt_kernel_wfd13
    s_add_u32 s62, s62, 1
    s_cmp_ge_u32 s62, 16384
    s_cbranch_scc1 parallel_sum__ssm_conv_s4__mixer_gmlp__prompt_kernel_wfd13
    buffer_load_dword v238, v237, s[16:19], 0 offen sc1
    s_branch parallel_sum__ssm_conv_s4__mixer_gmlp__prompt_kernel_wf12
parallel_sum__ssm_conv_s4__mixer_gmlp__prompt_kernel_wfd13:
    s_mov_b64 exec, -1
    s_setprio 3
    v_lshlrev_b32 v232, 16, v253
    v_lshlrev_b32 v234, 16, v251
    v_mov_b32 v233, v232
    v_mov_b32 v235, v234
    v_pk_add_f32 v[0:1], v[0:1], v[232:233]
    v_lshlrev_b32 v236, 16, v72
    v_and_b32 v237, 0xffff0000, v72
    v_pk_mul_f32 v[0:1], v[0:1], v[236:237]
    v_cvt_pk_bf16_f32 v144, v0, v1
    v_pk_add_f32 v[2:3], v[2:3], v[232:233]
    v_lshlrev_b32 v238, 16, v74
    v_and_b32 v239, 0xffff0000, v74
    v_pk_mul_f32 v[2:3], v[2:3], v[238:239]
    v_cvt_pk_bf16_f32 v145, v2, v3
    v_pk_add_f32 v[8:9], v[8:9], v[232:233]
    v_lshlrev_b32 v240, 16, v80
    v_and_b32 v241, 0xffff0000, v80
    v_pk_mul_f32 v[8:9], v[8:9], v[240:241]
    v_cvt_pk_bf16_f32 v146, v8, v9
    v_pk_add_f32 v[10:11], v[10:11], v[232:233]
    v_lshlrev_b32 v236, 16, v82
    v_and_b32 v237, 0xffff0000, v82
    v_pk_mul_f32 v[10:11], v[10:11], v[236:237]
    v_cvt_pk_bf16_f32 v147, v10, v11
    buffer_store_dwordx4 v[144:147], v242, s[12:15], s31 offen offset:0 sc1
    v_pk_add_f32 v[16:17], v[16:17], v[232:233]
    v_lshlrev_b32 v236, 16, v88
    v_and_b32 v237, 0xffff0000, v88
    v_pk_mul_f32 v[16:17], v[16:17], v[236:237]
    v_cvt_pk_bf16_f32 v148, v16, v17
    v_pk_add_f32 v[18:19], v[18:19], v[232:233]
    v_lshlrev_b32 v238, 16, v90
    v_and_b32 v239, 0xffff0000, v90
    v_pk_mul_f32 v[18:19], v[18:19], v[238:239]
    v_cvt_pk_bf16_f32 v149, v18, v19
    v_pk_add_f32 v[24:25], v[24:25], v[232:233]
    v_lshlrev_b32 v240, 16, v96
    v_and_b32 v241, 0xffff0000, v96
    v_pk_mul_f32 v[24:25], v[24:25], v[240:241]
    v_cvt_pk_bf16_f32 v150, v24, v25
    v_pk_add_f32 v[26:27], v[26:27], v[232:233]
    v_lshlrev_b32 v236, 16, v98
    v_and_b32 v237, 0xffff0000, v98
    v_pk_mul_f32 v[26:27], v[26:27], v[236:237]
    v_cvt_pk_bf16_f32 v151, v26, v27
    buffer_store_dwordx4 v[148:151], v242, s[12:15], s31 offen offset:1024 sc1
    v_pk_add_f32 v[32:33], v[32:33], v[232:233]
    v_lshlrev_b32 v236, 16, v104
    v_and_b32 v237, 0xffff0000, v104
    v_pk_mul_f32 v[32:33], v[32:33], v[236:237]
    v_cvt_pk_bf16_f32 v144, v32, v33
    v_pk_add_f32 v[34:35], v[34:35], v[232:233]
    v_lshlrev_b32 v238, 16, v106
    v_and_b32 v239, 0xffff0000, v106
    v_pk_mul_f32 v[34:35], v[34:35], v[238:239]
    v_cvt_pk_bf16_f32 v145, v34, v35
    v_pk_add_f32 v[40:41], v[40:41], v[232:233]
    v_lshlrev_b32 v240, 16, v112
    v_and_b32 v241, 0xffff0000, v112
    v_pk_mul_f32 v[40:41], v[40:41], v[240:241]
    v_cvt_pk_bf16_f32 v146, v40, v41
    v_pk_add_f32 v[42:43], v[42:43], v[232:233]
    v_lshlrev_b32 v236, 16, v114
    v_and_b32 v237, 0xffff0000, v114
    v_pk_mul_f32 v[42:43], v[42:43], v[236:237]
    v_cvt_pk_bf16_f32 v147, v42, v43
    buffer_store_dwordx4 v[144:147], v242, s[12:15], s31 offen offset:2048 sc1
    v_pk_add_f32 v[48:49], v[48:49], v[232:233]
    v_lshlrev_b32 v236, 16, v120
    v_and_b32 v237, 0xffff0000, v120
    v_pk_mul_f32 v[48:49], v[48:49], v[236:237]
    v_cvt_pk_bf16_f32 v148, v48, v49
    v_pk_add_f32 v[50:51], v[50:51], v[232:233]
    v_lshlrev_b32 v238, 16, v122
    v_and_b32 v239, 0xffff0000, v122
    v_pk_mul_f32 v[50:51], v[50:51], v[238:239]
    v_cvt_pk_bf16_f32 v149, v50, v51
    v_pk_add_f32 v[56:57], v[56:57], v[232:233]
    v_lshlrev_b32 v240, 16, v128
    v_and_b32 v241, 0xffff0000, v128
    v_pk_mul_f32 v[56:57], v[56:57], v[240:241]
    v_cvt_pk_bf16_f32 v150, v56, v57
    v_pk_add_f32 v[58:59], v[58:59], v[232:233]
    v_lshlrev_b32 v236, 16, v130
    v_and_b32 v237, 0xffff0000, v130
    v_pk_mul_f32 v[58:59], v[58:59], v[236:237]
    v_cvt_pk_bf16_f32 v151, v58, v59
    buffer_store_dwordx4 v[148:151], v242, s[12:15], s31 offen offset:3072 sc1
    v_pk_add_f32 v[64:65], v[64:65], v[232:233]
    v_lshlrev_b32 v236, 16, v136
    v_and_b32 v237, 0xffff0000, v136
    v_pk_mul_f32 v[64:65], v[64:65], v[236:237]
    v_cvt_pk_bf16_f32 v144, v64, v65
    v_pk_add_f32 v[66:67], v[66:67], v[232:233]
    v_lshlrev_b32 v238, 16, v138
    v_and_b32 v239, 0xffff0000, v138
    v_pk_mul_f32 v[66:67], v[66:67], v[238:239]
    v_cvt_pk_bf16_f32 v145, v66, v67
    s_add_u32 s33, s31, 4096
    buffer_store_dwordx2 v[144:145], v243, s[12:15], s33 offen sc1
    v_pk_add_f32 v[4:5], v[4:5], v[234:235]
    v_lshlrev_b32 v236, 16, v76
    v_and_b32 v237, 0xffff0000, v76
    v_pk_mul_f32 v[4:5], v[4:5], v[236:237]
    v_cvt_pk_bf16_f32 v148, v4, v5
    v_pk_add_f32 v[6:7], v[6:7], v[234:235]
    v_lshlrev_b32 v238, 16, v78
    v_and_b32 v239, 0xffff0000, v78
    v_pk_mul_f32 v[6:7], v[6:7], v[238:239]
    v_cvt_pk_bf16_f32 v149, v6, v7
    v_pk_add_f32 v[12:13], v[12:13], v[234:235]
    v_lshlrev_b32 v240, 16, v84
    v_and_b32 v241, 0xffff0000, v84
    v_pk_mul_f32 v[12:13], v[12:13], v[240:241]
    v_cvt_pk_bf16_f32 v150, v12, v13
    v_pk_add_f32 v[14:15], v[14:15], v[234:235]
    v_lshlrev_b32 v236, 16, v86
    v_and_b32 v237, 0xffff0000, v86
    v_pk_mul_f32 v[14:15], v[14:15], v[236:237]
    v_cvt_pk_bf16_f32 v151, v14, v15
    buffer_store_dwordx4 v[148:151], v242, s[12:15], s32 offen offset:0 sc1
    v_pk_add_f32 v[20:21], v[20:21], v[234:235]
    v_lshlrev_b32 v236, 16, v92
    v_and_b32 v237, 0xffff0000, v92
    v_pk_mul_f32 v[20:21], v[20:21], v[236:237]
    v_cvt_pk_bf16_f32 v144, v20, v21
    v_pk_add_f32 v[22:23], v[22:23], v[234:235]
    v_lshlrev_b32 v238, 16, v94
    v_and_b32 v239, 0xffff0000, v94
    v_pk_mul_f32 v[22:23], v[22:23], v[238:239]
    v_cvt_pk_bf16_f32 v145, v22, v23
    v_pk_add_f32 v[28:29], v[28:29], v[234:235]
    v_lshlrev_b32 v240, 16, v100
    v_and_b32 v241, 0xffff0000, v100
    v_pk_mul_f32 v[28:29], v[28:29], v[240:241]
    v_cvt_pk_bf16_f32 v146, v28, v29
    v_pk_add_f32 v[30:31], v[30:31], v[234:235]
    v_lshlrev_b32 v236, 16, v102
    v_and_b32 v237, 0xffff0000, v102
    v_pk_mul_f32 v[30:31], v[30:31], v[236:237]
    v_cvt_pk_bf16_f32 v147, v30, v31
    buffer_store_dwordx4 v[144:147], v242, s[12:15], s32 offen offset:1024 sc1
    v_pk_add_f32 v[36:37], v[36:37], v[234:235]
    v_lshlrev_b32 v236, 16, v108
    v_and_b32 v237, 0xffff0000, v108
    v_pk_mul_f32 v[36:37], v[36:37], v[236:237]
    v_cvt_pk_bf16_f32 v148, v36, v37
    v_pk_add_f32 v[38:39], v[38:39], v[234:235]
    v_lshlrev_b32 v238, 16, v110
    v_and_b32 v239, 0xffff0000, v110
    v_pk_mul_f32 v[38:39], v[38:39], v[238:239]
    v_cvt_pk_bf16_f32 v149, v38, v39
    v_pk_add_f32 v[44:45], v[44:45], v[234:235]
    v_lshlrev_b32 v240, 16, v116
    v_and_b32 v241, 0xffff0000, v116
    v_pk_mul_f32 v[44:45], v[44:45], v[240:241]
    v_cvt_pk_bf16_f32 v150, v44, v45
    v_pk_add_f32 v[46:47], v[46:47], v[234:235]
    v_lshlrev_b32 v236, 16, v118
    v_and_b32 v237, 0xffff0000, v118
    v_pk_mul_f32 v[46:47], v[46:47], v[236:237]
    v_cvt_pk_bf16_f32 v151, v46, v47
    buffer_store_dwordx4 v[148:151], v242, s[12:15], s32 offen offset:2048 sc1
    v_pk_add_f32 v[52:53], v[52:53], v[234:235]
    v_lshlrev_b32 v236, 16, v124
    v_and_b32 v237, 0xffff0000, v124
    v_pk_mul_f32 v[52:53], v[52:53], v[236:237]
    v_cvt_pk_bf16_f32 v144, v52, v53
    v_pk_add_f32 v[54:55], v[54:55], v[234:235]
    v_lshlrev_b32 v238, 16, v126
    v_and_b32 v239, 0xffff0000, v126
    v_pk_mul_f32 v[54:55], v[54:55], v[238:239]
    v_cvt_pk_bf16_f32 v145, v54, v55
    v_pk_add_f32 v[60:61], v[60:61], v[234:235]
    v_lshlrev_b32 v240, 16, v132
    v_and_b32 v241, 0xffff0000, v132
    v_pk_mul_f32 v[60:61], v[60:61], v[240:241]
    v_cvt_pk_bf16_f32 v146, v60, v61
    v_pk_add_f32 v[62:63], v[62:63], v[234:235]
    v_lshlrev_b32 v236, 16, v134
    v_and_b32 v237, 0xffff0000, v134
    v_pk_mul_f32 v[62:63], v[62:63], v[236:237]
    v_cvt_pk_bf16_f32 v147, v62, v63
    buffer_store_dwordx4 v[144:147], v242, s[12:15], s32 offen offset:3072 sc1
    v_pk_add_f32 v[68:69], v[68:69], v[234:235]
    v_lshlrev_b32 v236, 16, v140
    v_and_b32 v237, 0xffff0000, v140
    v_pk_mul_f32 v[68:69], v[68:69], v[236:237]
    v_cvt_pk_bf16_f32 v148, v68, v69
    v_pk_add_f32 v[70:71], v[70:71], v[234:235]
    v_lshlrev_b32 v238, 16, v142
    v_and_b32 v239, 0xffff0000, v142
    v_pk_mul_f32 v[70:71], v[70:71], v[238:239]
    v_cvt_pk_bf16_f32 v149, v70, v71
    s_add_u32 s33, s32, 4096
    buffer_store_dwordx2 v[148:149], v243, s[12:15], s33 offen sc1
    v_mov_b32 v0, 0
    v_mov_b32 v1, s23
    s_waitcnt vmcnt(0)
    s_mov_b64 exec, 1
    buffer_store_dword v1, v0, s[16:19], s28 offen sc1
    s_mov_b64 exec, -1
    s_setprio 1
    s_add_u32 s55, s54, 0
    buffer_load_dwordx4 v[152:155], v242, s[24:27], s55 offen offset:0 sc1
    buffer_load_dwordx4 v[156:159], v242, s[24:27], s55 offen offset:1024 sc1
    buffer_load_dwordx4 v[160:163], v242, s[24:27], s55 offen offset:2048 sc1
    buffer_load_dwordx4 v[164:167], v242, s[24:27], s55 offen offset:3072 sc1
    s_add_u32 s55, s55, 4096
    buffer_load_dwordx4 v[168:171], v244, s[24:27], s55 offen sc1
    s_add_u32 s55, s54, 4608
    buffer_load_dwordx4 v[172:175], v242, s[24:27], s55 offen offset:0 sc1
    buffer_load_dwordx4 v[176:179], v242, s[24:27], s55 offen offset:1024 sc1
    buffer_load_dwordx4 v[180:183], v242, s[24:27], s55 offen offset:2048 sc1
    buffer_load_dwordx4 v[184:187], v242, s[24:27], s55 offen offset:3072 sc1
    s_add_u32 s55, s55, 4096
    buffer_load_dwordx4 v[188:191], v244, s[24:27], s55 offen sc1
    s_add_u32 s55, s54, 9216
    buffer_load_dwordx4 v[192:195], v242, s[24:27], s55 offen offset:0 sc1
    buffer_load_dwordx4 v[196:199], v242, s[24:27], s55 offen offset:1024 sc1
    buffer_load_dwordx4 v[200:203], v242, s[24:27], s55 offen offset:2048 sc1
    buffer_load_dwordx4 v[204:207], v242, s[24:27], s55 offen offset:3072 sc1
    s_add_u32 s55, s55, 4096
    buffer_load_dwordx4 v[208:211], v244, s[24:27], s55 offen sc1
    s_add_u32 s55, s54, 13824
    buffer_load_dwordx4 v[212:215], v242, s[24:27], s55 offen offset:0 sc1
    buffer_load_dwordx4 v[216:219], v242, s[24:27], s55 offen offset:1024 sc1
    buffer_load_dwordx4 v[220:223], v242, s[24:27], s55 offen offset:2048 sc1
    buffer_load_dwordx4 v[224:227], v242, s[24:27], s55 offen offset:3072 sc1
    s_add_u32 s55, s55, 4096
    buffer_load_dwordx4 v[228:231], v244, s[24:27], s55 offen sc1
    s_add_u32 s55, s54, 18432
    buffer_load_dwordx2 v[232:233], v243, s[24:27], s55 offen offset:0 sc1
    buffer_load_dwordx2 v[234:235], v243, s[24:27], s55 offen offset:512 sc1
    buffer_load_dwordx2 v[236:237], v243, s[24:27], s55 offen offset:1024 sc1
    buffer_load_dwordx2 v[238:239], v243, s[24:27], s55 offen offset:1536 sc1
    buffer_load_dwordx2 v[240:241], v245, s[24:27], s55 offen offset:2048 sc1
    s_mul_i32 s56, s22, 21504
    s_cmp_eq_u32 s22, 3
    s_cselect_b32 s56, 139264, s56
    s_mov_b64 exec, -1
    s_mov_b64 exec, -1
    v_add_u32 v246, s56, v242
    v_add_u32 v247, s56, v243
    v_and_b32 v248, 0x1ff, v244
    v_add_u32 v248, s56, v248
    v_and_b32 v249, 0xff, v245
    v_add_u32 v249, s56, v249
    s_mov_b32 s59, 0xff
    s_mov_b32 s62, 0
parallel_sum__ssm_conv_s4__mixer_gmlp__prompt_kernel_hc14:
    s_and_b32 s33, s59, 3
    s_cbranch_scc0 parallel_sum__ssm_conv_s4__mixer_gmlp__prompt_kernel_hd15
    s_add_u32 s62, s62, 1
    s_cmp_ge_u32 s62, 16384
    s_cbranch_scc1 parallel_sum__ssm_conv_s4__mixer_gmlp__prompt_kernel_hd15
    s_mov_b32 exec_lo, 0xff
    s_mov_b32 exec_hi, 0x0
    buffer_load_dword v251, v250, s[16:19], 0 offen sc1
    s_waitcnt vmcnt(0)
    v_cmp_ne_u32 vcc, s23, v251
    s_mov_b64 exec, -1
    s_mov_b32 s59, vcc_lo
    s_branch parallel_sum__ssm_conv_s4__mixer_gmlp__prompt_kernel_hc14
parallel_sum__ssm_conv_s4__mixer_gmlp__prompt_kernel_hd15:
    buffer_load_dwordx4 v[80:83], v242, s[12:15], s50 offen offset:0 sc1
    buffer_load_dwordx4 v[84:87], v242, s[12:15], s51 offen offset:0 sc1
    buffer_load_dwordx4 v[88:91], v242, s[12:15], s52 offen offset:0 sc1
    buffer_load_dwordx4 v[92:95], v242, s[12:15], s63 offen offset:0 sc1
    buffer_load_dwordx4 v[96:99], v242, s[12:15], s50 offen offset:1024 sc1
    buffer_load_dwordx4 v[100:103], v242, s[12:15], s51 offen offset:1024 sc1
    buffer_load_dwordx4 v[104:107], v242, s[12:15], s52 offen offset:1024 sc1
    buffer_load_dwordx4 v[108:111], v242, s[12:15], s63 offen offset:1024 sc1
    buffer_load_dwordx4 v[112:115], v242, s[12:15], s50 offen offset:2048 sc1
    buffer_load_dwordx4 v[116:119], v242, s[12:15], s51 offen offset:2048 sc1
    buffer_load_dwordx4 v[120:123], v242, s[12:15], s52 offen offset:2048 sc1
    buffer_load_dwordx4 v[124:127], v242, s[12:15], s63 offen offset:2048 sc1
    buffer_load_dwordx4 v[128:131], v242, s[12:15], s50 offen offset:3072 sc1
    buffer_load_dwordx4 v[132:135], v242, s[12:15], s51 offen offset:3072 sc1
    buffer_load_dwordx4 v[136:139], v242, s[12:15], s52 offen offset:3072 sc1
    buffer_load_dwordx4 v[140:143], v242, s[12:15], s63 offen offset:3072 sc1
    s_add_u32 s55, s50, 4096
    buffer_load_dwordx2 v[144:145], v243, s[12:15], s55 offen sc1
    s_add_u32 s55, s51, 4096
    buffer_load_dwordx2 v[146:147], v243, s[12:15], s55 offen sc1
    s_add_u32 s55, s52, 4096
    buffer_load_dwordx2 v[148:149], v243, s[12:15], s55 offen sc1
    s_add_u32 s55, s63, 4096
    buffer_load_dwordx2 v[150:151], v243, s[12:15], s55 offen sc1
    s_add_u32 s29, s29, 4
    s_and_b32 s29, s29, 15
    s_mul_i32 s50, s29, 4608
    s_add_u32 s50, s50, s57
    s_add_u32 s51, s50, 73728
    s_add_u32 s52, s50, 147456
    s_add_u32 s63, s50, 221184
    s_mul_i32 s54, s29, 20736
    s_add_u32 s54, s54, s58
parallel_sum__ssm_conv_s4__mixer_gmlp__prompt_kernel_hc16:
    s_and_b32 s33, s59, 12
    s_cbranch_scc0 parallel_sum__ssm_conv_s4__mixer_gmlp__prompt_kernel_hd17
    s_add_u32 s62, s62, 1
    s_cmp_ge_u32 s62, 16384
    s_cbranch_scc1 parallel_sum__ssm_conv_s4__mixer_gmlp__prompt_kernel_hd17
    s_mov_b32 exec_lo, 0xff
    s_mov_b32 exec_hi, 0x0
    buffer_load_dword v251, v250, s[16:19], 0 offen sc1
    s_waitcnt vmcnt(0)
    v_cmp_ne_u32 vcc, s23, v251
    s_mov_b64 exec, -1
    s_mov_b32 s59, vcc_lo
    s_branch parallel_sum__ssm_conv_s4__mixer_gmlp__prompt_kernel_hc16
parallel_sum__ssm_conv_s4__mixer_gmlp__prompt_kernel_hd17:
    s_add_u32 s49, s29, 4
    s_and_b32 s49, s49, 15
    s_mul_i32 s49, s49, 20736
    s_add_u32 s49, s49, s58
    s_waitcnt vmcnt(16)
    v_mfma_f32_16x16x32_bf16 v[0:3], v[152:155], v[80:83], 0
    v_mfma_f32_16x16x32_bf16 v[4:7], v[152:155], v[84:87], 0
    v_mfma_f32_16x16x32_bf16 v[8:11], v[152:155], v[88:91], 0
    v_mfma_f32_16x16x32_bf16 v[12:15], v[152:155], v[92:95], 0
    v_mfma_f32_16x16x32_bf16 v[16:19], v[156:159], v[80:83], 0
    v_mfma_f32_16x16x32_bf16 v[20:23], v[156:159], v[84:87], 0
    v_mfma_f32_16x16x32_bf16 v[24:27], v[156:159], v[88:91], 0
    v_mfma_f32_16x16x32_bf16 v[28:31], v[156:159], v[92:95], 0
    v_mfma_f32_16x16x32_bf16 v[32:35], v[160:163], v[80:83], 0
    v_mfma_f32_16x16x32_bf16 v[36:39], v[160:163], v[84:87], 0
    v_mfma_f32_16x16x32_bf16 v[40:43], v[160:163], v[88:91], 0
    v_mfma_f32_16x16x32_bf16 v[44:47], v[160:163], v[92:95], 0
    v_mfma_f32_16x16x32_bf16 v[48:51], v[164:167], v[80:83], 0
    v_mfma_f32_16x16x32_bf16 v[52:55], v[164:167], v[84:87], 0
    v_mfma_f32_16x16x32_bf16 v[56:59], v[164:167], v[88:91], 0
    v_mfma_f32_16x16x32_bf16 v[60:63], v[164:167], v[92:95], 0
    v_mfma_f32_16x16x32_bf16 v[64:67], v[168:171], v[80:83], 0
    v_mfma_f32_16x16x32_bf16 v[68:71], v[168:171], v[84:87], 0
    v_mfma_f32_16x16x32_bf16 v[72:75], v[168:171], v[88:91], 0
    v_mfma_f32_16x16x32_bf16 v[76:79], v[168:171], v[92:95], 0
    buffer_load_dwordx4 v[80:83], v242, s[12:15], s50 offen offset:0 sc1
    buffer_load_dwordx4 v[84:87], v242, s[12:15], s51 offen offset:0 sc1
    buffer_load_dwordx4 v[88:91], v242, s[12:15], s52 offen offset:0 sc1
    buffer_load_dwordx4 v[92:95], v242, s[12:15], s63 offen offset:0 sc1
    ds_read_b128 v[152:155], v246 offset:0
    ds_read_b128 v[156:159], v246 offset:1024
    ds_read_b128 v[160:163], v246 offset:2048
    ds_read_b128 v[164:167], v246 offset:3072
    ds_read_b128 v[168:171], v248 offset:4096
    s_waitcnt vmcnt(16)
    v_mfma_f32_16x16x32_bf16 v[0:3], v[172:175], v[96:99], v[0:3]
    v_mfma_f32_16x16x32_bf16 v[4:7], v[172:175], v[100:103], v[4:7]
    v_mfma_f32_16x16x32_bf16 v[8:11], v[172:175], v[104:107], v[8:11]
    v_mfma_f32_16x16x32_bf16 v[12:15], v[172:175], v[108:111], v[12:15]
    v_mfma_f32_16x16x32_bf16 v[16:19], v[176:179], v[96:99], v[16:19]
    v_mfma_f32_16x16x32_bf16 v[20:23], v[176:179], v[100:103], v[20:23]
    v_mfma_f32_16x16x32_bf16 v[24:27], v[176:179], v[104:107], v[24:27]
    v_mfma_f32_16x16x32_bf16 v[28:31], v[176:179], v[108:111], v[28:31]
    v_mfma_f32_16x16x32_bf16 v[32:35], v[180:183], v[96:99], v[32:35]
    v_mfma_f32_16x16x32_bf16 v[36:39], v[180:183], v[100:103], v[36:39]
    v_mfma_f32_16x16x32_bf16 v[40:43], v[180:183], v[104:107], v[40:43]
    v_mfma_f32_16x16x32_bf16 v[44:47], v[180:183], v[108:111], v[44:47]
    v_mfma_f32_16x16x32_bf16 v[48:51], v[184:187], v[96:99], v[48:51]
    v_mfma_f32_16x16x32_bf16 v[52:55], v[184:187], v[100:103], v[52:55]
    v_mfma_f32_16x16x32_bf16 v[56:59], v[184:187], v[104:107], v[56:59]
    v_mfma_f32_16x16x32_bf16 v[60:63], v[184:187], v[108:111], v[60:63]
    v_mfma_f32_16x16x32_bf16 v[64:67], v[188:191], v[96:99], v[64:67]
    v_mfma_f32_16x16x32_bf16 v[68:71], v[188:191], v[100:103], v[68:71]
    v_mfma_f32_16x16x32_bf16 v[72:75], v[188:191], v[104:107], v[72:75]
    v_mfma_f32_16x16x32_bf16 v[76:79], v[188:191], v[108:111], v[76:79]
    buffer_load_dwordx4 v[96:99], v242, s[12:15], s50 offen offset:1024 sc1
    buffer_load_dwordx4 v[100:103], v242, s[12:15], s51 offen offset:1024 sc1
    buffer_load_dwordx4 v[104:107], v242, s[12:15], s52 offen offset:1024 sc1
    buffer_load_dwordx4 v[108:111], v242, s[12:15], s63 offen offset:1024 sc1
    ds_read_b128 v[172:175], v246 offset:4608
    ds_read_b128 v[176:179], v246 offset:5632
    ds_read_b128 v[180:183], v246 offset:6656
    ds_read_b128 v[184:187], v246 offset:7680
    ds_read_b128 v[188:191], v248 offset:8704
    s_waitcnt lgkmcnt(5)
    s_add_u32 s55, s49, 0
    s_add_u32 m0, s56, 0
    s_nop 0
    buffer_load_dwordx4 v242, s[24:27], s55 offen offset:0 sc1 lds
    buffer_load_dwordx4 v242, s[24:27], s55 offen offset:1024 sc1 lds
    buffer_load_dwordx4 v242, s[24:27], s55 offen offset:2048 sc1 lds
    buffer_load_dwordx4 v242, s[24:27], s55 offen offset:3072 sc1 lds
    s_add_u32 s55, s55, 4096
    s_add_u32 m0, m0, 4096
    s_mov_b32 exec_lo, 0xffffffff
    s_mov_b32 exec_hi, 0x0
    buffer_load_dwordx4 v242, s[24:27], s55 offen offset:0 sc1 lds
    s_mov_b64 exec, -1
    s_waitcnt vmcnt(21)
    v_mfma_f32_16x16x32_bf16 v[0:3], v[192:195], v[112:115], v[0:3]
    v_mfma_f32_16x16x32_bf16 v[4:7], v[192:195], v[116:119], v[4:7]
    v_mfma_f32_16x16x32_bf16 v[8:11], v[192:195], v[120:123], v[8:11]
    v_mfma_f32_16x16x32_bf16 v[12:15], v[192:195], v[124:127], v[12:15]
    v_mfma_f32_16x16x32_bf16 v[16:19], v[196:199], v[112:115], v[16:19]
    v_mfma_f32_16x16x32_bf16 v[20:23], v[196:199], v[116:119], v[20:23]
    v_mfma_f32_16x16x32_bf16 v[24:27], v[196:199], v[120:123], v[24:27]
    v_mfma_f32_16x16x32_bf16 v[28:31], v[196:199], v[124:127], v[28:31]
    v_mfma_f32_16x16x32_bf16 v[32:35], v[200:203], v[112:115], v[32:35]
    v_mfma_f32_16x16x32_bf16 v[36:39], v[200:203], v[116:119], v[36:39]
    v_mfma_f32_16x16x32_bf16 v[40:43], v[200:203], v[120:123], v[40:43]
    v_mfma_f32_16x16x32_bf16 v[44:47], v[200:203], v[124:127], v[44:47]
    v_mfma_f32_16x16x32_bf16 v[48:51], v[204:207], v[112:115], v[48:51]
    v_mfma_f32_16x16x32_bf16 v[52:55], v[204:207], v[116:119], v[52:55]
    v_mfma_f32_16x16x32_bf16 v[56:59], v[204:207], v[120:123], v[56:59]
    v_mfma_f32_16x16x32_bf16 v[60:63], v[204:207], v[124:127], v[60:63]
    v_mfma_f32_16x16x32_bf16 v[64:67], v[208:211], v[112:115], v[64:67]
    v_mfma_f32_16x16x32_bf16 v[68:71], v[208:211], v[116:119], v[68:71]
    v_mfma_f32_16x16x32_bf16 v[72:75], v[208:211], v[120:123], v[72:75]
    v_mfma_f32_16x16x32_bf16 v[76:79], v[208:211], v[124:127], v[76:79]
    buffer_load_dwordx4 v[112:115], v242, s[12:15], s50 offen offset:2048 sc1
    buffer_load_dwordx4 v[116:119], v242, s[12:15], s51 offen offset:2048 sc1
    buffer_load_dwordx4 v[120:123], v242, s[12:15], s52 offen offset:2048 sc1
    buffer_load_dwordx4 v[124:127], v242, s[12:15], s63 offen offset:2048 sc1
    ds_read_b128 v[192:195], v246 offset:9216
    ds_read_b128 v[196:199], v246 offset:10240
    ds_read_b128 v[200:203], v246 offset:11264
    ds_read_b128 v[204:207], v246 offset:12288
    ds_read_b128 v[208:211], v248 offset:13312
    s_waitcnt lgkmcnt(5)
    s_add_u32 s55, s49, 4608
    s_add_u32 m0, s56, 4608
    s_nop 0
    buffer_load_dwordx4 v242, s[24:27], s55 offen offset:0 sc1 lds
    buffer_load_dwordx4 v242, s[24:27], s55 offen offset:1024 sc1 lds
    buffer_load_dwordx4 v242, s[24:27], s55 offen offset:2048 sc1 lds
    buffer_load_dwordx4 v242, s[24:27], s55 offen offset:3072 sc1 lds
    s_add_u32 s55, s55, 4096
    s_add_u32 m0, m0, 4096
    s_mov_b32 exec_lo, 0xffffffff
    s_mov_b32 exec_hi, 0x0
    buffer_load_dwordx4 v242, s[24:27], s55 offen offset:0 sc1 lds
    s_mov_b64 exec, -1
    s_waitcnt vmcnt(26)
    v_mfma_f32_16x16x32_bf16 v[0:3], v[212:215], v[128:131], v[0:3]
    v_mfma_f32_16x16x32_bf16 v[4:7], v[212:215], v[132:135], v[4:7]
    v_mfma_f32_16x16x32_bf16 v[8:11], v[212:215], v[136:139], v[8:11]
    v_mfma_f32_16x16x32_bf16 v[12:15], v[212:215], v[140:143], v[12:15]
    v_mfma_f32_16x16x32_bf16 v[16:19], v[216:219], v[128:131], v[16:19]
    v_mfma_f32_16x16x32_bf16 v[20:23], v[216:219], v[132:135], v[20:23]
    v_mfma_f32_16x16x32_bf16 v[24:27], v[216:219], v[136:139], v[24:27]
    v_mfma_f32_16x16x32_bf16 v[28:31], v[216:219], v[140:143], v[28:31]
    v_mfma_f32_16x16x32_bf16 v[32:35], v[220:223], v[128:131], v[32:35]
    v_mfma_f32_16x16x32_bf16 v[36:39], v[220:223], v[132:135], v[36:39]
    v_mfma_f32_16x16x32_bf16 v[40:43], v[220:223], v[136:139], v[40:43]
    v_mfma_f32_16x16x32_bf16 v[44:47], v[220:223], v[140:143], v[44:47]
    v_mfma_f32_16x16x32_bf16 v[48:51], v[224:227], v[128:131], v[48:51]
    v_mfma_f32_16x16x32_bf16 v[52:55], v[224:227], v[132:135], v[52:55]
    v_mfma_f32_16x16x32_bf16 v[56:59], v[224:227], v[136:139], v[56:59]
    v_mfma_f32_16x16x32_bf16 v[60:63], v[224:227], v[140:143], v[60:63]
    v_mfma_f32_16x16x32_bf16 v[64:67], v[228:231], v[128:131], v[64:67]
    v_mfma_f32_16x16x32_bf16 v[68:71], v[228:231], v[132:135], v[68:71]
    v_mfma_f32_16x16x32_bf16 v[72:75], v[228:231], v[136:139], v[72:75]
    v_mfma_f32_16x16x32_bf16 v[76:79], v[228:231], v[140:143], v[76:79]
    buffer_load_dwordx4 v[128:131], v242, s[12:15], s50 offen offset:3072 sc1
    buffer_load_dwordx4 v[132:135], v242, s[12:15], s51 offen offset:3072 sc1
    buffer_load_dwordx4 v[136:139], v242, s[12:15], s52 offen offset:3072 sc1
    buffer_load_dwordx4 v[140:143], v242, s[12:15], s63 offen offset:3072 sc1
    ds_read_b128 v[212:215], v246 offset:13824
    ds_read_b128 v[216:219], v246 offset:14848
    ds_read_b128 v[220:223], v246 offset:15872
    ds_read_b128 v[224:227], v246 offset:16896
    ds_read_b128 v[228:231], v248 offset:17920
    s_waitcnt lgkmcnt(5)
    s_add_u32 s55, s49, 9216
    s_add_u32 m0, s56, 9216
    s_nop 0
    buffer_load_dwordx4 v242, s[24:27], s55 offen offset:0 sc1 lds
    buffer_load_dwordx4 v242, s[24:27], s55 offen offset:1024 sc1 lds
    buffer_load_dwordx4 v242, s[24:27], s55 offen offset:2048 sc1 lds
    buffer_load_dwordx4 v242, s[24:27], s55 offen offset:3072 sc1 lds
    s_add_u32 s55, s55, 4096
    s_add_u32 m0, m0, 4096
    s_mov_b32 exec_lo, 0xffffffff
    s_mov_b32 exec_hi, 0x0
    buffer_load_dwordx4 v242, s[24:27], s55 offen offset:0 sc1 lds
    s_mov_b64 exec, -1
    s_waitcnt vmcnt(31)
    v_mfma_f32_16x16x16_bf16 v[0:3], v[232:233], v[144:145], v[0:3]
    v_mfma_f32_16x16x16_bf16 v[4:7], v[232:233], v[146:147], v[4:7]
    v_mfma_f32_16x16x16_bf16 v[8:11], v[232:233], v[148:149], v[8:11]
    v_mfma_f32_16x16x16_bf16 v[12:15], v[232:233], v[150:151], v[12:15]
    v_mfma_f32_16x16x16_bf16 v[16:19], v[234:235], v[144:145], v[16:19]
    v_mfma_f32_16x16x16_bf16 v[20:23], v[234:235], v[146:147], v[20:23]
    v_mfma_f32_16x16x16_bf16 v[24:27], v[234:235], v[148:149], v[24:27]
    v_mfma_f32_16x16x16_bf16 v[28:31], v[234:235], v[150:151], v[28:31]
    v_mfma_f32_16x16x16_bf16 v[32:35], v[236:237], v[144:145], v[32:35]
    v_mfma_f32_16x16x16_bf16 v[36:39], v[236:237], v[146:147], v[36:39]
    v_mfma_f32_16x16x16_bf16 v[40:43], v[236:237], v[148:149], v[40:43]
    v_mfma_f32_16x16x16_bf16 v[44:47], v[236:237], v[150:151], v[44:47]
    v_mfma_f32_16x16x16_bf16 v[48:51], v[238:239], v[144:145], v[48:51]
    v_mfma_f32_16x16x16_bf16 v[52:55], v[238:239], v[146:147], v[52:55]
    v_mfma_f32_16x16x16_bf16 v[56:59], v[238:239], v[148:149], v[56:59]
    v_mfma_f32_16x16x16_bf16 v[60:63], v[238:239], v[150:151], v[60:63]
    v_mfma_f32_16x16x16_bf16 v[64:67], v[240:241], v[144:145], v[64:67]
    v_mfma_f32_16x16x16_bf16 v[68:71], v[240:241], v[146:147], v[68:71]
    v_mfma_f32_16x16x16_bf16 v[72:75], v[240:241], v[148:149], v[72:75]
    v_mfma_f32_16x16x16_bf16 v[76:79], v[240:241], v[150:151], v[76:79]
    s_add_u32 s55, s50, 4096
    buffer_load_dwordx2 v[144:145], v243, s[12:15], s55 offen sc1
    s_add_u32 s55, s51, 4096
    buffer_load_dwordx2 v[146:147], v243, s[12:15], s55 offen sc1
    s_add_u32 s55, s52, 4096
    buffer_load_dwordx2 v[148:149], v243, s[12:15], s55 offen sc1
    s_add_u32 s55, s63, 4096
    buffer_load_dwordx2 v[150:151], v243, s[12:15], s55 offen sc1
    ds_read_b64 v[232:233], v247 offset:18432
    ds_read_b64 v[234:235], v247 offset:18944
    ds_read_b64 v[236:237], v247 offset:19456
    ds_read_b64 v[238:239], v247 offset:19968
    ds_read_b64 v[240:241], v249 offset:20480
    s_waitcnt lgkmcnt(5)
    s_add_u32 s55, s49, 13824
    s_add_u32 m0, s56, 13824
    s_nop 0
    buffer_load_dwordx4 v242, s[24:27], s55 offen offset:0 sc1 lds
    buffer_load_dwordx4 v242, s[24:27], s55 offen offset:1024 sc1 lds
    buffer_load_dwordx4 v242, s[24:27], s55 offen offset:2048 sc1 lds
    buffer_load_dwordx4 v242, s[24:27], s55 offen offset:3072 sc1 lds
    s_add_u32 s55, s55, 4096
    s_add_u32 m0, m0, 4096
    s_mov_b32 exec_lo, 0xffffffff
    s_mov_b32 exec_hi, 0x0
    buffer_load_dwordx4 v242, s[24:27], s55 offen offset:0 sc1 lds
    s_mov_b64 exec, -1
    s_waitcnt lgkmcnt(0)
    s_add_u32 s55, s49, 18432
    s_add_u32 m0, s56, 18432
    s_nop 0
    buffer_load_dwordx4 v242, s[24:27], s55 offen offset:0 sc1 lds
    buffer_load_dwordx4 v242, s[24:27], s55 offen offset:1024 sc1 lds
    s_mov_b32 exec_lo, 0xffff
    s_mov_b32 exec_hi, 0x0
    buffer_load_dwordx4 v242, s[24:27], s55 offen offset:2048 sc1 lds
    s_mov_b64 exec, -1
    s_add_u32 s29, s29, 4
    s_and_b32 s29, s29, 15
    s_mul_i32 s50, s29, 4608
    s_add_u32 s50, s50, s57
    s_add_u32 s51, s50, 73728
    s_add_u32 s52, s50, 147456
    s_add_u32 s63, s50, 221184
    s_mul_i32 s54, s29, 20736
    s_add_u32 s54, s54, s58
parallel_sum__ssm_conv_s4__mixer_gmlp__prompt_kernel_hc18:
    s_and_b32 s33, s59, 48
    s_cbranch_scc0 parallel_sum__ssm_conv_s4__mixer_gmlp__prompt_kernel_hd19
    s_add_u32 s62, s62, 1
    s_cmp_ge_u32 s62, 16384
    s_cbranch_scc1 parallel_sum__ssm_conv_s4__mixer_gmlp__prompt_kernel_hd19
    s_mov_b32 exec_lo, 0xff
    s_mov_b32 exec_hi, 0x0
    buffer_load_dword v251, v250, s[16:19], 0 offen sc1
    s_waitcnt vmcnt(0)
    v_cmp_ne_u32 vcc, s23, v251
    s_mov_b64 exec, -1
    s_mov_b32 s59, vcc_lo
    s_branch parallel_sum__ssm_conv_s4__mixer_gmlp__prompt_kernel_hc18
parallel_sum__ssm_conv_s4__mixer_gmlp__prompt_kernel_hd19:
    s_add_u32 s49, s29, 4
    s_and_b32 s49, s49, 15
    s_mul_i32 s49, s49, 20736
    s_add_u32 s49, s49, s58
    s_waitcnt vmcnt(39)
    s_waitcnt lgkmcnt(0)
    v_mfma_f32_16x16x32_bf16 v[0:3], v[152:155], v[80:83], v[0:3]
    v_mfma_f32_16x16x32_bf16 v[4:7], v[152:155], v[84:87], v[4:7]
    v_mfma_f32_16x16x32_bf16 v[8:11], v[152:155], v[88:91], v[8:11]
    v_mfma_f32_16x16x32_bf16 v[12:15], v[152:155], v[92:95], v[12:15]
    v_mfma_f32_16x16x32_bf16 v[16:19], v[156:159], v[80:83], v[16:19]
    v_mfma_f32_16x16x32_bf16 v[20:23], v[156:159], v[84:87], v[20:23]
    v_mfma_f32_16x16x32_bf16 v[24:27], v[156:159], v[88:91], v[24:27]
    v_mfma_f32_16x16x32_bf16 v[28:31], v[156:159], v[92:95], v[28:31]
    v_mfma_f32_16x16x32_bf16 v[32:35], v[160:163], v[80:83], v[32:35]
    v_mfma_f32_16x16x32_bf16 v[36:39], v[160:163], v[84:87], v[36:39]
    v_mfma_f32_16x16x32_bf16 v[40:43], v[160:163], v[88:91], v[40:43]
    v_mfma_f32_16x16x32_bf16 v[44:47], v[160:163], v[92:95], v[44:47]
    v_mfma_f32_16x16x32_bf16 v[48:51], v[164:167], v[80:83], v[48:51]
    v_mfma_f32_16x16x32_bf16 v[52:55], v[164:167], v[84:87], v[52:55]
    v_mfma_f32_16x16x32_bf16 v[56:59], v[164:167], v[88:91], v[56:59]
    v_mfma_f32_16x16x32_bf16 v[60:63], v[164:167], v[92:95], v[60:63]
    v_mfma_f32_16x16x32_bf16 v[64:67], v[168:171], v[80:83], v[64:67]
    v_mfma_f32_16x16x32_bf16 v[68:71], v[168:171], v[84:87], v[68:71]
    v_mfma_f32_16x16x32_bf16 v[72:75], v[168:171], v[88:91], v[72:75]
    v_mfma_f32_16x16x32_bf16 v[76:79], v[168:171], v[92:95], v[76:79]
    buffer_load_dwordx4 v[80:83], v242, s[12:15], s50 offen offset:0 sc1
    buffer_load_dwordx4 v[84:87], v242, s[12:15], s51 offen offset:0 sc1
    buffer_load_dwordx4 v[88:91], v242, s[12:15], s52 offen offset:0 sc1
    buffer_load_dwordx4 v[92:95], v242, s[12:15], s63 offen offset:0 sc1
    s_waitcnt vmcnt(34)
    ds_read_b128 v[152:155], v246 offset:0
    ds_read_b128 v[156:159], v246 offset:1024
    ds_read_b128 v[160:163], v246 offset:2048
    ds_read_b128 v[164:167], v246 offset:3072
    ds_read_b128 v[168:171], v248 offset:4096
    v_mfma_f32_16x16x32_bf16 v[0:3], v[172:175], v[96:99], v[0:3]
    v_mfma_f32_16x16x32_bf16 v[4:7], v[172:175], v[100:103], v[4:7]
    v_mfma_f32_16x16x32_bf16 v[8:11], v[172:175], v[104:107], v[8:11]
    v_mfma_f32_16x16x32_bf16 v[12:15], v[172:175], v[108:111], v[12:15]
    v_mfma_f32_16x16x32_bf16 v[16:19], v[176:179], v[96:99], v[16:19]
    v_mfma_f32_16x16x32_bf16 v[20:23], v[176:179], v[100:103], v[20:23]
    v_mfma_f32_16x16x32_bf16 v[24:27], v[176:179], v[104:107], v[24:27]
    v_mfma_f32_16x16x32_bf16 v[28:31], v[176:179], v[108:111], v[28:31]
    v_mfma_f32_16x16x32_bf16 v[32:35], v[180:183], v[96:99], v[32:35]
    v_mfma_f32_16x16x32_bf16 v[36:39], v[180:183], v[100:103], v[36:39]
    v_mfma_f32_16x16x32_bf16 v[40:43], v[180:183], v[104:107], v[40:43]
    v_mfma_f32_16x16x32_bf16 v[44:47], v[180:183], v[108:111], v[44:47]
    v_mfma_f32_16x16x32_bf16 v[48:51], v[184:187], v[96:99], v[48:51]
    v_mfma_f32_16x16x32_bf16 v[52:55], v[184:187], v[100:103], v[52:55]
    v_mfma_f32_16x16x32_bf16 v[56:59], v[184:187], v[104:107], v[56:59]
    v_mfma_f32_16x16x32_bf16 v[60:63], v[184:187], v[108:111], v[60:63]
    v_mfma_f32_16x16x32_bf16 v[64:67], v[188:191], v[96:99], v[64:67]
    v_mfma_f32_16x16x32_bf16 v[68:71], v[188:191], v[100:103], v[68:71]
    v_mfma_f32_16x16x32_bf16 v[72:75], v[188:191], v[104:107], v[72:75]
    v_mfma_f32_16x16x32_bf16 v[76:79], v[188:191], v[108:111], v[76:79]
    buffer_load_dwordx4 v[96:99], v242, s[12:15], s50 offen offset:1024 sc1
    buffer_load_dwordx4 v[100:103], v242, s[12:15], s51 offen offset:1024 sc1
    buffer_load_dwordx4 v[104:107], v242, s[12:15], s52 offen offset:1024 sc1
    buffer_load_dwordx4 v[108:111], v242, s[12:15], s63 offen offset:1024 sc1
    s_waitcnt vmcnt(29)
    ds_read_b128 v[172:175], v246 offset:4608
    ds_read_b128 v[176:179], v246 offset:5632
    ds_read_b128 v[180:183], v246 offset:6656
    ds_read_b128 v[184:187], v246 offset:7680
    ds_read_b128 v[188:191], v248 offset:8704
    s_waitcnt lgkmcnt(5)
    s_add_u32 s55, s49, 0
    s_add_u32 m0, s56, 0
    s_nop 0
    buffer_load_dwordx4 v242, s[24:27], s55 offen offset:0 sc1 lds
    buffer_load_dwordx4 v242, s[24:27], s55 offen offset:1024 sc1 lds
    buffer_load_dwordx4 v242, s[24:27], s55 offen offset:2048 sc1 lds
    buffer_load_dwordx4 v242, s[24:27], s55 offen offset:3072 sc1 lds
    s_add_u32 s55, s55, 4096
    s_add_u32 m0, m0, 4096
    s_mov_b32 exec_lo, 0xffffffff
    s_mov_b32 exec_hi, 0x0
    buffer_load_dwordx4 v242, s[24:27], s55 offen offset:0 sc1 lds
    s_mov_b64 exec, -1
    v_mfma_f32_16x16x32_bf16 v[0:3], v[192:195], v[112:115], v[0:3]
    v_mfma_f32_16x16x32_bf16 v[4:7], v[192:195], v[116:119], v[4:7]
    v_mfma_f32_16x16x32_bf16 v[8:11], v[192:195], v[120:123], v[8:11]
    v_mfma_f32_16x16x32_bf16 v[12:15], v[192:195], v[124:127], v[12:15]
    v_mfma_f32_16x16x32_bf16 v[16:19], v[196:199], v[112:115], v[16:19]
    v_mfma_f32_16x16x32_bf16 v[20:23], v[196:199], v[116:119], v[20:23]
    v_mfma_f32_16x16x32_bf16 v[24:27], v[196:199], v[120:123], v[24:27]
    v_mfma_f32_16x16x32_bf16 v[28:31], v[196:199], v[124:127], v[28:31]
    v_mfma_f32_16x16x32_bf16 v[32:35], v[200:203], v[112:115], v[32:35]
    v_mfma_f32_16x16x32_bf16 v[36:39], v[200:203], v[116:119], v[36:39]
    v_mfma_f32_16x16x32_bf16 v[40:43], v[200:203], v[120:123], v[40:43]
    v_mfma_f32_16x16x32_bf16 v[44:47], v[200:203], v[124:127], v[44:47]
    v_mfma_f32_16x16x32_bf16 v[48:51], v[204:207], v[112:115], v[48:51]
    v_mfma_f32_16x16x32_bf16 v[52:55], v[204:207], v[116:119], v[52:55]
    v_mfma_f32_16x16x32_bf16 v[56:59], v[204:207], v[120:123], v[56:59]
    v_mfma_f32_16x16x32_bf16 v[60:63], v[204:207], v[124:127], v[60:63]
    v_mfma_f32_16x16x32_bf16 v[64:67], v[208:211], v[112:115], v[64:67]
    v_mfma_f32_16x16x32_bf16 v[68:71], v[208:211], v[116:119], v[68:71]
    v_mfma_f32_16x16x32_bf16 v[72:75], v[208:211], v[120:123], v[72:75]
    v_mfma_f32_16x16x32_bf16 v[76:79], v[208:211], v[124:127], v[76:79]
    buffer_load_dwordx4 v[112:115], v242, s[12:15], s50 offen offset:2048 sc1
    buffer_load_dwordx4 v[116:119], v242, s[12:15], s51 offen offset:2048 sc1
    buffer_load_dwordx4 v[120:123], v242, s[12:15], s52 offen offset:2048 sc1
    buffer_load_dwordx4 v[124:127], v242, s[12:15], s63 offen offset:2048 sc1
    s_waitcnt vmcnt(29)
    ds_read_b128 v[192:195], v246 offset:9216
    ds_read_b128 v[196:199], v246 offset:10240
    ds_read_b128 v[200:203], v246 offset:11264
    ds_read_b128 v[204:207], v246 offset:12288
    ds_read_b128 v[208:211], v248 offset:13312
    s_waitcnt lgkmcnt(5)
    s_add_u32 s55, s49, 4608
    s_add_u32 m0, s56, 4608
    s_nop 0
    buffer_load_dwordx4 v242, s[24:27], s55 offen offset:0 sc1 lds
    buffer_load_dwordx4 v242, s[24:27], s55 offen offset:1024 sc1 lds
    buffer_load_dwordx4 v242, s[24:27], s55 offen offset:2048 sc1 lds
    buffer_load_dwordx4 v242, s[24:27], s55 offen offset:3072 sc1 lds
    s_add_u32 s55, s55, 4096
    s_add_u32 m0, m0, 4096
    s_mov_b32 exec_lo, 0xffffffff
    s_mov_b32 exec_hi, 0x0
    buffer_load_dwordx4 v242, s[24:27], s55 offen offset:0 sc1 lds
    s_mov_b64 exec, -1
    v_mfma_f32_16x16x32_bf16 v[0:3], v[212:215], v[128:131], v[0:3]
    v_mfma_f32_16x16x32_bf16 v[4:7], v[212:215], v[132:135], v[4:7]
    v_mfma_f32_16x16x32_bf16 v[8:11], v[212:215], v[136:139], v[8:11]
    v_mfma_f32_16x16x32_bf16 v[12:15], v[212:215], v[140:143], v[12:15]
    v_mfma_f32_16x16x32_bf16 v[16:19], v[216:219], v[128:131], v[16:19]
    v_mfma_f32_16x16x32_bf16 v[20:23], v[216:219], v[132:135], v[20:23]
    v_mfma_f32_16x16x32_bf16 v[24:27], v[216:219], v[136:139], v[24:27]
    v_mfma_f32_16x16x32_bf16 v[28:31], v[216:219], v[140:143], v[28:31]
    v_mfma_f32_16x16x32_bf16 v[32:35], v[220:223], v[128:131], v[32:35]
    v_mfma_f32_16x16x32_bf16 v[36:39], v[220:223], v[132:135], v[36:39]
    v_mfma_f32_16x16x32_bf16 v[40:43], v[220:223], v[136:139], v[40:43]
    v_mfma_f32_16x16x32_bf16 v[44:47], v[220:223], v[140:143], v[44:47]
    v_mfma_f32_16x16x32_bf16 v[48:51], v[224:227], v[128:131], v[48:51]
    v_mfma_f32_16x16x32_bf16 v[52:55], v[224:227], v[132:135], v[52:55]
    v_mfma_f32_16x16x32_bf16 v[56:59], v[224:227], v[136:139], v[56:59]
    v_mfma_f32_16x16x32_bf16 v[60:63], v[224:227], v[140:143], v[60:63]
    v_mfma_f32_16x16x32_bf16 v[64:67], v[228:231], v[128:131], v[64:67]
    v_mfma_f32_16x16x32_bf16 v[68:71], v[228:231], v[132:135], v[68:71]
    v_mfma_f32_16x16x32_bf16 v[72:75], v[228:231], v[136:139], v[72:75]
    v_mfma_f32_16x16x32_bf16 v[76:79], v[228:231], v[140:143], v[76:79]
    buffer_load_dwordx4 v[128:131], v242, s[12:15], s50 offen offset:3072 sc1
    buffer_load_dwordx4 v[132:135], v242, s[12:15], s51 offen offset:3072 sc1
    buffer_load_dwordx4 v[136:139], v242, s[12:15], s52 offen offset:3072 sc1
    buffer_load_dwordx4 v[140:143], v242, s[12:15], s63 offen offset:3072 sc1
    s_waitcnt vmcnt(29)
    ds_read_b128 v[212:215], v246 offset:13824
    ds_read_b128 v[216:219], v246 offset:14848
    ds_read_b128 v[220:223], v246 offset:15872
    ds_read_b128 v[224:227], v246 offset:16896
    ds_read_b128 v[228:231], v248 offset:17920
    s_waitcnt lgkmcnt(5)
    s_add_u32 s55, s49, 9216
    s_add_u32 m0, s56, 9216
    s_nop 0
    buffer_load_dwordx4 v242, s[24:27], s55 offen offset:0 sc1 lds
    buffer_load_dwordx4 v242, s[24:27], s55 offen offset:1024 sc1 lds
    buffer_load_dwordx4 v242, s[24:27], s55 offen offset:2048 sc1 lds
    buffer_load_dwordx4 v242, s[24:27], s55 offen offset:3072 sc1 lds
    s_add_u32 s55, s55, 4096
    s_add_u32 m0, m0, 4096
    s_mov_b32 exec_lo, 0xffffffff
    s_mov_b32 exec_hi, 0x0
    buffer_load_dwordx4 v242, s[24:27], s55 offen offset:0 sc1 lds
    s_mov_b64 exec, -1
    v_mfma_f32_16x16x16_bf16 v[0:3], v[232:233], v[144:145], v[0:3]
    v_mfma_f32_16x16x16_bf16 v[4:7], v[232:233], v[146:147], v[4:7]
    v_mfma_f32_16x16x16_bf16 v[8:11], v[232:233], v[148:149], v[8:11]
    v_mfma_f32_16x16x16_bf16 v[12:15], v[232:233], v[150:151], v[12:15]
    v_mfma_f32_16x16x16_bf16 v[16:19], v[234:235], v[144:145], v[16:19]
    v_mfma_f32_16x16x16_bf16 v[20:23], v[234:235], v[146:147], v[20:23]
    v_mfma_f32_16x16x16_bf16 v[24:27], v[234:235], v[148:149], v[24:27]
    v_mfma_f32_16x16x16_bf16 v[28:31], v[234:235], v[150:151], v[28:31]
    v_mfma_f32_16x16x16_bf16 v[32:35], v[236:237], v[144:145], v[32:35]
    v_mfma_f32_16x16x16_bf16 v[36:39], v[236:237], v[146:147], v[36:39]
    v_mfma_f32_16x16x16_bf16 v[40:43], v[236:237], v[148:149], v[40:43]
    v_mfma_f32_16x16x16_bf16 v[44:47], v[236:237], v[150:151], v[44:47]
    v_mfma_f32_16x16x16_bf16 v[48:51], v[238:239], v[144:145], v[48:51]
    v_mfma_f32_16x16x16_bf16 v[52:55], v[238:239], v[146:147], v[52:55]
    v_mfma_f32_16x16x16_bf16 v[56:59], v[238:239], v[148:149], v[56:59]
    v_mfma_f32_16x16x16_bf16 v[60:63], v[238:239], v[150:151], v[60:63]
    v_mfma_f32_16x16x16_bf16 v[64:67], v[240:241], v[144:145], v[64:67]
    v_mfma_f32_16x16x16_bf16 v[68:71], v[240:241], v[146:147], v[68:71]
    v_mfma_f32_16x16x16_bf16 v[72:75], v[240:241], v[148:149], v[72:75]
    v_mfma_f32_16x16x16_bf16 v[76:79], v[240:241], v[150:151], v[76:79]
    s_add_u32 s55, s50, 4096
    buffer_load_dwordx2 v[144:145], v243, s[12:15], s55 offen sc1
    s_add_u32 s55, s51, 4096
    buffer_load_dwordx2 v[146:147], v243, s[12:15], s55 offen sc1
    s_add_u32 s55, s52, 4096
    buffer_load_dwordx2 v[148:149], v243, s[12:15], s55 offen sc1
    s_add_u32 s55, s63, 4096
    buffer_load_dwordx2 v[150:151], v243, s[12:15], s55 offen sc1
    s_waitcnt vmcnt(35)
    ds_read_b64 v[232:233], v247 offset:18432
    ds_read_b64 v[234:235], v247 offset:18944
    ds_read_b64 v[236:237], v247 offset:19456
    ds_read_b64 v[238:239], v247 offset:19968
    ds_read_b64 v[240:241], v249 offset:20480
    s_waitcnt lgkmcnt(5)
    s_add_u32 s55, s49, 13824
    s_add_u32 m0, s56, 13824
    s_nop 0
    buffer_load_dwordx4 v242, s[24:27], s55 offen offset:0 sc1 lds
    buffer_load_dwordx4 v242, s[24:27], s55 offen offset:1024 sc1 lds
    buffer_load_dwordx4 v242, s[24:27], s55 offen offset:2048 sc1 lds
    buffer_load_dwordx4 v242, s[24:27], s55 offen offset:3072 sc1 lds
    s_add_u32 s55, s55, 4096
    s_add_u32 m0, m0, 4096
    s_mov_b32 exec_lo, 0xffffffff
    s_mov_b32 exec_hi, 0x0
    buffer_load_dwordx4 v242, s[24:27], s55 offen offset:0 sc1 lds
    s_mov_b64 exec, -1
    s_waitcnt lgkmcnt(0)
    s_add_u32 s55, s49, 18432
    s_add_u32 m0, s56, 18432
    s_nop 0
    buffer_load_dwordx4 v242, s[24:27], s55 offen offset:0 sc1 lds
    buffer_load_dwordx4 v242, s[24:27], s55 offen offset:1024 sc1 lds
    s_mov_b32 exec_lo, 0xffff
    s_mov_b32 exec_hi, 0x0
    buffer_load_dwordx4 v242, s[24:27], s55 offen offset:2048 sc1 lds
    s_mov_b64 exec, -1
    s_add_u32 s29, s29, 4
    s_and_b32 s29, s29, 15
    s_mul_i32 s50, s29, 4608
    s_add_u32 s50, s50, s57
    s_add_u32 s51, s50, 73728
    s_add_u32 s52, s50, 147456
    s_add_u32 s63, s50, 221184
    s_mul_i32 s54, s29, 20736
    s_add_u32 s54, s54, s58
parallel_sum__ssm_conv_s4__mixer_gmlp__prompt_kernel_hc20:
    s_and_b32 s33, s59, 192
    s_cbranch_scc0 parallel_sum__ssm_conv_s4__mixer_gmlp__prompt_kernel_hd21
    s_add_u32 s62, s62, 1
    s_cmp_ge_u32 s62, 16384
    s_cbranch_scc1 parallel_sum__ssm_conv_s4__mixer_gmlp__prompt_kernel_hd21
    s_mov_b32 exec_lo, 0xff
    s_mov_b32 exec_hi, 0x0
    buffer_load_dword v251, v250, s[16:19], 0 offen sc1
    s_waitcnt vmcnt(0)
    v_cmp_ne_u32 vcc, s23, v251
    s_mov_b64 exec, -1
    s_mov_b32 s59, vcc_lo
    s_branch parallel_sum__ssm_conv_s4__mixer_gmlp__prompt_kernel_hc20
parallel_sum__ssm_conv_s4__mixer_gmlp__prompt_kernel_hd21:
    s_waitcnt vmcnt(39)
    s_waitcnt lgkmcnt(0)
    v_mfma_f32_16x16x32_bf16 v[0:3], v[152:155], v[80:83], v[0:3]
    v_mfma_f32_16x16x32_bf16 v[4:7], v[152:155], v[84:87], v[4:7]
    v_mfma_f32_16x16x32_bf16 v[8:11], v[152:155], v[88:91], v[8:11]
    v_mfma_f32_16x16x32_bf16 v[12:15], v[152:155], v[92:95], v[12:15]
    v_mfma_f32_16x16x32_bf16 v[16:19], v[156:159], v[80:83], v[16:19]
    v_mfma_f32_16x16x32_bf16 v[20:23], v[156:159], v[84:87], v[20:23]
    v_mfma_f32_16x16x32_bf16 v[24:27], v[156:159], v[88:91], v[24:27]
    v_mfma_f32_16x16x32_bf16 v[28:31], v[156:159], v[92:95], v[28:31]
    v_mfma_f32_16x16x32_bf16 v[32:35], v[160:163], v[80:83], v[32:35]
    v_mfma_f32_16x16x32_bf16 v[36:39], v[160:163], v[84:87], v[36:39]
    v_mfma_f32_16x16x32_bf16 v[40:43], v[160:163], v[88:91], v[40:43]
    v_mfma_f32_16x16x32_bf16 v[44:47], v[160:163], v[92:95], v[44:47]
    v_mfma_f32_16x16x32_bf16 v[48:51], v[164:167], v[80:83], v[48:51]
    v_mfma_f32_16x16x32_bf16 v[52:55], v[164:167], v[84:87], v[52:55]
    v_mfma_f32_16x16x32_bf16 v[56:59], v[164:167], v[88:91], v[56:59]
    v_mfma_f32_16x16x32_bf16 v[60:63], v[164:167], v[92:95], v[60:63]
    v_mfma_f32_16x16x32_bf16 v[64:67], v[168:171], v[80:83], v[64:67]
    v_mfma_f32_16x16x32_bf16 v[68:71], v[168:171], v[84:87], v[68:71]
    v_mfma_f32_16x16x32_bf16 v[72:75], v[168:171], v[88:91], v[72:75]
    v_mfma_f32_16x16x32_bf16 v[76:79], v[168:171], v[92:95], v[76:79]
    buffer_load_dwordx4 v[80:83], v242, s[12:15], s50 offen offset:0 sc1
    buffer_load_dwordx4 v[84:87], v242, s[12:15], s51 offen offset:0 sc1
    buffer_load_dwordx4 v[88:91], v242, s[12:15], s52 offen offset:0 sc1
    buffer_load_dwordx4 v[92:95], v242, s[12:15], s63 offen offset:0 sc1
    s_waitcnt vmcnt(34)
    ds_read_b128 v[152:155], v246 offset:0
    ds_read_b128 v[156:159], v246 offset:1024
    ds_read_b128 v[160:163], v246 offset:2048
    ds_read_b128 v[164:167], v246 offset:3072
    ds_read_b128 v[168:171], v248 offset:4096
    v_mfma_f32_16x16x32_bf16 v[0:3], v[172:175], v[96:99], v[0:3]
    v_mfma_f32_16x16x32_bf16 v[4:7], v[172:175], v[100:103], v[4:7]
    v_mfma_f32_16x16x32_bf16 v[8:11], v[172:175], v[104:107], v[8:11]
    v_mfma_f32_16x16x32_bf16 v[12:15], v[172:175], v[108:111], v[12:15]
    v_mfma_f32_16x16x32_bf16 v[16:19], v[176:179], v[96:99], v[16:19]
    v_mfma_f32_16x16x32_bf16 v[20:23], v[176:179], v[100:103], v[20:23]
    v_mfma_f32_16x16x32_bf16 v[24:27], v[176:179], v[104:107], v[24:27]
    v_mfma_f32_16x16x32_bf16 v[28:31], v[176:179], v[108:111], v[28:31]
    v_mfma_f32_16x16x32_bf16 v[32:35], v[180:183], v[96:99], v[32:35]
    v_mfma_f32_16x16x32_bf16 v[36:39], v[180:183], v[100:103], v[36:39]
    v_mfma_f32_16x16x32_bf16 v[40:43], v[180:183], v[104:107], v[40:43]
    v_mfma_f32_16x16x32_bf16 v[44:47], v[180:183], v[108:111], v[44:47]
    v_mfma_f32_16x16x32_bf16 v[48:51], v[184:187], v[96:99], v[48:51]
    v_mfma_f32_16x16x32_bf16 v[52:55], v[184:187], v[100:103], v[52:55]
    v_mfma_f32_16x16x32_bf16 v[56:59], v[184:187], v[104:107], v[56:59]
    v_mfma_f32_16x16x32_bf16 v[60:63], v[184:187], v[108:111], v[60:63]
    v_mfma_f32_16x16x32_bf16 v[64:67], v[188:191], v[96:99], v[64:67]
    v_mfma_f32_16x16x32_bf16 v[68:71], v[188:191], v[100:103], v[68:71]
    v_mfma_f32_16x16x32_bf16 v[72:75], v[188:191], v[104:107], v[72:75]
    v_mfma_f32_16x16x32_bf16 v[76:79], v[188:191], v[108:111], v[76:79]
    buffer_load_dwordx4 v[96:99], v242, s[12:15], s50 offen offset:1024 sc1
    buffer_load_dwordx4 v[100:103], v242, s[12:15], s51 offen offset:1024 sc1
    buffer_load_dwordx4 v[104:107], v242, s[12:15], s52 offen offset:1024 sc1
    buffer_load_dwordx4 v[108:111], v242, s[12:15], s63 offen offset:1024 sc1
    s_waitcnt vmcnt(29)
    ds_read_b128 v[172:175], v246 offset:4608
    ds_read_b128 v[176:179], v246 offset:5632
    ds_read_b128 v[180:183], v246 offset:6656
    ds_read_b128 v[184:187], v246 offset:7680
    ds_read_b128 v[188:191], v248 offset:8704
    v_mfma_f32_16x16x32_bf16 v[0:3], v[192:195], v[112:115], v[0:3]
    v_mfma_f32_16x16x32_bf16 v[4:7], v[192:195], v[116:119], v[4:7]
    v_mfma_f32_16x16x32_bf16 v[8:11], v[192:195], v[120:123], v[8:11]
    v_mfma_f32_16x16x32_bf16 v[12:15], v[192:195], v[124:127], v[12:15]
    v_mfma_f32_16x16x32_bf16 v[16:19], v[196:199], v[112:115], v[16:19]
    v_mfma_f32_16x16x32_bf16 v[20:23], v[196:199], v[116:119], v[20:23]
    v_mfma_f32_16x16x32_bf16 v[24:27], v[196:199], v[120:123], v[24:27]
    v_mfma_f32_16x16x32_bf16 v[28:31], v[196:199], v[124:127], v[28:31]
    v_mfma_f32_16x16x32_bf16 v[32:35], v[200:203], v[112:115], v[32:35]
    v_mfma_f32_16x16x32_bf16 v[36:39], v[200:203], v[116:119], v[36:39]
    v_mfma_f32_16x16x32_bf16 v[40:43], v[200:203], v[120:123], v[40:43]
    v_mfma_f32_16x16x32_bf16 v[44:47], v[200:203], v[124:127], v[44:47]
    v_mfma_f32_16x16x32_bf16 v[48:51], v[204:207], v[112:115], v[48:51]
    v_mfma_f32_16x16x32_bf16 v[52:55], v[204:207], v[116:119], v[52:55]
    v_mfma_f32_16x16x32_bf16 v[56:59], v[204:207], v[120:123], v[56:59]
    v_mfma_f32_16x16x32_bf16 v[60:63], v[204:207], v[124:127], v[60:63]
    v_mfma_f32_16x16x32_bf16 v[64:67], v[208:211], v[112:115], v[64:67]
    v_mfma_f32_16x16x32_bf16 v[68:71], v[208:211], v[116:119], v[68:71]
    v_mfma_f32_16x16x32_bf16 v[72:75], v[208:211], v[120:123], v[72:75]
    v_mfma_f32_16x16x32_bf16 v[76:79], v[208:211], v[124:127], v[76:79]
    buffer_load_dwordx4 v[112:115], v242, s[12:15], s50 offen offset:2048 sc1
    buffer_load_dwordx4 v[116:119], v242, s[12:15], s51 offen offset:2048 sc1
    buffer_load_dwordx4 v[120:123], v242, s[12:15], s52 offen offset:2048 sc1
    buffer_load_dwordx4 v[124:127], v242, s[12:15], s63 offen offset:2048 sc1
    s_waitcnt vmcnt(24)
    ds_read_b128 v[192:195], v246 offset:9216
    ds_read_b128 v[196:199], v246 offset:10240
    ds_read_b128 v[200:203], v246 offset:11264
    ds_read_b128 v[204:207], v246 offset:12288
    ds_read_b128 v[208:211], v248 offset:13312
    v_mfma_f32_16x16x32_bf16 v[0:3], v[212:215], v[128:131], v[0:3]
    v_mfma_f32_16x16x32_bf16 v[4:7], v[212:215], v[132:135], v[4:7]
    v_mfma_f32_16x16x32_bf16 v[8:11], v[212:215], v[136:139], v[8:11]
    v_mfma_f32_16x16x32_bf16 v[12:15], v[212:215], v[140:143], v[12:15]
    v_mfma_f32_16x16x32_bf16 v[16:19], v[216:219], v[128:131], v[16:19]
    v_mfma_f32_16x16x32_bf16 v[20:23], v[216:219], v[132:135], v[20:23]
    v_mfma_f32_16x16x32_bf16 v[24:27], v[216:219], v[136:139], v[24:27]
    v_mfma_f32_16x16x32_bf16 v[28:31], v[216:219], v[140:143], v[28:31]
    v_mfma_f32_16x16x32_bf16 v[32:35], v[220:223], v[128:131], v[32:35]
    v_mfma_f32_16x16x32_bf16 v[36:39], v[220:223], v[132:135], v[36:39]
    v_mfma_f32_16x16x32_bf16 v[40:43], v[220:223], v[136:139], v[40:43]
    v_mfma_f32_16x16x32_bf16 v[44:47], v[220:223], v[140:143], v[44:47]
    v_mfma_f32_16x16x32_bf16 v[48:51], v[224:227], v[128:131], v[48:51]
    v_mfma_f32_16x16x32_bf16 v[52:55], v[224:227], v[132:135], v[52:55]
    v_mfma_f32_16x16x32_bf16 v[56:59], v[224:227], v[136:139], v[56:59]
    v_mfma_f32_16x16x32_bf16 v[60:63], v[224:227], v[140:143], v[60:63]
    v_mfma_f32_16x16x32_bf16 v[64:67], v[228:231], v[128:131], v[64:67]
    v_mfma_f32_16x16x32_bf16 v[68:71], v[228:231], v[132:135], v[68:71]
    v_mfma_f32_16x16x32_bf16 v[72:75], v[228:231], v[136:139], v[72:75]
    v_mfma_f32_16x16x32_bf16 v[76:79], v[228:231], v[140:143], v[76:79]
    buffer_load_dwordx4 v[128:131], v242, s[12:15], s50 offen offset:3072 sc1
    buffer_load_dwordx4 v[132:135], v242, s[12:15], s51 offen offset:3072 sc1
    buffer_load_dwordx4 v[136:139], v242, s[12:15], s52 offen offset:3072 sc1
    buffer_load_dwordx4 v[140:143], v242, s[12:15], s63 offen offset:3072 sc1
    s_waitcnt vmcnt(19)
    ds_read_b128 v[212:215], v246 offset:13824
    ds_read_b128 v[216:219], v246 offset:14848
    ds_read_b128 v[220:223], v246 offset:15872
    ds_read_b128 v[224:227], v246 offset:16896
    ds_read_b128 v[228:231], v248 offset:17920
    v_mfma_f32_16x16x16_bf16 v[0:3], v[232:233], v[144:145], v[0:3]
    v_mfma_f32_16x16x16_bf16 v[4:7], v[232:233], v[146:147], v[4:7]
    v_mfma_f32_16x16x16_bf16 v[8:11], v[232:233], v[148:149], v[8:11]
    v_mfma_f32_16x16x16_bf16 v[12:15], v[232:233], v[150:151], v[12:15]
    v_mfma_f32_16x16x16_bf16 v[16:19], v[234:235], v[144:145], v[16:19]
    v_mfma_f32_16x16x16_bf16 v[20:23], v[234:235], v[146:147], v[20:23]
    v_mfma_f32_16x16x16_bf16 v[24:27], v[234:235], v[148:149], v[24:27]
    v_mfma_f32_16x16x16_bf16 v[28:31], v[234:235], v[150:151], v[28:31]
    v_mfma_f32_16x16x16_bf16 v[32:35], v[236:237], v[144:145], v[32:35]
    v_mfma_f32_16x16x16_bf16 v[36:39], v[236:237], v[146:147], v[36:39]
    v_mfma_f32_16x16x16_bf16 v[40:43], v[236:237], v[148:149], v[40:43]
    v_mfma_f32_16x16x16_bf16 v[44:47], v[236:237], v[150:151], v[44:47]
    v_mfma_f32_16x16x16_bf16 v[48:51], v[238:239], v[144:145], v[48:51]
    v_mfma_f32_16x16x16_bf16 v[52:55], v[238:239], v[146:147], v[52:55]
    v_mfma_f32_16x16x16_bf16 v[56:59], v[238:239], v[148:149], v[56:59]
    v_mfma_f32_16x16x16_bf16 v[60:63], v[238:239], v[150:151], v[60:63]
    v_mfma_f32_16x16x16_bf16 v[64:67], v[240:241], v[144:145], v[64:67]
    v_mfma_f32_16x16x16_bf16 v[68:71], v[240:241], v[146:147], v[68:71]
    v_mfma_f32_16x16x16_bf16 v[72:75], v[240:241], v[148:149], v[72:75]
    v_mfma_f32_16x16x16_bf16 v[76:79], v[240:241], v[150:151], v[76:79]
    s_add_u32 s55, s50, 4096
    buffer_load_dwordx2 v[144:145], v243, s[12:15], s55 offen sc1
    s_add_u32 s55, s51, 4096
    buffer_load_dwordx2 v[146:147], v243, s[12:15], s55 offen sc1
    s_add_u32 s55, s52, 4096
    buffer_load_dwordx2 v[148:149], v243, s[12:15], s55 offen sc1
    s_add_u32 s55, s63, 4096
    buffer_load_dwordx2 v[150:151], v243, s[12:15], s55 offen sc1
    s_waitcnt vmcnt(20)
    ds_read_b64 v[232:233], v247 offset:18432
    ds_read_b64 v[234:235], v247 offset:18944
    ds_read_b64 v[236:237], v247 offset:19456
    ds_read_b64 v[238:239], v247 offset:19968
    ds_read_b64 v[240:241], v249 offset:20480
    s_waitcnt vmcnt(16) lgkmcnt(0)
    v_mfma_f32_16x16x32_bf16 v[0:3], v[152:155], v[80:83], v[0:3]
    v_mfma_f32_16x16x32_bf16 v[4:7], v[152:155], v[84:87], v[4:7]
    v_mfma_f32_16x16x32_bf16 v[8:11], v[152:155], v[88:91], v[8:11]
    v_mfma_f32_16x16x32_bf16 v[12:15], v[152:155], v[92:95], v[12:15]
    v_mfma_f32_16x16x32_bf16 v[16:19], v[156:159], v[80:83], v[16:19]
    v_mfma_f32_16x16x32_bf16 v[20:23], v[156:159], v[84:87], v[20:23]
    v_mfma_f32_16x16x32_bf16 v[24:27], v[156:159], v[88:91], v[24:27]
    v_mfma_f32_16x16x32_bf16 v[28:31], v[156:159], v[92:95], v[28:31]
    v_mfma_f32_16x16x32_bf16 v[32:35], v[160:163], v[80:83], v[32:35]
    v_mfma_f32_16x16x32_bf16 v[36:39], v[160:163], v[84:87], v[36:39]
    v_mfma_f32_16x16x32_bf16 v[40:43], v[160:163], v[88:91], v[40:43]
    v_mfma_f32_16x16x32_bf16 v[44:47], v[160:163], v[92:95], v[44:47]
    v_mfma_f32_16x16x32_bf16 v[48:51], v[164:167], v[80:83], v[48:51]
    v_mfma_f32_16x16x32_bf16 v[52:55], v[164:167], v[84:87], v[52:55]
    v_mfma_f32_16x16x32_bf16 v[56:59], v[164:167], v[88:91], v[56:59]
    v_mfma_f32_16x16x32_bf16 v[60:63], v[164:167], v[92:95], v[60:63]
    v_mfma_f32_16x16x32_bf16 v[64:67], v[168:171], v[80:83], v[64:67]
    v_mfma_f32_16x16x32_bf16 v[68:71], v[168:171], v[84:87], v[68:71]
    v_mfma_f32_16x16x32_bf16 v[72:75], v[168:171], v[88:91], v[72:75]
    v_mfma_f32_16x16x32_bf16 v[76:79], v[168:171], v[92:95], v[76:79]
    s_lshl_b32 s30, s20, 6
    v_add_u32 v243, s30, v255
    v_mul_u32_u24 v243, 1152, v243
    s_mul_i32 s30, s21, 144
    s_lshl_b32 s31, s22, 4
    s_add_u32 s30, s30, s31
    v_add_u32 v243, s30, v243
    s_mul_i32 s30, s21, 576
    s_add_u32 s30, s30, 28672
    v_lshlrev_b32 v247, 4, v255
    buffer_load_dwordx4 v[248:251], v247, s[16:19], s30 offen sc1
    buffer_load_dwordx4 v[80:83], v243, s[40:43], 0 offen
    buffer_load_dwordx4 v[84:87], v243, s[40:43], 0 offen offset:64
    buffer_load_dwordx4 v[88:91], v243, s[40:43], 0 offen offset:128
    v_and_b32 v244, 15, v255
    v_mul_u32_u24 v244, 336, v244
    v_lshrrev_b32 v245, 4, v255
    v_lshl_add_u32 v244, v245, 4, v244
    v_add_u32 v244, s56, v244
    s_waitcnt vmcnt(16)
    v_mfma_f32_16x16x32_bf16 v[0:3], v[172:175], v[96:99], v[0:3]
    v_mfma_f32_16x16x32_bf16 v[4:7], v[172:175], v[100:103], v[4:7]
    v_mfma_f32_16x16x32_bf16 v[8:11], v[172:175], v[104:107], v[8:11]
    v_mfma_f32_16x16x32_bf16 v[12:15], v[172:175], v[108:111], v[12:15]
    v_mfma_f32_16x16x32_bf16 v[16:19], v[176:179], v[96:99], v[16:19]
    v_mfma_f32_16x16x32_bf16 v[20:23], v[176:179], v[100:103], v[20:23]
    v_mfma_f32_16x16x32_bf16 v[24:27], v[176:179], v[104:107], v[24:27]
    v_mfma_f32_16x16x32_bf16 v[28:31], v[176:179], v[108:111], v[28:31]
    v_mfma_f32_16x16x32_bf16 v[32:35], v[180:183], v[96:99], v[32:35]
    v_mfma_f32_16x16x32_bf16 v[36:39], v[180:183], v[100:103], v[36:39]
    v_mfma_f32_16x16x32_bf16 v[40:43], v[180:183], v[104:107], v[40:43]
    v_mfma_f32_16x16x32_bf16 v[44:47], v[180:183], v[108:111], v[44:47]
    v_mfma_f32_16x16x32_bf16 v[48:51], v[184:187], v[96:99], v[48:51]
    v_mfma_f32_16x16x32_bf16 v[52:55], v[184:187], v[100:103], v[52:55]
    v_mfma_f32_16x16x32_bf16 v[56:59], v[184:187], v[104:107], v[56:59]
    v_mfma_f32_16x16x32_bf16 v[60:63], v[184:187], v[108:111], v[60:63]
    v_mfma_f32_16x16x32_bf16 v[64:67], v[188:191], v[96:99], v[64:67]
    v_mfma_f32_16x16x32_bf16 v[68:71], v[188:191], v[100:103], v[68:71]
    v_mfma_f32_16x16x32_bf16 v[72:75], v[188:191], v[104:107], v[72:75]
    v_mfma_f32_16x16x32_bf16 v[76:79], v[188:191], v[108:111], v[76:79]
    s_waitcnt vmcnt(12)
    v_mfma_f32_16x16x32_bf16 v[0:3], v[192:195], v[112:115], v[0:3]
    v_mfma_f32_16x16x32_bf16 v[4:7], v[192:195], v[116:119], v[4:7]
    v_mfma_f32_16x16x32_bf16 v[8:11], v[192:195], v[120:123], v[8:11]
    v_mfma_f32_16x16x32_bf16 v[12:15], v[192:195], v[124:127], v[12:15]
    v_mfma_f32_16x16x32_bf16 v[16:19], v[196:199], v[112:115], v[16:19]
    v_mfma_f32_16x16x32_bf16 v[20:23], v[196:199], v[116:119], v[20:23]
    v_mfma_f32_16x16x32_bf16 v[24:27], v[196:199], v[120:123], v[24:27]
    v_mfma_f32_16x16x32_bf16 v[28:31], v[196:199], v[124:127], v[28:31]
    v_mfma_f32_16x16x32_bf16 v[32:35], v[200:203], v[112:115], v[32:35]
    v_mfma_f32_16x16x32_bf16 v[36:39], v[200:203], v[116:119], v[36:39]
    v_mfma_f32_16x16x32_bf16 v[40:43], v[200:203], v[120:123], v[40:43]
    v_mfma_f32_16x16x32_bf16 v[44:47], v[200:203], v[124:127], v[44:47]
    v_mfma_f32_16x16x32_bf16 v[48:51], v[204:207], v[112:115], v[48:51]
    v_mfma_f32_16x16x32_bf16 v[52:55], v[204:207], v[116:119], v[52:55]
    v_mfma_f32_16x16x32_bf16 v[56:59], v[204:207], v[120:123], v[56:59]
    v_mfma_f32_16x16x32_bf16 v[60:63], v[204:207], v[124:127], v[60:63]
    v_mfma_f32_16x16x32_bf16 v[64:67], v[208:211], v[112:115], v[64:67]
    v_mfma_f32_16x16x32_bf16 v[68:71], v[208:211], v[116:119], v[68:71]
    v_mfma_f32_16x16x32_bf16 v[72:75], v[208:211], v[120:123], v[72:75]
    v_mfma_f32_16x16x32_bf16 v[76:79], v[208:211], v[124:127], v[76:79]
    s_waitcnt vmcnt(8)
    v_mfma_f32_16x16x32_bf16 v[0:3], v[212:215], v[128:131], v[0:3]
    v_mfma_f32_16x16x32_bf16 v[4:7], v[212:215], v[132:135], v[4:7]
    v_mfma_f32_16x16x32_bf16 v[8:11], v[212:215], v[136:139], v[8:11]
    v_mfma_f32_16x16x32_bf16 v[12:15], v[212:215], v[140:143], v[12:15]
    v_mfma_f32_16x16x32_bf16 v[16:19], v[216:219], v[128:131], v[16:19]
    v_mfma_f32_16x16x32_bf16 v[20:23], v[216:219], v[132:135], v[20:23]
    v_mfma_f32_16x16x32_bf16 v[24:27], v[216:219], v[136:139], v[24:27]
    v_mfma_f32_16x16x32_bf16 v[28:31], v[216:219], v[140:143], v[28:31]
    v_mfma_f32_16x16x32_bf16 v[32:35], v[220:223], v[128:131], v[32:35]
    v_mfma_f32_16x16x32_bf16 v[36:39], v[220:223], v[132:135], v[36:39]
    v_mfma_f32_16x16x32_bf16 v[40:43], v[220:223], v[136:139], v[40:43]
    v_mfma_f32_16x16x32_bf16 v[44:47], v[220:223], v[140:143], v[44:47]
    v_mfma_f32_16x16x32_bf16 v[48:51], v[224:227], v[128:131], v[48:51]
    v_mfma_f32_16x16x32_bf16 v[52:55], v[224:227], v[132:135], v[52:55]
    v_mfma_f32_16x16x32_bf16 v[56:59], v[224:227], v[136:139], v[56:59]
    v_mfma_f32_16x16x32_bf16 v[60:63], v[224:227], v[140:143], v[60:63]
    v_mfma_f32_16x16x32_bf16 v[64:67], v[228:231], v[128:131], v[64:67]
    v_mfma_f32_16x16x32_bf16 v[68:71], v[228:231], v[132:135], v[68:71]
    v_mfma_f32_16x16x32_bf16 v[72:75], v[228:231], v[136:139], v[72:75]
    v_mfma_f32_16x16x32_bf16 v[76:79], v[228:231], v[140:143], v[76:79]
    s_waitcnt vmcnt(4)
    v_mfma_f32_16x16x16_bf16 v[0:3], v[232:233], v[144:145], v[0:3]
    v_mfma_f32_16x16x16_bf16 v[4:7], v[232:233], v[146:147], v[4:7]
    v_mfma_f32_16x16x16_bf16 v[8:11], v[232:233], v[148:149], v[8:11]
    v_mfma_f32_16x16x16_bf16 v[12:15], v[232:233], v[150:151], v[12:15]
    v_mfma_f32_16x16x16_bf16 v[16:19], v[234:235], v[144:145], v[16:19]
    v_mfma_f32_16x16x16_bf16 v[20:23], v[234:235], v[146:147], v[20:23]
    v_mfma_f32_16x16x16_bf16 v[24:27], v[234:235], v[148:149], v[24:27]
    v_mfma_f32_16x16x16_bf16 v[28:31], v[234:235], v[150:151], v[28:31]
    v_mfma_f32_16x16x16_bf16 v[32:35], v[236:237], v[144:145], v[32:35]
    v_mfma_f32_16x16x16_bf16 v[36:39], v[236:237], v[146:147], v[36:39]
    v_mfma_f32_16x16x16_bf16 v[40:43], v[236:237], v[148:149], v[40:43]
    v_mfma_f32_16x16x16_bf16 v[44:47], v[236:237], v[150:151], v[44:47]
    v_mfma_f32_16x16x16_bf16 v[48:51], v[238:239], v[144:145], v[48:51]
    v_mfma_f32_16x16x16_bf16 v[52:55], v[238:239], v[146:147], v[52:55]
    v_mfma_f32_16x16x16_bf16 v[56:59], v[238:239], v[148:149], v[56:59]
    v_mfma_f32_16x16x16_bf16 v[60:63], v[238:239], v[150:151], v[60:63]
    v_mfma_f32_16x16x16_bf16 v[64:67], v[240:241], v[144:145], v[64:67]
    v_mfma_f32_16x16x16_bf16 v[68:71], v[240:241], v[146:147], v[68:71]
    v_mfma_f32_16x16x16_bf16 v[72:75], v[240:241], v[148:149], v[72:75]
    v_mfma_f32_16x16x16_bf16 v[76:79], v[240:241], v[150:151], v[76:79]
    s_mov_b32 s62, 0
    s_waitcnt vmcnt(3)
    s_mov_b32 exec_lo, 0xffffffff
    s_mov_b32 exec_hi, 0xf
parallel_sum__ssm_conv_s4__mixer_gmlp__prompt_kernel_yp22:
    v_cmp_ne_u32 vcc, s23, v248
    v_cmp_ne_u32 s[60:61], s23, v249
    s_nop 0
    s_or_b64 vcc, vcc, s[60:61]
    v_cmp_ne_u32 s[60:61], s23, v250
    s_nop 0
    s_or_b64 vcc, vcc, s[60:61]
    v_cmp_ne_u32 s[60:61], s23, v251
    s_nop 0
    s_or_b64 vcc, vcc, s[60:61]
    s_cbranch_vccz parallel_sum__ssm_conv_s4__mixer_gmlp__prompt_kernel_ypd23
    s_add_u32 s62, s62, 1
    s_cmp_ge_u32 s62, 16384
    s_cbranch_scc1 parallel_sum__ssm_conv_s4__mixer_gmlp__prompt_kernel_ypd23
    buffer_load_dwordx4 v[248:251], v247, s[16:19], s30 offen sc1
    s_waitcnt vmcnt(0)
    s_branch parallel_sum__ssm_conv_s4__mixer_gmlp__prompt_kernel_yp22
parallel_sum__ssm_conv_s4__mixer_gmlp__prompt_kernel_ypd23:
    s_mov_b64 exec, -1
    v_lshrrev_b32 v100, 3, v255
    v_and_b32 v101, 7, v255
    v_lshlrev_b32 v100, 12, v100
    v_lshl_add_u32 v100, v101, 4, v100
    s_mul_i32 s30, s21, 294912
    s_lshl_b32 s31, s20, 7
    s_add_u32 s30, s30, s31
    s_lshl_b32 s31, s22, 15
    s_add_u32 s30, s30, s31
    s_lshl_b32 s31, s22, 10
    s_add_u32 m0, s31, 129024
    s_nop 0
    buffer_load_dwordx4 v100, s[36:39], s30 offen sc1 lds
    s_add_u32 s30, s30, 131072
    s_add_u32 m0, s31, 133120
    s_nop 0
    buffer_load_dwordx4 v100, s[36:39], s30 offen sc1 lds
    s_cmp_lg_u32 s22, 0
    s_cbranch_scc1 fz_y2
    s_add_u32 s30, s30, 131072
    s_mov_b32 m0, 137216
    s_nop 0
    buffer_load_dwordx4 v100, s[36:39], s30 offen sc1 lds
fz_y2:
    ds_write_b128 v244, v[0:3] offset:0
    ds_write_b128 v244, v[4:7] offset:5376
    ds_write_b128 v244, v[8:11] offset:10752
    ds_write_b128 v244, v[12:15] offset:16128
    ds_write_b128 v244, v[16:19] offset:64
    ds_write_b128 v244, v[20:23] offset:5440
    ds_write_b128 v244, v[24:27] offset:10816
    ds_write_b128 v244, v[28:31] offset:16192
    ds_write_b128 v244, v[32:35] offset:128
    ds_write_b128 v244, v[36:39] offset:5504
    ds_write_b128 v244, v[40:43] offset:10880
    ds_write_b128 v244, v[44:47] offset:16256
    ds_write_b128 v244, v[48:51] offset:192
    ds_write_b128 v244, v[52:55] offset:5568
    ds_write_b128 v244, v[56:59] offset:10944
    ds_write_b128 v244, v[60:63] offset:16320
    ds_write_b128 v244, v[64:67] offset:256
    ds_write_b128 v244, v[68:71] offset:5632
    ds_write_b128 v244, v[72:75] offset:11008
    ds_write_b128 v244, v[76:79] offset:16384
    s_waitcnt lgkmcnt(0)
    s_barrier
    v_mul_u32_u24 v244, 336, v255
    s_lshl_b32 s30, s22, 5
    v_add_u32 v244, s30, v244
    v_add_u32 v246, 139264, v244
    v_lshlrev_b32 v245, 1, v255
    s_lshl_b32 s30, s22, 10
    s_add_u32 s30, s30, 129024
    v_add_u32 v245, s30, v245
    ds_read_b128 v[0:3], v244 offset:0
    ds_read_b128 v[4:7], v244 offset:16
    ds_read_b128 v[8:11], v244 offset:21504
    ds_read_b128 v[12:15], v244 offset:21520
    ds_read_b128 v[16:19], v244 offset:43008
    ds_read_b128 v[20:23], v244 offset:43024
    ds_read_b128 v[24:27], v246 offset:0
    ds_read_b128 v[28:31], v246 offset:16
    s_waitcnt vmcnt(0)
    ds_read_u16 v40, v245 offset:0
    ds_read_u16 v41, v245 offset:128
    ds_read_u16 v42, v245 offset:256
    ds_read_u16 v43, v245 offset:384
    ds_read_u16 v44, v245 offset:512
    ds_read_u16 v45, v245 offset:640
    ds_read_u16 v46, v245 offset:768
    ds_read_u16 v47, v245 offset:896
    s_waitcnt lgkmcnt(0)
    v_pk_add_f32 v[0:1], v[0:1], v[8:9]
    v_pk_add_f32 v[16:17], v[16:17], v[24:25]
    v_pk_add_f32 v[0:1], v[0:1], v[16:17]
    v_lshlrev_b32 v50, 16, v80
    v_and_b32 v51, 0xffff0000, v80
    v_lshlrev_b32 v52, 16, v40
    v_lshlrev_b32 v53, 16, v41
    v_pk_add_f32 v[50:51], v[50:51], v[52:53]
    v_pk_add_f32 v[0:1], v[0:1], v[50:51]
    v_cvt_pk_bf16_f32 v56, v0, v1
    v_pk_add_f32 v[2:3], v[2:3], v[10:11]
    v_pk_add_f32 v[18:19], v[18:19], v[26:27]
    v_pk_add_f32 v[2:3], v[2:3], v[18:19]
    v_lshlrev_b32 v50, 16, v81
    v_and_b32 v51, 0xffff0000, v81
    v_lshlrev_b32 v52, 16, v42
    v_lshlrev_b32 v53, 16, v43
    v_pk_add_f32 v[50:51], v[50:51], v[52:53]
    v_pk_add_f32 v[2:3], v[2:3], v[50:51]
    v_cvt_pk_bf16_f32 v57, v2, v3
    v_pk_add_f32 v[4:5], v[4:5], v[12:13]
    v_pk_add_f32 v[20:21], v[20:21], v[28:29]
    v_pk_add_f32 v[4:5], v[4:5], v[20:21]
    v_lshlrev_b32 v50, 16, v82
    v_and_b32 v51, 0xffff0000, v82
    v_lshlrev_b32 v52, 16, v44
    v_lshlrev_b32 v53, 16, v45
    v_pk_add_f32 v[50:51], v[50:51], v[52:53]
    v_pk_add_f32 v[4:5], v[4:5], v[50:51]
    v_cvt_pk_bf16_f32 v58, v4, v5
    v_pk_add_f32 v[6:7], v[6:7], v[14:15]
    v_pk_add_f32 v[22:23], v[22:23], v[30:31]
    v_pk_add_f32 v[6:7], v[6:7], v[22:23]
    v_lshlrev_b32 v50, 16, v83
    v_and_b32 v51, 0xffff0000, v83
    v_lshlrev_b32 v52, 16, v46
    v_lshlrev_b32 v53, 16, v47
    v_pk_add_f32 v[50:51], v[50:51], v[52:53]
    v_pk_add_f32 v[6:7], v[6:7], v[50:51]
    v_cvt_pk_bf16_f32 v59, v6, v7
    buffer_store_dwordx4 v[56:59], v243, s[44:47], 0 offen offset:0
    ds_read_b128 v[0:3], v244 offset:128
    ds_read_b128 v[4:7], v244 offset:144
    ds_read_b128 v[8:11], v244 offset:21632
    ds_read_b128 v[12:15], v244 offset:21648
    ds_read_b128 v[16:19], v244 offset:43136
    ds_read_b128 v[20:23], v244 offset:43152
    ds_read_b128 v[24:27], v246 offset:128
    ds_read_b128 v[28:31], v246 offset:144
    ds_read_u16 v40, v245 offset:4096
    ds_read_u16 v41, v245 offset:4224
    ds_read_u16 v42, v245 offset:4352
    ds_read_u16 v43, v245 offset:4480
    ds_read_u16 v44, v245 offset:4608
    ds_read_u16 v45, v245 offset:4736
    ds_read_u16 v46, v245 offset:4864
    ds_read_u16 v47, v245 offset:4992
    s_waitcnt lgkmcnt(0)
    v_pk_add_f32 v[0:1], v[0:1], v[8:9]
    v_pk_add_f32 v[16:17], v[16:17], v[24:25]
    v_pk_add_f32 v[0:1], v[0:1], v[16:17]
    v_lshlrev_b32 v50, 16, v84
    v_and_b32 v51, 0xffff0000, v84
    v_lshlrev_b32 v52, 16, v40
    v_lshlrev_b32 v53, 16, v41
    v_pk_add_f32 v[50:51], v[50:51], v[52:53]
    v_pk_add_f32 v[0:1], v[0:1], v[50:51]
    v_cvt_pk_bf16_f32 v60, v0, v1
    v_pk_add_f32 v[2:3], v[2:3], v[10:11]
    v_pk_add_f32 v[18:19], v[18:19], v[26:27]
    v_pk_add_f32 v[2:3], v[2:3], v[18:19]
    v_lshlrev_b32 v50, 16, v85
    v_and_b32 v51, 0xffff0000, v85
    v_lshlrev_b32 v52, 16, v42
    v_lshlrev_b32 v53, 16, v43
    v_pk_add_f32 v[50:51], v[50:51], v[52:53]
    v_pk_add_f32 v[2:3], v[2:3], v[50:51]
    v_cvt_pk_bf16_f32 v61, v2, v3
    v_pk_add_f32 v[4:5], v[4:5], v[12:13]
    v_pk_add_f32 v[20:21], v[20:21], v[28:29]
    v_pk_add_f32 v[4:5], v[4:5], v[20:21]
    v_lshlrev_b32 v50, 16, v86
    v_and_b32 v51, 0xffff0000, v86
    v_lshlrev_b32 v52, 16, v44
    v_lshlrev_b32 v53, 16, v45
    v_pk_add_f32 v[50:51], v[50:51], v[52:53]
    v_pk_add_f32 v[4:5], v[4:5], v[50:51]
    v_cvt_pk_bf16_f32 v62, v4, v5
    v_pk_add_f32 v[6:7], v[6:7], v[14:15]
    v_pk_add_f32 v[22:23], v[22:23], v[30:31]
    v_pk_add_f32 v[6:7], v[6:7], v[22:23]
    v_lshlrev_b32 v50, 16, v87
    v_and_b32 v51, 0xffff0000, v87
    v_lshlrev_b32 v52, 16, v46
    v_lshlrev_b32 v53, 16, v47
    v_pk_add_f32 v[50:51], v[50:51], v[52:53]
    v_pk_add_f32 v[6:7], v[6:7], v[50:51]
    v_cvt_pk_bf16_f32 v63, v6, v7
    buffer_store_dwordx4 v[60:63], v243, s[44:47], 0 offen offset:64
    s_cmp_lg_u32 s22, 0
    s_cbranch_scc1 fz_fin
    ds_read_b128 v[0:3], v244 offset:256
    ds_read_b128 v[4:7], v244 offset:272
    ds_read_b128 v[8:11], v244 offset:21760
    ds_read_b128 v[12:15], v244 offset:21776
    ds_read_b128 v[16:19], v244 offset:43264
    ds_read_b128 v[20:23], v244 offset:43280
    ds_read_b128 v[24:27], v246 offset:256
    ds_read_b128 v[28:31], v246 offset:272
    ds_read_u16 v40, v245 offset:8192
    ds_read_u16 v41, v245 offset:8320
    ds_read_u16 v42, v245 offset:8448
    ds_read_u16 v43, v245 offset:8576
    ds_read_u16 v44, v245 offset:8704
    ds_read_u16 v45, v245 offset:8832
    ds_read_u16 v46, v245 offset:8960
    ds_read_u16 v47, v245 offset:9088
    s_waitcnt lgkmcnt(0)
    v_pk_add_f32 v[0:1], v[0:1], v[8:9]
    v_pk_add_f32 v[16:17], v[16:17], v[24:25]
    v_pk_add_f32 v[0:1], v[0:1], v[16:17]
    v_lshlrev_b32 v50, 16, v88
    v_and_b32 v51, 0xffff0000, v88
    v_lshlrev_b32 v52, 16, v40
    v_lshlrev_b32 v53, 16, v41
    v_pk_add_f32 v[50:51], v[50:51], v[52:53]
    v_pk_add_f32 v[0:1], v[0:1], v[50:51]
    v_cvt_pk_bf16_f32 v64, v0, v1
    v_pk_add_f32 v[2:3], v[2:3], v[10:11]
    v_pk_add_f32 v[18:19], v[18:19], v[26:27]
    v_pk_add_f32 v[2:3], v[2:3], v[18:19]
    v_lshlrev_b32 v50, 16, v89
    v_and_b32 v51, 0xffff0000, v89
    v_lshlrev_b32 v52, 16, v42
    v_lshlrev_b32 v53, 16, v43
    v_pk_add_f32 v[50:51], v[50:51], v[52:53]
    v_pk_add_f32 v[2:3], v[2:3], v[50:51]
    v_cvt_pk_bf16_f32 v65, v2, v3
    v_pk_add_f32 v[4:5], v[4:5], v[12:13]
    v_pk_add_f32 v[20:21], v[20:21], v[28:29]
    v_pk_add_f32 v[4:5], v[4:5], v[20:21]
    v_lshlrev_b32 v50, 16, v90
    v_and_b32 v51, 0xffff0000, v90
    v_lshlrev_b32 v52, 16, v44
    v_lshlrev_b32 v53, 16, v45
    v_pk_add_f32 v[50:51], v[50:51], v[52:53]
    v_pk_add_f32 v[4:5], v[4:5], v[50:51]
    v_cvt_pk_bf16_f32 v66, v4, v5
    v_pk_add_f32 v[6:7], v[6:7], v[14:15]
    v_pk_add_f32 v[22:23], v[22:23], v[30:31]
    v_pk_add_f32 v[6:7], v[6:7], v[22:23]
    v_lshlrev_b32 v50, 16, v91
    v_and_b32 v51, 0xffff0000, v91
    v_lshlrev_b32 v52, 16, v46
    v_lshlrev_b32 v53, 16, v47
    v_pk_add_f32 v[50:51], v[50:51], v[52:53]
    v_pk_add_f32 v[6:7], v[6:7], v[50:51]
    v_cvt_pk_bf16_f32 v67, v6, v7
    buffer_store_dwordx4 v[64:67], v243, s[44:47], 0 offen offset:128
    s_cmp_lg_u32 s2, 0
    s_cbranch_scc1 fz_fin
    v_mov_b32 v0, 0
    v_mov_b32 v1, s23
    s_mov_b64 exec, 1
    buffer_store_dword v1, v0, s[16:19], 0 offen
    s_mov_b64 exec, -1
    s_branch fz_fin
fz_loader:
    s_setprio 0
    v_mov_b32 v198, 0
    v_mov_b32 v199, 0
    v_mov_b32 v200, 0
    v_mov_b32 v201, 0
    v_mov_b32 v202, 0
    v_mov_b32 v203, 0
    v_mov_b32 v204, 0
    v_mov_b32 v205, 0
    v_mov_b32 v206, 0
    v_mov_b32 v207, 0
    v_mov_b32 v208, 0
    v_mov_b32 v209, 0
    v_mov_b32 v210, 0
    v_mov_b32 v211, 0
    v_mov_b32 v212, 0
    v_mov_b32 v213, 0
    s_cmp_ge_u32 s58, 576
    s_cbranch_scc1 fz_nk0
    s_mov_b32 s54, 0x3fb8aa3b
    s_mov_b32 s55, 0x3e22f983
    v_mov_b32 v0, 0
    v_mov_b32 v1, 0
    v_mov_b32 v2, 0
    v_mov_b32 v3, 0
    v_mov_b32 v4, 0
    v_mov_b32 v5, 0
    v_mov_b32 v6, 0
    v_mov_b32 v7, 0
    v_mov_b32 v8, 0
    v_mov_b32 v9, 0
    v_mov_b32 v10, 0
    v_mov_b32 v11, 0
    v_mov_b32 v12, 0
    v_mov_b32 v13, 0
    v_mov_b32 v14, 0
    v_mov_b32 v15, 0
    v_mov_b32 v16, 0
    v_mov_b32 v17, 0
    v_mov_b32 v18, 0
    v_mov_b32 v19, 0
    v_mov_b32 v20, 0
    v_mov_b32 v21, 0
    v_mov_b32 v22, 0
    v_mov_b32 v23, 0
    v_mov_b32 v24, 0
    v_mov_b32 v25, 0
    v_mov_b32 v26, 0
    v_mov_b32 v27, 0
    v_mov_b32 v28, 0
    v_mov_b32 v29, 0
    v_mov_b32 v30, 0
    v_mov_b32 v31, 0
    v_mov_b32 v32, 0
    v_mov_b32 v33, 0
    v_mov_b32 v34, 0
    v_mov_b32 v35, 0
    v_mov_b32 v36, 0
    v_mov_b32 v37, 0
    v_mov_b32 v38, 0
    v_mov_b32 v39, 0
    v_lshlrev_b32 v44, 16, v196
    v_lshlrev_b32 v168, 16, v197
    v_mul_f32 v45, 0x3fb8aa3b, v44
    v_fma_f32 v46, v44, s54, -v45
    v_fmac_f32 v46, 0x32a57060, v44
    v_exp_f32 v45, v45
    v_mul_f32 v46, 0x3f317218, v46
    v_fma_f32 v169, v45, v46, v45
    v_cvt_pk_bf16_f32 v169, v169, v169
    v_lshlrev_b32 v169, 16, v169
    s_mov_b32 s53, 0
fz_kg:
    v_lshlrev_b32 v220, 16, v170
    v_lshlrev_b32 v221, 16, v171
    v_lshlrev_b32 v222, 16, v172
    v_lshlrev_b32 v223, 16, v173
    v_lshlrev_b32 v224, 16, v174
    v_lshlrev_b32 v225, 16, v175
    v_mul_f32 v220, v169, v220
    v_mul_f32 v221, v169, v221
    v_mul_f32 v222, v169, v222
    v_mul_f32 v223, v169, v223
    v_mul_f32 v226, v224, v222
    v_mul_f32 v227, v224, v223
    v_fma_f32 v226, -v225, v223, v226
    v_fma_f32 v227, v225, v222, v227
    v_mul_f32 v108, 16.0, v220
    v_mul_f32 v112, 512.0, v220
    v_mul_f32 v116, 64.0, v220
    v_mul_f32 v120, 1.0, v220
    v_mul_f32 v109, 16.0, v221
    v_mul_f32 v113, 512.0, v221
    v_mul_f32 v117, 64.0, v221
    v_mul_f32 v121, 1.0, v221
    v_mul_f32 v108, s54, v108
    v_mul_f32 v112, s54, v112
    v_mul_f32 v116, s54, v116
    v_mul_f32 v120, s54, v120
    v_mul_f32 v110, s55, v109
    v_mul_f32 v114, s55, v113
    v_mul_f32 v118, s55, v117
    v_mul_f32 v122, s55, v121
    v_exp_f32 v108, v108
    v_exp_f32 v112, v112
    v_exp_f32 v116, v116
    v_exp_f32 v120, v120
    v_fma_f32 v111, v109, s55, -v110
    v_fma_f32 v115, v113, s55, -v114
    v_fma_f32 v119, v117, s55, -v118
    v_fma_f32 v123, v121, s55, -v122
    v_fmac_f32 v111, 0x31dc9c88, v109
    v_fmac_f32 v115, 0x31dc9c88, v113
    v_fmac_f32 v119, 0x31dc9c88, v117
    v_fmac_f32 v123, 0x31dc9c88, v121
    v_fract_f32 v110, v110
    v_fract_f32 v114, v114
    v_fract_f32 v118, v118
    v_fract_f32 v122, v122
    v_add_f32 v110, v110, v111
    v_add_f32 v114, v114, v115
    v_add_f32 v118, v118, v119
    v_add_f32 v122, v122, v123
    v_cos_f32 v230, v110
    v_cos_f32 v234, v114
    v_cos_f32 v232, v118
    v_cos_f32 v228, v122
    v_sin_f32 v231, v110
    v_sin_f32 v235, v114
    v_sin_f32 v233, v118
    v_sin_f32 v229, v122
    v_mul_f32 v230, v108, v230
    v_mul_f32 v234, v112, v234
    v_mul_f32 v232, v116, v232
    v_mul_f32 v228, v120, v228
    v_mul_f32 v231, v108, v231
    v_mul_f32 v235, v112, v235
    v_mul_f32 v233, v116, v233
    v_mul_f32 v229, v120, v229
    v_pk_mul_f32 v[244:245], v[226:227], v[234:235] op_sel_hi:[0,1]
    v_pk_fma_f32 v[244:245], v[226:227], v[234:235], v[244:245] op_sel:[1,1,0] op_sel_hi:[1,0,1] neg_lo:[1,0,0]
    v_pk_mul_f32 v[242:243], v[226:227], v[230:231] op_sel_hi:[0,1]
    v_pk_mul_f32 v[246:247], v[244:245], v[232:233] op_sel_hi:[0,1]
    v_cvt_pk_bf16_f32 v250, v226, v227
    v_cvt_pk_bf16_f32 v251, v244, v245
    v_pk_fma_f32 v[242:243], v[226:227], v[230:231], v[242:243] op_sel:[1,1,0] op_sel_hi:[1,0,1] neg_lo:[1,0,0]
    v_pk_fma_f32 v[246:247], v[244:245], v[232:233], v[246:247] op_sel:[1,1,0] op_sel_hi:[1,0,1] neg_lo:[1,0,0]
    s_cmp_lg_u32 s53, 0
    s_cbranch_scc1 fz_kgb
    s_barrier
fz_kgb:
    ds_write_b32 v150, v250 offset:0
    ds_write_b32 v150, v251 offset:4096
    v_pk_mul_f32 v[252:253], v[242:243], v[230:231] op_sel_hi:[0,1]
    v_pk_mul_f32 v[248:249], v[246:247], v[232:233] op_sel_hi:[0,1]
    v_cvt_pk_bf16_f32 v250, v242, v243
    v_cvt_pk_bf16_f32 v251, v246, v247
    v_pk_fma_f32 v[252:253], v[242:243], v[230:231], v[252:253] op_sel:[1,1,0] op_sel_hi:[1,0,1] neg_lo:[1,0,0]
    v_pk_fma_f32 v[248:249], v[246:247], v[232:233], v[248:249] op_sel:[1,1,0] op_sel_hi:[1,0,1] neg_lo:[1,0,0]
    ds_write_b32 v151, v250 offset:256
    ds_write_b32 v151, v251 offset:4352
    v_pk_mul_f32 v[240:241], v[252:253], v[230:231] op_sel_hi:[0,1]
    v_pk_mul_f32 v[244:245], v[248:249], v[232:233] op_sel_hi:[0,1]
    v_cvt_pk_bf16_f32 v250, v252, v253
    v_cvt_pk_bf16_f32 v251, v248, v249
    v_pk_fma_f32 v[240:241], v[252:253], v[230:231], v[240:241] op_sel:[1,1,0] op_sel_hi:[1,0,1] neg_lo:[1,0,0]
    v_pk_fma_f32 v[244:245], v[248:249], v[232:233], v[244:245] op_sel:[1,1,0] op_sel_hi:[1,0,1] neg_lo:[1,0,0]
    ds_write_b32 v152, v250 offset:512
    ds_write_b32 v152, v251 offset:4608
    v_pk_mul_f32 v[242:243], v[240:241], v[230:231] op_sel_hi:[0,1]
    v_pk_mul_f32 v[246:247], v[244:245], v[232:233] op_sel_hi:[0,1]
    v_cvt_pk_bf16_f32 v250, v240, v241
    v_cvt_pk_bf16_f32 v251, v244, v245
    v_pk_fma_f32 v[242:243], v[240:241], v[230:231], v[242:243] op_sel:[1,1,0] op_sel_hi:[1,0,1] neg_lo:[1,0,0]
    v_pk_fma_f32 v[246:247], v[244:245], v[232:233], v[246:247] op_sel:[1,1,0] op_sel_hi:[1,0,1] neg_lo:[1,0,0]
    ds_write_b32 v153, v250 offset:768
    ds_write_b32 v153, v251 offset:4864
    v_pk_mul_f32 v[252:253], v[242:243], v[230:231] op_sel_hi:[0,1]
    v_pk_mul_f32 v[248:249], v[246:247], v[232:233] op_sel_hi:[0,1]
    v_cvt_pk_bf16_f32 v250, v242, v243
    v_cvt_pk_bf16_f32 v251, v246, v247
    v_pk_fma_f32 v[252:253], v[242:243], v[230:231], v[252:253] op_sel:[1,1,0] op_sel_hi:[1,0,1] neg_lo:[1,0,0]
    v_pk_fma_f32 v[248:249], v[246:247], v[232:233], v[248:249] op_sel:[1,1,0] op_sel_hi:[1,0,1] neg_lo:[1,0,0]
    ds_write_b32 v154, v250 offset:1024
    ds_write_b32 v154, v251 offset:5120
    v_pk_mul_f32 v[240:241], v[252:253], v[230:231] op_sel_hi:[0,1]
    v_pk_mul_f32 v[244:245], v[248:249], v[232:233] op_sel_hi:[0,1]
    v_cvt_pk_bf16_f32 v250, v252, v253
    v_cvt_pk_bf16_f32 v251, v248, v249
    v_pk_fma_f32 v[240:241], v[252:253], v[230:231], v[240:241] op_sel:[1,1,0] op_sel_hi:[1,0,1] neg_lo:[1,0,0]
    v_pk_fma_f32 v[244:245], v[248:249], v[232:233], v[244:245] op_sel:[1,1,0] op_sel_hi:[1,0,1] neg_lo:[1,0,0]
    ds_write_b32 v155, v250 offset:1280
    ds_write_b32 v155, v251 offset:5376
    v_pk_mul_f32 v[242:243], v[240:241], v[230:231] op_sel_hi:[0,1]
    v_pk_mul_f32 v[246:247], v[244:245], v[232:233] op_sel_hi:[0,1]
    v_cvt_pk_bf16_f32 v250, v240, v241
    v_cvt_pk_bf16_f32 v251, v244, v245
    v_pk_fma_f32 v[242:243], v[240:241], v[230:231], v[242:243] op_sel:[1,1,0] op_sel_hi:[1,0,1] neg_lo:[1,0,0]
    v_pk_fma_f32 v[246:247], v[244:245], v[232:233], v[246:247] op_sel:[1,1,0] op_sel_hi:[1,0,1] neg_lo:[1,0,0]
    ds_write_b32 v156, v250 offset:1536
    ds_write_b32 v156, v251 offset:5632
    v_pk_mul_f32 v[252:253], v[242:243], v[230:231] op_sel_hi:[0,1]
    v_pk_mul_f32 v[248:249], v[246:247], v[232:233] op_sel_hi:[0,1]
    v_cvt_pk_bf16_f32 v250, v242, v243
    v_cvt_pk_bf16_f32 v251, v246, v247
    v_pk_fma_f32 v[252:253], v[242:243], v[230:231], v[252:253] op_sel:[1,1,0] op_sel_hi:[1,0,1] neg_lo:[1,0,0]
    v_pk_fma_f32 v[248:249], v[246:247], v[232:233], v[248:249] op_sel:[1,1,0] op_sel_hi:[1,0,1] neg_lo:[1,0,0]
    ds_write_b32 v157, v250 offset:1792
    ds_write_b32 v157, v251 offset:5888
    ds_read_b128 v[76:79], v140 offset:4096
    ds_read_b128 v[80:83], v141 offset:4096
    ds_read_b128 v[84:87], v142 offset:4096
    ds_read_b128 v[88:91], v143 offset:4096
    v_pk_mul_f32 v[240:241], v[252:253], v[230:231] op_sel_hi:[0,1]
    v_pk_mul_f32 v[244:245], v[248:249], v[232:233] op_sel_hi:[0,1]
    v_cvt_pk_bf16_f32 v250, v252, v253
    v_cvt_pk_bf16_f32 v251, v248, v249
    v_pk_fma_f32 v[240:241], v[252:253], v[230:231], v[240:241] op_sel:[1,1,0] op_sel_hi:[1,0,1] neg_lo:[1,0,0]
    v_pk_fma_f32 v[244:245], v[248:249], v[232:233], v[244:245] op_sel:[1,1,0] op_sel_hi:[1,0,1] neg_lo:[1,0,0]
    ds_write_b32 v158, v250 offset:2048
    ds_write_b32 v150, v251 offset:4096
    v_pk_mul_f32 v[242:243], v[240:241], v[230:231] op_sel_hi:[0,1]
    v_pk_mul_f32 v[246:247], v[244:245], v[232:233] op_sel_hi:[0,1]
    v_cvt_pk_bf16_f32 v250, v240, v241
    v_cvt_pk_bf16_f32 v251, v244, v245
    v_pk_fma_f32 v[242:243], v[240:241], v[230:231], v[242:243] op_sel:[1,1,0] op_sel_hi:[1,0,1] neg_lo:[1,0,0]
    v_pk_fma_f32 v[246:247], v[244:245], v[232:233], v[246:247] op_sel:[1,1,0] op_sel_hi:[1,0,1] neg_lo:[1,0,0]
    ds_write_b32 v159, v250 offset:2304
    ds_write_b32 v151, v251 offset:4352
    v_pk_mul_f32 v[252:253], v[242:243], v[230:231] op_sel_hi:[0,1]
    v_pk_mul_f32 v[248:249], v[246:247], v[232:233] op_sel_hi:[0,1]
    v_cvt_pk_bf16_f32 v250, v242, v243
    v_cvt_pk_bf16_f32 v251, v246, v247
    v_pk_fma_f32 v[252:253], v[242:243], v[230:231], v[252:253] op_sel:[1,1,0] op_sel_hi:[1,0,1] neg_lo:[1,0,0]
    v_pk_fma_f32 v[248:249], v[246:247], v[232:233], v[248:249] op_sel:[1,1,0] op_sel_hi:[1,0,1] neg_lo:[1,0,0]
    ds_write_b32 v160, v250 offset:2560
    ds_write_b32 v152, v251 offset:4608
    v_pk_mul_f32 v[240:241], v[252:253], v[230:231] op_sel_hi:[0,1]
    v_pk_mul_f32 v[244:245], v[248:249], v[232:233] op_sel_hi:[0,1]
    v_cvt_pk_bf16_f32 v250, v252, v253
    v_cvt_pk_bf16_f32 v251, v248, v249
    v_pk_fma_f32 v[240:241], v[252:253], v[230:231], v[240:241] op_sel:[1,1,0] op_sel_hi:[1,0,1] neg_lo:[1,0,0]
    v_pk_fma_f32 v[244:245], v[248:249], v[232:233], v[244:245] op_sel:[1,1,0] op_sel_hi:[1,0,1] neg_lo:[1,0,0]
    ds_write_b32 v161, v250 offset:2816
    ds_write_b32 v153, v251 offset:4864
    v_pk_mul_f32 v[242:243], v[240:241], v[230:231] op_sel_hi:[0,1]
    v_pk_mul_f32 v[246:247], v[244:245], v[232:233] op_sel_hi:[0,1]
    v_cvt_pk_bf16_f32 v250, v240, v241
    v_cvt_pk_bf16_f32 v251, v244, v245
    v_pk_fma_f32 v[242:243], v[240:241], v[230:231], v[242:243] op_sel:[1,1,0] op_sel_hi:[1,0,1] neg_lo:[1,0,0]
    v_pk_fma_f32 v[246:247], v[244:245], v[232:233], v[246:247] op_sel:[1,1,0] op_sel_hi:[1,0,1] neg_lo:[1,0,0]
    ds_write_b32 v162, v250 offset:3072
    ds_write_b32 v154, v251 offset:5120
    v_pk_mul_f32 v[252:253], v[242:243], v[230:231] op_sel_hi:[0,1]
    v_pk_mul_f32 v[248:249], v[246:247], v[232:233] op_sel_hi:[0,1]
    v_cvt_pk_bf16_f32 v250, v242, v243
    v_cvt_pk_bf16_f32 v251, v246, v247
    v_pk_fma_f32 v[252:253], v[242:243], v[230:231], v[252:253] op_sel:[1,1,0] op_sel_hi:[1,0,1] neg_lo:[1,0,0]
    v_pk_fma_f32 v[248:249], v[246:247], v[232:233], v[248:249] op_sel:[1,1,0] op_sel_hi:[1,0,1] neg_lo:[1,0,0]
    ds_write_b32 v163, v250 offset:3328
    ds_write_b32 v155, v251 offset:5376
    v_pk_mul_f32 v[240:241], v[252:253], v[230:231] op_sel_hi:[0,1]
    v_pk_mul_f32 v[244:245], v[248:249], v[232:233] op_sel_hi:[0,1]
    v_cvt_pk_bf16_f32 v250, v252, v253
    v_cvt_pk_bf16_f32 v251, v248, v249
    v_pk_fma_f32 v[240:241], v[252:253], v[230:231], v[240:241] op_sel:[1,1,0] op_sel_hi:[1,0,1] neg_lo:[1,0,0]
    v_pk_fma_f32 v[244:245], v[248:249], v[232:233], v[244:245] op_sel:[1,1,0] op_sel_hi:[1,0,1] neg_lo:[1,0,0]
    ds_write_b32 v164, v250 offset:3584
    ds_write_b32 v156, v251 offset:5632
    v_pk_mul_f32 v[242:243], v[240:241], v[230:231] op_sel_hi:[0,1]
    v_pk_mul_f32 v[246:247], v[244:245], v[232:233] op_sel_hi:[0,1]
    v_cvt_pk_bf16_f32 v250, v240, v241
    v_cvt_pk_bf16_f32 v251, v244, v245
    v_pk_fma_f32 v[242:243], v[240:241], v[230:231], v[242:243] op_sel:[1,1,0] op_sel_hi:[1,0,1] neg_lo:[1,0,0]
    v_pk_fma_f32 v[246:247], v[244:245], v[232:233], v[246:247] op_sel:[1,1,0] op_sel_hi:[1,0,1] neg_lo:[1,0,0]
    ds_write_b32 v165, v250 offset:3840
    ds_read_b128 v[44:47], v140 offset:0
    ds_read_b128 v[48:51], v141 offset:0
    ds_read_b128 v[52:55], v142 offset:0
    ds_read_b128 v[56:59], v143 offset:0
    ds_write_b32 v157, v251 offset:5888
    v_pk_mul_f32 v[252:253], v[242:243], v[230:231] op_sel_hi:[0,1]
    v_pk_mul_f32 v[248:249], v[246:247], v[232:233] op_sel_hi:[0,1]
    v_cvt_pk_bf16_f32 v250, v242, v243
    v_cvt_pk_bf16_f32 v251, v246, v247
    v_pk_fma_f32 v[252:253], v[242:243], v[230:231], v[252:253] op_sel:[1,1,0] op_sel_hi:[1,0,1] neg_lo:[1,0,0]
    v_pk_fma_f32 v[248:249], v[246:247], v[232:233], v[248:249] op_sel:[1,1,0] op_sel_hi:[1,0,1] neg_lo:[1,0,0]
    ds_write_b32 v150, v250 offset:0
    ds_write_b32 v158, v251 offset:6144
    v_pk_mul_f32 v[240:241], v[252:253], v[230:231] op_sel_hi:[0,1]
    v_pk_mul_f32 v[244:245], v[248:249], v[232:233] op_sel_hi:[0,1]
    v_cvt_pk_bf16_f32 v250, v252, v253
    v_cvt_pk_bf16_f32 v251, v248, v249
    v_pk_fma_f32 v[240:241], v[252:253], v[230:231], v[240:241] op_sel:[1,1,0] op_sel_hi:[1,0,1] neg_lo:[1,0,0]
    v_pk_fma_f32 v[244:245], v[248:249], v[232:233], v[244:245] op_sel:[1,1,0] op_sel_hi:[1,0,1] neg_lo:[1,0,0]
    ds_write_b32 v151, v250 offset:256
    ds_write_b32 v159, v251 offset:6400
    v_pk_mul_f32 v[242:243], v[240:241], v[230:231] op_sel_hi:[0,1]
    v_pk_mul_f32 v[246:247], v[244:245], v[232:233] op_sel_hi:[0,1]
    v_cvt_pk_bf16_f32 v250, v240, v241
    v_cvt_pk_bf16_f32 v251, v244, v245
    v_pk_fma_f32 v[242:243], v[240:241], v[230:231], v[242:243] op_sel:[1,1,0] op_sel_hi:[1,0,1] neg_lo:[1,0,0]
    v_pk_fma_f32 v[246:247], v[244:245], v[232:233], v[246:247] op_sel:[1,1,0] op_sel_hi:[1,0,1] neg_lo:[1,0,0]
    ds_write_b32 v152, v250 offset:512
    ds_write_b32 v160, v251 offset:6656
    v_pk_mul_f32 v[252:253], v[242:243], v[230:231] op_sel_hi:[0,1]
    v_pk_mul_f32 v[248:249], v[246:247], v[232:233] op_sel_hi:[0,1]
    v_cvt_pk_bf16_f32 v250, v242, v243
    v_cvt_pk_bf16_f32 v251, v246, v247
    v_pk_fma_f32 v[252:253], v[242:243], v[230:231], v[252:253] op_sel:[1,1,0] op_sel_hi:[1,0,1] neg_lo:[1,0,0]
    v_pk_fma_f32 v[248:249], v[246:247], v[232:233], v[248:249] op_sel:[1,1,0] op_sel_hi:[1,0,1] neg_lo:[1,0,0]
    ds_write_b32 v153, v250 offset:768
    ds_write_b32 v161, v251 offset:6912
    v_pk_mul_f32 v[240:241], v[252:253], v[230:231] op_sel_hi:[0,1]
    v_pk_mul_f32 v[244:245], v[248:249], v[232:233] op_sel_hi:[0,1]
    v_cvt_pk_bf16_f32 v250, v252, v253
    v_cvt_pk_bf16_f32 v251, v248, v249
    v_pk_fma_f32 v[240:241], v[252:253], v[230:231], v[240:241] op_sel:[1,1,0] op_sel_hi:[1,0,1] neg_lo:[1,0,0]
    v_pk_fma_f32 v[244:245], v[248:249], v[232:233], v[244:245] op_sel:[1,1,0] op_sel_hi:[1,0,1] neg_lo:[1,0,0]
    ds_write_b32 v154, v250 offset:1024
    ds_write_b32 v162, v251 offset:7168
    v_pk_mul_f32 v[242:243], v[240:241], v[230:231] op_sel_hi:[0,1]
    v_pk_mul_f32 v[246:247], v[244:245], v[232:233] op_sel_hi:[0,1]
    v_cvt_pk_bf16_f32 v250, v240, v241
    v_cvt_pk_bf16_f32 v251, v244, v245
    v_pk_fma_f32 v[242:243], v[240:241], v[230:231], v[242:243] op_sel:[1,1,0] op_sel_hi:[1,0,1] neg_lo:[1,0,0]
    v_pk_fma_f32 v[246:247], v[244:245], v[232:233], v[246:247] op_sel:[1,1,0] op_sel_hi:[1,0,1] neg_lo:[1,0,0]
    ds_write_b32 v155, v250 offset:1280
    ds_write_b32 v163, v251 offset:7424
    v_pk_mul_f32 v[252:253], v[242:243], v[230:231] op_sel_hi:[0,1]
    v_pk_mul_f32 v[248:249], v[246:247], v[232:233] op_sel_hi:[0,1]
    v_cvt_pk_bf16_f32 v250, v242, v243
    v_cvt_pk_bf16_f32 v251, v246, v247
    v_pk_fma_f32 v[252:253], v[242:243], v[230:231], v[252:253] op_sel:[1,1,0] op_sel_hi:[1,0,1] neg_lo:[1,0,0]
    v_pk_fma_f32 v[248:249], v[246:247], v[232:233], v[248:249] op_sel:[1,1,0] op_sel_hi:[1,0,1] neg_lo:[1,0,0]
    ds_write_b32 v156, v250 offset:1536
    ds_write_b32 v164, v251 offset:7680
    v_pk_mul_f32 v[240:241], v[252:253], v[230:231] op_sel_hi:[0,1]
    v_pk_mul_f32 v[222:223], v[228:229], v[228:229] op_sel_hi:[0,1]
    v_cvt_pk_bf16_f32 v250, v252, v253
    v_cvt_pk_bf16_f32 v251, v248, v249
    v_pk_fma_f32 v[240:241], v[252:253], v[230:231], v[240:241] op_sel:[1,1,0] op_sel_hi:[1,0,1] neg_lo:[1,0,0]
    v_pk_fma_f32 v[222:223], v[228:229], v[228:229], v[222:223] op_sel:[1,1,0] op_sel_hi:[1,0,1] neg_lo:[1,0,0]
    ds_write_b32 v157, v250 offset:1792
    ds_write_b32 v165, v251 offset:7936
    ds_read_b128 v[92:95], v140 offset:4096
    ds_read_b128 v[96:99], v141 offset:4096
    s_cmp_lg_u32 s53, 0
    s_cbranch_scc1 fz_kgc
    s_barrier
fz_kgc:
    ds_read_b128 v[100:103], v142 offset:4096
    ds_read_b128 v[104:107], v143 offset:4096
    v_pk_mul_f32 v[242:243], v[240:241], v[230:231] op_sel_hi:[0,1]
    v_cvt_pk_bf16_f32 v250, v240, v241
    v_pk_fma_f32 v[242:243], v[240:241], v[230:231], v[242:243] op_sel:[1,1,0] op_sel_hi:[1,0,1] neg_lo:[1,0,0]
    ds_write_b32 v158, v250 offset:2048
    v_pk_mul_f32 v[252:253], v[242:243], v[230:231] op_sel_hi:[0,1]
    v_pk_mul_f32 v[224:225], v[222:223], v[228:229] op_sel_hi:[0,1]
    v_cvt_pk_bf16_f32 v250, v242, v243
    v_pk_fma_f32 v[252:253], v[242:243], v[230:231], v[252:253] op_sel:[1,1,0] op_sel_hi:[1,0,1] neg_lo:[1,0,0]
    v_pk_fma_f32 v[224:225], v[222:223], v[228:229], v[224:225] op_sel:[1,1,0] op_sel_hi:[1,0,1] neg_lo:[1,0,0]
    ds_write_b32 v159, v250 offset:2304
    v_pk_mul_f32 v[240:241], v[252:253], v[230:231] op_sel_hi:[0,1]
    v_cvt_pk_bf16_f32 v250, v252, v253
    v_pk_fma_f32 v[240:241], v[252:253], v[230:231], v[240:241] op_sel:[1,1,0] op_sel_hi:[1,0,1] neg_lo:[1,0,0]
    ds_write_b32 v160, v250 offset:2560
    v_pk_mul_f32 v[242:243], v[240:241], v[230:231] op_sel_hi:[0,1]
    v_pk_mul_f32 v[236:237], v[224:225], v[228:229] op_sel_hi:[0,1]
    v_cvt_pk_bf16_f32 v250, v240, v241
    v_pk_fma_f32 v[242:243], v[240:241], v[230:231], v[242:243] op_sel:[1,1,0] op_sel_hi:[1,0,1] neg_lo:[1,0,0]
    v_pk_fma_f32 v[236:237], v[224:225], v[228:229], v[236:237] op_sel:[1,1,0] op_sel_hi:[1,0,1] neg_lo:[1,0,0]
    ds_write_b32 v161, v250 offset:2816
    v_pk_mul_f32 v[252:253], v[242:243], v[230:231] op_sel_hi:[0,1]
    v_cvt_pk_bf16_f32 v250, v242, v243
    v_pk_fma_f32 v[252:253], v[242:243], v[230:231], v[252:253] op_sel:[1,1,0] op_sel_hi:[1,0,1] neg_lo:[1,0,0]
    ds_write_b32 v162, v250 offset:3072
    v_pk_mul_f32 v[240:241], v[252:253], v[230:231] op_sel_hi:[0,1]
    v_cvt_pk_bf16_f32 v250, v252, v253
    v_pk_fma_f32 v[240:241], v[252:253], v[230:231], v[240:241] op_sel:[1,1,0] op_sel_hi:[1,0,1] neg_lo:[1,0,0]
    ds_write_b32 v163, v250 offset:3328
    v_pk_mul_f32 v[242:243], v[240:241], v[230:231] op_sel_hi:[0,1]
    v_cvt_pk_bf16_f32 v250, v240, v241
    v_pk_fma_f32 v[242:243], v[240:241], v[230:231], v[242:243] op_sel:[1,1,0] op_sel_hi:[1,0,1] neg_lo:[1,0,0]
    ds_write_b32 v164, v250 offset:3584
    v_cvt_pk_bf16_f32 v250, v242, v243
    ds_write_b32 v165, v250 offset:3840
    ds_read_b128 v[60:63], v140 offset:0
    ds_read_b128 v[64:67], v141 offset:0
    ds_read_b128 v[68:71], v142 offset:0
    ds_read_b128 v[72:75], v143 offset:0
    v_mov_b32 v238, 1.0
    v_mov_b32 v239, 0
    v_pk_mul_f32 v[252:253], v[236:237], v[228:229] op_sel_hi:[0,1]
    v_pk_mul_f32 v[244:245], v[230:231], v[236:237] op_sel_hi:[0,1]
    v_cvt_pk_bf16_f32 v250, v238, -v239
    v_cvt_pk_bf16_f32 v251, v230, -v231
    v_pk_fma_f32 v[252:253], v[236:237], v[228:229], v[252:253] op_sel:[1,1,0] op_sel_hi:[1,0,1] neg_lo:[1,0,0]
    v_pk_fma_f32 v[244:245], v[230:231], v[236:237], v[244:245] op_sel:[1,1,0] op_sel_hi:[1,0,1] neg_lo:[1,0,0]
    ds_write_b32 v150, v250 offset:0
    ds_write_b32 v150, v251 offset:4096
    v_pk_mul_f32 v[240:241], v[252:253], v[228:229] op_sel_hi:[0,1]
    v_pk_mul_f32 v[246:247], v[244:245], v[236:237] op_sel_hi:[0,1]
    v_cvt_pk_bf16_f32 v250, v252, -v253
    v_cvt_pk_bf16_f32 v251, v244, -v245
    v_pk_fma_f32 v[240:241], v[252:253], v[228:229], v[240:241] op_sel:[1,1,0] op_sel_hi:[1,0,1] neg_lo:[1,0,0]
    v_pk_fma_f32 v[246:247], v[244:245], v[236:237], v[246:247] op_sel:[1,1,0] op_sel_hi:[1,0,1] neg_lo:[1,0,0]
    ds_write_b32 v155, v250 offset:1280
    ds_write_b32 v151, v251 offset:4352
    v_pk_mul_f32 v[242:243], v[240:241], v[228:229] op_sel_hi:[0,1]
    v_pk_mul_f32 v[248:249], v[246:247], v[236:237] op_sel_hi:[0,1]
    v_cvt_pk_bf16_f32 v250, v240, -v241
    v_cvt_pk_bf16_f32 v251, v246, -v247
    v_pk_fma_f32 v[242:243], v[240:241], v[228:229], v[242:243] op_sel:[1,1,0] op_sel_hi:[1,0,1] neg_lo:[1,0,0]
    v_pk_fma_f32 v[248:249], v[246:247], v[236:237], v[248:249] op_sel:[1,1,0] op_sel_hi:[1,0,1] neg_lo:[1,0,0]
    ds_write_b32 v156, v250 offset:1536
    ds_write_b32 v152, v251 offset:4608
    v_pk_mul_f32 v[252:253], v[242:243], v[228:229] op_sel_hi:[0,1]
    v_pk_mul_f32 v[244:245], v[248:249], v[236:237] op_sel_hi:[0,1]
    v_cvt_pk_bf16_f32 v250, v242, -v243
    v_cvt_pk_bf16_f32 v251, v248, -v249
    v_pk_fma_f32 v[252:253], v[242:243], v[228:229], v[252:253] op_sel:[1,1,0] op_sel_hi:[1,0,1] neg_lo:[1,0,0]
    v_pk_fma_f32 v[244:245], v[248:249], v[236:237], v[244:245] op_sel:[1,1,0] op_sel_hi:[1,0,1] neg_lo:[1,0,0]
    ds_write_b32 v157, v250 offset:1792
    ds_write_b32 v153, v251 offset:4864
    v_pk_mul_f32 v[240:241], v[252:253], v[228:229] op_sel_hi:[0,1]
    v_pk_mul_f32 v[246:247], v[244:245], v[236:237] op_sel_hi:[0,1]
    v_cvt_pk_bf16_f32 v250, v252, -v253
    v_cvt_pk_bf16_f32 v251, v244, -v245
    v_pk_fma_f32 v[240:241], v[252:253], v[228:229], v[240:241] op_sel:[1,1,0] op_sel_hi:[1,0,1] neg_lo:[1,0,0]
    v_pk_fma_f32 v[246:247], v[244:245], v[236:237], v[246:247] op_sel:[1,1,0] op_sel_hi:[1,0,1] neg_lo:[1,0,0]
    ds_write_b32 v158, v250 offset:2048
    ds_write_b32 v154, v251 offset:5120
    v_pk_mul_f32 v[242:243], v[240:241], v[228:229] op_sel_hi:[0,1]
    v_pk_mul_f32 v[248:249], v[246:247], v[236:237] op_sel_hi:[0,1]
    v_cvt_pk_bf16_f32 v250, v240, -v241
    v_cvt_pk_bf16_f32 v251, v246, -v247
    v_pk_fma_f32 v[242:243], v[240:241], v[228:229], v[242:243] op_sel:[1,1,0] op_sel_hi:[1,0,1] neg_lo:[1,0,0]
    v_pk_fma_f32 v[248:249], v[246:247], v[236:237], v[248:249] op_sel:[1,1,0] op_sel_hi:[1,0,1] neg_lo:[1,0,0]
    ds_write_b32 v159, v250 offset:2304
    ds_write_b32 v155, v251 offset:5376
    v_pk_mul_f32 v[252:253], v[242:243], v[228:229] op_sel_hi:[0,1]
    v_pk_mul_f32 v[244:245], v[248:249], v[236:237] op_sel_hi:[0,1]
    v_cvt_pk_bf16_f32 v250, v242, -v243
    v_cvt_pk_bf16_f32 v251, v248, -v249
    v_pk_fma_f32 v[252:253], v[242:243], v[228:229], v[252:253] op_sel:[1,1,0] op_sel_hi:[1,0,1] neg_lo:[1,0,0]
    v_pk_fma_f32 v[244:245], v[248:249], v[236:237], v[244:245] op_sel:[1,1,0] op_sel_hi:[1,0,1] neg_lo:[1,0,0]
    ds_write_b32 v160, v250 offset:2560
    ds_write_b32 v156, v251 offset:5632
    v_pk_mul_f32 v[240:241], v[252:253], v[228:229] op_sel_hi:[0,1]
    v_pk_mul_f32 v[246:247], v[244:245], v[236:237] op_sel_hi:[0,1]
    v_cvt_pk_bf16_f32 v250, v252, -v253
    v_cvt_pk_bf16_f32 v251, v244, -v245
    v_pk_fma_f32 v[240:241], v[252:253], v[228:229], v[240:241] op_sel:[1,1,0] op_sel_hi:[1,0,1] neg_lo:[1,0,0]
    v_pk_fma_f32 v[246:247], v[244:245], v[236:237], v[246:247] op_sel:[1,1,0] op_sel_hi:[1,0,1] neg_lo:[1,0,0]
    ds_write_b32 v161, v250 offset:2816
    ds_write_b32 v157, v251 offset:5888
    v_pk_mul_f32 v[242:243], v[240:241], v[228:229] op_sel_hi:[0,1]
    v_pk_mul_f32 v[248:249], v[246:247], v[236:237] op_sel_hi:[0,1]
    v_cvt_pk_bf16_f32 v250, v240, -v241
    v_cvt_pk_bf16_f32 v251, v246, -v247
    v_pk_fma_f32 v[242:243], v[240:241], v[228:229], v[242:243] op_sel:[1,1,0] op_sel_hi:[1,0,1] neg_lo:[1,0,0]
    v_pk_fma_f32 v[248:249], v[246:247], v[236:237], v[248:249] op_sel:[1,1,0] op_sel_hi:[1,0,1] neg_lo:[1,0,0]
    ds_write_b32 v162, v250 offset:3072
    ds_write_b32 v158, v251 offset:6144
    v_pk_mul_f32 v[252:253], v[242:243], v[228:229] op_sel_hi:[0,1]
    v_pk_mul_f32 v[244:245], v[248:249], v[236:237] op_sel_hi:[0,1]
    v_cvt_pk_bf16_f32 v250, v242, -v243
    v_cvt_pk_bf16_f32 v251, v248, -v249
    v_pk_fma_f32 v[252:253], v[242:243], v[228:229], v[252:253] op_sel:[1,1,0] op_sel_hi:[1,0,1] neg_lo:[1,0,0]
    v_pk_fma_f32 v[244:245], v[248:249], v[236:237], v[244:245] op_sel:[1,1,0] op_sel_hi:[1,0,1] neg_lo:[1,0,0]
    ds_write_b32 v163, v250 offset:3328
    ds_write_b32 v159, v251 offset:6400
    v_pk_mul_f32 v[240:241], v[252:253], v[228:229] op_sel_hi:[0,1]
    v_pk_mul_f32 v[246:247], v[244:245], v[236:237] op_sel_hi:[0,1]
    v_cvt_pk_bf16_f32 v250, v252, -v253
    v_cvt_pk_bf16_f32 v251, v244, -v245
    v_pk_fma_f32 v[240:241], v[252:253], v[228:229], v[240:241] op_sel:[1,1,0] op_sel_hi:[1,0,1] neg_lo:[1,0,0]
    v_pk_fma_f32 v[246:247], v[244:245], v[236:237], v[246:247] op_sel:[1,1,0] op_sel_hi:[1,0,1] neg_lo:[1,0,0]
    ds_write_b32 v164, v250 offset:3584
    ds_write_b32 v160, v251 offset:6656
    v_cvt_pk_bf16_f32 v250, v240, -v241
    v_cvt_pk_bf16_f32 v251, v246, -v247
    ds_write_b32 v165, v250 offset:3840
    ds_write_b32 v161, v251 offset:6912
    v_cvt_pk_bf16_f32 v250, v228, -v229
    v_cvt_pk_bf16_f32 v251, v232, -v233
    ds_write_b32 v151, v250 offset:256
    ds_write_b32 v162, v251 offset:7168
    v_cvt_pk_bf16_f32 v250, v222, -v223
    v_cvt_pk_bf16_f32 v251, v224, -v225
    ds_write_b32 v152, v250 offset:512
    ds_write_b32 v153, v251 offset:768
    v_cvt_pk_bf16_f32 v251, v236, -v237
    ds_write_b32 v154, v251 offset:1024
    ds_read_b128 v[108:111], v182
    v_xor_b32 v193, 64, v182
    ds_read_b128 v[112:115], v193
    v_xor_b32 v194, 128, v182
    ds_read_b128 v[116:119], v194
    v_xor_b32 v195, 192, v182
    ds_read_b128 v[120:123], v195
    ds_read_b128 v[124:127], v183
    v_xor_b32 v193, 64, v183
    ds_read_b128 v[128:131], v193
    v_xor_b32 v194, 128, v183
    ds_read_b128 v[132:135], v194
    v_xor_b32 v195, 192, v183
    ds_read_b128 v[136:139], v195
    s_waitcnt lgkmcnt(4)
    v_mfma_f32_16x16x32_bf16 v[0:3], v[108:111], v[44:47], v[0:3]
    ds_read_b128 v[220:223], v184
    v_xor_b32 v193, 64, v184
    v_mfma_f32_16x16x32_bf16 v[0:3], v[112:115], v[48:51], v[0:3]
    ds_read_b128 v[224:227], v193
    v_xor_b32 v194, 128, v184
    v_mfma_f32_16x16x32_bf16 v[0:3], v[116:119], v[52:55], v[0:3]
    ds_read_b128 v[228:231], v194
    v_xor_b32 v195, 192, v184
    v_mfma_f32_16x16x32_bf16 v[0:3], v[120:123], v[56:59], v[0:3]
    ds_read_b128 v[232:235], v195
    s_waitcnt lgkmcnt(4)
    v_mfma_f32_16x16x32_bf16 v[4:7], v[124:127], v[60:63], v[4:7]
    ds_read_b128 v[108:111], v185
    v_xor_b32 v193, 64, v185
    v_mfma_f32_16x16x32_bf16 v[4:7], v[128:131], v[64:67], v[4:7]
    ds_read_b128 v[112:115], v193
    v_xor_b32 v194, 128, v185
    v_mfma_f32_16x16x32_bf16 v[4:7], v[132:135], v[68:71], v[4:7]
    ds_read_b128 v[116:119], v194
    v_xor_b32 v195, 192, v185
    v_mfma_f32_16x16x32_bf16 v[4:7], v[136:139], v[72:75], v[4:7]
    ds_read_b128 v[120:123], v195
    s_waitcnt lgkmcnt(4)
    v_mfma_f32_16x16x32_bf16 v[8:11], v[220:223], v[76:79], v[8:11]
    ds_read_b128 v[124:127], v186
    v_xor_b32 v193, 64, v186
    v_mfma_f32_16x16x32_bf16 v[8:11], v[224:227], v[80:83], v[8:11]
    ds_read_b128 v[128:131], v193
    v_xor_b32 v194, 128, v186
    v_mfma_f32_16x16x32_bf16 v[8:11], v[228:231], v[84:87], v[8:11]
    ds_read_b128 v[132:135], v194
    v_xor_b32 v195, 192, v186
    v_mfma_f32_16x16x32_bf16 v[8:11], v[232:235], v[88:91], v[8:11]
    ds_read_b128 v[136:139], v195
    s_waitcnt lgkmcnt(4)
    v_mfma_f32_16x16x32_bf16 v[12:15], v[108:111], v[76:79], v[12:15]
    ds_read_b128 v[220:223], v187
    v_xor_b32 v193, 64, v187
    v_mfma_f32_16x16x32_bf16 v[12:15], v[112:115], v[80:83], v[12:15]
    ds_read_b128 v[224:227], v193
    v_xor_b32 v194, 128, v187
    v_mfma_f32_16x16x32_bf16 v[12:15], v[116:119], v[84:87], v[12:15]
    ds_read_b128 v[228:231], v194
    v_xor_b32 v195, 192, v187
    v_mfma_f32_16x16x32_bf16 v[12:15], v[120:123], v[88:91], v[12:15]
    ds_read_b128 v[232:235], v195
    s_waitcnt lgkmcnt(4)
    v_mfma_f32_16x16x32_bf16 v[16:19], v[124:127], v[76:79], v[16:19]
    ds_read_b128 v[108:111], v188
    v_xor_b32 v193, 64, v188
    v_mfma_f32_16x16x32_bf16 v[16:19], v[128:131], v[80:83], v[16:19]
    ds_read_b128 v[112:115], v193
    v_xor_b32 v194, 128, v188
    v_mfma_f32_16x16x32_bf16 v[16:19], v[132:135], v[84:87], v[16:19]
    ds_read_b128 v[116:119], v194
    v_xor_b32 v195, 192, v188
    v_mfma_f32_16x16x32_bf16 v[16:19], v[136:139], v[88:91], v[16:19]
    ds_read_b128 v[120:123], v195
    s_waitcnt lgkmcnt(4)
    v_mfma_f32_16x16x32_bf16 v[20:23], v[220:223], v[76:79], v[20:23]
    ds_read_b128 v[124:127], v189
    v_xor_b32 v193, 64, v189
    v_mfma_f32_16x16x32_bf16 v[20:23], v[224:227], v[80:83], v[20:23]
    ds_read_b128 v[128:131], v193
    v_xor_b32 v194, 128, v189
    v_mfma_f32_16x16x32_bf16 v[20:23], v[228:231], v[84:87], v[20:23]
    ds_read_b128 v[132:135], v194
    v_xor_b32 v195, 192, v189
    v_mfma_f32_16x16x32_bf16 v[20:23], v[232:235], v[88:91], v[20:23]
    ds_read_b128 v[136:139], v195
    s_waitcnt lgkmcnt(4)
    v_mfma_f32_16x16x32_bf16 v[24:27], v[108:111], v[92:95], v[24:27]
    ds_read_b128 v[220:223], v190
    v_xor_b32 v193, 64, v190
    v_mfma_f32_16x16x32_bf16 v[24:27], v[112:115], v[96:99], v[24:27]
    ds_read_b128 v[224:227], v193
    v_xor_b32 v194, 128, v190
    v_mfma_f32_16x16x32_bf16 v[24:27], v[116:119], v[100:103], v[24:27]
    ds_read_b128 v[228:231], v194
    v_xor_b32 v195, 192, v190
    v_mfma_f32_16x16x32_bf16 v[24:27], v[120:123], v[104:107], v[24:27]
    ds_read_b128 v[232:235], v195
    s_waitcnt lgkmcnt(4)
    v_mfma_f32_16x16x32_bf16 v[28:31], v[124:127], v[92:95], v[28:31]
    ds_read_b128 v[108:111], v191
    v_xor_b32 v193, 64, v191
    v_mfma_f32_16x16x32_bf16 v[28:31], v[128:131], v[96:99], v[28:31]
    ds_read_b128 v[112:115], v193
    v_xor_b32 v194, 128, v191
    v_mfma_f32_16x16x32_bf16 v[28:31], v[132:135], v[100:103], v[28:31]
    ds_read_b128 v[116:119], v194
    v_xor_b32 v195, 192, v191
    v_mfma_f32_16x16x32_bf16 v[28:31], v[136:139], v[104:107], v[28:31]
    ds_read_b128 v[120:123], v195
    s_waitcnt lgkmcnt(4)
    v_mfma_f32_16x16x32_bf16 v[32:35], v[220:223], v[92:95], v[32:35]
    v_mfma_f32_16x16x32_bf16 v[32:35], v[224:227], v[96:99], v[32:35]
    v_mfma_f32_16x16x32_bf16 v[32:35], v[228:231], v[100:103], v[32:35]
    v_mfma_f32_16x16x32_bf16 v[32:35], v[232:235], v[104:107], v[32:35]
    s_waitcnt lgkmcnt(0)
    v_mfma_f32_16x16x32_bf16 v[36:39], v[108:111], v[92:95], v[36:39]
    v_mfma_f32_16x16x32_bf16 v[36:39], v[112:115], v[96:99], v[36:39]
    v_mfma_f32_16x16x32_bf16 v[36:39], v[116:119], v[100:103], v[36:39]
    v_mfma_f32_16x16x32_bf16 v[36:39], v[120:123], v[104:107], v[36:39]
    v_mov_b32 v170, v176
    v_mov_b32 v171, v177
    v_mov_b32 v172, v178
    v_mov_b32 v173, v179
    v_mov_b32 v174, v180
    v_mov_b32 v175, v181
    s_cmp_eq_u32 s53, 1
    s_cbranch_scc1 fz_kg2
    s_cmp_eq_u32 s53, 0
    s_cbranch_scc1 fz_nk
    s_mov_b32 s53, 1
    s_branch fz_kg
fz_nk0:
    s_barrier
    s_barrier
fz_nk:
    s_mov_b32 s43, 0
    s_mov_b32 s42, -1
    s_cmp_lg_u32 s22, 4
    s_cbranch_scc1 fz_idle
    s_mov_b32 s12, s4
    s_mov_b32 s13, s5
    s_mov_b32 s14, 9437184
    s_mov_b32 s15, 0x20000
    s_lshl_b32 s45, s20, 12
    s_mov_b32 s40, s45
    s_mul_i32 s31, s21, 589824
    v_lshlrev_b32 v198, 4, v255
    v_add_u32 v198, s31, v198
    s_mov_b32 s44, 0
    s_mov_b32 s41, 0
    v_add_u32 v112, 0, v198
    v_add_u32 v113, 1024, v198
    v_add_u32 v114, 65536, v198
    v_add_u32 v115, 66560, v198
    v_add_u32 v116, 131072, v198
    v_add_u32 v117, 132096, v198
    v_add_u32 v118, 196608, v198
    v_add_u32 v119, 197632, v198
    v_add_u32 v120, 262144, v198
    v_add_u32 v121, 263168, v198
    v_add_u32 v122, 327680, v198
    v_add_u32 v123, 328704, v198
    v_add_u32 v124, 393216, v198
    v_add_u32 v125, 394240, v198
    v_add_u32 v126, 458752, v198
    v_add_u32 v127, 459776, v198
    v_add_u32 v128, 524288, v198
    v_add_u32 v129, 525312, v198
    s_lshl_b32 s30, s21, 8
    s_add_u32 s30, s30, 8192
    v_lshlrev_b32 v199, 2, v255
    s_mov_b64 s[46:47], -1
    s_mov_b32 s62, 0
    s_add_u32 s40, s40, 2048
    s_add_u32 s43, s43, 1
    s_cmp_eq_u32 s43, 2
    s_cselect_b32 s40, 0, s40
    s_cselect_b32 s42, s45, s42
    s_cmp_eq_u32 s40, s42
    s_cselect_b32 s33, 4096, 0
    s_add_u32 s40, s40, s33
    s_add_u32 s41, s41, 34816
    s_cmp_ge_u32 s41, 139264
    s_cselect_b32 s41, s44, s41
    s_add_u32 s40, s40, 2048
    s_add_u32 s43, s43, 1
    s_cmp_eq_u32 s43, 2
    s_cselect_b32 s40, 0, s40
    s_cselect_b32 s42, s45, s42
    s_cmp_eq_u32 s40, s42
    s_cselect_b32 s33, 4096, 0
    s_add_u32 s40, s40, s33
    s_add_u32 s41, s41, 34816
    s_cmp_ge_u32 s41, 139264
    s_cselect_b32 s41, s44, s41
parallel_sum__ssm_conv_s4__mixer_gmlp__prompt_kernel_pc24:
    s_lshr_b32 s33, s40, 10
    s_and_b32 s33, s33, 60
    s_lshr_b64 s[48:49], s[46:47], s33
    s_and_b32 s48, s48, 15
    s_cbranch_scc0 parallel_sum__ssm_conv_s4__mixer_gmlp__prompt_kernel_pd25
    s_add_u32 s62, s62, 1
    s_cmp_ge_u32 s62, 16384
    s_cbranch_scc1 parallel_sum__ssm_conv_s4__mixer_gmlp__prompt_kernel_pd25
    buffer_load_dword v200, v199, s[16:19], s30 offen sc1
    s_waitcnt vmcnt(0)
    v_cmp_ne_u32 s[46:47], s23, v200
    s_branch parallel_sum__ssm_conv_s4__mixer_gmlp__prompt_kernel_pc24
parallel_sum__ssm_conv_s4__mixer_gmlp__prompt_kernel_pd25:
    s_mov_b32 m0, s41
    s_nop 0
    buffer_load_dwordx4 v112, s[12:15], s40 offen sc1 lds
    s_add_u32 m0, s41, 1024
    s_nop 0
    buffer_load_dwordx4 v113, s[12:15], s40 offen sc1 lds
    s_add_u32 m0, s41, 2048
    s_nop 0
    buffer_load_dwordx4 v114, s[12:15], s40 offen sc1 lds
    s_add_u32 m0, s41, 3072
    s_nop 0
    buffer_load_dwordx4 v115, s[12:15], s40 offen sc1 lds
    s_add_u32 m0, s41, 4096
    s_nop 0
    buffer_load_dwordx4 v116, s[12:15], s40 offen sc1 lds
    s_add_u32 m0, s41, 5120
    s_nop 0
    buffer_load_dwordx4 v117, s[12:15], s40 offen sc1 lds
    s_add_u32 m0, s41, 6144
    s_nop 0
    buffer_load_dwordx4 v118, s[12:15], s40 offen sc1 lds
    s_add_u32 m0, s41, 7168
    s_nop 0
    buffer_load_dwordx4 v119, s[12:15], s40 offen sc1 lds
    s_add_u32 m0, s41, 8192
    s_nop 0
    buffer_load_dwordx4 v120, s[12:15], s40 offen sc1 lds
    s_add_u32 m0, s41, 9216
    s_nop 0
    buffer_load_dwordx4 v121, s[12:15], s40 offen sc1 lds
    s_add_u32 m0, s41, 10240
    s_nop 0
    buffer_load_dwordx4 v122, s[12:15], s40 offen sc1 lds
    s_add_u32 m0, s41, 11264
    s_nop 0
    buffer_load_dwordx4 v123, s[12:15], s40 offen sc1 lds
    s_add_u32 m0, s41, 12288
    s_nop 0
    buffer_load_dwordx4 v124, s[12:15], s40 offen sc1 lds
    s_add_u32 m0, s41, 13312
    s_nop 0
    buffer_load_dwordx4 v125, s[12:15], s40 offen sc1 lds
    s_add_u32 m0, s41, 14336
    s_nop 0
    buffer_load_dwordx4 v126, s[12:15], s40 offen sc1 lds
    s_add_u32 m0, s41, 15360
    s_nop 0
    buffer_load_dwordx4 v127, s[12:15], s40 offen sc1 lds
    s_add_u32 m0, s41, 16384
    s_nop 0
    buffer_load_dwordx4 v128, s[12:15], s40 offen sc1 lds
    s_add_u32 m0, s41, 17408
    s_nop 0
    buffer_load_dwordx4 v129, s[12:15], s40 offen sc1 lds
    s_add_u32 s40, s40, 2048
    s_add_u32 s43, s43, 1
    s_cmp_eq_u32 s43, 2
    s_cselect_b32 s40, 0, s40
    s_cselect_b32 s42, s45, s42
    s_cmp_eq_u32 s40, s42
    s_cselect_b32 s33, 4096, 0
    s_add_u32 s40, s40, s33
    s_add_u32 s41, s41, 34816
    s_cmp_ge_u32 s41, 139264
    s_cselect_b32 s41, s44, s41
parallel_sum__ssm_conv_s4__mixer_gmlp__prompt_kernel_pc26:
    s_lshr_b32 s33, s40, 10
    s_and_b32 s33, s33, 60
    s_lshr_b64 s[48:49], s[46:47], s33
    s_and_b32 s48, s48, 15
    s_cbranch_scc0 parallel_sum__ssm_conv_s4__mixer_gmlp__prompt_kernel_pd27
    s_add_u32 s62, s62, 1
    s_cmp_ge_u32 s62, 16384
    s_cbranch_scc1 parallel_sum__ssm_conv_s4__mixer_gmlp__prompt_kernel_pd27
    buffer_load_dword v200, v199, s[16:19], s30 offen sc1
    s_waitcnt vmcnt(0)
    v_cmp_ne_u32 s[46:47], s23, v200
    s_branch parallel_sum__ssm_conv_s4__mixer_gmlp__prompt_kernel_pc26
parallel_sum__ssm_conv_s4__mixer_gmlp__prompt_kernel_pd27:
    s_mov_b32 m0, s41
    s_nop 0
    buffer_load_dwordx4 v112, s[12:15], s40 offen sc1 lds
    s_add_u32 m0, s41, 1024
    s_nop 0
    buffer_load_dwordx4 v113, s[12:15], s40 offen sc1 lds
    s_add_u32 m0, s41, 2048
    s_nop 0
    buffer_load_dwordx4 v114, s[12:15], s40 offen sc1 lds
    s_add_u32 m0, s41, 3072
    s_nop 0
    buffer_load_dwordx4 v115, s[12:15], s40 offen sc1 lds
    s_add_u32 m0, s41, 4096
    s_nop 0
    buffer_load_dwordx4 v116, s[12:15], s40 offen sc1 lds
    s_add_u32 m0, s41, 5120
    s_nop 0
    buffer_load_dwordx4 v117, s[12:15], s40 offen sc1 lds
    s_add_u32 m0, s41, 6144
    s_nop 0
    buffer_load_dwordx4 v118, s[12:15], s40 offen sc1 lds
    s_add_u32 m0, s41, 7168
    s_nop 0
    buffer_load_dwordx4 v119, s[12:15], s40 offen sc1 lds
    s_add_u32 m0, s41, 8192
    s_nop 0
    buffer_load_dwordx4 v120, s[12:15], s40 offen sc1 lds
    s_add_u32 m0, s41, 9216
    s_nop 0
    buffer_load_dwordx4 v121, s[12:15], s40 offen sc1 lds
    s_add_u32 m0, s41, 10240
    s_nop 0
    buffer_load_dwordx4 v122, s[12:15], s40 offen sc1 lds
    s_add_u32 m0, s41, 11264
    s_nop 0
    buffer_load_dwordx4 v123, s[12:15], s40 offen sc1 lds
    s_add_u32 m0, s41, 12288
    s_nop 0
    buffer_load_dwordx4 v124, s[12:15], s40 offen sc1 lds
    s_add_u32 m0, s41, 13312
    s_nop 0
    buffer_load_dwordx4 v125, s[12:15], s40 offen sc1 lds
    s_add_u32 m0, s41, 14336
    s_nop 0
    buffer_load_dwordx4 v126, s[12:15], s40 offen sc1 lds
    s_add_u32 m0, s41, 15360
    s_nop 0
    buffer_load_dwordx4 v127, s[12:15], s40 offen sc1 lds
    s_add_u32 m0, s41, 16384
    s_nop 0
    buffer_load_dwordx4 v128, s[12:15], s40 offen sc1 lds
    s_add_u32 m0, s41, 17408
    s_nop 0
    buffer_load_dwordx4 v129, s[12:15], s40 offen sc1 lds
    s_add_u32 s40, s40, 2048
    s_add_u32 s43, s43, 1
    s_cmp_eq_u32 s43, 2
    s_cselect_b32 s40, 0, s40
    s_cselect_b32 s42, s45, s42
    s_cmp_eq_u32 s40, s42
    s_cselect_b32 s33, 4096, 0
    s_add_u32 s40, s40, s33
    s_add_u32 s41, s41, 34816
    s_cmp_ge_u32 s41, 139264
    s_cselect_b32 s41, s44, s41
parallel_sum__ssm_conv_s4__mixer_gmlp__prompt_kernel_pc28:
    s_lshr_b32 s33, s40, 10
    s_and_b32 s33, s33, 60
    s_lshr_b64 s[48:49], s[46:47], s33
    s_and_b32 s48, s48, 15
    s_cbranch_scc0 parallel_sum__ssm_conv_s4__mixer_gmlp__prompt_kernel_pd29
    s_add_u32 s62, s62, 1
    s_cmp_ge_u32 s62, 16384
    s_cbranch_scc1 parallel_sum__ssm_conv_s4__mixer_gmlp__prompt_kernel_pd29
    buffer_load_dword v200, v199, s[16:19], s30 offen sc1
    s_waitcnt vmcnt(0)
    v_cmp_ne_u32 s[46:47], s23, v200
    s_branch parallel_sum__ssm_conv_s4__mixer_gmlp__prompt_kernel_pc28
parallel_sum__ssm_conv_s4__mixer_gmlp__prompt_kernel_pd29:
    s_mov_b32 m0, s41
    s_nop 0
    buffer_load_dwordx4 v112, s[12:15], s40 offen sc1 lds
    s_add_u32 m0, s41, 1024
    s_nop 0
    buffer_load_dwordx4 v113, s[12:15], s40 offen sc1 lds
    s_add_u32 m0, s41, 2048
    s_nop 0
    buffer_load_dwordx4 v114, s[12:15], s40 offen sc1 lds
    s_add_u32 m0, s41, 3072
    s_nop 0
    buffer_load_dwordx4 v115, s[12:15], s40 offen sc1 lds
    s_add_u32 m0, s41, 4096
    s_nop 0
    buffer_load_dwordx4 v116, s[12:15], s40 offen sc1 lds
    s_add_u32 m0, s41, 5120
    s_nop 0
    buffer_load_dwordx4 v117, s[12:15], s40 offen sc1 lds
    s_add_u32 m0, s41, 6144
    s_nop 0
    buffer_load_dwordx4 v118, s[12:15], s40 offen sc1 lds
    s_add_u32 m0, s41, 7168
    s_nop 0
    buffer_load_dwordx4 v119, s[12:15], s40 offen sc1 lds
    s_add_u32 m0, s41, 8192
    s_nop 0
    buffer_load_dwordx4 v120, s[12:15], s40 offen sc1 lds
    s_add_u32 m0, s41, 9216
    s_nop 0
    buffer_load_dwordx4 v121, s[12:15], s40 offen sc1 lds
    s_add_u32 m0, s41, 10240
    s_nop 0
    buffer_load_dwordx4 v122, s[12:15], s40 offen sc1 lds
    s_add_u32 m0, s41, 11264
    s_nop 0
    buffer_load_dwordx4 v123, s[12:15], s40 offen sc1 lds
    s_add_u32 m0, s41, 12288
    s_nop 0
    buffer_load_dwordx4 v124, s[12:15], s40 offen sc1 lds
    s_add_u32 m0, s41, 13312
    s_nop 0
    buffer_load_dwordx4 v125, s[12:15], s40 offen sc1 lds
    s_add_u32 m0, s41, 14336
    s_nop 0
    buffer_load_dwordx4 v126, s[12:15], s40 offen sc1 lds
    s_add_u32 m0, s41, 15360
    s_nop 0
    buffer_load_dwordx4 v127, s[12:15], s40 offen sc1 lds
    s_add_u32 m0, s41, 16384
    s_nop 0
    buffer_load_dwordx4 v128, s[12:15], s40 offen sc1 lds
    s_add_u32 m0, s41, 17408
    s_nop 0
    buffer_load_dwordx4 v129, s[12:15], s40 offen sc1 lds
    s_add_u32 s40, s40, 2048
    s_add_u32 s43, s43, 1
    s_cmp_eq_u32 s43, 2
    s_cselect_b32 s40, 0, s40
    s_cselect_b32 s42, s45, s42
    s_cmp_eq_u32 s40, s42
    s_cselect_b32 s33, 4096, 0
    s_add_u32 s40, s40, s33
    s_add_u32 s41, s41, 34816
    s_cmp_ge_u32 s41, 139264
    s_cselect_b32 s41, s44, s41
    s_setprio 3
    s_and_b32 s50, s2, 7
    s_lshl_b32 s50, s50, 2
    s_lshr_b32 s51, s2, 6
    s_add_u32 s50, s50, s51
    s_lshr_b32 s51, s2, 3
    s_and_b32 s51, s51, 7
    s_add_u32 s24, s4, 35389440
    s_addc_u32 s25, s5, 0
    s_mov_b32 s26, 2654208
    s_mov_b32 s27, 0x20000
    s_lshl_b32 s52, s51, 9
    s_add_u32 s52, s52, 20480
    s_mul_i32 s63, s51, 331776
    v_lshlrev_b32 v216, 3, v255
    v_lshlrev_b32 v217, 4, v255
    v_mov_b32 v214, 0
    v_mov_b32 v215, 0
    s_mov_b32 s35, 2
fz_hA:
    s_waitcnt vmcnt(36)
    s_barrier
parallel_sum__ssm_conv_s4__mixer_gmlp__prompt_kernel_pc30:
    s_lshr_b32 s33, s40, 10
    s_and_b32 s33, s33, 60
    s_lshr_b64 s[48:49], s[46:47], s33
    s_and_b32 s48, s48, 15
    s_cbranch_scc0 parallel_sum__ssm_conv_s4__mixer_gmlp__prompt_kernel_pd31
    s_add_u32 s62, s62, 1
    s_cmp_ge_u32 s62, 16384
    s_cbranch_scc1 parallel_sum__ssm_conv_s4__mixer_gmlp__prompt_kernel_pd31
    buffer_load_dword v200, v199, s[16:19], s30 offen sc1
    s_waitcnt vmcnt(0)
    v_cmp_ne_u32 s[46:47], s23, v200
    s_branch parallel_sum__ssm_conv_s4__mixer_gmlp__prompt_kernel_pc30
parallel_sum__ssm_conv_s4__mixer_gmlp__prompt_kernel_pd31:
    s_mov_b32 m0, s41
    s_nop 0
    buffer_load_dwordx4 v112, s[12:15], s40 offen sc1 lds
    s_add_u32 m0, s41, 1024
    s_nop 0
    buffer_load_dwordx4 v113, s[12:15], s40 offen sc1 lds
    s_add_u32 m0, s41, 2048
    s_nop 0
    buffer_load_dwordx4 v114, s[12:15], s40 offen sc1 lds
    s_add_u32 m0, s41, 3072
    s_nop 0
    buffer_load_dwordx4 v115, s[12:15], s40 offen sc1 lds
    s_add_u32 m0, s41, 4096
    s_nop 0
    buffer_load_dwordx4 v116, s[12:15], s40 offen sc1 lds
    s_add_u32 m0, s41, 5120
    s_nop 0
    buffer_load_dwordx4 v117, s[12:15], s40 offen sc1 lds
    s_add_u32 m0, s41, 6144
    s_nop 0
    buffer_load_dwordx4 v118, s[12:15], s40 offen sc1 lds
    s_add_u32 m0, s41, 7168
    s_nop 0
    buffer_load_dwordx4 v119, s[12:15], s40 offen sc1 lds
    s_add_u32 m0, s41, 8192
    s_nop 0
    buffer_load_dwordx4 v120, s[12:15], s40 offen sc1 lds
    s_add_u32 m0, s41, 9216
    s_nop 0
    buffer_load_dwordx4 v121, s[12:15], s40 offen sc1 lds
    s_add_u32 m0, s41, 10240
    s_nop 0
    buffer_load_dwordx4 v122, s[12:15], s40 offen sc1 lds
    s_add_u32 m0, s41, 11264
    s_nop 0
    buffer_load_dwordx4 v123, s[12:15], s40 offen sc1 lds
    s_add_u32 m0, s41, 12288
    s_nop 0
    buffer_load_dwordx4 v124, s[12:15], s40 offen sc1 lds
    s_add_u32 m0, s41, 13312
    s_nop 0
    buffer_load_dwordx4 v125, s[12:15], s40 offen sc1 lds
    s_add_u32 m0, s41, 14336
    s_nop 0
    buffer_load_dwordx4 v126, s[12:15], s40 offen sc1 lds
    s_add_u32 m0, s41, 15360
    s_nop 0
    buffer_load_dwordx4 v127, s[12:15], s40 offen sc1 lds
    s_add_u32 m0, s41, 16384
    s_nop 0
    buffer_load_dwordx4 v128, s[12:15], s40 offen sc1 lds
    s_add_u32 m0, s41, 17408
    s_nop 0
    buffer_load_dwordx4 v129, s[12:15], s40 offen sc1 lds
    s_add_u32 s40, s40, 2048
    s_add_u32 s43, s43, 1
    s_cmp_eq_u32 s43, 2
    s_cselect_b32 s40, 0, s40
    s_cselect_b32 s42, s45, s42
    s_cmp_eq_u32 s40, s42
    s_cselect_b32 s33, 4096, 0
    s_add_u32 s40, s40, s33
    s_add_u32 s41, s41, 34816
    s_cmp_ge_u32 s41, 139264
    s_cselect_b32 s41, s44, s41
    s_add_u32 s35, s35, 1
    s_cmp_lt_u32 s35, 5
    s_cbranch_scc1 fz_hA
    s_waitcnt vmcnt(36)
    s_barrier
parallel_sum__ssm_conv_s4__mixer_gmlp__prompt_kernel_pc32:
    s_lshr_b32 s33, s40, 10
    s_and_b32 s33, s33, 60
    s_lshr_b64 s[48:49], s[46:47], s33
    s_and_b32 s48, s48, 15
    s_cbranch_scc0 parallel_sum__ssm_conv_s4__mixer_gmlp__prompt_kernel_pd33
    s_add_u32 s62, s62, 1
    s_cmp_ge_u32 s62, 16384
    s_cbranch_scc1 parallel_sum__ssm_conv_s4__mixer_gmlp__prompt_kernel_pd33
    buffer_load_dword v200, v199, s[16:19], s30 offen sc1
    s_waitcnt vmcnt(0)
    v_cmp_ne_u32 s[46:47], s23, v200
    s_branch parallel_sum__ssm_conv_s4__mixer_gmlp__prompt_kernel_pc32
parallel_sum__ssm_conv_s4__mixer_gmlp__prompt_kernel_pd33:
    s_mov_b32 m0, s41
    s_nop 0
    buffer_load_dwordx4 v112, s[12:15], s40 offen sc1 lds
    s_add_u32 m0, s41, 1024
    s_nop 0
    buffer_load_dwordx4 v113, s[12:15], s40 offen sc1 lds
    s_add_u32 m0, s41, 2048
    s_nop 0
    buffer_load_dwordx4 v114, s[12:15], s40 offen sc1 lds
    s_add_u32 m0, s41, 3072
    s_nop 0
    buffer_load_dwordx4 v115, s[12:15], s40 offen sc1 lds
    s_add_u32 m0, s41, 4096
    s_nop 0
    buffer_load_dwordx4 v116, s[12:15], s40 offen sc1 lds
    s_add_u32 m0, s41, 5120
    s_nop 0
    buffer_load_dwordx4 v117, s[12:15], s40 offen sc1 lds
    s_add_u32 m0, s41, 6144
    s_nop 0
    buffer_load_dwordx4 v118, s[12:15], s40 offen sc1 lds
    s_add_u32 m0, s41, 7168
    s_nop 0
    buffer_load_dwordx4 v119, s[12:15], s40 offen sc1 lds
    s_add_u32 m0, s41, 8192
    s_nop 0
    buffer_load_dwordx4 v120, s[12:15], s40 offen sc1 lds
    s_add_u32 s40, s40, 2048
    s_add_u32 s43, s43, 1
    s_cmp_eq_u32 s43, 2
    s_cselect_b32 s40, 0, s40
    s_cselect_b32 s42, s45, s42
    s_cmp_eq_u32 s40, s42
    s_cselect_b32 s33, 4096, 0
    s_add_u32 s40, s40, s33
    s_add_u32 s41, s41, 34816
    s_cmp_ge_u32 s41, 139264
    s_cselect_b32 s41, s44, s41
    s_waitcnt vmcnt(27)
    s_barrier
parallel_sum__ssm_conv_s4__mixer_gmlp__prompt_kernel_pc34:
    s_lshr_b32 s33, s40, 10
    s_and_b32 s33, s33, 60
    s_lshr_b64 s[48:49], s[46:47], s33
    s_and_b32 s48, s48, 15
    s_cbranch_scc0 parallel_sum__ssm_conv_s4__mixer_gmlp__prompt_kernel_pd35
    s_add_u32 s62, s62, 1
    s_cmp_ge_u32 s62, 16384
    s_cbranch_scc1 parallel_sum__ssm_conv_s4__mixer_gmlp__prompt_kernel_pd35
    buffer_load_dword v200, v199, s[16:19], s30 offen sc1
    s_waitcnt vmcnt(0)
    v_cmp_ne_u32 s[46:47], s23, v200
    s_branch parallel_sum__ssm_conv_s4__mixer_gmlp__prompt_kernel_pc34
parallel_sum__ssm_conv_s4__mixer_gmlp__prompt_kernel_pd35:
    s_mov_b32 m0, s41
    s_nop 0
    buffer_load_dwordx4 v112, s[12:15], s40 offen sc1 lds
    s_add_u32 m0, s41, 1024
    s_nop 0
    buffer_load_dwordx4 v113, s[12:15], s40 offen sc1 lds
    s_add_u32 m0, s41, 2048
    s_nop 0
    buffer_load_dwordx4 v114, s[12:15], s40 offen sc1 lds
    s_add_u32 m0, s41, 3072
    s_nop 0
    buffer_load_dwordx4 v115, s[12:15], s40 offen sc1 lds
    s_add_u32 m0, s41, 4096
    s_nop 0
    buffer_load_dwordx4 v116, s[12:15], s40 offen sc1 lds
    s_add_u32 m0, s41, 5120
    s_nop 0
    buffer_load_dwordx4 v117, s[12:15], s40 offen sc1 lds
    s_add_u32 m0, s41, 6144
    s_nop 0
    buffer_load_dwordx4 v118, s[12:15], s40 offen sc1 lds
    s_add_u32 m0, s41, 7168
    s_nop 0
    buffer_load_dwordx4 v119, s[12:15], s40 offen sc1 lds
    s_add_u32 m0, s41, 8192
    s_nop 0
    buffer_load_dwordx4 v120, s[12:15], s40 offen sc1 lds
    s_add_u32 s40, s40, 2048
    s_add_u32 s43, s43, 1
    s_cmp_eq_u32 s43, 2
    s_cselect_b32 s40, 0, s40
    s_cselect_b32 s42, s45, s42
    s_cmp_eq_u32 s40, s42
    s_cselect_b32 s33, 4096, 0
    s_add_u32 s40, s40, s33
    s_add_u32 s41, s41, 34816
    s_cmp_ge_u32 s41, 139264
    s_cselect_b32 s41, s44, s41
    s_mov_b32 s35, 7
fz_lA:
    s_waitcnt vmcnt(18)
    s_barrier
parallel_sum__ssm_conv_s4__mixer_gmlp__prompt_kernel_pc36:
    s_lshr_b32 s33, s40, 10
    s_and_b32 s33, s33, 60
    s_lshr_b64 s[48:49], s[46:47], s33
    s_and_b32 s48, s48, 15
    s_cbranch_scc0 parallel_sum__ssm_conv_s4__mixer_gmlp__prompt_kernel_pd37
    s_add_u32 s62, s62, 1
    s_cmp_ge_u32 s62, 16384
    s_cbranch_scc1 parallel_sum__ssm_conv_s4__mixer_gmlp__prompt_kernel_pd37
    buffer_load_dword v200, v199, s[16:19], s30 offen sc1
    s_waitcnt vmcnt(0)
    v_cmp_ne_u32 s[46:47], s23, v200
    s_branch parallel_sum__ssm_conv_s4__mixer_gmlp__prompt_kernel_pc36
parallel_sum__ssm_conv_s4__mixer_gmlp__prompt_kernel_pd37:
    s_mov_b32 m0, s41
    s_nop 0
    buffer_load_dwordx4 v112, s[12:15], s40 offen sc1 lds
    s_add_u32 m0, s41, 1024
    s_nop 0
    buffer_load_dwordx4 v113, s[12:15], s40 offen sc1 lds
    s_add_u32 m0, s41, 2048
    s_nop 0
    buffer_load_dwordx4 v114, s[12:15], s40 offen sc1 lds
    s_add_u32 m0, s41, 3072
    s_nop 0
    buffer_load_dwordx4 v115, s[12:15], s40 offen sc1 lds
    s_add_u32 m0, s41, 4096
    s_nop 0
    buffer_load_dwordx4 v116, s[12:15], s40 offen sc1 lds
    s_add_u32 m0, s41, 5120
    s_nop 0
    buffer_load_dwordx4 v117, s[12:15], s40 offen sc1 lds
    s_add_u32 m0, s41, 6144
    s_nop 0
    buffer_load_dwordx4 v118, s[12:15], s40 offen sc1 lds
    s_add_u32 m0, s41, 7168
    s_nop 0
    buffer_load_dwordx4 v119, s[12:15], s40 offen sc1 lds
    s_add_u32 m0, s41, 8192
    s_nop 0
    buffer_load_dwordx4 v120, s[12:15], s40 offen sc1 lds
    s_add_u32 s40, s40, 2048
    s_add_u32 s43, s43, 1
    s_cmp_eq_u32 s43, 2
    s_cselect_b32 s40, 0, s40
    s_cselect_b32 s42, s45, s42
    s_cmp_eq_u32 s40, s42
    s_cselect_b32 s33, 4096, 0
    s_add_u32 s40, s40, s33
    s_add_u32 s41, s41, 34816
    s_cmp_ge_u32 s41, 139264
    s_cselect_b32 s41, s44, s41
    s_cmp_eq_u32 s35, 24
    s_cbranch_scc0 fz_mA
    buffer_load_dwordx2 v[214:215], v216, s[16:19], s52 offen sc1
fz_mA:
    s_add_u32 s35, s35, 1
    s_cmp_lt_u32 s35, 29
    s_cbranch_scc1 fz_lA
    s_mov_b32 s62, 0
parallel_sum__ssm_conv_s4__mixer_gmlp__prompt_kernel_w438:
    v_cmp_ne_u32 vcc, s23, v214
    s_nop 0
    s_and_b32 vcc_lo, vcc_lo, 0x77777777
    s_and_b32 vcc_hi, vcc_hi, 0x77777777
    v_cmp_ne_u32 s[60:61], s23, v215
    s_nop 0
    s_and_b32 s60, s60, 0x33333333
    s_and_b32 s61, s61, 0x33333333
    s_or_b64 vcc, vcc, s[60:61]
    s_cbranch_scc0 parallel_sum__ssm_conv_s4__mixer_gmlp__prompt_kernel_w4d39
    s_add_u32 s62, s62, 1
    s_cmp_ge_u32 s62, 16384
    s_cbranch_scc1 parallel_sum__ssm_conv_s4__mixer_gmlp__prompt_kernel_w4d39
    buffer_load_dwordx2 v[214:215], v216, s[16:19], s52 offen sc1
    s_waitcnt vmcnt(0)
    s_branch parallel_sum__ssm_conv_s4__mixer_gmlp__prompt_kernel_w438
parallel_sum__ssm_conv_s4__mixer_gmlp__prompt_kernel_w4d39:
    v_mov_b32 v60, 163072
    v_mov_b32 v61, 0
    ds_write_b32 v60, v61 offset:8
    ds_write_b32 v60, v61 offset:16
    s_min_u32 s58, s58, 1000
    s_mul_i32 s33, s58, 911
    s_lshr_b32 s33, s33, 16
    s_lshl_b32 s33, s33, 8
    s_add_u32 s33, s33, 24576
    v_lshlrev_b32 v60, 2, v255
    v_add_u32 v60, s33, v60
    buffer_load_dword v64, v60, s[16:19], 0 offen sc1
    s_add_u32 s48, s21, 7
    s_and_b32 s48, s48, 15
    s_mul_i32 s48, s48, 20736
    s_add_u32 s48, s48, s63
    s_mov_b32 m0, 139264
    s_nop 0
    buffer_load_dwordx4 v217, s[24:27], s48 offen sc1 lds
    s_add_u32 s48, s48, 1024
    s_mov_b32 m0, 140288
    s_nop 0
    buffer_load_dwordx4 v217, s[24:27], s48 offen sc1 lds
    s_add_u32 s48, s48, 1024
    s_mov_b32 m0, 141312
    s_nop 0
    buffer_load_dwordx4 v217, s[24:27], s48 offen sc1 lds
    s_add_u32 s48, s48, 1024
    s_mov_b32 m0, 142336
    s_nop 0
    buffer_load_dwordx4 v217, s[24:27], s48 offen sc1 lds
    s_add_u32 s48, s48, 1024
    s_mov_b32 m0, 143360
    s_nop 0
    buffer_load_dwordx4 v217, s[24:27], s48 offen sc1 lds
    s_add_u32 s48, s48, 1024
    s_mov_b32 m0, 144384
    s_nop 0
    buffer_load_dwordx4 v217, s[24:27], s48 offen sc1 lds
    s_add_u32 s48, s48, 1024
    s_mov_b32 m0, 145408
    s_nop 0
    buffer_load_dwordx4 v217, s[24:27], s48 offen sc1 lds
    s_add_u32 s48, s48, 1024
    s_mov_b32 m0, 146432
    s_nop 0
    buffer_load_dwordx4 v217, s[24:27], s48 offen sc1 lds
    s_add_u32 s48, s48, 1024
    s_mov_b32 m0, 147456
    s_nop 0
    buffer_load_dwordx4 v217, s[24:27], s48 offen sc1 lds
    s_add_u32 s48, s48, 1024
    s_mov_b32 m0, 148480
    s_nop 0
    buffer_load_dwordx4 v217, s[24:27], s48 offen sc1 lds
    s_add_u32 s48, s48, 1024
    s_mov_b32 m0, 149504
    s_nop 0
    buffer_load_dwordx4 v217, s[24:27], s48 offen sc1 lds
    s_add_u32 s48, s48, 1024
    s_mov_b32 m0, 150528
    s_nop 0
    buffer_load_dwordx4 v217, s[24:27], s48 offen sc1 lds
    s_add_u32 s48, s48, 1024
    s_mov_b32 m0, 151552
    s_nop 0
    buffer_load_dwordx4 v217, s[24:27], s48 offen sc1 lds
    s_add_u32 s48, s48, 1024
    s_mov_b32 m0, 152576
    s_nop 0
    buffer_load_dwordx4 v217, s[24:27], s48 offen sc1 lds
    s_add_u32 s48, s48, 1024
    s_mov_b32 m0, 153600
    s_nop 0
    buffer_load_dwordx4 v217, s[24:27], s48 offen sc1 lds
    s_add_u32 s48, s48, 1024
    s_mov_b32 m0, 154624
    s_nop 0
    buffer_load_dwordx4 v217, s[24:27], s48 offen sc1 lds
    s_add_u32 s48, s48, 1024
    s_mov_b32 m0, 155648
    s_nop 0
    buffer_load_dwordx4 v217, s[24:27], s48 offen sc1 lds
    s_add_u32 s48, s48, 1024
    s_mov_b32 m0, 156672
    s_nop 0
    buffer_load_dwordx4 v217, s[24:27], s48 offen sc1 lds
    s_add_u32 s48, s48, 1024
    s_mov_b32 m0, 157696
    s_nop 0
    buffer_load_dwordx4 v217, s[24:27], s48 offen sc1 lds
    s_add_u32 s48, s48, 1024
    s_mov_b32 m0, 158720
    s_nop 0
    buffer_load_dwordx4 v217, s[24:27], s48 offen sc1 lds
    s_add_u32 s48, s48, 1024
    s_mov_b32 exec_lo, 0xffff
    s_mov_b32 exec_hi, 0x0
    s_mov_b32 m0, 159744
    s_nop 0
    buffer_load_dwordx4 v217, s[24:27], s48 offen sc1 lds
    s_add_u32 s48, s48, 1024
    s_mov_b64 exec, -1
    s_waitcnt vmcnt(40)
    s_barrier
    s_add_u32 s48, s21, 4
    s_and_b32 s48, s48, 15
    s_mul_i32 s48, s48, 20736
    s_add_u32 s48, s48, s63
    s_mov_b32 m0, 0
    s_nop 0
    buffer_load_dwordx4 v217, s[24:27], s48 offen sc1 lds
    s_add_u32 s48, s48, 1024
    s_mov_b32 m0, 1024
    s_nop 0
    buffer_load_dwordx4 v217, s[24:27], s48 offen sc1 lds
    s_add_u32 s48, s48, 1024
    s_mov_b32 m0, 2048
    s_nop 0
    buffer_load_dwordx4 v217, s[24:27], s48 offen sc1 lds
    s_add_u32 s48, s48, 1024
    s_mov_b32 m0, 3072
    s_nop 0
    buffer_load_dwordx4 v217, s[24:27], s48 offen sc1 lds
    s_add_u32 s48, s48, 1024
    s_mov_b32 m0, 4096
    s_nop 0
    buffer_load_dwordx4 v217, s[24:27], s48 offen sc1 lds
    s_add_u32 s48, s48, 1024
    s_mov_b32 m0, 5120
    s_nop 0
    buffer_load_dwordx4 v217, s[24:27], s48 offen sc1 lds
    s_add_u32 s48, s48, 1024
    s_mov_b32 m0, 6144
    s_nop 0
    buffer_load_dwordx4 v217, s[24:27], s48 offen sc1 lds
    s_add_u32 s48, s48, 1024
    s_mov_b32 m0, 7168
    s_nop 0
    buffer_load_dwordx4 v217, s[24:27], s48 offen sc1 lds
    s_add_u32 s48, s48, 1024
    s_mov_b32 m0, 8192
    s_nop 0
    buffer_load_dwordx4 v217, s[24:27], s48 offen sc1 lds
    s_add_u32 s48, s48, 1024
    s_mov_b32 m0, 9216
    s_nop 0
    buffer_load_dwordx4 v217, s[24:27], s48 offen sc1 lds
    s_add_u32 s48, s48, 1024
    s_mov_b32 m0, 10240
    s_nop 0
    buffer_load_dwordx4 v217, s[24:27], s48 offen sc1 lds
    s_add_u32 s48, s48, 1024
    s_mov_b32 m0, 11264
    s_nop 0
    buffer_load_dwordx4 v217, s[24:27], s48 offen sc1 lds
    s_add_u32 s48, s48, 1024
    s_mov_b32 m0, 12288
    s_nop 0
    buffer_load_dwordx4 v217, s[24:27], s48 offen sc1 lds
    s_add_u32 s48, s48, 1024
    s_mov_b32 m0, 13312
    s_nop 0
    buffer_load_dwordx4 v217, s[24:27], s48 offen sc1 lds
    s_add_u32 s48, s48, 1024
    s_mov_b32 m0, 14336
    s_nop 0
    buffer_load_dwordx4 v217, s[24:27], s48 offen sc1 lds
    s_add_u32 s48, s48, 1024
    s_mov_b32 m0, 15360
    s_nop 0
    buffer_load_dwordx4 v217, s[24:27], s48 offen sc1 lds
    s_add_u32 s48, s48, 1024
    s_mov_b32 m0, 16384
    s_nop 0
    buffer_load_dwordx4 v217, s[24:27], s48 offen sc1 lds
    s_add_u32 s48, s48, 1024
    s_mov_b32 m0, 17408
    s_nop 0
    buffer_load_dwordx4 v217, s[24:27], s48 offen sc1 lds
    s_add_u32 s48, s48, 1024
    s_mov_b32 m0, 18432
    s_nop 0
    buffer_load_dwordx4 v217, s[24:27], s48 offen sc1 lds
    s_add_u32 s48, s48, 1024
    s_mov_b32 m0, 19456
    s_nop 0
    buffer_load_dwordx4 v217, s[24:27], s48 offen sc1 lds
    s_add_u32 s48, s48, 1024
    s_mov_b32 exec_lo, 0xffff
    s_mov_b32 exec_hi, 0x0
    s_mov_b32 m0, 20480
    s_nop 0
    buffer_load_dwordx4 v217, s[24:27], s48 offen sc1 lds
    s_add_u32 s48, s48, 1024
    s_mov_b64 exec, -1
    s_waitcnt vmcnt(52)
    s_barrier
    s_waitcnt vmcnt(43) lgkmcnt(0)
    s_barrier
    s_waitcnt vmcnt(0)
    s_barrier
    s_branch fz_p34
fz_ld5:
    s_setprio 0
    s_mov_b32 m0, s41
    s_nop 0
    buffer_load_dwordx4 v220, s[12:15], s40 offen lds
    s_add_u32 m0, s41, 1024
    s_nop 0
    buffer_load_dwordx4 v221, s[12:15], s40 offen lds
    s_add_u32 m0, s41, 2048
    s_nop 0
    buffer_load_dwordx4 v222, s[12:15], s40 offen lds
    s_add_u32 m0, s41, 3072
    s_nop 0
    buffer_load_dwordx4 v223, s[12:15], s40 offen lds
    s_add_u32 m0, s41, 4096
    s_nop 0
    buffer_load_dwordx4 v224, s[12:15], s40 offen lds
    s_add_u32 m0, s41, 5120
    s_nop 0
    buffer_load_dwordx4 v225, s[12:15], s40 offen lds
    s_add_u32 m0, s41, 6144
    s_nop 0
    buffer_load_dwordx4 v226, s[12:15], s40 offen lds
    s_add_u32 m0, s41, 7168
    s_nop 0
    buffer_load_dwordx4 v227, s[12:15], s40 offen lds
    s_add_u32 m0, s41, 8192
    s_nop 0
    buffer_load_dwordx4 v228, s[12:15], s40 offen lds
    s_add_u32 m0, s41, 9216
    s_nop 0
    buffer_load_dwordx4 v229, s[12:15], s40 offen lds
    s_add_u32 m0, s41, 10240
    s_nop 0
    buffer_load_dwordx4 v230, s[12:15], s40 offen lds
    s_add_u32 m0, s41, 11264
    s_nop 0
    buffer_load_dwordx4 v231, s[12:15], s40 offen lds
    s_add_u32 m0, s41, 12288
    s_nop 0
    buffer_load_dwordx4 v232, s[12:15], s40 offen lds
    s_add_u32 m0, s41, 13312
    s_nop 0
    buffer_load_dwordx4 v233, s[12:15], s40 offen lds
    s_add_u32 m0, s41, 14336
    s_nop 0
    buffer_load_dwordx4 v234, s[12:15], s40 offen lds
    s_add_u32 m0, s41, 15360
    s_nop 0
    buffer_load_dwordx4 v235, s[12:15], s40 offen lds
    s_add_u32 s40, s40, 128
    s_add_u32 s43, s43, 1
    s_cmp_eq_u32 s43, 2
    s_cselect_b32 s40, 0, s40
    s_cselect_b32 s42, s45, s42
    s_cmp_eq_u32 s40, s42
    s_cselect_b32 s33, 256, 0
    s_add_u32 s40, s40, s33
    s_add_u32 s41, s41, 34816
    s_cmp_ge_u32 s41, 139264
    s_cselect_b32 s41, s44, s41
    s_mov_b32 m0, s41
    s_nop 0
    buffer_load_dwordx4 v220, s[12:15], s40 offen lds
    s_add_u32 m0, s41, 1024
    s_nop 0
    buffer_load_dwordx4 v221, s[12:15], s40 offen lds
    s_add_u32 m0, s41, 2048
    s_nop 0
    buffer_load_dwordx4 v222, s[12:15], s40 offen lds
    s_add_u32 m0, s41, 3072
    s_nop 0
    buffer_load_dwordx4 v223, s[12:15], s40 offen lds
    s_add_u32 m0, s41, 4096
    s_nop 0
    buffer_load_dwordx4 v224, s[12:15], s40 offen lds
    s_add_u32 m0, s41, 5120
    s_nop 0
    buffer_load_dwordx4 v225, s[12:15], s40 offen lds
    s_add_u32 m0, s41, 6144
    s_nop 0
    buffer_load_dwordx4 v226, s[12:15], s40 offen lds
    s_add_u32 m0, s41, 7168
    s_nop 0
    buffer_load_dwordx4 v227, s[12:15], s40 offen lds
    s_add_u32 m0, s41, 8192
    s_nop 0
    buffer_load_dwordx4 v228, s[12:15], s40 offen lds
    s_add_u32 m0, s41, 9216
    s_nop 0
    buffer_load_dwordx4 v229, s[12:15], s40 offen lds
    s_add_u32 m0, s41, 10240
    s_nop 0
    buffer_load_dwordx4 v230, s[12:15], s40 offen lds
    s_add_u32 m0, s41, 11264
    s_nop 0
    buffer_load_dwordx4 v231, s[12:15], s40 offen lds
    s_add_u32 m0, s41, 12288
    s_nop 0
    buffer_load_dwordx4 v232, s[12:15], s40 offen lds
    s_add_u32 m0, s41, 13312
    s_nop 0
    buffer_load_dwordx4 v233, s[12:15], s40 offen lds
    s_add_u32 m0, s41, 14336
    s_nop 0
    buffer_load_dwordx4 v234, s[12:15], s40 offen lds
    s_add_u32 m0, s41, 15360
    s_nop 0
    buffer_load_dwordx4 v235, s[12:15], s40 offen lds
    s_add_u32 s40, s40, 128
    s_add_u32 s43, s43, 1
    s_cmp_eq_u32 s43, 2
    s_cselect_b32 s40, 0, s40
    s_cselect_b32 s42, s45, s42
    s_cmp_eq_u32 s40, s42
    s_cselect_b32 s33, 256, 0
    s_add_u32 s40, s40, s33
    s_add_u32 s41, s41, 34816
    s_cmp_ge_u32 s41, 139264
    s_cselect_b32 s41, s44, s41
    s_setprio 3
    s_and_b32 s50, s2, 7
    s_lshl_b32 s50, s50, 2
    s_lshr_b32 s51, s2, 6
    s_add_u32 s50, s50, s51
    s_lshr_b32 s51, s2, 3
    s_and_b32 s51, s51, 7
    s_add_u32 s24, s4, 35389440
    s_addc_u32 s25, s5, 0
    s_mov_b32 s26, 2654208
    s_mov_b32 s27, 0x20000
    s_lshl_b32 s52, s51, 9
    s_add_u32 s52, s52, 20480
    s_mul_i32 s63, s51, 331776
    v_lshlrev_b32 v216, 3, v255
    v_lshlrev_b32 v217, 4, v255
    v_mov_b32 v214, 0
    v_mov_b32 v215, 0
    s_mov_b32 s35, 0
fz_hB:
    s_waitcnt vmcnt(32)
    s_barrier
    s_mov_b32 m0, s41
    s_nop 0
    buffer_load_dwordx4 v220, s[12:15], s40 offen lds
    s_add_u32 m0, s41, 1024
    s_nop 0
    buffer_load_dwordx4 v221, s[12:15], s40 offen lds
    s_add_u32 m0, s41, 2048
    s_nop 0
    buffer_load_dwordx4 v222, s[12:15], s40 offen lds
    s_add_u32 m0, s41, 3072
    s_nop 0
    buffer_load_dwordx4 v223, s[12:15], s40 offen lds
    s_add_u32 m0, s41, 4096
    s_nop 0
    buffer_load_dwordx4 v224, s[12:15], s40 offen lds
    s_add_u32 m0, s41, 5120
    s_nop 0
    buffer_load_dwordx4 v225, s[12:15], s40 offen lds
    s_add_u32 m0, s41, 6144
    s_nop 0
    buffer_load_dwordx4 v226, s[12:15], s40 offen lds
    s_add_u32 m0, s41, 7168
    s_nop 0
    buffer_load_dwordx4 v227, s[12:15], s40 offen lds
    s_add_u32 m0, s41, 8192
    s_nop 0
    buffer_load_dwordx4 v228, s[12:15], s40 offen lds
    s_add_u32 m0, s41, 9216
    s_nop 0
    buffer_load_dwordx4 v229, s[12:15], s40 offen lds
    s_add_u32 m0, s41, 10240
    s_nop 0
    buffer_load_dwordx4 v230, s[12:15], s40 offen lds
    s_add_u32 m0, s41, 11264
    s_nop 0
    buffer_load_dwordx4 v231, s[12:15], s40 offen lds
    s_add_u32 m0, s41, 12288
    s_nop 0
    buffer_load_dwordx4 v232, s[12:15], s40 offen lds
    s_add_u32 m0, s41, 13312
    s_nop 0
    buffer_load_dwordx4 v233, s[12:15], s40 offen lds
    s_add_u32 m0, s41, 14336
    s_nop 0
    buffer_load_dwordx4 v234, s[12:15], s40 offen lds
    s_add_u32 m0, s41, 15360
    s_nop 0
    buffer_load_dwordx4 v235, s[12:15], s40 offen lds
    s_add_u32 s40, s40, 128
    s_add_u32 s43, s43, 1
    s_cmp_eq_u32 s43, 2
    s_cselect_b32 s40, 0, s40
    s_cselect_b32 s42, s45, s42
    s_cmp_eq_u32 s40, s42
    s_cselect_b32 s33, 256, 0
    s_add_u32 s40, s40, s33
    s_add_u32 s41, s41, 34816
    s_cmp_ge_u32 s41, 139264
    s_cselect_b32 s41, s44, s41
    s_add_u32 s35, s35, 1
    s_cmp_lt_u32 s35, 5
    s_cbranch_scc1 fz_hB
    s_waitcnt vmcnt(32)
    s_barrier
    s_mov_b32 m0, s41
    s_nop 0
    buffer_load_dwordx4 v220, s[12:15], s40 offen lds
    s_add_u32 m0, s41, 1024
    s_nop 0
    buffer_load_dwordx4 v221, s[12:15], s40 offen lds
    s_add_u32 m0, s41, 2048
    s_nop 0
    buffer_load_dwordx4 v222, s[12:15], s40 offen lds
    s_add_u32 m0, s41, 3072
    s_nop 0
    buffer_load_dwordx4 v223, s[12:15], s40 offen lds
    s_add_u32 m0, s41, 4096
    s_nop 0
    buffer_load_dwordx4 v224, s[12:15], s40 offen lds
    s_add_u32 m0, s41, 5120
    s_nop 0
    buffer_load_dwordx4 v225, s[12:15], s40 offen lds
    s_add_u32 m0, s41, 6144
    s_nop 0
    buffer_load_dwordx4 v226, s[12:15], s40 offen lds
    s_add_u32 m0, s41, 7168
    s_nop 0
    buffer_load_dwordx4 v227, s[12:15], s40 offen lds
    s_add_u32 s40, s40, 128
    s_add_u32 s43, s43, 1
    s_cmp_eq_u32 s43, 2
    s_cselect_b32 s40, 0, s40
    s_cselect_b32 s42, s45, s42
    s_cmp_eq_u32 s40, s42
    s_cselect_b32 s33, 256, 0
    s_add_u32 s40, s40, s33
    s_add_u32 s41, s41, 34816
    s_cmp_ge_u32 s41, 139264
    s_cselect_b32 s41, s44, s41
    s_waitcnt vmcnt(24)
    s_barrier
    s_mov_b32 m0, s41
    s_nop 0
    buffer_load_dwordx4 v220, s[12:15], s40 offen lds
    s_add_u32 m0, s41, 1024
    s_nop 0
    buffer_load_dwordx4 v221, s[12:15], s40 offen lds
    s_add_u32 m0, s41, 2048
    s_nop 0
    buffer_load_dwordx4 v222, s[12:15], s40 offen lds
    s_add_u32 m0, s41, 3072
    s_nop 0
    buffer_load_dwordx4 v223, s[12:15], s40 offen lds
    s_add_u32 m0, s41, 4096
    s_nop 0
    buffer_load_dwordx4 v224, s[12:15], s40 offen lds
    s_add_u32 m0, s41, 5120
    s_nop 0
    buffer_load_dwordx4 v225, s[12:15], s40 offen lds
    s_add_u32 m0, s41, 6144
    s_nop 0
    buffer_load_dwordx4 v226, s[12:15], s40 offen lds
    s_add_u32 m0, s41, 7168
    s_nop 0
    buffer_load_dwordx4 v227, s[12:15], s40 offen lds
    s_add_u32 s40, s40, 128
    s_add_u32 s43, s43, 1
    s_cmp_eq_u32 s43, 2
    s_cselect_b32 s40, 0, s40
    s_cselect_b32 s42, s45, s42
    s_cmp_eq_u32 s40, s42
    s_cselect_b32 s33, 256, 0
    s_add_u32 s40, s40, s33
    s_add_u32 s41, s41, 34816
    s_cmp_ge_u32 s41, 139264
    s_cselect_b32 s41, s44, s41
    s_mov_b32 s35, 7
fz_lB:
    s_waitcnt vmcnt(16)
    s_barrier
    s_mov_b32 m0, s41
    s_nop 0
    buffer_load_dwordx4 v220, s[12:15], s40 offen lds
    s_add_u32 m0, s41, 1024
    s_nop 0
    buffer_load_dwordx4 v221, s[12:15], s40 offen lds
    s_add_u32 m0, s41, 2048
    s_nop 0
    buffer_load_dwordx4 v222, s[12:15], s40 offen lds
    s_add_u32 m0, s41, 3072
    s_nop 0
    buffer_load_dwordx4 v223, s[12:15], s40 offen lds
    s_add_u32 m0, s41, 4096
    s_nop 0
    buffer_load_dwordx4 v224, s[12:15], s40 offen lds
    s_add_u32 m0, s41, 5120
    s_nop 0
    buffer_load_dwordx4 v225, s[12:15], s40 offen lds
    s_add_u32 m0, s41, 6144
    s_nop 0
    buffer_load_dwordx4 v226, s[12:15], s40 offen lds
    s_add_u32 m0, s41, 7168
    s_nop 0
    buffer_load_dwordx4 v227, s[12:15], s40 offen lds
    s_add_u32 s40, s40, 128
    s_add_u32 s43, s43, 1
    s_cmp_eq_u32 s43, 2
    s_cselect_b32 s40, 0, s40
    s_cselect_b32 s42, s45, s42
    s_cmp_eq_u32 s40, s42
    s_cselect_b32 s33, 256, 0
    s_add_u32 s40, s40, s33
    s_add_u32 s41, s41, 34816
    s_cmp_ge_u32 s41, 139264
    s_cselect_b32 s41, s44, s41
    s_cmp_eq_u32 s35, 24
    s_cbranch_scc0 fz_mB
    buffer_load_dwordx2 v[214:215], v216, s[16:19], s52 offen sc1
fz_mB:
    s_add_u32 s35, s35, 1
    s_cmp_lt_u32 s35, 29
    s_cbranch_scc1 fz_lB
    s_mov_b32 s62, 0
parallel_sum__ssm_conv_s4__mixer_gmlp__prompt_kernel_w440:
    v_cmp_ne_u32 vcc, s23, v214
    s_nop 0
    s_and_b32 vcc_lo, vcc_lo, 0x77777777
    s_and_b32 vcc_hi, vcc_hi, 0x77777777
    v_cmp_ne_u32 s[60:61], s23, v215
    s_nop 0
    s_and_b32 s60, s60, 0x33333333
    s_and_b32 s61, s61, 0x33333333
    s_or_b64 vcc, vcc, s[60:61]
    s_cbranch_scc0 parallel_sum__ssm_conv_s4__mixer_gmlp__prompt_kernel_w4d41
    s_add_u32 s62, s62, 1
    s_cmp_ge_u32 s62, 16384
    s_cbranch_scc1 parallel_sum__ssm_conv_s4__mixer_gmlp__prompt_kernel_w4d41
    buffer_load_dwordx2 v[214:215], v216, s[16:19], s52 offen sc1
    s_waitcnt vmcnt(0)
    s_branch parallel_sum__ssm_conv_s4__mixer_gmlp__prompt_kernel_w440
parallel_sum__ssm_conv_s4__mixer_gmlp__prompt_kernel_w4d41:
    s_waitcnt vmcnt(16)
    s_barrier
    s_waitcnt vmcnt(8)
    s_barrier
    s_add_u32 s48, s21, 5
    s_and_b32 s48, s48, 15
    s_mul_i32 s48, s48, 20736
    s_add_u32 s48, s48, s63
    s_mov_b32 m0, 21504
    s_nop 0
    buffer_load_dwordx4 v217, s[24:27], s48 offen sc1 lds
    s_add_u32 s48, s48, 1024
    s_mov_b32 m0, 22528
    s_nop 0
    buffer_load_dwordx4 v217, s[24:27], s48 offen sc1 lds
    s_add_u32 s48, s48, 1024
    s_mov_b32 m0, 23552
    s_nop 0
    buffer_load_dwordx4 v217, s[24:27], s48 offen sc1 lds
    s_add_u32 s48, s48, 1024
    s_mov_b32 m0, 24576
    s_nop 0
    buffer_load_dwordx4 v217, s[24:27], s48 offen sc1 lds
    s_add_u32 s48, s48, 1024
    s_mov_b32 m0, 25600
    s_nop 0
    buffer_load_dwordx4 v217, s[24:27], s48 offen sc1 lds
    s_add_u32 s48, s48, 1024
    s_mov_b32 m0, 26624
    s_nop 0
    buffer_load_dwordx4 v217, s[24:27], s48 offen sc1 lds
    s_add_u32 s48, s48, 1024
    s_mov_b32 m0, 27648
    s_nop 0
    buffer_load_dwordx4 v217, s[24:27], s48 offen sc1 lds
    s_add_u32 s48, s48, 1024
    s_mov_b32 m0, 28672
    s_nop 0
    buffer_load_dwordx4 v217, s[24:27], s48 offen sc1 lds
    s_add_u32 s48, s48, 1024
    s_mov_b32 m0, 29696
    s_nop 0
    buffer_load_dwordx4 v217, s[24:27], s48 offen sc1 lds
    s_add_u32 s48, s48, 1024
    s_mov_b32 m0, 30720
    s_nop 0
    buffer_load_dwordx4 v217, s[24:27], s48 offen sc1 lds
    s_add_u32 s48, s48, 1024
    s_mov_b32 m0, 31744
    s_nop 0
    buffer_load_dwordx4 v217, s[24:27], s48 offen sc1 lds
    s_add_u32 s48, s48, 1024
    s_mov_b32 m0, 32768
    s_nop 0
    buffer_load_dwordx4 v217, s[24:27], s48 offen sc1 lds
    s_add_u32 s48, s48, 1024
    s_mov_b32 m0, 33792
    s_nop 0
    buffer_load_dwordx4 v217, s[24:27], s48 offen sc1 lds
    s_add_u32 s48, s48, 1024
    s_mov_b32 m0, 34816
    s_nop 0
    buffer_load_dwordx4 v217, s[24:27], s48 offen sc1 lds
    s_add_u32 s48, s48, 1024
    s_mov_b32 m0, 35840
    s_nop 0
    buffer_load_dwordx4 v217, s[24:27], s48 offen sc1 lds
    s_add_u32 s48, s48, 1024
    s_mov_b32 m0, 36864
    s_nop 0
    buffer_load_dwordx4 v217, s[24:27], s48 offen sc1 lds
    s_add_u32 s48, s48, 1024
    s_mov_b32 m0, 37888
    s_nop 0
    buffer_load_dwordx4 v217, s[24:27], s48 offen sc1 lds
    s_add_u32 s48, s48, 1024
    s_mov_b32 m0, 38912
    s_nop 0
    buffer_load_dwordx4 v217, s[24:27], s48 offen sc1 lds
    s_add_u32 s48, s48, 1024
    s_mov_b32 m0, 39936
    s_nop 0
    buffer_load_dwordx4 v217, s[24:27], s48 offen sc1 lds
    s_add_u32 s48, s48, 1024
    s_mov_b32 m0, 40960
    s_nop 0
    buffer_load_dwordx4 v217, s[24:27], s48 offen sc1 lds
    s_add_u32 s48, s48, 1024
    s_mov_b32 exec_lo, 0xffff
    s_mov_b32 exec_hi, 0x0
    s_mov_b32 m0, 41984
    s_nop 0
    buffer_load_dwordx4 v217, s[24:27], s48 offen sc1 lds
    s_add_u32 s48, s48, 1024
    s_mov_b64 exec, -1
    s_add_u32 s48, s21, 6
    s_and_b32 s48, s48, 15
    s_mul_i32 s48, s48, 20736
    s_add_u32 s48, s48, s63
    s_mov_b32 m0, 43008
    s_nop 0
    buffer_load_dwordx4 v217, s[24:27], s48 offen sc1 lds
    s_add_u32 s48, s48, 1024
    s_mov_b32 m0, 44032
    s_nop 0
    buffer_load_dwordx4 v217, s[24:27], s48 offen sc1 lds
    s_add_u32 s48, s48, 1024
    s_mov_b32 m0, 45056
    s_nop 0
    buffer_load_dwordx4 v217, s[24:27], s48 offen sc1 lds
    s_add_u32 s48, s48, 1024
    s_mov_b32 m0, 46080
    s_nop 0
    buffer_load_dwordx4 v217, s[24:27], s48 offen sc1 lds
    s_add_u32 s48, s48, 1024
    s_mov_b32 m0, 47104
    s_nop 0
    buffer_load_dwordx4 v217, s[24:27], s48 offen sc1 lds
    s_add_u32 s48, s48, 1024
    s_mov_b32 m0, 48128
    s_nop 0
    buffer_load_dwordx4 v217, s[24:27], s48 offen sc1 lds
    s_add_u32 s48, s48, 1024
    s_mov_b32 m0, 49152
    s_nop 0
    buffer_load_dwordx4 v217, s[24:27], s48 offen sc1 lds
    s_add_u32 s48, s48, 1024
    s_mov_b32 m0, 50176
    s_nop 0
    buffer_load_dwordx4 v217, s[24:27], s48 offen sc1 lds
    s_add_u32 s48, s48, 1024
    s_mov_b32 m0, 51200
    s_nop 0
    buffer_load_dwordx4 v217, s[24:27], s48 offen sc1 lds
    s_add_u32 s48, s48, 1024
    s_mov_b32 m0, 52224
    s_nop 0
    buffer_load_dwordx4 v217, s[24:27], s48 offen sc1 lds
    s_add_u32 s48, s48, 1024
    s_mov_b32 m0, 53248
    s_nop 0
    buffer_load_dwordx4 v217, s[24:27], s48 offen sc1 lds
    s_add_u32 s48, s48, 1024
    s_mov_b32 m0, 54272
    s_nop 0
    buffer_load_dwordx4 v217, s[24:27], s48 offen sc1 lds
    s_add_u32 s48, s48, 1024
    s_mov_b32 m0, 55296
    s_nop 0
    buffer_load_dwordx4 v217, s[24:27], s48 offen sc1 lds
    s_add_u32 s48, s48, 1024
    s_mov_b32 m0, 56320
    s_nop 0
    buffer_load_dwordx4 v217, s[24:27], s48 offen sc1 lds
    s_add_u32 s48, s48, 1024
    s_mov_b32 m0, 57344
    s_nop 0
    buffer_load_dwordx4 v217, s[24:27], s48 offen sc1 lds
    s_add_u32 s48, s48, 1024
    s_mov_b32 m0, 58368
    s_nop 0
    buffer_load_dwordx4 v217, s[24:27], s48 offen sc1 lds
    s_add_u32 s48, s48, 1024
    s_mov_b32 m0, 59392
    s_nop 0
    buffer_load_dwordx4 v217, s[24:27], s48 offen sc1 lds
    s_add_u32 s48, s48, 1024
    s_mov_b32 m0, 60416
    s_nop 0
    buffer_load_dwordx4 v217, s[24:27], s48 offen sc1 lds
    s_add_u32 s48, s48, 1024
    s_mov_b32 m0, 61440
    s_nop 0
    buffer_load_dwordx4 v217, s[24:27], s48 offen sc1 lds
    s_add_u32 s48, s48, 1024
    s_mov_b32 m0, 62464
    s_nop 0
    buffer_load_dwordx4 v217, s[24:27], s48 offen sc1 lds
    s_add_u32 s48, s48, 1024
    s_mov_b32 exec_lo, 0xffff
    s_mov_b32 exec_hi, 0x0
    s_mov_b32 m0, 63488
    s_nop 0
    buffer_load_dwordx4 v217, s[24:27], s48 offen sc1 lds
    s_add_u32 s48, s48, 1024
    s_mov_b64 exec, -1
    s_waitcnt vmcnt(42)
    s_barrier
    s_waitcnt vmcnt(0)
    s_barrier
    s_lshl_b32 s58, s2, 1
    s_mov_b32 s59, 64512
    s_mov_b32 s57, 163072
    s_cmp_ge_u32 s2, 64
    s_cbranch_scc1 fz_help
    s_add_u32 s58, s2, 512
    s_mov_b32 s59, 107520
    s_mov_b32 s57, 163080
    s_branch fz_help
fz_idle:
    v_mov_b32 v44, 163072
    v_mov_b32 v45, 0
    ds_write_b32 v44, v45
    ds_write_b32 v44, v45 offset:4
    s_load_dwordx2 s[6:7], s[0:1], 88
    s_load_dwordx2 s[8:9], s[0:1], 104
    s_lshl_b32 s50, s56, 8
    s_add_u32 s50, s50, s2
    s_add_u32 s51, s2, 384
    s_cmp_ge_u32 s2, 128
    s_cselect_b32 s51, s51, 999
    s_cmp_eq_u32 s56, 0
    s_cselect_b32 s51, s51, 999
    s_lshl_b32 s52, s56, 13
    s_add_u32 s52, s52, 139264
    s_mov_b32 s63, 155648
    s_mov_b32 s38, 36864
    s_mov_b32 s39, 36864
    s_waitcnt lgkmcnt(0)
    s_mov_b32 s24, s8
    s_mov_b32 s25, s9
    s_mov_b32 s26, 2654208
    s_mov_b32 s27, 0x20000
    s_add_u32 s28, s4, 35389440
    s_addc_u32 s29, s5, 0
    s_mov_b32 s30, 2654208
    s_mov_b32 s31, 0x20000
    s_mov_b32 s12, s6
    s_mov_b32 s13, s7
    s_mov_b32 s14, 8388608
    s_mov_b32 s15, 0x20000
    s_mul_i32 s36, s50, 52429
    s_lshr_b32 s36, s36, 18
    s_mul_i32 s37, s36, 5
    s_sub_u32 s37, s50, s37
    s_lshr_b32 s33, s36, 4
    s_and_b32 s35, s36, 15
    s_mul_i32 s35, s35, 144
    s_lshl_b32 s37, s37, 5
    s_add_u32 s35, s35, s37
    s_mul_i32 s35, s35, 1152
    s_mul_i32 s33, s33, 144
    s_add_u32 s35, s35, s33
    s_cmp_lt_u32 s50, 640
    s_cselect_b32 s35, s35, 2146435072
    s_mov_b32 s33, 7282
    v_add_u32 v44, 0, v255
    v_mul_lo_u32 v45, v44, s33
    v_lshrrev_b32 v45, 16, v45
    v_mul_u32_u24 v46, 9, v45
    v_sub_u32 v46, v44, v46
    v_mul_u32_u24 v45, 1152, v45
    v_lshl_add_u32 v45, v46, 4, v45
    s_add_u32 m0, s52, 0
    s_nop 0
    buffer_load_dwordx4 v45, s[24:27], s35 offen lds
    v_add_u32 v44, 64, v255
    v_mul_lo_u32 v45, v44, s33
    v_lshrrev_b32 v45, 16, v45
    v_mul_u32_u24 v46, 9, v45
    v_sub_u32 v46, v44, v46
    v_mul_u32_u24 v45, 1152, v45
    v_lshl_add_u32 v45, v46, 4, v45
    s_add_u32 m0, s52, 1024
    s_nop 0
    buffer_load_dwordx4 v45, s[24:27], s35 offen lds
    v_add_u32 v44, 128, v255
    v_mul_lo_u32 v45, v44, s33
    v_lshrrev_b32 v45, 16, v45
    v_mul_u32_u24 v46, 9, v45
    v_sub_u32 v46, v44, v46
    v_mul_u32_u24 v45, 1152, v45
    v_lshl_add_u32 v45, v46, 4, v45
    s_add_u32 m0, s52, 2048
    s_nop 0
    buffer_load_dwordx4 v45, s[24:27], s35 offen lds
    v_add_u32 v44, 192, v255
    v_mul_lo_u32 v45, v44, s33
    v_lshrrev_b32 v45, 16, v45
    v_mul_u32_u24 v46, 9, v45
    v_sub_u32 v46, v44, v46
    v_mul_u32_u24 v45, 1152, v45
    v_lshl_add_u32 v45, v46, 4, v45
    s_add_u32 m0, s52, 3072
    s_nop 0
    buffer_load_dwordx4 v45, s[24:27], s35 offen lds
    v_add_u32 v44, 256, v255
    v_mul_lo_u32 v45, v44, s33
    v_lshrrev_b32 v45, 16, v45
    v_mul_u32_u24 v46, 9, v45
    v_sub_u32 v46, v44, v46
    v_mul_u32_u24 v45, 1152, v45
    v_lshl_add_u32 v45, v46, 4, v45
    s_add_u32 m0, s52, 4096
    s_nop 0
    buffer_load_dwordx4 v45, s[24:27], s35 offen lds
    s_cmp_ge_u32 s51, 640
    s_cbranch_scc1 fz_ns2
    s_mul_i32 s36, s51, 52429
    s_lshr_b32 s36, s36, 18
    s_mul_i32 s37, s36, 5
    s_sub_u32 s37, s51, s37
    s_lshr_b32 s33, s36, 4
    s_and_b32 s35, s36, 15
    s_mul_i32 s35, s35, 144
    s_lshl_b32 s37, s37, 5
    s_add_u32 s35, s35, s37
    s_mul_i32 s35, s35, 1152
    s_mul_i32 s33, s33, 144
    s_add_u32 s35, s35, s33
    s_cmp_lt_u32 s51, 640
    s_cselect_b32 s35, s35, 2146435072
    s_mov_b32 s33, 7282
    v_add_u32 v44, 0, v255
    v_mul_lo_u32 v45, v44, s33
    v_lshrrev_b32 v45, 16, v45
    v_mul_u32_u24 v46, 9, v45
    v_sub_u32 v46, v44, v46
    v_mul_u32_u24 v45, 1152, v45
    v_lshl_add_u32 v45, v46, 4, v45
    s_add_u32 m0, s63, 0
    s_nop 0
    buffer_load_dwordx4 v45, s[24:27], s35 offen lds
    v_add_u32 v44, 64, v255
    v_mul_lo_u32 v45, v44, s33
    v_lshrrev_b32 v45, 16, v45
    v_mul_u32_u24 v46, 9, v45
    v_sub_u32 v46, v44, v46
    v_mul_u32_u24 v45, 1152, v45
    v_lshl_add_u32 v45, v46, 4, v45
    s_add_u32 m0, s63, 1024
    s_nop 0
    buffer_load_dwordx4 v45, s[24:27], s35 offen lds
    v_add_u32 v44, 128, v255
    v_mul_lo_u32 v45, v44, s33
    v_lshrrev_b32 v45, 16, v45
    v_mul_u32_u24 v46, 9, v45
    v_sub_u32 v46, v44, v46
    v_mul_u32_u24 v45, 1152, v45
    v_lshl_add_u32 v45, v46, 4, v45
    s_add_u32 m0, s63, 2048
    s_nop 0
    buffer_load_dwordx4 v45, s[24:27], s35 offen lds
    v_add_u32 v44, 192, v255
    v_mul_lo_u32 v45, v44, s33
    v_lshrrev_b32 v45, 16, v45
    v_mul_u32_u24 v46, 9, v45
    v_sub_u32 v46, v44, v46
    v_mul_u32_u24 v45, 1152, v45
    v_lshl_add_u32 v45, v46, 4, v45
    s_add_u32 m0, s63, 3072
    s_nop 0
    buffer_load_dwordx4 v45, s[24:27], s35 offen lds
    v_add_u32 v44, 256, v255
    v_mul_lo_u32 v45, v44, s33
    v_lshrrev_b32 v45, 16, v45
    v_mul_u32_u24 v46, 9, v45
    v_sub_u32 v46, v44, v46
    v_mul_u32_u24 v45, 1152, v45
    v_lshl_add_u32 v45, v46, 4, v45
    s_add_u32 m0, s63, 4096
    s_nop 0
    buffer_load_dwordx4 v45, s[24:27], s35 offen lds
fz_ns2:
    s_barrier
    s_barrier
    s_waitcnt vmcnt(0)
    s_cmp_ge_u32 s50, 640
    s_cbranch_scc1 parallel_sum__ssm_conv_s4__mixer_gmlp__prompt_kernel_sr42
    v_bfe_u32 v47, v255, 2, 2
    v_and_b32 v48, 3, v255
    v_lshrrev_b32 v51, 4, v255
    v_lshl_add_u32 v47, v51, 2, v47
    v_mul_u32_u24 v47, 144, v47
    v_lshl_add_u32 v47, v48, 3, v47
    v_add_u32 v47, s52, v47
    ds_read_b64_tr_b16 v[54:55], v47 offset:0
    ds_read_b64_tr_b16 v[56:57], v47 offset:2304
    ds_read_b64_tr_b16 v[58:59], v47 offset:32
    ds_read_b64_tr_b16 v[60:61], v47 offset:2336
    ds_read_b64_tr_b16 v[62:63], v47 offset:64
    ds_read_b64_tr_b16 v[64:65], v47 offset:2368
    ds_read_b64_tr_b16 v[66:67], v47 offset:96
    ds_read_b64_tr_b16 v[68:69], v47 offset:2400
    ds_read_b64_tr_b16 v[70:71], v47 offset:128
    ds_read_b64_tr_b16 v[72:73], v47 offset:2432
    v_lshlrev_b32 v52, 4, v255
    v_lshlrev_b32 v53, 3, v255
    v_and_b32 v78, 7, v255
    v_lshl_add_u32 v78, v51, 3, v78
    v_lshlrev_b32 v79, 4, v78
    v_lshlrev_b32 v78, 3, v78
    s_mul_i32 s36, s50, 52429
    s_lshr_b32 s36, s36, 18
    s_mul_i32 s37, s36, 5
    s_sub_u32 s37, s50, s37
    s_mul_i32 s33, s36, 20736
    s_mul_i32 s35, s37, 4608
    s_add_u32 s33, s33, s35
    s_add_u32 s35, s33, 4096
    s_lshl_b32 s38, s36, 3
    s_add_u32 s38, s38, s37
    s_lshl_b32 s38, s38, 2
    s_add_u32 s38, s38, 20480
    s_cmp_eq_u32 s37, 4
    s_waitcnt lgkmcnt(0)
    s_cbranch_scc1 parallel_sum__ssm_conv_s4__mixer_gmlp__prompt_kernel_sr43
    buffer_store_dwordx4 v[54:57], v52, s[28:31], s33 offen offset:0 sc1
    buffer_store_dwordx4 v[58:61], v52, s[28:31], s33 offen offset:1024 sc1
    buffer_store_dwordx4 v[62:65], v52, s[28:31], s33 offen offset:2048 sc1
    buffer_store_dwordx4 v[66:69], v52, s[28:31], s33 offen offset:3072 sc1
    s_mov_b32 exec_lo, 0xff00ff
    s_mov_b32 exec_hi, 0xff00ff
    buffer_store_dwordx4 v[70:73], v79, s[28:31], s35 offen sc1
    s_branch parallel_sum__ssm_conv_s4__mixer_gmlp__prompt_kernel_sr44
parallel_sum__ssm_conv_s4__mixer_gmlp__prompt_kernel_sr43:
    buffer_store_dwordx2 v[54:55], v53, s[28:31], s33 offen offset:0 sc1
    buffer_store_dwordx2 v[58:59], v53, s[28:31], s33 offen offset:512 sc1
    buffer_store_dwordx2 v[62:63], v53, s[28:31], s33 offen offset:1024 sc1
    buffer_store_dwordx2 v[66:67], v53, s[28:31], s33 offen offset:1536 sc1
    s_mov_b32 exec_lo, 0xff00ff
    s_mov_b32 exec_hi, 0xff00ff
    buffer_store_dwordx2 v[70:71], v78, s[28:31], s33 offen offset:2048 sc1
parallel_sum__ssm_conv_s4__mixer_gmlp__prompt_kernel_sr44:
    s_mov_b64 exec, -1
parallel_sum__ssm_conv_s4__mixer_gmlp__prompt_kernel_sr42:
    s_cmp_ge_u32 s51, 640
    s_cbranch_scc1 parallel_sum__ssm_conv_s4__mixer_gmlp__prompt_kernel_sr45
    v_bfe_u32 v47, v255, 2, 2
    v_and_b32 v48, 3, v255
    v_lshrrev_b32 v51, 4, v255
    v_lshl_add_u32 v47, v51, 2, v47
    v_mul_u32_u24 v47, 144, v47
    v_lshl_add_u32 v47, v48, 3, v47
    v_add_u32 v47, s63, v47
    ds_read_b64_tr_b16 v[54:55], v47 offset:0
    ds_read_b64_tr_b16 v[56:57], v47 offset:2304
    ds_read_b64_tr_b16 v[58:59], v47 offset:32
    ds_read_b64_tr_b16 v[60:61], v47 offset:2336
    ds_read_b64_tr_b16 v[62:63], v47 offset:64
    ds_read_b64_tr_b16 v[64:65], v47 offset:2368
    ds_read_b64_tr_b16 v[66:67], v47 offset:96
    ds_read_b64_tr_b16 v[68:69], v47 offset:2400
    ds_read_b64_tr_b16 v[70:71], v47 offset:128
    ds_read_b64_tr_b16 v[72:73], v47 offset:2432
    v_lshlrev_b32 v52, 4, v255
    v_lshlrev_b32 v53, 3, v255
    v_and_b32 v78, 7, v255
    v_lshl_add_u32 v78, v51, 3, v78
    v_lshlrev_b32 v79, 4, v78
    v_lshlrev_b32 v78, 3, v78
    s_mul_i32 s36, s51, 52429
    s_lshr_b32 s36, s36, 18
    s_mul_i32 s37, s36, 5
    s_sub_u32 s37, s51, s37
    s_mul_i32 s33, s36, 20736
    s_mul_i32 s35, s37, 4608
    s_add_u32 s33, s33, s35
    s_add_u32 s35, s33, 4096
    s_lshl_b32 s39, s36, 3
    s_add_u32 s39, s39, s37
    s_lshl_b32 s39, s39, 2
    s_add_u32 s39, s39, 20480
    s_cmp_eq_u32 s37, 4
    s_waitcnt lgkmcnt(0)
    s_cbranch_scc1 parallel_sum__ssm_conv_s4__mixer_gmlp__prompt_kernel_sr46
    buffer_store_dwordx4 v[54:57], v52, s[28:31], s33 offen offset:0 sc1
    buffer_store_dwordx4 v[58:61], v52, s[28:31], s33 offen offset:1024 sc1
    buffer_store_dwordx4 v[62:65], v52, s[28:31], s33 offen offset:2048 sc1
    buffer_store_dwordx4 v[66:69], v52, s[28:31], s33 offen offset:3072 sc1
    s_mov_b32 exec_lo, 0xff00ff
    s_mov_b32 exec_hi, 0xff00ff
    buffer_store_dwordx4 v[70:73], v79, s[28:31], s35 offen sc1
    s_branch parallel_sum__ssm_conv_s4__mixer_gmlp__prompt_kernel_sr47
parallel_sum__ssm_conv_s4__mixer_gmlp__prompt_kernel_sr46:
    buffer_store_dwordx2 v[54:55], v53, s[28:31], s33 offen offset:0 sc1
    buffer_store_dwordx2 v[58:59], v53, s[28:31], s33 offen offset:512 sc1
    buffer_store_dwordx2 v[62:63], v53, s[28:31], s33 offen offset:1024 sc1
    buffer_store_dwordx2 v[66:67], v53, s[28:31], s33 offen offset:1536 sc1
    s_mov_b32 exec_lo, 0xff00ff
    s_mov_b32 exec_hi, 0xff00ff
    buffer_store_dwordx2 v[70:71], v78, s[28:31], s33 offen offset:2048 sc1
parallel_sum__ssm_conv_s4__mixer_gmlp__prompt_kernel_sr47:
    s_mov_b64 exec, -1
parallel_sum__ssm_conv_s4__mixer_gmlp__prompt_kernel_sr45:
    s_setprio 3
    s_cmp_eq_u32 s22, 7
    s_cbranch_scc1 fz_h7
    s_mov_b32 s12, s4
    s_mov_b32 s13, s5
    s_mov_b32 s14, 9437184
    s_mov_b32 s15, 0x20000
    s_lshl_b32 s45, s20, 12
    s_mul_i32 s31, s21, 589824
    v_lshlrev_b32 v198, 4, v255
    v_add_u32 v198, s31, v198
    s_mov_b32 s44, 0
    v_add_u32 v202, 263168, v198
    v_add_u32 v203, 327680, v198
    v_add_u32 v204, 328704, v198
    v_add_u32 v205, 393216, v198
    v_add_u32 v206, 394240, v198
    v_add_u32 v207, 458752, v198
    v_add_u32 v208, 459776, v198
    v_add_u32 v209, 524288, v198
    v_add_u32 v210, 525312, v198
    s_lshl_b32 s30, s21, 8
    s_add_u32 s30, s30, 8192
    v_lshlrev_b32 v199, 2, v255
    s_mov_b64 s[46:47], -1
    s_mov_b32 s62, 0
    s_mov_b32 s40, s45
    s_mov_b32 s41, s44
    s_mov_b32 s35, 0
fz_a6:
    s_add_u32 s40, s40, 2048
    s_add_u32 s43, s43, 1
    s_cmp_eq_u32 s43, 2
    s_cselect_b32 s40, 0, s40
    s_cselect_b32 s42, s45, s42
    s_cmp_eq_u32 s40, s42
    s_cselect_b32 s33, 4096, 0
    s_add_u32 s40, s40, s33
    s_add_u32 s41, s41, 34816
    s_cmp_ge_u32 s41, 139264
    s_cselect_b32 s41, s44, s41
    s_add_u32 s35, s35, 1
    s_cmp_lt_u32 s35, 8
    s_cbranch_scc1 fz_a6
    s_barrier
    s_mov_b32 s35, 5
fz_r6:
    s_waitcnt vmcnt(18)
    s_barrier
parallel_sum__ssm_conv_s4__mixer_gmlp__prompt_kernel_pc48:
    s_lshr_b32 s33, s40, 10
    s_and_b32 s33, s33, 60
    s_lshr_b64 s[48:49], s[46:47], s33
    s_and_b32 s48, s48, 15
    s_cbranch_scc0 parallel_sum__ssm_conv_s4__mixer_gmlp__prompt_kernel_pd49
    s_add_u32 s62, s62, 1
    s_cmp_ge_u32 s62, 16384
    s_cbranch_scc1 parallel_sum__ssm_conv_s4__mixer_gmlp__prompt_kernel_pd49
    buffer_load_dword v200, v199, s[16:19], s30 offen sc1
    s_waitcnt vmcnt(0)
    v_cmp_ne_u32 s[46:47], s23, v200
    s_branch parallel_sum__ssm_conv_s4__mixer_gmlp__prompt_kernel_pc48
parallel_sum__ssm_conv_s4__mixer_gmlp__prompt_kernel_pd49:
    s_add_u32 m0, s41, 9216
    s_nop 0
    buffer_load_dwordx4 v202, s[12:15], s40 offen sc1 lds
    s_add_u32 m0, s41, 10240
    s_nop 0
    buffer_load_dwordx4 v203, s[12:15], s40 offen sc1 lds
    s_add_u32 m0, s41, 11264
    s_nop 0
    buffer_load_dwordx4 v204, s[12:15], s40 offen sc1 lds
    s_add_u32 m0, s41, 12288
    s_nop 0
    buffer_load_dwordx4 v205, s[12:15], s40 offen sc1 lds
    s_add_u32 m0, s41, 13312
    s_nop 0
    buffer_load_dwordx4 v206, s[12:15], s40 offen sc1 lds
    s_add_u32 m0, s41, 14336
    s_nop 0
    buffer_load_dwordx4 v207, s[12:15], s40 offen sc1 lds
    s_add_u32 m0, s41, 15360
    s_nop 0
    buffer_load_dwordx4 v208, s[12:15], s40 offen sc1 lds
    s_add_u32 m0, s41, 16384
    s_nop 0
    buffer_load_dwordx4 v209, s[12:15], s40 offen sc1 lds
    s_add_u32 m0, s41, 17408
    s_nop 0
    buffer_load_dwordx4 v210, s[12:15], s40 offen sc1 lds
    s_add_u32 s40, s40, 2048
    s_add_u32 s43, s43, 1
    s_cmp_eq_u32 s43, 2
    s_cselect_b32 s40, 0, s40
    s_cselect_b32 s42, s45, s42
    s_cmp_eq_u32 s40, s42
    s_cselect_b32 s33, 4096, 0
    s_add_u32 s40, s40, s33
    s_add_u32 s41, s41, 34816
    s_cmp_ge_u32 s41, 139264
    s_cselect_b32 s41, s44, s41
    s_cmp_eq_u32 s35, 8
    s_cbranch_scc0 fz_f6
    v_mov_b32 v44, 0
    v_mov_b32 v45, s23
    s_mov_b64 exec, 1
    buffer_store_dword v45, v44, s[16:19], s38 offen sc1
    buffer_store_dword v45, v44, s[16:19], s39 offen sc1
    s_mov_b64 exec, -1
fz_f6:
    s_add_u32 s35, s35, 1
    s_cmp_lt_u32 s35, 29
    s_cbranch_scc1 fz_r6
    s_waitcnt vmcnt(18)
    s_barrier
    s_waitcnt vmcnt(9)
    s_barrier
    s_waitcnt vmcnt(0)
    s_branch fz_h9
fz_h7:
    v_lshrrev_b32 v44, 3, v255
    v_and_b32 v45, 7, v255
    v_lshrrev_b32 v46, 4, v255
    v_xor_b32 v45, v45, v46
    v_and_b32 v46, 1, v45
    v_lshlrev_b32 v46, 1, v46
    v_bfe_u32 v47, v45, 1, 1
    v_and_b32 v45, 4, v45
    v_or_b32 v45, v45, v46
    v_or_b32 v45, v45, v47
    v_lshlrev_b32 v45, 4, v45
    v_lshl_add_u32 v45, v44, 12, v45
    s_lshl_b32 s31, s20, 19
    v_add_u32 v44, s31, v45
    v_xor_b32 v45, 64, v44
    s_lshl_b32 s45, s20, 8
    s_mov_b32 s44, 18432
    v_add_u32 v202, 262144, v44
    v_add_u32 v203, 294912, v45
    v_add_u32 v204, 327680, v44
    v_add_u32 v205, 360448, v45
    v_add_u32 v206, 393216, v44
    v_add_u32 v207, 425984, v45
    v_add_u32 v208, 458752, v44
    v_add_u32 v209, 491520, v45
    s_mov_b32 s40, s45
    s_mov_b32 s41, s44
    s_mov_b32 s35, 0
fz_a7:
    s_add_u32 s40, s40, 128
    s_add_u32 s43, s43, 1
    s_cmp_eq_u32 s43, 2
    s_cselect_b32 s40, 0, s40
    s_cselect_b32 s42, s45, s42
    s_cmp_eq_u32 s40, s42
    s_cselect_b32 s33, 256, 0
    s_add_u32 s40, s40, s33
    s_add_u32 s41, s41, 34816
    s_cmp_ge_u32 s41, 139264
    s_cselect_b32 s41, s44, s41
    s_add_u32 s35, s35, 1
    s_cmp_lt_u32 s35, 8
    s_cbranch_scc1 fz_a7
    s_barrier
    s_mov_b32 s35, 5
fz_r7:
    s_waitcnt vmcnt(16)
    s_barrier
    s_add_u32 m0, s41, 8192
    s_nop 0
    buffer_load_dwordx4 v202, s[12:15], s40 offen lds
    s_add_u32 m0, s41, 9216
    s_nop 0
    buffer_load_dwordx4 v203, s[12:15], s40 offen lds
    s_add_u32 m0, s41, 10240
    s_nop 0
    buffer_load_dwordx4 v204, s[12:15], s40 offen lds
    s_add_u32 m0, s41, 11264
    s_nop 0
    buffer_load_dwordx4 v205, s[12:15], s40 offen lds
    s_add_u32 m0, s41, 12288
    s_nop 0
    buffer_load_dwordx4 v206, s[12:15], s40 offen lds
    s_add_u32 m0, s41, 13312
    s_nop 0
    buffer_load_dwordx4 v207, s[12:15], s40 offen lds
    s_add_u32 m0, s41, 14336
    s_nop 0
    buffer_load_dwordx4 v208, s[12:15], s40 offen lds
    s_add_u32 m0, s41, 15360
    s_nop 0
    buffer_load_dwordx4 v209, s[12:15], s40 offen lds
    s_add_u32 s40, s40, 128
    s_add_u32 s43, s43, 1
    s_cmp_eq_u32 s43, 2
    s_cselect_b32 s40, 0, s40
    s_cselect_b32 s42, s45, s42
    s_cmp_eq_u32 s40, s42
    s_cselect_b32 s33, 256, 0
    s_add_u32 s40, s40, s33
    s_add_u32 s41, s41, 34816
    s_cmp_ge_u32 s41, 139264
    s_cselect_b32 s41, s44, s41
    s_cmp_eq_u32 s35, 8
    s_cbranch_scc0 fz_f7
    v_mov_b32 v44, 0
    v_mov_b32 v45, s23
    s_mov_b64 exec, 1
    buffer_store_dword v45, v44, s[16:19], s38 offen sc1
    buffer_store_dword v45, v44, s[16:19], s39 offen sc1
    s_mov_b64 exec, -1
fz_f7:
    s_add_u32 s35, s35, 1
    s_cmp_lt_u32 s35, 29
    s_cbranch_scc1 fz_r7
    s_waitcnt vmcnt(16)
    s_barrier
    s_waitcnt vmcnt(8)
    s_barrier
    s_waitcnt vmcnt(0)
fz_h9:
    s_mul_i32 s33, s58, 911
    s_lshr_b32 s33, s33, 16
    s_lshl_b32 s33, s33, 8
    s_add_u32 s33, s33, 24576
    v_lshlrev_b32 v60, 2, v255
    v_add_u32 v60, s33, v60
    buffer_load_dword v64, v60, s[16:19], 0 offen sc1
    s_barrier
    s_barrier
    s_lshl_b32 s57, s56, 2
    s_add_u32 s57, s57, 163072
    s_mov_b32 s3, 0
    s_cmp_ge_u32 s2, 64
    s_cbranch_scc1 fz_k2
    s_mov_b32 s3, 1
fz_k2:
    s_setprio 3
    s_mul_i32 s59, s56, 21504
    s_add_u32 s59, s59, 64512
    s_add_u32 s24, s4, 30670848
    s_addc_u32 s25, s5, 0
    s_mov_b32 s26, 2359296
    s_mov_b32 s27, 0x20000
    s_mov_b32 s62, 0
parallel_sum__ssm_conv_s4__mixer_gmlp__prompt_kernel_ft50:
    s_waitcnt vmcnt(0)
    v_cmp_ne_u32 vcc, s23, v64
    s_cbranch_vccz parallel_sum__ssm_conv_s4__mixer_gmlp__prompt_kernel_ftd51
    s_add_u32 s62, s62, 1
    s_cmp_ge_u32 s62, 16384
    s_cbranch_scc1 parallel_sum__ssm_conv_s4__mixer_gmlp__prompt_kernel_ftd51
    buffer_load_dword v64, v60, s[16:19], 0 offen sc1
    s_branch parallel_sum__ssm_conv_s4__mixer_gmlp__prompt_kernel_ft50
parallel_sum__ssm_conv_s4__mixer_gmlp__prompt_kernel_ftd51:
    v_lshlrev_b32 v61, 4, v255
    s_lshl_b32 s30, s58, 12
    s_add_u32 m0, s59, 480
    s_nop 0
    buffer_load_dwordx4 v61, s[24:27], s30 offen offset:0 sc1 lds
    buffer_load_dwordx4 v61, s[24:27], s30 offen offset:1024 sc1 lds
    buffer_load_dwordx4 v61, s[24:27], s30 offen offset:2048 sc1 lds
    buffer_load_dwordx4 v61, s[24:27], s30 offen offset:3072 sc1 lds
    s_lshl_b32 s33, s56, 13
    s_add_u32 s33, s33, 134656
    s_sub_u32 s33, s59, s33
    v_add_u32 v150, s33, v150
    v_add_u32 v151, s33, v151
    v_add_u32 v152, s33, v152
    v_add_u32 v153, s33, v153
    v_add_u32 v154, s33, v154
    v_add_u32 v155, s33, v155
    v_add_u32 v156, s33, v156
    v_add_u32 v157, s33, v157
    v_add_u32 v158, s33, v158
    v_add_u32 v159, s33, v159
    v_add_u32 v160, s33, v160
    v_add_u32 v161, s33, v161
    v_add_u32 v162, s33, v162
    v_add_u32 v163, s33, v163
    v_add_u32 v164, s33, v164
    v_add_u32 v165, s33, v165
    v_add_u32 v140, s33, v140
    v_add_u32 v141, s33, v141
    v_add_u32 v142, s33, v142
    v_add_u32 v143, s33, v143
    v_add_u32 v182, s33, v182
    v_add_u32 v183, s33, v183
    v_add_u32 v184, s33, v184
    v_add_u32 v185, s33, v185
    v_add_u32 v186, s33, v186
    v_add_u32 v187, s33, v187
    v_add_u32 v188, s33, v188
    v_add_u32 v189, s33, v189
    v_add_u32 v190, s33, v190
    v_add_u32 v191, s33, v191
    s_mov_b32 s53, 1
    s_branch fz_kg
fz_kg2:
    v_mov_b32 v60, 0
    v_mov_b32 v61, 0
    v_mov_b32 v62, 0
    v_mov_b32 v63, 0
    v_lshlrev_b32 v127, 4, v255
    v_add_u32 v127, s59, v127
    s_mov_b32 exec_lo, 0x3fffffff
    s_mov_b32 exec_hi, 0x0
    ds_write_b128 v127, v[60:63]
    s_mov_b32 exec_lo, 0x3
    s_mov_b32 exec_hi, 0x0
    ds_write_b128 v127, v[60:63] offset:8768
    s_mov_b64 exec, 1
    ds_write_b32 v127, v168 offset:4608
    s_mov_b64 exec, -1
    v_lshlrev_b32 v124, 3, v167
    v_lshl_add_u32 v125, v166, 5, v124
    v_sub_u32 v122, 8248, v125
    v_add_u32 v122, s59, v122
    v_lshl_add_u32 v125, v166, 7, v124
    v_sub_u32 v123, 6616, v125
    v_add_u32 v123, s59, v123
    v_cvt_pk_bf16_f32 v128, v3, v2
    v_cvt_pk_bf16_f32 v129, v1, v0
    ds_write_b64 v122, v[128:129] offset:512
    v_cvt_pk_bf16_f32 v130, v7, v6
    v_cvt_pk_bf16_f32 v131, v5, v4
    ds_write_b64 v122, v[130:131] offset:0
    s_mov_b32 exec_lo, 0xff00ff
    s_mov_b32 exec_hi, 0xff00ff
    v_cvt_pk_bf16_f32 v132, v11, v10
    v_cvt_pk_bf16_f32 v133, v9, v8
    ds_write_b64 v123, v[132:133] offset:1120
    v_cvt_pk_bf16_f32 v134, v15, v14
    v_cvt_pk_bf16_f32 v135, v13, v12
    ds_write_b64 v123, v[134:135] offset:1088
    v_cvt_pk_bf16_f32 v128, v19, v18
    v_cvt_pk_bf16_f32 v129, v17, v16
    ds_write_b64 v123, v[128:129] offset:1056
    v_cvt_pk_bf16_f32 v130, v23, v22
    v_cvt_pk_bf16_f32 v131, v21, v20
    ds_write_b64 v123, v[130:131] offset:1024
    s_mov_b64 exec, -1
    v_cvt_pk_bf16_f32 v132, v27, v26
    v_cvt_pk_bf16_f32 v133, v25, v24
    ds_write_b64 v123, v[132:133] offset:96
    v_cvt_pk_bf16_f32 v134, v31, v30
    v_cvt_pk_bf16_f32 v135, v29, v28
    ds_write_b64 v123, v[134:135] offset:64
    v_cvt_pk_bf16_f32 v128, v35, v34
    v_cvt_pk_bf16_f32 v129, v33, v32
    ds_write_b64 v123, v[128:129] offset:32
    v_cvt_pk_bf16_f32 v130, v39, v38
    v_cvt_pk_bf16_f32 v131, v37, v36
    ds_write_b64 v123, v[130:131] offset:0
    ds_read_b128 v[64:67], v127 offset:4672
    ds_read_b64 v[68:69], v127 offset:4688
    ds_read_b128 v[70:73], v127 offset:5696
    ds_read_b64 v[74:75], v127 offset:5712
    ds_read_b128 v[76:79], v127 offset:6720
    ds_read_b64 v[80:81], v127 offset:6736
    ds_read_b128 v[82:85], v127 offset:7744
    ds_read_b64 v[86:87], v127 offset:7760
    s_mov_b32 exec_lo, 0x3
    s_mov_b32 exec_hi, 0x0
    ds_read_b128 v[88:91], v127 offset:8768
    ds_read_b64 v[92:93], v127 offset:8784
    s_mov_b64 exec, -1
    s_waitcnt lgkmcnt(0)
    v_alignbit_b32 v96, v65, v64, 16
    v_alignbit_b32 v97, v66, v65, 16
    v_alignbit_b32 v98, v67, v66, 16
    v_alignbit_b32 v99, v68, v67, 16
    v_mov_b32 v100, v65
    v_mov_b32 v101, v66
    v_mov_b32 v102, v67
    v_mov_b32 v103, v68
    v_mov_b32 v104, v97
    v_mov_b32 v105, v98
    v_mov_b32 v106, v99
    v_alignbit_b32 v107, v69, v68, 16
    ds_write_b128 v127, v[96:99] offset:8832
    ds_write_b128 v127, v[100:103] offset:12992
    ds_write_b128 v127, v[104:107] offset:17152
    v_alignbit_b32 v108, v71, v70, 16
    v_alignbit_b32 v109, v72, v71, 16
    v_alignbit_b32 v110, v73, v72, 16
    v_alignbit_b32 v111, v74, v73, 16
    v_mov_b32 v112, v71
    v_mov_b32 v113, v72
    v_mov_b32 v114, v73
    v_mov_b32 v115, v74
    v_mov_b32 v116, v109
    v_mov_b32 v117, v110
    v_mov_b32 v118, v111
    v_alignbit_b32 v119, v75, v74, 16
    ds_write_b128 v127, v[108:111] offset:9856
    ds_write_b128 v127, v[112:115] offset:14016
    ds_write_b128 v127, v[116:119] offset:18176
    v_alignbit_b32 v96, v77, v76, 16
    v_alignbit_b32 v97, v78, v77, 16
    v_alignbit_b32 v98, v79, v78, 16
    v_alignbit_b32 v99, v80, v79, 16
    v_mov_b32 v100, v77
    v_mov_b32 v101, v78
    v_mov_b32 v102, v79
    v_mov_b32 v103, v80
    v_mov_b32 v104, v97
    v_mov_b32 v105, v98
    v_mov_b32 v106, v99
    v_alignbit_b32 v107, v81, v80, 16
    ds_write_b128 v127, v[96:99] offset:10880
    ds_write_b128 v127, v[100:103] offset:15040
    ds_write_b128 v127, v[104:107] offset:19200
    v_alignbit_b32 v108, v83, v82, 16
    v_alignbit_b32 v109, v84, v83, 16
    v_alignbit_b32 v110, v85, v84, 16
    v_alignbit_b32 v111, v86, v85, 16
    v_mov_b32 v112, v83
    v_mov_b32 v113, v84
    v_mov_b32 v114, v85
    v_mov_b32 v115, v86
    v_mov_b32 v116, v109
    v_mov_b32 v117, v110
    v_mov_b32 v118, v111
    v_alignbit_b32 v119, v87, v86, 16
    ds_write_b128 v127, v[108:111] offset:11904
    ds_write_b128 v127, v[112:115] offset:16064
    ds_write_b128 v127, v[116:119] offset:20224
    s_mov_b32 exec_lo, 0x3
    s_mov_b32 exec_hi, 0x0
    v_alignbit_b32 v96, v89, v88, 16
    v_alignbit_b32 v97, v90, v89, 16
    v_alignbit_b32 v98, v91, v90, 16
    v_alignbit_b32 v99, v92, v91, 16
    v_mov_b32 v100, v89
    v_mov_b32 v101, v90
    v_mov_b32 v102, v91
    v_mov_b32 v103, v92
    v_mov_b32 v104, v97
    v_mov_b32 v105, v98
    v_mov_b32 v106, v99
    v_alignbit_b32 v107, v93, v92, 16
    ds_write_b128 v127, v[96:99] offset:12928
    ds_write_b128 v127, v[100:103] offset:17088
    ds_write_b128 v127, v[104:107] offset:21248
    s_mov_b64 exec, -1
    v_mov_b32 v60, s57
    v_mov_b32 v61, 1
    s_waitcnt vmcnt(0)
    ds_write_b32 v60, v61
    s_cmp_eq_u32 s3, 1
    s_cbranch_scc1 fz_full
    v_and_b32 v20, 15, v255
    v_lshrrev_b32 v21, 4, v255
    v_sub_u32 v22, 3, v20
    v_and_b32 v22, 3, v22
    v_mul_u32_u24 v22, 4160, v22
    v_lshrrev_b32 v23, 2, v20
    v_lshlrev_b32 v23, 3, v23
    v_sub_u32 v22, v22, v23
    v_lshl_add_u32 v22, v21, 4, v22
    v_add_u32 v22, 4696, v22
    v_add_u32 v140, s59, v22
    v_lshlrev_b32 v23, 5, v20
    v_lshl_add_u32 v141, v21, 4, v23
    v_add_u32 v141, s59, v141
    v_lshl_add_u32 v130, v21, 3, v23
    v_add_u32 v131, s59, v130
    v_mov_b32 v24, s59
    ds_read_b32 v132, v24 offset:4608
    v_mov_b32 v0, 0
    v_mov_b32 v1, 0
    v_mov_b32 v2, 0
    v_mov_b32 v3, 0
    v_mov_b32 v4, 0
    v_mov_b32 v5, 0
    v_mov_b32 v6, 0
    v_mov_b32 v7, 0
    v_mov_b32 v8, 0
    v_mov_b32 v9, 0
    v_mov_b32 v10, 0
    v_mov_b32 v11, 0
    v_mov_b32 v12, 0
    v_mov_b32 v13, 0
    v_mov_b32 v14, 0
    v_mov_b32 v15, 0
    ds_read_b128 v[64:67], v141 offset:448
    ds_read_b64 v[32:33], v140 offset:4032
    ds_read_b64 v[34:35], v140 offset:4040
    ds_read_b128 v[68:71], v141 offset:960
    ds_read_b64 v[36:37], v140 offset:3520
    ds_read_b64 v[38:39], v140 offset:3528
    ds_read_b128 v[72:75], v141 offset:1472
    ds_read_b64 v[40:41], v140 offset:3008
    ds_read_b64 v[42:43], v140 offset:3016
    ds_read_b128 v[76:79], v141 offset:1984
    ds_read_b64 v[44:45], v140 offset:2496
    ds_read_b64 v[46:47], v140 offset:2504
    ds_read_b128 v[80:83], v141 offset:2496
    ds_read_b64 v[48:49], v140 offset:1984
    ds_read_b64 v[50:51], v140 offset:1992
    ds_read_b128 v[84:87], v141 offset:3008
    ds_read_b64 v[52:53], v140 offset:1472
    ds_read_b64 v[54:55], v140 offset:1480
    ds_read_b128 v[88:91], v141 offset:3520
    ds_read_b64 v[56:57], v140 offset:960
    ds_read_b64 v[58:59], v140 offset:968
    ds_read_b128 v[92:95], v141 offset:4032
    ds_read_b64 v[60:61], v140 offset:448
    ds_read_b64 v[62:63], v140 offset:456
    s_mov_b32 s35, 0
fz_cv0:
    s_waitcnt lgkmcnt(0)
    v_mfma_f32_16x16x32_bf16 v[0:3], v[32:35], v[92:95], v[0:3]
    ds_read_b128 v[174:177], v141 offset:384
    ds_read_b64 v[142:143], v140 offset:3968
    v_mfma_f32_16x16x32_bf16 v[4:7], v[32:35], v[88:91], v[4:7]
    ds_read_b64 v[144:145], v140 offset:3976
    ds_read_b128 v[178:181], v141 offset:896
    v_mfma_f32_16x16x32_bf16 v[8:11], v[32:35], v[68:71], v[8:11]
    ds_read_b64 v[146:147], v140 offset:3456
    ds_read_b64 v[148:149], v140 offset:3464
    v_mfma_f32_16x16x32_bf16 v[12:15], v[32:35], v[64:67], v[12:15]
    ds_read_b128 v[182:185], v141 offset:1408
    ds_read_b64 v[150:151], v140 offset:2944
    v_mfma_f32_16x16x32_bf16 v[0:3], v[36:39], v[88:91], v[0:3]
    ds_read_b64 v[152:153], v140 offset:2952
    ds_read_b128 v[186:189], v141 offset:1920
    v_mfma_f32_16x16x32_bf16 v[4:7], v[36:39], v[84:87], v[4:7]
    ds_read_b64 v[154:155], v140 offset:2432
    ds_read_b64 v[156:157], v140 offset:2440
    v_mfma_f32_16x16x32_bf16 v[8:11], v[36:39], v[64:67], v[8:11]
    ds_read_b128 v[190:193], v141 offset:2432
    ds_read_b64 v[158:159], v140 offset:1920
    v_mfma_f32_16x16x32_bf16 v[0:3], v[40:43], v[84:87], v[0:3]
    ds_read_b64 v[160:161], v140 offset:1928
    ds_read_b128 v[194:197], v141 offset:2944
    v_mfma_f32_16x16x32_bf16 v[4:7], v[40:43], v[80:83], v[4:7]
    ds_read_b64 v[162:163], v140 offset:1408
    ds_read_b64 v[164:165], v140 offset:1416
    v_mfma_f32_16x16x32_bf16 v[0:3], v[44:47], v[80:83], v[0:3]
    ds_read_b128 v[198:201], v141 offset:3456
    ds_read_b64 v[166:167], v140 offset:896
    v_mfma_f32_16x16x32_bf16 v[4:7], v[44:47], v[76:79], v[4:7]
    ds_read_b64 v[168:169], v140 offset:904
    ds_read_b128 v[202:205], v141 offset:3968
    v_mfma_f32_16x16x32_bf16 v[0:3], v[48:51], v[76:79], v[0:3]
    ds_read_b64 v[170:171], v140 offset:384
    ds_read_b64 v[172:173], v140 offset:392
    v_mfma_f32_16x16x32_bf16 v[4:7], v[48:51], v[72:75], v[4:7]
    v_mfma_f32_16x16x32_bf16 v[0:3], v[52:55], v[72:75], v[0:3]
    v_mfma_f32_16x16x32_bf16 v[4:7], v[52:55], v[68:71], v[4:7]
    v_mfma_f32_16x16x32_bf16 v[0:3], v[56:59], v[68:71], v[0:3]
    v_mfma_f32_16x16x32_bf16 v[4:7], v[56:59], v[64:67], v[4:7]
    v_mfma_f32_16x16x32_bf16 v[0:3], v[60:63], v[64:67], v[0:3]
    v_subrev_u32 v140, 128, v140
    v_subrev_u32 v141, 128, v141
    s_waitcnt lgkmcnt(0)
    v_mfma_f32_16x16x32_bf16 v[0:3], v[142:145], v[202:205], v[0:3]
    ds_read_b128 v[64:67], v141 offset:448
    ds_read_b64 v[32:33], v140 offset:4032
    v_mfma_f32_16x16x32_bf16 v[4:7], v[142:145], v[198:201], v[4:7]
    ds_read_b64 v[34:35], v140 offset:4040
    ds_read_b128 v[68:71], v141 offset:960
    v_mfma_f32_16x16x32_bf16 v[8:11], v[142:145], v[178:181], v[8:11]
    ds_read_b64 v[36:37], v140 offset:3520
    ds_read_b64 v[38:39], v140 offset:3528
    v_mfma_f32_16x16x32_bf16 v[12:15], v[142:145], v[174:177], v[12:15]
    ds_read_b128 v[72:75], v141 offset:1472
    ds_read_b64 v[40:41], v140 offset:3008
    v_mfma_f32_16x16x32_bf16 v[0:3], v[146:149], v[198:201], v[0:3]
    ds_read_b64 v[42:43], v140 offset:3016
    ds_read_b128 v[76:79], v141 offset:1984
    v_mfma_f32_16x16x32_bf16 v[4:7], v[146:149], v[194:197], v[4:7]
    ds_read_b64 v[44:45], v140 offset:2496
    ds_read_b64 v[46:47], v140 offset:2504
    v_mfma_f32_16x16x32_bf16 v[8:11], v[146:149], v[174:177], v[8:11]
    ds_read_b128 v[80:83], v141 offset:2496
    ds_read_b64 v[48:49], v140 offset:1984
    v_mfma_f32_16x16x32_bf16 v[0:3], v[150:153], v[194:197], v[0:3]
    ds_read_b64 v[50:51], v140 offset:1992
    ds_read_b128 v[84:87], v141 offset:3008
    v_mfma_f32_16x16x32_bf16 v[4:7], v[150:153], v[190:193], v[4:7]
    ds_read_b64 v[52:53], v140 offset:1472
    ds_read_b64 v[54:55], v140 offset:1480
    v_mfma_f32_16x16x32_bf16 v[0:3], v[154:157], v[190:193], v[0:3]
    ds_read_b128 v[88:91], v141 offset:3520
    ds_read_b64 v[56:57], v140 offset:960
    v_mfma_f32_16x16x32_bf16 v[4:7], v[154:157], v[186:189], v[4:7]
    ds_read_b64 v[58:59], v140 offset:968
    ds_read_b128 v[92:95], v141 offset:4032
    v_mfma_f32_16x16x32_bf16 v[0:3], v[158:161], v[186:189], v[0:3]
    ds_read_b64 v[60:61], v140 offset:448
    ds_read_b64 v[62:63], v140 offset:456
    v_mfma_f32_16x16x32_bf16 v[4:7], v[158:161], v[182:185], v[4:7]
    v_mfma_f32_16x16x32_bf16 v[0:3], v[162:165], v[182:185], v[0:3]
    v_mfma_f32_16x16x32_bf16 v[4:7], v[162:165], v[178:181], v[4:7]
    v_mfma_f32_16x16x32_bf16 v[0:3], v[166:169], v[178:181], v[0:3]
    v_mfma_f32_16x16x32_bf16 v[4:7], v[166:169], v[174:177], v[4:7]
    v_mfma_f32_16x16x32_bf16 v[0:3], v[170:173], v[174:177], v[0:3]
    s_add_u32 s35, s35, 1
    s_cmp_lt_u32 s35, 4
    s_cbranch_scc1 fz_cv0
    s_add_u32 s44, s4, 33030144
    s_addc_u32 s45, s5, 0
    s_mov_b32 s46, 2359296
    s_mov_b32 s47, 0x20000
    s_lshl_b32 s30, s58, 12
    s_lshl_b32 s31, s58, 3
    s_add_u32 s31, s31, 28672
    s_waitcnt lgkmcnt(0)
    ds_read_b64 v[32:33], v131 offset:4064
    ds_read_b64 v[34:35], v131 offset:3552
    ds_read_b64 v[36:37], v131 offset:992
    ds_read_b64 v[38:39], v131 offset:480
    s_waitcnt lgkmcnt(0)
    v_lshlrev_b32 v100, 16, v32
    v_and_b32 v101, 0xffff0000, v32
    v_pk_fma_f32 v[100:101], v[100:101], v[132:133], v[0:1] op_sel_hi:[1,0,1]
    v_cvt_pk_bf16_f32 v64, v100, v101
    v_lshlrev_b32 v108, 16, v33
    v_and_b32 v109, 0xffff0000, v33
    v_pk_fma_f32 v[108:109], v[108:109], v[132:133], v[2:3] op_sel_hi:[1,0,1]
    v_cvt_pk_bf16_f32 v65, v108, v109
    buffer_store_dwordx2 v[64:65], v130, s[44:47], s30 offen offset:3584 sc1
    v_lshlrev_b32 v100, 16, v34
    v_and_b32 v101, 0xffff0000, v34
    v_pk_fma_f32 v[100:101], v[100:101], v[132:133], v[4:5] op_sel_hi:[1,0,1]
    v_cvt_pk_bf16_f32 v66, v100, v101
    v_lshlrev_b32 v108, 16, v35
    v_and_b32 v109, 0xffff0000, v35
    v_pk_fma_f32 v[108:109], v[108:109], v[132:133], v[6:7] op_sel_hi:[1,0,1]
    v_cvt_pk_bf16_f32 v67, v108, v109
    buffer_store_dwordx2 v[66:67], v130, s[44:47], s30 offen offset:3072 sc1
    v_lshlrev_b32 v100, 16, v36
    v_and_b32 v101, 0xffff0000, v36
    v_pk_fma_f32 v[100:101], v[100:101], v[132:133], v[8:9] op_sel_hi:[1,0,1]
    v_cvt_pk_bf16_f32 v68, v100, v101
    v_lshlrev_b32 v108, 16, v37
    v_and_b32 v109, 0xffff0000, v37
    v_pk_fma_f32 v[108:109], v[108:109], v[132:133], v[10:11] op_sel_hi:[1,0,1]
    v_cvt_pk_bf16_f32 v69, v108, v109
    buffer_store_dwordx2 v[68:69], v130, s[44:47], s30 offen offset:512 sc1
    v_lshlrev_b32 v100, 16, v38
    v_and_b32 v101, 0xffff0000, v38
    v_pk_fma_f32 v[100:101], v[100:101], v[132:133], v[12:13] op_sel_hi:[1,0,1]
    v_cvt_pk_bf16_f32 v70, v100, v101
    v_lshlrev_b32 v108, 16, v39
    v_and_b32 v109, 0xffff0000, v39
    v_pk_fma_f32 v[108:109], v[108:109], v[132:133], v[14:15] op_sel_hi:[1,0,1]
    v_cvt_pk_bf16_f32 v71, v108, v109
    buffer_store_dwordx2 v[70:71], v130, s[44:47], s30 offen offset:0 sc1
    s_mov_b32 s52, s31
    s_cmp_eq_u32 s3, 1
    s_cbranch_scc1 fz_runb
    v_mov_b32 v16, 0
    v_mov_b32 v17, s23
    s_waitcnt vmcnt(0)
    s_mov_b64 exec, 1
    buffer_store_dword v17, v16, s[16:19], s31 offen sc1
    s_mov_b64 exec, -1
    s_branch fz_fin
fz_full:
    v_and_b32 v20, 15, v255
    v_lshrrev_b32 v21, 4, v255
    v_sub_u32 v22, 3, v20
    v_and_b32 v22, 3, v22
    v_mul_u32_u24 v22, 4160, v22
    v_lshrrev_b32 v23, 2, v20
    v_lshlrev_b32 v23, 3, v23
    v_sub_u32 v22, v22, v23
    v_lshl_add_u32 v22, v21, 4, v22
    v_add_u32 v22, 4696, v22
    v_add_u32 v140, s59, v22
    v_lshlrev_b32 v23, 5, v20
    v_lshl_add_u32 v141, v21, 4, v23
    v_add_u32 v141, s59, v141
    v_lshl_add_u32 v130, v21, 3, v23
    v_add_u32 v131, s59, v130
    v_mov_b32 v24, s59
    ds_read_b32 v132, v24 offset:4608
    v_mov_b32 v0, 0
    v_mov_b32 v1, 0
    v_mov_b32 v2, 0
    v_mov_b32 v3, 0
    v_mov_b32 v4, 0
    v_mov_b32 v5, 0
    v_mov_b32 v6, 0
    v_mov_b32 v7, 0
    v_mov_b32 v8, 0
    v_mov_b32 v9, 0
    v_mov_b32 v10, 0
    v_mov_b32 v11, 0
    v_mov_b32 v12, 0
    v_mov_b32 v13, 0
    v_mov_b32 v14, 0
    v_mov_b32 v15, 0
    v_mov_b32 v16, 0
    v_mov_b32 v17, 0
    v_mov_b32 v18, 0
    v_mov_b32 v19, 0
    v_mov_b32 v20, 0
    v_mov_b32 v21, 0
    v_mov_b32 v22, 0
    v_mov_b32 v23, 0
    v_mov_b32 v24, 0
    v_mov_b32 v25, 0
    v_mov_b32 v26, 0
    v_mov_b32 v27, 0
    v_mov_b32 v28, 0
    v_mov_b32 v29, 0
    v_mov_b32 v30, 0
    v_mov_b32 v31, 0
    ds_read_b128 v[64:67], v141 offset:448
    ds_read_b64 v[32:33], v140 offset:4032
    ds_read_b64 v[34:35], v140 offset:4040
    ds_read_b128 v[68:71], v141 offset:960
    ds_read_b64 v[36:37], v140 offset:3520
    ds_read_b64 v[38:39], v140 offset:3528
    ds_read_b128 v[72:75], v141 offset:1472
    ds_read_b64 v[40:41], v140 offset:3008
    ds_read_b64 v[42:43], v140 offset:3016
    ds_read_b128 v[76:79], v141 offset:1984
    ds_read_b64 v[44:45], v140 offset:2496
    ds_read_b64 v[46:47], v140 offset:2504
    ds_read_b128 v[80:83], v141 offset:2496
    ds_read_b64 v[48:49], v140 offset:1984
    ds_read_b64 v[50:51], v140 offset:1992
    ds_read_b128 v[84:87], v141 offset:3008
    ds_read_b64 v[52:53], v140 offset:1472
    ds_read_b64 v[54:55], v140 offset:1480
    ds_read_b128 v[88:91], v141 offset:3520
    ds_read_b64 v[56:57], v140 offset:960
    ds_read_b64 v[58:59], v140 offset:968
    ds_read_b128 v[92:95], v141 offset:4032
    ds_read_b64 v[60:61], v140 offset:448
    ds_read_b64 v[62:63], v140 offset:456
    s_mov_b32 s35, 0
fz_cv2:
    s_waitcnt lgkmcnt(0)
    v_mfma_f32_16x16x32_bf16 v[0:3], v[32:35], v[64:67], v[0:3]
    ds_read_b128 v[174:177], v141 offset:384
    v_mfma_f32_16x16x32_bf16 v[4:7], v[32:35], v[68:71], v[4:7]
    ds_read_b64 v[142:143], v140 offset:3968
    v_mfma_f32_16x16x32_bf16 v[8:11], v[32:35], v[72:75], v[8:11]
    ds_read_b64 v[144:145], v140 offset:3976
    v_mfma_f32_16x16x32_bf16 v[12:15], v[32:35], v[76:79], v[12:15]
    ds_read_b128 v[178:181], v141 offset:896
    v_mfma_f32_16x16x32_bf16 v[16:19], v[32:35], v[80:83], v[16:19]
    ds_read_b64 v[146:147], v140 offset:3456
    v_mfma_f32_16x16x32_bf16 v[20:23], v[32:35], v[84:87], v[20:23]
    ds_read_b64 v[148:149], v140 offset:3464
    v_mfma_f32_16x16x32_bf16 v[24:27], v[32:35], v[88:91], v[24:27]
    ds_read_b128 v[182:185], v141 offset:1408
    v_mfma_f32_16x16x32_bf16 v[28:31], v[32:35], v[92:95], v[28:31]
    ds_read_b64 v[150:151], v140 offset:2944
    v_mfma_f32_16x16x32_bf16 v[4:7], v[36:39], v[64:67], v[4:7]
    ds_read_b64 v[152:153], v140 offset:2952
    v_mfma_f32_16x16x32_bf16 v[8:11], v[36:39], v[68:71], v[8:11]
    ds_read_b128 v[186:189], v141 offset:1920
    v_mfma_f32_16x16x32_bf16 v[12:15], v[36:39], v[72:75], v[12:15]
    ds_read_b64 v[154:155], v140 offset:2432
    v_mfma_f32_16x16x32_bf16 v[16:19], v[36:39], v[76:79], v[16:19]
    ds_read_b64 v[156:157], v140 offset:2440
    v_mfma_f32_16x16x32_bf16 v[20:23], v[36:39], v[80:83], v[20:23]
    ds_read_b128 v[190:193], v141 offset:2432
    v_mfma_f32_16x16x32_bf16 v[24:27], v[36:39], v[84:87], v[24:27]
    ds_read_b64 v[158:159], v140 offset:1920
    v_mfma_f32_16x16x32_bf16 v[28:31], v[36:39], v[88:91], v[28:31]
    ds_read_b64 v[160:161], v140 offset:1928
    v_mfma_f32_16x16x32_bf16 v[8:11], v[40:43], v[64:67], v[8:11]
    ds_read_b128 v[194:197], v141 offset:2944
    v_mfma_f32_16x16x32_bf16 v[12:15], v[40:43], v[68:71], v[12:15]
    ds_read_b64 v[162:163], v140 offset:1408
    v_mfma_f32_16x16x32_bf16 v[16:19], v[40:43], v[72:75], v[16:19]
    ds_read_b64 v[164:165], v140 offset:1416
    v_mfma_f32_16x16x32_bf16 v[20:23], v[40:43], v[76:79], v[20:23]
    ds_read_b128 v[198:201], v141 offset:3456
    v_mfma_f32_16x16x32_bf16 v[24:27], v[40:43], v[80:83], v[24:27]
    ds_read_b64 v[166:167], v140 offset:896
    v_mfma_f32_16x16x32_bf16 v[28:31], v[40:43], v[84:87], v[28:31]
    ds_read_b64 v[168:169], v140 offset:904
    v_mfma_f32_16x16x32_bf16 v[12:15], v[44:47], v[64:67], v[12:15]
    ds_read_b128 v[202:205], v141 offset:3968
    v_mfma_f32_16x16x32_bf16 v[16:19], v[44:47], v[68:71], v[16:19]
    ds_read_b64 v[170:171], v140 offset:384
    v_mfma_f32_16x16x32_bf16 v[20:23], v[44:47], v[72:75], v[20:23]
    ds_read_b64 v[172:173], v140 offset:392
    v_mfma_f32_16x16x32_bf16 v[24:27], v[44:47], v[76:79], v[24:27]
    v_mfma_f32_16x16x32_bf16 v[28:31], v[44:47], v[80:83], v[28:31]
    v_mfma_f32_16x16x32_bf16 v[16:19], v[48:51], v[64:67], v[16:19]
    v_mfma_f32_16x16x32_bf16 v[20:23], v[48:51], v[68:71], v[20:23]
    v_mfma_f32_16x16x32_bf16 v[24:27], v[48:51], v[72:75], v[24:27]
    v_mfma_f32_16x16x32_bf16 v[28:31], v[48:51], v[76:79], v[28:31]
    v_mfma_f32_16x16x32_bf16 v[20:23], v[52:55], v[64:67], v[20:23]
    v_mfma_f32_16x16x32_bf16 v[24:27], v[52:55], v[68:71], v[24:27]
    v_mfma_f32_16x16x32_bf16 v[28:31], v[52:55], v[72:75], v[28:31]
    v_mfma_f32_16x16x32_bf16 v[24:27], v[56:59], v[64:67], v[24:27]
    v_mfma_f32_16x16x32_bf16 v[28:31], v[56:59], v[68:71], v[28:31]
    v_mfma_f32_16x16x32_bf16 v[28:31], v[60:63], v[64:67], v[28:31]
    v_subrev_u32 v140, 128, v140
    v_subrev_u32 v141, 128, v141
    s_waitcnt lgkmcnt(0)
    v_mfma_f32_16x16x32_bf16 v[0:3], v[142:145], v[174:177], v[0:3]
    ds_read_b128 v[64:67], v141 offset:448
    v_mfma_f32_16x16x32_bf16 v[4:7], v[142:145], v[178:181], v[4:7]
    ds_read_b64 v[32:33], v140 offset:4032
    v_mfma_f32_16x16x32_bf16 v[8:11], v[142:145], v[182:185], v[8:11]
    ds_read_b64 v[34:35], v140 offset:4040
    v_mfma_f32_16x16x32_bf16 v[12:15], v[142:145], v[186:189], v[12:15]
    ds_read_b128 v[68:71], v141 offset:960
    v_mfma_f32_16x16x32_bf16 v[16:19], v[142:145], v[190:193], v[16:19]
    ds_read_b64 v[36:37], v140 offset:3520
    v_mfma_f32_16x16x32_bf16 v[20:23], v[142:145], v[194:197], v[20:23]
    ds_read_b64 v[38:39], v140 offset:3528
    v_mfma_f32_16x16x32_bf16 v[24:27], v[142:145], v[198:201], v[24:27]
    ds_read_b128 v[72:75], v141 offset:1472
    v_mfma_f32_16x16x32_bf16 v[28:31], v[142:145], v[202:205], v[28:31]
    ds_read_b64 v[40:41], v140 offset:3008
    v_mfma_f32_16x16x32_bf16 v[4:7], v[146:149], v[174:177], v[4:7]
    ds_read_b64 v[42:43], v140 offset:3016
    v_mfma_f32_16x16x32_bf16 v[8:11], v[146:149], v[178:181], v[8:11]
    ds_read_b128 v[76:79], v141 offset:1984
    v_mfma_f32_16x16x32_bf16 v[12:15], v[146:149], v[182:185], v[12:15]
    ds_read_b64 v[44:45], v140 offset:2496
    v_mfma_f32_16x16x32_bf16 v[16:19], v[146:149], v[186:189], v[16:19]
    ds_read_b64 v[46:47], v140 offset:2504
    v_mfma_f32_16x16x32_bf16 v[20:23], v[146:149], v[190:193], v[20:23]
    ds_read_b128 v[80:83], v141 offset:2496
    v_mfma_f32_16x16x32_bf16 v[24:27], v[146:149], v[194:197], v[24:27]
    ds_read_b64 v[48:49], v140 offset:1984
    v_mfma_f32_16x16x32_bf16 v[28:31], v[146:149], v[198:201], v[28:31]
    ds_read_b64 v[50:51], v140 offset:1992
    v_mfma_f32_16x16x32_bf16 v[8:11], v[150:153], v[174:177], v[8:11]
    ds_read_b128 v[84:87], v141 offset:3008
    v_mfma_f32_16x16x32_bf16 v[12:15], v[150:153], v[178:181], v[12:15]
    ds_read_b64 v[52:53], v140 offset:1472
    v_mfma_f32_16x16x32_bf16 v[16:19], v[150:153], v[182:185], v[16:19]
    ds_read_b64 v[54:55], v140 offset:1480
    v_mfma_f32_16x16x32_bf16 v[20:23], v[150:153], v[186:189], v[20:23]
    ds_read_b128 v[88:91], v141 offset:3520
    v_mfma_f32_16x16x32_bf16 v[24:27], v[150:153], v[190:193], v[24:27]
    ds_read_b64 v[56:57], v140 offset:960
    v_mfma_f32_16x16x32_bf16 v[28:31], v[150:153], v[194:197], v[28:31]
    ds_read_b64 v[58:59], v140 offset:968
    v_mfma_f32_16x16x32_bf16 v[12:15], v[154:157], v[174:177], v[12:15]
    ds_read_b128 v[92:95], v141 offset:4032
    v_mfma_f32_16x16x32_bf16 v[16:19], v[154:157], v[178:181], v[16:19]
    ds_read_b64 v[60:61], v140 offset:448
    v_mfma_f32_16x16x32_bf16 v[20:23], v[154:157], v[182:185], v[20:23]
    ds_read_b64 v[62:63], v140 offset:456
    v_mfma_f32_16x16x32_bf16 v[24:27], v[154:157], v[186:189], v[24:27]
    v_mfma_f32_16x16x32_bf16 v[28:31], v[154:157], v[190:193], v[28:31]
    v_mfma_f32_16x16x32_bf16 v[16:19], v[158:161], v[174:177], v[16:19]
    v_mfma_f32_16x16x32_bf16 v[20:23], v[158:161], v[178:181], v[20:23]
    v_mfma_f32_16x16x32_bf16 v[24:27], v[158:161], v[182:185], v[24:27]
    v_mfma_f32_16x16x32_bf16 v[28:31], v[158:161], v[186:189], v[28:31]
    v_mfma_f32_16x16x32_bf16 v[20:23], v[162:165], v[174:177], v[20:23]
    v_mfma_f32_16x16x32_bf16 v[24:27], v[162:165], v[178:181], v[24:27]
    v_mfma_f32_16x16x32_bf16 v[28:31], v[162:165], v[182:185], v[28:31]
    v_mfma_f32_16x16x32_bf16 v[24:27], v[166:169], v[174:177], v[24:27]
    v_mfma_f32_16x16x32_bf16 v[28:31], v[166:169], v[178:181], v[28:31]
    v_mfma_f32_16x16x32_bf16 v[28:31], v[170:173], v[174:177], v[28:31]
    s_add_u32 s35, s35, 1
    s_cmp_lt_u32 s35, 4
    s_cbranch_scc1 fz_cv2
    s_add_u32 s44, s4, 33030144
    s_addc_u32 s45, s5, 0
    s_mov_b32 s46, 2359296
    s_mov_b32 s47, 0x20000
    s_lshl_b32 s30, s58, 12
    s_lshl_b32 s31, s58, 3
    s_add_u32 s31, s31, 28672
    s_waitcnt lgkmcnt(0)
    ds_read_b64 v[32:33], v131 offset:480
    ds_read_b64 v[34:35], v131 offset:992
    ds_read_b64 v[36:37], v131 offset:1504
    ds_read_b64 v[38:39], v131 offset:2016
    ds_read_b64 v[40:41], v131 offset:2528
    ds_read_b64 v[42:43], v131 offset:3040
    ds_read_b64 v[44:45], v131 offset:3552
    ds_read_b64 v[46:47], v131 offset:4064
    s_waitcnt lgkmcnt(0)
    v_lshlrev_b32 v100, 16, v32
    v_and_b32 v101, 0xffff0000, v32
    v_pk_fma_f32 v[100:101], v[100:101], v[132:133], v[0:1] op_sel_hi:[1,0,1]
    v_cvt_pk_bf16_f32 v64, v100, v101
    v_lshlrev_b32 v108, 16, v33
    v_and_b32 v109, 0xffff0000, v33
    v_pk_fma_f32 v[108:109], v[108:109], v[132:133], v[2:3] op_sel_hi:[1,0,1]
    v_cvt_pk_bf16_f32 v65, v108, v109
    buffer_store_dwordx2 v[64:65], v130, s[44:47], s30 offen offset:0 sc1
    v_lshlrev_b32 v100, 16, v34
    v_and_b32 v101, 0xffff0000, v34
    v_pk_fma_f32 v[100:101], v[100:101], v[132:133], v[4:5] op_sel_hi:[1,0,1]
    v_cvt_pk_bf16_f32 v66, v100, v101
    v_lshlrev_b32 v108, 16, v35
    v_and_b32 v109, 0xffff0000, v35
    v_pk_fma_f32 v[108:109], v[108:109], v[132:133], v[6:7] op_sel_hi:[1,0,1]
    v_cvt_pk_bf16_f32 v67, v108, v109
    buffer_store_dwordx2 v[66:67], v130, s[44:47], s30 offen offset:512 sc1
    v_lshlrev_b32 v100, 16, v36
    v_and_b32 v101, 0xffff0000, v36
    v_pk_fma_f32 v[100:101], v[100:101], v[132:133], v[8:9] op_sel_hi:[1,0,1]
    v_cvt_pk_bf16_f32 v68, v100, v101
    v_lshlrev_b32 v108, 16, v37
    v_and_b32 v109, 0xffff0000, v37
    v_pk_fma_f32 v[108:109], v[108:109], v[132:133], v[10:11] op_sel_hi:[1,0,1]
    v_cvt_pk_bf16_f32 v69, v108, v109
    buffer_store_dwordx2 v[68:69], v130, s[44:47], s30 offen offset:1024 sc1
    v_lshlrev_b32 v100, 16, v38
    v_and_b32 v101, 0xffff0000, v38
    v_pk_fma_f32 v[100:101], v[100:101], v[132:133], v[12:13] op_sel_hi:[1,0,1]
    v_cvt_pk_bf16_f32 v70, v100, v101
    v_lshlrev_b32 v108, 16, v39
    v_and_b32 v109, 0xffff0000, v39
    v_pk_fma_f32 v[108:109], v[108:109], v[132:133], v[14:15] op_sel_hi:[1,0,1]
    v_cvt_pk_bf16_f32 v71, v108, v109
    buffer_store_dwordx2 v[70:71], v130, s[44:47], s30 offen offset:1536 sc1
    v_lshlrev_b32 v100, 16, v40
    v_and_b32 v101, 0xffff0000, v40
    v_pk_fma_f32 v[100:101], v[100:101], v[132:133], v[16:17] op_sel_hi:[1,0,1]
    v_cvt_pk_bf16_f32 v72, v100, v101
    v_lshlrev_b32 v108, 16, v41
    v_and_b32 v109, 0xffff0000, v41
    v_pk_fma_f32 v[108:109], v[108:109], v[132:133], v[18:19] op_sel_hi:[1,0,1]
    v_cvt_pk_bf16_f32 v73, v108, v109
    buffer_store_dwordx2 v[72:73], v130, s[44:47], s30 offen offset:2048 sc1
    v_lshlrev_b32 v100, 16, v42
    v_and_b32 v101, 0xffff0000, v42
    v_pk_fma_f32 v[100:101], v[100:101], v[132:133], v[20:21] op_sel_hi:[1,0,1]
    v_cvt_pk_bf16_f32 v74, v100, v101
    v_lshlrev_b32 v108, 16, v43
    v_and_b32 v109, 0xffff0000, v43
    v_pk_fma_f32 v[108:109], v[108:109], v[132:133], v[22:23] op_sel_hi:[1,0,1]
    v_cvt_pk_bf16_f32 v75, v108, v109
    buffer_store_dwordx2 v[74:75], v130, s[44:47], s30 offen offset:2560 sc1
    v_lshlrev_b32 v100, 16, v44
    v_and_b32 v101, 0xffff0000, v44
    v_pk_fma_f32 v[100:101], v[100:101], v[132:133], v[24:25] op_sel_hi:[1,0,1]
    v_cvt_pk_bf16_f32 v76, v100, v101
    v_lshlrev_b32 v108, 16, v45
    v_and_b32 v109, 0xffff0000, v45
    v_pk_fma_f32 v[108:109], v[108:109], v[132:133], v[26:27] op_sel_hi:[1,0,1]
    v_cvt_pk_bf16_f32 v77, v108, v109
    buffer_store_dwordx2 v[76:77], v130, s[44:47], s30 offen offset:3072 sc1
    v_lshlrev_b32 v100, 16, v46
    v_and_b32 v101, 0xffff0000, v46
    v_pk_fma_f32 v[100:101], v[100:101], v[132:133], v[28:29] op_sel_hi:[1,0,1]
    v_cvt_pk_bf16_f32 v78, v100, v101
    v_lshlrev_b32 v108, 16, v47
    v_and_b32 v109, 0xffff0000, v47
    v_pk_fma_f32 v[108:109], v[108:109], v[132:133], v[30:31] op_sel_hi:[1,0,1]
    v_cvt_pk_bf16_f32 v79, v108, v109
    buffer_store_dwordx2 v[78:79], v130, s[44:47], s30 offen offset:3584 sc1
    v_mov_b32 v34, 0
    v_mov_b32 v36, s23
    v_mov_b32 v37, s23
    s_waitcnt vmcnt(0)
    s_mov_b64 exec, 1
    buffer_store_dwordx2 v[36:37], v34, s[16:19], s31 offen sc1
    s_branch fz_fin
fz_p34:
    s_cmp_lt_u32 s58, 576
    s_cbranch_scc1 fz_own3
    s_lshl_b32 s58, s2, 1
    s_add_u32 s58, s58, 1
    s_mov_b32 s59, 86016
    s_mov_b32 s57, 163076
fz_help:
    s_mov_b32 s3, 0
    s_setprio 3
    v_mov_b32 v20, s57
    s_mov_b32 s62, 0
fz_hw:
    ds_read_b32 v21, v20
    s_add_u32 s62, s62, 1
    s_waitcnt lgkmcnt(0)
    v_readfirstlane_b32 s33, v21
    s_nop 0
    s_cmp_eq_u32 s33, 1
    s_cbranch_scc1 fz_runb
    s_cmp_lt_u32 s62, 262144
    s_cbranch_scc1 fz_hw
fz_runb:
    v_and_b32 v20, 15, v255
    v_lshrrev_b32 v21, 4, v255
    v_sub_u32 v22, 3, v20
    v_and_b32 v22, 3, v22
    v_mul_u32_u24 v22, 4160, v22
    v_lshrrev_b32 v23, 2, v20
    v_lshlrev_b32 v23, 3, v23
    v_sub_u32 v22, v22, v23
    v_lshl_add_u32 v22, v21, 4, v22
    v_add_u32 v22, 4696, v22
    v_add_u32 v140, s59, v22
    v_lshlrev_b32 v23, 5, v20
    v_lshl_add_u32 v141, v21, 4, v23
    v_add_u32 v141, s59, v141
    v_lshl_add_u32 v130, v21, 3, v23
    v_add_u32 v131, s59, v130
    v_mov_b32 v24, s59
    ds_read_b32 v132, v24 offset:4608
    v_mov_b32 v0, 0
    v_mov_b32 v1, 0
    v_mov_b32 v2, 0
    v_mov_b32 v3, 0
    v_mov_b32 v4, 0
    v_mov_b32 v5, 0
    v_mov_b32 v6, 0
    v_mov_b32 v7, 0
    v_mov_b32 v8, 0
    v_mov_b32 v9, 0
    v_mov_b32 v10, 0
    v_mov_b32 v11, 0
    v_mov_b32 v12, 0
    v_mov_b32 v13, 0
    v_mov_b32 v14, 0
    v_mov_b32 v15, 0
    ds_read_b128 v[64:67], v141 offset:448
    ds_read_b64 v[32:33], v140 offset:4032
    ds_read_b64 v[34:35], v140 offset:4040
    ds_read_b128 v[68:71], v141 offset:960
    ds_read_b64 v[36:37], v140 offset:3520
    ds_read_b64 v[38:39], v140 offset:3528
    ds_read_b128 v[72:75], v141 offset:1472
    ds_read_b64 v[40:41], v140 offset:3008
    ds_read_b64 v[42:43], v140 offset:3016
    ds_read_b128 v[76:79], v141 offset:1984
    ds_read_b64 v[44:45], v140 offset:2496
    ds_read_b64 v[46:47], v140 offset:2504
    ds_read_b128 v[80:83], v141 offset:2496
    ds_read_b64 v[48:49], v140 offset:1984
    ds_read_b64 v[50:51], v140 offset:1992
    ds_read_b128 v[84:87], v141 offset:3008
    ds_read_b64 v[52:53], v140 offset:1472
    ds_read_b64 v[54:55], v140 offset:1480
    s_mov_b32 s35, 0
fz_cv1:
    s_waitcnt lgkmcnt(0)
    v_mfma_f32_16x16x32_bf16 v[0:3], v[32:35], v[84:87], v[0:3]
    ds_read_b128 v[174:177], v141 offset:384
    ds_read_b64 v[142:143], v140 offset:3968
    v_mfma_f32_16x16x32_bf16 v[4:7], v[32:35], v[80:83], v[4:7]
    ds_read_b64 v[144:145], v140 offset:3976
    ds_read_b128 v[178:181], v141 offset:896
    v_mfma_f32_16x16x32_bf16 v[8:11], v[32:35], v[76:79], v[8:11]
    ds_read_b64 v[146:147], v140 offset:3456
    ds_read_b64 v[148:149], v140 offset:3464
    v_mfma_f32_16x16x32_bf16 v[12:15], v[32:35], v[72:75], v[12:15]
    ds_read_b128 v[182:185], v141 offset:1408
    ds_read_b64 v[150:151], v140 offset:2944
    v_mfma_f32_16x16x32_bf16 v[0:3], v[36:39], v[80:83], v[0:3]
    ds_read_b64 v[152:153], v140 offset:2952
    ds_read_b128 v[186:189], v141 offset:1920
    v_mfma_f32_16x16x32_bf16 v[4:7], v[36:39], v[76:79], v[4:7]
    ds_read_b64 v[154:155], v140 offset:2432
    ds_read_b64 v[156:157], v140 offset:2440
    v_mfma_f32_16x16x32_bf16 v[8:11], v[36:39], v[72:75], v[8:11]
    ds_read_b128 v[190:193], v141 offset:2432
    ds_read_b64 v[158:159], v140 offset:1920
    v_mfma_f32_16x16x32_bf16 v[12:15], v[36:39], v[68:71], v[12:15]
    ds_read_b64 v[160:161], v140 offset:1928
    ds_read_b128 v[194:197], v141 offset:2944
    v_mfma_f32_16x16x32_bf16 v[0:3], v[40:43], v[76:79], v[0:3]
    ds_read_b64 v[162:163], v140 offset:1408
    ds_read_b64 v[164:165], v140 offset:1416
    v_mfma_f32_16x16x32_bf16 v[4:7], v[40:43], v[72:75], v[4:7]
    v_mfma_f32_16x16x32_bf16 v[8:11], v[40:43], v[68:71], v[8:11]
    v_mfma_f32_16x16x32_bf16 v[12:15], v[40:43], v[64:67], v[12:15]
    v_mfma_f32_16x16x32_bf16 v[0:3], v[44:47], v[72:75], v[0:3]
    v_mfma_f32_16x16x32_bf16 v[4:7], v[44:47], v[68:71], v[4:7]
    v_mfma_f32_16x16x32_bf16 v[8:11], v[44:47], v[64:67], v[8:11]
    v_mfma_f32_16x16x32_bf16 v[0:3], v[48:51], v[68:71], v[0:3]
    v_mfma_f32_16x16x32_bf16 v[4:7], v[48:51], v[64:67], v[4:7]
    v_mfma_f32_16x16x32_bf16 v[0:3], v[52:55], v[64:67], v[0:3]
    v_subrev_u32 v140, 128, v140
    v_subrev_u32 v141, 128, v141
    s_waitcnt lgkmcnt(0)
    v_mfma_f32_16x16x32_bf16 v[0:3], v[142:145], v[194:197], v[0:3]
    ds_read_b128 v[64:67], v141 offset:448
    ds_read_b64 v[32:33], v140 offset:4032
    v_mfma_f32_16x16x32_bf16 v[4:7], v[142:145], v[190:193], v[4:7]
    ds_read_b64 v[34:35], v140 offset:4040
    ds_read_b128 v[68:71], v141 offset:960
    v_mfma_f32_16x16x32_bf16 v[8:11], v[142:145], v[186:189], v[8:11]
    ds_read_b64 v[36:37], v140 offset:3520
    ds_read_b64 v[38:39], v140 offset:3528
    v_mfma_f32_16x16x32_bf16 v[12:15], v[142:145], v[182:185], v[12:15]
    ds_read_b128 v[72:75], v141 offset:1472
    ds_read_b64 v[40:41], v140 offset:3008
    v_mfma_f32_16x16x32_bf16 v[0:3], v[146:149], v[190:193], v[0:3]
    ds_read_b64 v[42:43], v140 offset:3016
    ds_read_b128 v[76:79], v141 offset:1984
    v_mfma_f32_16x16x32_bf16 v[4:7], v[146:149], v[186:189], v[4:7]
    ds_read_b64 v[44:45], v140 offset:2496
    ds_read_b64 v[46:47], v140 offset:2504
    v_mfma_f32_16x16x32_bf16 v[8:11], v[146:149], v[182:185], v[8:11]
    ds_read_b128 v[80:83], v141 offset:2496
    ds_read_b64 v[48:49], v140 offset:1984
    v_mfma_f32_16x16x32_bf16 v[12:15], v[146:149], v[178:181], v[12:15]
    ds_read_b64 v[50:51], v140 offset:1992
    ds_read_b128 v[84:87], v141 offset:3008
    v_mfma_f32_16x16x32_bf16 v[0:3], v[150:153], v[186:189], v[0:3]
    ds_read_b64 v[52:53], v140 offset:1472
    ds_read_b64 v[54:55], v140 offset:1480
    v_mfma_f32_16x16x32_bf16 v[4:7], v[150:153], v[182:185], v[4:7]
    v_mfma_f32_16x16x32_bf16 v[8:11], v[150:153], v[178:181], v[8:11]
    v_mfma_f32_16x16x32_bf16 v[12:15], v[150:153], v[174:177], v[12:15]
    v_mfma_f32_16x16x32_bf16 v[0:3], v[154:157], v[182:185], v[0:3]
    v_mfma_f32_16x16x32_bf16 v[4:7], v[154:157], v[178:181], v[4:7]
    v_mfma_f32_16x16x32_bf16 v[8:11], v[154:157], v[174:177], v[8:11]
    v_mfma_f32_16x16x32_bf16 v[0:3], v[158:161], v[178:181], v[0:3]
    v_mfma_f32_16x16x32_bf16 v[4:7], v[158:161], v[174:177], v[4:7]
    v_mfma_f32_16x16x32_bf16 v[0:3], v[162:165], v[174:177], v[0:3]
    s_add_u32 s35, s35, 1
    s_cmp_lt_u32 s35, 4
    s_cbranch_scc1 fz_cv1
    s_add_u32 s44, s4, 33030144
    s_addc_u32 s45, s5, 0
    s_mov_b32 s46, 2359296
    s_mov_b32 s47, 0x20000
    s_lshl_b32 s30, s58, 12
    s_lshl_b32 s31, s58, 3
    s_add_u32 s31, s31, 28676
    s_waitcnt lgkmcnt(0)
    ds_read_b64 v[32:33], v131 offset:3040
    ds_read_b64 v[34:35], v131 offset:2528
    ds_read_b64 v[36:37], v131 offset:2016
    ds_read_b64 v[38:39], v131 offset:1504
    s_waitcnt lgkmcnt(0)
    v_lshlrev_b32 v100, 16, v32
    v_and_b32 v101, 0xffff0000, v32
    v_pk_fma_f32 v[100:101], v[100:101], v[132:133], v[0:1] op_sel_hi:[1,0,1]
    v_cvt_pk_bf16_f32 v64, v100, v101
    v_lshlrev_b32 v108, 16, v33
    v_and_b32 v109, 0xffff0000, v33
    v_pk_fma_f32 v[108:109], v[108:109], v[132:133], v[2:3] op_sel_hi:[1,0,1]
    v_cvt_pk_bf16_f32 v65, v108, v109
    buffer_store_dwordx2 v[64:65], v130, s[44:47], s30 offen offset:2560 sc1
    v_lshlrev_b32 v100, 16, v34
    v_and_b32 v101, 0xffff0000, v34
    v_pk_fma_f32 v[100:101], v[100:101], v[132:133], v[4:5] op_sel_hi:[1,0,1]
    v_cvt_pk_bf16_f32 v66, v100, v101
    v_lshlrev_b32 v108, 16, v35
    v_and_b32 v109, 0xffff0000, v35
    v_pk_fma_f32 v[108:109], v[108:109], v[132:133], v[6:7] op_sel_hi:[1,0,1]
    v_cvt_pk_bf16_f32 v67, v108, v109
    buffer_store_dwordx2 v[66:67], v130, s[44:47], s30 offen offset:2048 sc1
    v_lshlrev_b32 v100, 16, v36
    v_and_b32 v101, 0xffff0000, v36
    v_pk_fma_f32 v[100:101], v[100:101], v[132:133], v[8:9] op_sel_hi:[1,0,1]
    v_cvt_pk_bf16_f32 v68, v100, v101
    v_lshlrev_b32 v108, 16, v37
    v_and_b32 v109, 0xffff0000, v37
    v_pk_fma_f32 v[108:109], v[108:109], v[132:133], v[10:11] op_sel_hi:[1,0,1]
    v_cvt_pk_bf16_f32 v69, v108, v109
    buffer_store_dwordx2 v[68:69], v130, s[44:47], s30 offen offset:1536 sc1
    v_lshlrev_b32 v100, 16, v38
    v_and_b32 v101, 0xffff0000, v38
    v_pk_fma_f32 v[100:101], v[100:101], v[132:133], v[12:13] op_sel_hi:[1,0,1]
    v_cvt_pk_bf16_f32 v70, v100, v101
    v_lshlrev_b32 v108, 16, v39
    v_and_b32 v109, 0xffff0000, v39
    v_pk_fma_f32 v[108:109], v[108:109], v[132:133], v[14:15] op_sel_hi:[1,0,1]
    v_cvt_pk_bf16_f32 v71, v108, v109
    buffer_store_dwordx2 v[70:71], v130, s[44:47], s30 offen offset:1024 sc1
    v_mov_b32 v16, 0
    v_mov_b32 v17, s23
    s_waitcnt vmcnt(0)
    s_mov_b64 exec, 1
    buffer_store_dword v17, v16, s[16:19], s31 offen sc1
    s_mov_b64 exec, -1
    s_cmp_eq_u32 s3, 1
    s_cbranch_scc0 fz_fin
    s_mov_b64 exec, 1
    buffer_store_dword v17, v16, s[16:19], s52 offen sc1
    s_branch fz_fin
fz_own3:
    s_mov_b32 s57, 163080
    s_mov_b32 s3, 0
    s_branch fz_k2
fz_fin:
fz_end:
    s_endpgm
.section .rodata,"a"
.p2align 6
.amdhsa_kernel parallel_sum__ssm_conv_s4__mixer_gmlp__prompt_kernel
  .amdhsa_next_free_vgpr 256
  .amdhsa_next_free_sgpr 102
  .amdhsa_accum_offset 256
  .amdhsa_group_segment_fixed_size 0
  .amdhsa_kernarg_size 136
  .amdhsa_user_sgpr_count 2
  .amdhsa_user_sgpr_kernarg_segment_ptr 1
  .amdhsa_system_sgpr_workgroup_id_x 1
.end_amdhsa_kernel
```
